```python
import torch

def _softmax(x, axis=-1):
    return torch.softmax(x, dim=axis)

def _gelu(x):
    return torch.nn.functional.gelu(x, approximate='tanh')

def _silu(x):
    return torch.nn.functional.silu(x)

def _sigmoid(x):
    return torch.sigmoid(x)

def _layernorm(x, axis=-1, eps=1e-05):
    m = x.mean(dim=axis, keepdim=True)
    v = x.var(dim=axis, keepdim=True, unbiased=False)
    return (x - m) / torch.sqrt(v + eps)

def _scatter_add(tgt, idx, src, axis=0):
    return tgt.clone().index_add_(axis, idx, src)

def _segment_sum(src, seg, n):
    out = torch.zeros((n,) + src.shape[1:], dtype=src.dtype)
    return out.index_add_(0, seg, src)

def _pad(x, pw):
    flat = tuple((v for pair in reversed(pw) for v in pair))
    return torch.nn.functional.pad(x, flat)
kernel_name = 'adaLN_cond__sliding_block_cached__dense_activation_silu__prompt'

def setup_inputs():

    _w = lambda a: (lambda t: t.to(torch.bfloat16) if t.is_floating_point() else t)(torch.as_tensor(a))

    def _A_setup():
        B, Sq, D = (1, 2048, 512)
        Hq, Hkv, Sk, Dh = (32, 8, 2048, 128)
        assert Hq % Hkv == 0, (Hq, Hkv)
        return {'x': _w((lambda *s: torch.randn(*s, dtype=torch.bfloat16) * 0.05)(B, Sq, D)), 'k_cache': _w((lambda *s: torch.randn(*s, dtype=torch.bfloat16) * 1.6)(B, Hkv, Sk, Dh)), 'v_cache': _w((lambda *s: torch.randn(*s, dtype=torch.bfloat16) * 0.8)(B, Hkv, Sk, Dh)), 'wq': _w((lambda *s: torch.randn(*s, dtype=torch.bfloat16) * 1.6)(D, Hq * Dh) * D ** (-0.5)), 'wo': _w((lambda *s: torch.randn(*s, dtype=torch.bfloat16) * 0.8)(Hq * Dh, D) * (Hq * Dh) ** (-0.5))}
    _A_in = _A_setup()

    def _B_setup():
        B, S, D, F = (1, 2048, 512, 1792)
        return {'x': _w((lambda *s: torch.randn(*s, dtype=torch.bfloat16) * 0.05)(B, S, D)), 'w1': _w((lambda *s: torch.randn(*s, dtype=torch.bfloat16) * 1.6)(D, F) * D ** (-0.5)), 'w2': _w((lambda *s: torch.randn(*s, dtype=torch.bfloat16) * 0.2)(F, D) * F ** (-0.5))}
    _B_in = _B_setup()
    return {'A_x': _A_in['x'], 'A_k_cache': _A_in['k_cache'], 'A_v_cache': _A_in['v_cache'], 'A_wq': _A_in['wq'], 'A_wo': _A_in['wo'], 'B_x': _B_in['x'], 'B_w1': _B_in['w1'], 'B_w2': _B_in['w2'], 'c': _w((lambda *s: torch.randn(*s, dtype=torch.bfloat16) * 0.1)(1, 512) * 8.0), 'w_mod': _w((lambda *s: torch.randn(*s, dtype=torch.bfloat16) * 0.1)(512, 6 * 512) * 512 ** (-0.5) * 8.0)}

def reference(A_x, A_k_cache, A_v_cache, A_wq, A_wo, B_x, B_w1, B_w2, c, w_mod):

    def _A_ref(x, k_cache, v_cache, wq, wo):
        B, Sq, D = x.shape
        Hq, Dh = (32, 128)
        Hkv, Sk = (k_cache.shape[1], k_cache.shape[2])
        W = min(4096, max(256, Sk // 4))
        rep = Hq // Hkv
        q = (lambda x, *d: x.permute(*d))((x @ wq).reshape(B, Sq, Hq, Dh), 0, 2, 1, 3)
        k = (lambda x, n, axis: torch.repeat_interleave(x, n, dim=axis))(k_cache[:, :, Sk - W:, :], rep, axis=1)
        v = (lambda x, n, axis: torch.repeat_interleave(x, n, dim=axis))(v_cache[:, :, Sk - W:, :], rep, axis=1)
        scores = torch.einsum('bhqd,bhkd->bhqk', q, k) * Dh ** (-0.5)
        p = _softmax(scores, axis=-1)
        o = torch.einsum('bhqk,bhkd->bhqd', p, v)
        return (lambda x, *d: x.permute(*d))(o, 0, 2, 1, 3).reshape(B, Sq, Hq * Dh) @ wo

    def _B_ref(x, w1, w2):
        h = torch.einsum('bsd,df->bsf', x, w1)
        h = _silu(h)
        out = torch.einsum('bsf,fd->bsd', h, w2)
        return out
    x = A_x
    mod = (_silu(c) @ w_mod).reshape(c.shape[0], 6, 1, -1)
    sa, ca, ga, sb, cb, gb = (mod[:, 0].clone(), mod[:, 1].clone(), mod[:, 2].clone(), mod[:, 3].clone(), mod[:, 4].clone(), mod[:, 5].clone())
    h = _layernorm(x, axis=-1) * (1 + ca) + sa
    x = x + ga * _A_ref(h, A_k_cache, A_v_cache, A_wq, A_wo)
    h = _layernorm(x, axis=-1) * (1 + cb) + sb
    x = x + gb * _B_ref(h, B_w1, B_w2)
    return x
```

```asm
; @launch grid=(256,1,1) block=(256,1,1) lds=163840
.amdgcn_target "amdgcn-amd-amdhsa--gfx950"
.text
.globl adaLN_cond__sliding_block_cached__dense_activation_silu__prompt_kernel
.p2align 8
.type adaLN_cond__sliding_block_cached__dense_activation_silu__prompt_kernel,@function
adaLN_cond__sliding_block_cached__dense_activation_silu__prompt_kernel:
  s_cmp_ge_u32 s2, 256
  s_cbranch_scc1 L_end
  s_load_dwordx2 s[20:21], s[0:1], 96
  s_mov_b32 s22, 268435456
  s_mov_b32 s23, 0x20000
  s_load_dwordx2 s[44:45], s[0:1], 72
  s_mov_b32 s46, 3145728
  s_mov_b32 s47, 0x20000
  s_load_dwordx2 s[40:41], s[0:1], 64
  s_mov_b32 s42, 1024
  s_mov_b32 s43, 0x20000
  s_load_dwordx2 s[4:5], s[0:1], 0
  s_mov_b32 s6, 2097152
  s_mov_b32 s7, 0x20000
  s_load_dwordx2 s[8:9], s[0:1], 24
  s_mov_b32 s10, 4194304
  s_mov_b32 s11, 0x20000
  s_load_dwordx2 s[12:13], s[0:1], 8
  s_mov_b32 s14, 4194304
  s_mov_b32 s15, 0x20000
  s_load_dwordx2 s[16:17], s[0:1], 16
  s_mov_b32 s18, 4194304
  s_mov_b32 s19, 0x20000
  v_lshrrev_b32 v14, 6, v0
  v_and_b32 v1, 63, v0
  s_and_b32 s101, s2, 7
  s_lshr_b32 s99, s2, 3
  s_and_b32 s24, s101, 3
  s_lshl_b32 s24, s24, 1
  s_and_b32 s25, s99, 1
  s_or_b32 s24, s24, s25
  s_lshr_b32 s25, s101, 2
  s_lshl_b32 s25, s25, 5
  s_or_b32 s25, s25, s99
  s_lshr_b32 s25, s25, 1
  v_readfirstlane_b32 s3, v14
  s_lshl_b32 s68, s101, 8
  s_lshl_b32 s34, s99, 3
  s_add_u32 s68, s68, s34
  s_getpc_b64 s[38:39]
L_pcref:
  s_add_u32 s38, s38, L_pg0-L_pcref
  s_addc_u32 s39, s39, 0
  s_mov_b32 s100, 0
  s_bfe_u32 s36, s99, 0x20001
  s_lshl_b32 s36, s36, 6
  s_and_b32 s37, s99, 1
  s_lshl_b32 s37, s37, 8
  s_or_b32 s36, s36, s37
  v_xor_b32 v98, s36, v0
  v_xor_b32 v99, 0x100, v98
  v_mul_u32_u24 v96, 6144, v98
  v_mul_u32_u24 v97, 6144, v99
  v_lshlrev_b32 v98, 1, v98
  v_lshlrev_b32 v99, 1, v99
  v_lshlrev_b32 v240, 4, v1
  s_lshl_b32 s71, s25, 16
  s_lshl_b32 s37, s3, 14
  s_add_u32 s71, s71, s37
  s_lshl_b32 s37, s24, 2
  s_lshr_b32 s67, s24, 1
  s_add_u32 s67, s67, s37
  s_add_u32 s60, s67, 0
  s_and_b32 s60, s60, 7
  s_add_u32 s61, s67, 1
  s_and_b32 s61, s61, 7
  s_add_u32 s62, s67, 2
  s_and_b32 s62, s62, 7
  s_add_u32 s63, s67, 3
  s_and_b32 s63, s63, 7
  s_add_u32 s64, s67, 4
  s_and_b32 s64, s64, 7
  s_add_u32 s65, s67, 5
  s_and_b32 s65, s65, 7
  s_add_u32 s66, s67, 6
  s_and_b32 s66, s66, 7
  s_add_u32 s67, s67, 7
  s_and_b32 s67, s67, 7
  v_and_b32 v243, 15, v0
  v_lshrrev_b32 v15, 6, v0
  v_lshl_add_u32 v243, v15, 4, v243
  v_lshlrev_b32 v243, 7, v243
  s_lshl_b32 s34, s99, 2
  s_add_u32 s34, s34, s3
  s_and_b32 s34, s34, 7
  s_add_u32 s34, s34, 4
  s_lshl_b32 s34, s34, 12
  s_min_u32 s34, s34, L_end-L_pg0-128
  v_writelane_b32 v243, s34, 16
  s_add_u32 s34, s34, 128
  v_writelane_b32 v243, s34, 17
  s_waitcnt lgkmcnt(0)
  s_load_dword s30, s[20:21], 32768
  buffer_load_dwordx2 v[104:105], v96, s[44:47], s68 offen
  buffer_load_dwordx2 v[106:107], v97, s[44:47], s68 offen
  buffer_load_ushort v100, v98, s[40:43], 0 offen
  buffer_load_ushort v101, v99, s[40:43], 0 offen
  s_branch L_pg0
.p2align 12
L_pg0:
  v_accvgpr_write_b32 a247, v96
  v_accvgpr_write_b32 a246, v97
  s_mul_i32 s26, s3, 24576
  s_add_u32 s26, s26, 65536
  v_lshrrev_b32 v14, 3, v1
  v_mul_u32_u24 v14, 8192, v14
  v_and_b32 v15, 1, v1
  v_lshl_add_u32 v14, v15, 4, v14
  v_bfe_u32 v15, v1, 1, 2
  v_bfe_u32 v16, v1, 4, 1
  v_xor_b32 v15, v15, v16
  v_xor_b32 v16, 0, v15
  v_lshl_add_u32 v16, v16, 5, v14
  v_add_u32 v10, 0, v16
  v_xor_b32 v16, 2, v15
  v_lshl_add_u32 v16, v16, 5, v14
  v_add_u32 v11, 64512, v16
  v_xor_b32 v16, 0, v15
  v_lshl_add_u32 v16, v16, 5, v14
  v_add_u32 v12, 129024, v16
  v_xor_b32 v16, 2, v15
  v_lshl_add_u32 v16, v16, 5, v14
  v_add_u32 v13, 193536, v16
  v_lshrrev_b32 v14, 4, v1
  v_bfe_u32 v15, v1, 2, 2
  v_lshl_add_u32 v16, v14, 3, v15
  v_lshlrev_b32 v16, 7, v16
  v_and_b32 v17, 3, v1
  v_lshl_add_u32 v16, v17, 3, v16
  v_add_u32 v16, s26, v16
  v_bfe_u32 v17, v1, 3, 2
  v_xor_b32 v18, 0, v17
  v_lshl_add_u32 v2, v18, 5, v16
  v_xor_b32 v18, 1, v17
  v_lshl_add_u32 v3, v18, 5, v16
  v_xor_b32 v18, 2, v17
  v_lshl_add_u32 v4, v18, 5, v16
  v_xor_b32 v18, 3, v17
  v_lshl_add_u32 v5, v18, 5, v16
  v_and_b32 v15, 15, v1
  v_add_u32 v16, 0, v14
  v_xor_b32 v16, v16, v15
  v_lshlrev_b32 v16, 4, v16
  v_lshl_add_u32 v6, v15, 10, v16
  v_add_u32 v16, 4, v14
  v_xor_b32 v16, v16, v15
  v_lshlrev_b32 v16, 4, v16
  v_lshl_add_u32 v7, v15, 10, v16
  v_add_u32 v16, 8, v14
  v_xor_b32 v16, v16, v15
  v_lshlrev_b32 v16, 4, v16
  v_lshl_add_u32 v8, v15, 10, v16
  v_add_u32 v16, 12, v14
  v_xor_b32 v16, v16, v15
  v_lshlrev_b32 v16, 4, v16
  v_lshl_add_u32 v9, v15, 10, v16
  s_lshl_b32 s28, s24, 10
  s_lshl_b32 s37, s3, 8
  s_add_u32 s28, s28, s37
  s_mov_b32 s70, 0xffff0000
  s_lshl_b32 s34, s3, 14
  v_add_u32 v84, s34, v240
  s_mul_i32 s34, s60, 2080
  v_xor_b32 v90, s34, v84
  v_xor_b32 v91, 1040, v90
  s_mul_i32 s34, s61, 2080
  v_xor_b32 v92, s34, v84
  v_xor_b32 v93, 1040, v92
  s_mul_i32 s34, s62, 2080
  v_xor_b32 v94, s34, v84
  v_xor_b32 v95, 1040, v94
  s_mul_i32 s34, s63, 2080
  v_xor_b32 v244, s34, v84
  v_xor_b32 v245, 1040, v244
  s_mul_i32 s34, s64, 2080
  v_xor_b32 v246, s34, v84
  v_xor_b32 v247, 1040, v246
  s_mul_i32 s34, s65, 2080
  v_xor_b32 v248, s34, v84
  v_xor_b32 v249, 1040, v248
  s_mul_i32 s34, s66, 2080
  v_xor_b32 v250, s34, v84
  v_xor_b32 v251, 1040, v250
  s_mul_i32 s34, s67, 2080
  v_xor_b32 v252, s34, v84
  v_xor_b32 v253, 1040, v252
  s_cmp_ge_u32 s101, 4
  s_cselect_b32 s37, 1.0, 0
  s_lshl_b32 s34, s60, 11
  s_add_u32 s34, s34, s71
  buffer_load_dwordx4 v[20:23], v240, s[4:7], s34 offen offset:0
  buffer_load_dwordx4 v[24:27], v240, s[4:7], s34 offen offset:1024
  v_lshrrev_b32 v242, 3, v1
  v_lshlrev_b32 v242, 20, v242
  v_and_b32 v15, 7, v1
  v_lshl_add_u32 v242, v15, 7, v242
  s_lshr_b32 s69, s25, 0
  s_lshl_b32 s69, s69, 15
  s_lshl_b32 s35, s3, 13
  s_add_u32 s69, s69, s35
  s_lshl_b32 s35, s24, 10
  s_add_u32 s69, s69, s35
  s_mov_b64 exec, 0x3ffff
  global_load_dword a255, v243, s[38:39]
  s_mov_b64 exec, -1
  s_lshl_b32 s29, s24, 19
  s_lshl_b32 s34, s61, 11
  s_add_u32 s34, s34, s71
  buffer_load_dwordx4 v[28:31], v240, s[4:7], s34 offen offset:0
  buffer_load_dwordx4 v[32:35], v240, s[4:7], s34 offen offset:1024
  s_waitcnt lgkmcnt(0)
  s_add_u32 s30, s30, 0x9e3779b1
  s_waitcnt vmcnt(6)
  v_lshlrev_b32 v100, 16, v100
  s_waitcnt vmcnt(5)
  v_lshlrev_b32 v101, 16, v101
  v_mul_f32 v102, 0xbfb8aa3b, v100
  v_mul_f32 v103, 0xbfb8aa3b, v101
  v_exp_f32 v102, v102
  v_exp_f32 v103, v103
  v_add_f32 v102, 1.0, v102
  v_add_f32 v103, 1.0, v103
  v_rcp_f32 v102, v102
  v_rcp_f32 v103, v103
  v_mul_f32 v100, v100, v102
  v_mul_f32 v101, v101, v103
  v_cvt_pk_bf16_f32 v102, v100, v101
  v_lshlrev_b32 v100, 16, v102
  v_and_b32 v101, 0xffff0000, v102
  v_lshlrev_b32 v102, 16, v104
  v_lshlrev_b32 v103, 16, v106
  v_and_b32 v104, s70, v104
  v_and_b32 v106, s70, v106
  v_mul_f32 v102, v100, v102
  v_mul_f32 v104, v100, v104
  v_fma_f32 v106, v106, v101, v104
  v_fma_f32 v104, v103, v101, v102
  v_lshlrev_b32 v102, 16, v105
  v_lshlrev_b32 v103, 16, v107
  v_and_b32 v105, s70, v105
  v_and_b32 v107, s70, v107
  v_mul_f32 v102, v100, v102
  v_mul_f32 v105, v100, v105
  v_fma_f32 v107, v107, v101, v105
  v_fma_f32 v105, v103, v101, v102
  s_nop 1
  v_permlane32_swap_b32 v104, v105
  v_permlane32_swap_b32 v106, v107
  v_add_f32 v104, v104, v105
  v_add_f32 v106, v106, v107
  s_nop 1
  v_permlane16_swap_b32 v104, v106
  v_add_f32 v104, v104, v106
  s_nop 1
  v_add_f32_dpp v104, v104, v104 row_ror:8 row_mask:0xf bank_mask:0xf
  s_nop 1
  v_add_f32_dpp v104, v104, v104 row_ror:4 row_mask:0xf bank_mask:0xf
  s_nop 1
  v_add_f32_dpp v104, v104, v104 row_ror:2 row_mask:0xf bank_mask:0xf
  s_nop 1
  v_add_f32_dpp v104, v104, v104 row_ror:1 row_mask:0xf bank_mask:0xf
  v_lshrrev_b32 v96, 4, v0
  v_lshlrev_b32 v96, 2, v96
  ds_write_b32 v96, v104
  v_accvgpr_write_b32 a245, v100
  v_accvgpr_write_b32 a244, v101
  v_and_b32 v96, 1, v1
  v_lshlrev_b32 v96, 3, v96
  s_and_b32 s36, s68, 0x3f0
  s_bfe_u32 s35, s68, 0x10003
  s_lshl_b32 s35, s35, 10
  s_or_b32 s36, s36, s35
  s_lshr_b32 s35, s68, 10
  s_lshl_b32 s35, s35, 11
  s_or_b32 s36, s36, s35
  s_lshl_b32 s34, s62, 11
  s_add_u32 s34, s34, s71
  buffer_load_dwordx4 v[36:39], v240, s[4:7], s34 offen offset:0
  buffer_load_dwordx4 v[40:43], v240, s[4:7], s34 offen offset:1024
  s_waitcnt lgkmcnt(0)
  s_barrier
  s_cmp_lg_u32 s3, 0
  s_cbranch_scc1 L_modpub
  ds_read_b64 v[100:101], v96 offset:0
  ds_read_b64 v[102:103], v96 offset:16
  ds_read_b64 v[104:105], v96 offset:32
  ds_read_b64 v[106:107], v96 offset:48
  s_waitcnt lgkmcnt(2)
  v_add_f32 v100, v100, v102
  v_add_f32 v101, v101, v103
  s_waitcnt lgkmcnt(0)
  v_add_f32 v104, v104, v106
  v_add_f32 v105, v105, v107
  v_add_f32 v100, v100, v104
  v_add_f32 v101, v101, v105
  v_cvt_pk_bf16_f32 v102, v100, v101
  v_lshlrev_b32 v100, 16, v102
  v_and_b32 v101, s70, v102
  v_add_f32 v100, s37, v100
  v_add_f32 v101, s37, v101
  v_cvt_pk_bf16_f32 v100, v100, v101
  s_mov_b32 s89, s30
  s_mov_b32 s91, s30
  v_readlane_b32 s88, v100, 0
  v_readlane_b32 s90, v100, 1
  s_nop 3
  s_atomic_swap_x2 s[88:89], s[20:21], s36 offset:0
  s_atomic_swap_x2 s[90:91], s[20:21], s36 offset:8
L_modpub:
  s_lshl_b32 s34, s63, 11
  s_add_u32 s34, s34, s71
  buffer_load_dwordx4 v[44:47], v240, s[4:7], s34 offen offset:0
  buffer_load_dwordx4 v[48:51], v240, s[4:7], s34 offen offset:1024
  s_lshl_b32 s34, s64, 11
  s_add_u32 s34, s34, s71
  buffer_load_dwordx4 v[52:55], v240, s[4:7], s34 offen offset:0
  buffer_load_dwordx4 v[56:59], v240, s[4:7], s34 offen offset:1024
  s_mov_b32 s100, 1
  s_cmp_eq_u32 s3, 1
  s_cbranch_scc1 L_page6
  s_cmp_eq_u32 s3, 2
  s_cbranch_scc1 L_page7
  s_cmp_eq_u32 s3, 3
  s_cbranch_scc1 L_page8
L_pgretX:
  s_mov_b32 s100, 0
  s_waitcnt vmcnt(10)
  v_lshlrev_b32 v96, 16, v20
  v_and_b32 v97, s70, v20
  v_lshlrev_b32 v98, 16, v21
  v_and_b32 v99, s70, v21
  v_lshlrev_b32 v100, 16, v22
  v_and_b32 v101, s70, v22
  v_lshlrev_b32 v102, 16, v23
  v_and_b32 v103, s70, v23
  v_pk_add_f32 v[84:85], v[96:97], v[98:99]
  v_pk_mul_f32 v[88:89], v[96:97], v[96:97]
  v_pk_add_f32 v[86:87], v[100:101], v[102:103]
  v_pk_fma_f32 v[88:89], v[98:99], v[98:99], v[88:89]
  v_pk_add_f32 v[84:85], v[84:85], v[86:87]
  v_pk_fma_f32 v[88:89], v[100:101], v[100:101], v[88:89]
  v_add_f32 v20, v84, v85
  v_pk_fma_f32 v[88:89], v[102:103], v[102:103], v[88:89]
  v_add_f32 v21, v88, v89
  s_waitcnt vmcnt(9)
  v_lshlrev_b32 v104, 16, v24
  v_and_b32 v105, s70, v24
  v_lshlrev_b32 v106, 16, v25
  v_and_b32 v107, s70, v25
  v_lshlrev_b32 v108, 16, v26
  v_and_b32 v109, s70, v26
  v_lshlrev_b32 v110, 16, v27
  v_and_b32 v111, s70, v27
  v_pk_add_f32 v[84:85], v[104:105], v[106:107]
  v_pk_mul_f32 v[88:89], v[104:105], v[104:105]
  v_pk_add_f32 v[86:87], v[108:109], v[110:111]
  v_pk_fma_f32 v[88:89], v[106:107], v[106:107], v[88:89]
  v_pk_add_f32 v[84:85], v[84:85], v[86:87]
  v_pk_fma_f32 v[88:89], v[108:109], v[108:109], v[88:89]
  v_add_f32 v24, v84, v85
  v_pk_fma_f32 v[88:89], v[110:111], v[110:111], v[88:89]
  v_add_f32 v25, v88, v89
  s_lshl_b32 s34, s65, 11
  s_add_u32 s34, s34, s71
  buffer_load_dwordx4 v[60:63], v240, s[4:7], s34 offen offset:0
  buffer_load_dwordx4 v[64:67], v240, s[4:7], s34 offen offset:1024
  s_waitcnt vmcnt(9)
  v_lshlrev_b32 v112, 16, v28
  v_and_b32 v113, s70, v28
  v_lshlrev_b32 v114, 16, v29
  v_and_b32 v115, s70, v29
  v_lshlrev_b32 v116, 16, v30
  v_and_b32 v117, s70, v30
  v_lshlrev_b32 v118, 16, v31
  v_and_b32 v119, s70, v31
  v_pk_add_f32 v[84:85], v[112:113], v[114:115]
  v_pk_mul_f32 v[88:89], v[112:113], v[112:113]
  v_pk_add_f32 v[86:87], v[116:117], v[118:119]
  v_pk_fma_f32 v[88:89], v[114:115], v[114:115], v[88:89]
  v_pk_add_f32 v[84:85], v[84:85], v[86:87]
  v_pk_fma_f32 v[88:89], v[116:117], v[116:117], v[88:89]
  v_add_f32 v28, v84, v85
  v_pk_fma_f32 v[88:89], v[118:119], v[118:119], v[88:89]
  v_add_f32 v29, v88, v89
  s_waitcnt vmcnt(8)
  v_lshlrev_b32 v120, 16, v32
  v_and_b32 v121, s70, v32
  v_lshlrev_b32 v122, 16, v33
  v_and_b32 v123, s70, v33
  v_lshlrev_b32 v124, 16, v34
  v_and_b32 v125, s70, v34
  v_lshlrev_b32 v126, 16, v35
  v_and_b32 v127, s70, v35
  v_pk_add_f32 v[84:85], v[120:121], v[122:123]
  v_pk_mul_f32 v[88:89], v[120:121], v[120:121]
  v_pk_add_f32 v[86:87], v[124:125], v[126:127]
  v_pk_fma_f32 v[88:89], v[122:123], v[122:123], v[88:89]
  v_pk_add_f32 v[84:85], v[84:85], v[86:87]
  v_pk_fma_f32 v[88:89], v[124:125], v[124:125], v[88:89]
  v_add_f32 v32, v84, v85
  v_pk_fma_f32 v[88:89], v[126:127], v[126:127], v[88:89]
  v_add_f32 v33, v88, v89
  s_lshl_b32 s34, s66, 11
  s_add_u32 s34, s34, s71
  buffer_load_dwordx4 v[68:71], v240, s[4:7], s34 offen offset:0
  buffer_load_dwordx4 v[72:75], v240, s[4:7], s34 offen offset:1024
  s_waitcnt vmcnt(9)
  v_lshlrev_b32 v128, 16, v36
  v_and_b32 v129, s70, v36
  v_lshlrev_b32 v130, 16, v37
  v_and_b32 v131, s70, v37
  v_lshlrev_b32 v132, 16, v38
  v_and_b32 v133, s70, v38
  v_lshlrev_b32 v134, 16, v39
  v_and_b32 v135, s70, v39
  v_pk_add_f32 v[84:85], v[128:129], v[130:131]
  v_pk_mul_f32 v[88:89], v[128:129], v[128:129]
  v_pk_add_f32 v[86:87], v[132:133], v[134:135]
  v_pk_fma_f32 v[88:89], v[130:131], v[130:131], v[88:89]
  v_pk_add_f32 v[84:85], v[84:85], v[86:87]
  v_pk_fma_f32 v[88:89], v[132:133], v[132:133], v[88:89]
  v_add_f32 v36, v84, v85
  v_pk_fma_f32 v[88:89], v[134:135], v[134:135], v[88:89]
  v_add_f32 v37, v88, v89
  s_waitcnt vmcnt(8)
  v_lshlrev_b32 v136, 16, v40
  v_and_b32 v137, s70, v40
  v_lshlrev_b32 v138, 16, v41
  v_and_b32 v139, s70, v41
  v_lshlrev_b32 v140, 16, v42
  v_and_b32 v141, s70, v42
  v_lshlrev_b32 v142, 16, v43
  v_and_b32 v143, s70, v43
  v_pk_add_f32 v[84:85], v[136:137], v[138:139]
  v_pk_mul_f32 v[88:89], v[136:137], v[136:137]
  v_pk_add_f32 v[86:87], v[140:141], v[142:143]
  v_pk_fma_f32 v[88:89], v[138:139], v[138:139], v[88:89]
  v_pk_add_f32 v[84:85], v[84:85], v[86:87]
  v_pk_fma_f32 v[88:89], v[140:141], v[140:141], v[88:89]
  v_add_f32 v40, v84, v85
  v_pk_fma_f32 v[88:89], v[142:143], v[142:143], v[88:89]
  v_add_f32 v41, v88, v89
  s_lshl_b32 s34, s67, 11
  s_add_u32 s34, s34, s71
  buffer_load_dwordx4 v[76:79], v240, s[4:7], s34 offen offset:0
  buffer_load_dwordx4 v[80:83], v240, s[4:7], s34 offen offset:1024
  s_mov_b64 exec, 0xff
  buffer_load_dword a250, v242, s[8:11], s69 offen
  s_mov_b64 exec, -1
  s_waitcnt vmcnt(10)
  v_lshlrev_b32 v144, 16, v44
  v_and_b32 v145, s70, v44
  v_lshlrev_b32 v146, 16, v45
  v_and_b32 v147, s70, v45
  v_lshlrev_b32 v148, 16, v46
  v_and_b32 v149, s70, v46
  v_lshlrev_b32 v150, 16, v47
  v_and_b32 v151, s70, v47
  v_pk_add_f32 v[84:85], v[144:145], v[146:147]
  v_pk_mul_f32 v[88:89], v[144:145], v[144:145]
  v_pk_add_f32 v[86:87], v[148:149], v[150:151]
  v_pk_fma_f32 v[88:89], v[146:147], v[146:147], v[88:89]
  v_pk_add_f32 v[84:85], v[84:85], v[86:87]
  v_pk_fma_f32 v[88:89], v[148:149], v[148:149], v[88:89]
  v_add_f32 v44, v84, v85
  v_pk_fma_f32 v[88:89], v[150:151], v[150:151], v[88:89]
  v_add_f32 v45, v88, v89
  s_waitcnt vmcnt(9)
  v_lshlrev_b32 v152, 16, v48
  v_and_b32 v153, s70, v48
  v_lshlrev_b32 v154, 16, v49
  v_and_b32 v155, s70, v49
  v_lshlrev_b32 v156, 16, v50
  v_and_b32 v157, s70, v50
  v_lshlrev_b32 v158, 16, v51
  v_and_b32 v159, s70, v51
  v_pk_add_f32 v[84:85], v[152:153], v[154:155]
  v_pk_mul_f32 v[88:89], v[152:153], v[152:153]
  v_pk_add_f32 v[86:87], v[156:157], v[158:159]
  v_pk_fma_f32 v[88:89], v[154:155], v[154:155], v[88:89]
  v_pk_add_f32 v[84:85], v[84:85], v[86:87]
  v_pk_fma_f32 v[88:89], v[156:157], v[156:157], v[88:89]
  v_add_f32 v48, v84, v85
  v_pk_fma_f32 v[88:89], v[158:159], v[158:159], v[88:89]
  v_add_f32 v49, v88, v89
  v_permlane32_swap_b32 v20, v36
  v_permlane32_swap_b32 v24, v40
  v_permlane32_swap_b32 v28, v44
  v_permlane32_swap_b32 v32, v48
  v_permlane32_swap_b32 v21, v37
  v_permlane32_swap_b32 v25, v41
  v_permlane32_swap_b32 v29, v45
  v_permlane32_swap_b32 v33, v49
  v_add_f32 v20, v20, v36
  v_add_f32 v24, v24, v40
  v_add_f32 v28, v28, v44
  v_add_f32 v32, v32, v48
  v_add_f32 v21, v21, v37
  v_add_f32 v25, v25, v41
  v_add_f32 v29, v29, v45
  v_add_f32 v33, v33, v49
  v_permlane16_swap_b32 v20, v28
  v_permlane16_swap_b32 v24, v32
  v_permlane16_swap_b32 v21, v29
  v_permlane16_swap_b32 v25, v33
  v_add_f32 v20, v20, v28
  v_add_f32 v24, v24, v32
  v_add_f32 v21, v21, v29
  v_add_f32 v25, v25, v33
  v_add_f32_dpp v20, v20, v20 row_ror:8 row_mask:0xf bank_mask:0xf
  v_add_f32_dpp v24, v24, v24 row_ror:8 row_mask:0xf bank_mask:0xf
  v_add_f32_dpp v21, v21, v21 row_ror:8 row_mask:0xf bank_mask:0xf
  v_add_f32_dpp v25, v25, v25 row_ror:8 row_mask:0xf bank_mask:0xf
  v_add_f32_dpp v20, v20, v20 row_ror:4 row_mask:0xf bank_mask:0xf
  v_add_f32_dpp v24, v24, v24 row_ror:4 row_mask:0xf bank_mask:0xf
  v_add_f32_dpp v21, v21, v21 row_ror:4 row_mask:0xf bank_mask:0xf
  v_add_f32_dpp v25, v25, v25 row_ror:4 row_mask:0xf bank_mask:0xf
  v_add_f32_dpp v20, v20, v20 row_ror:2 row_mask:0xf bank_mask:0xf
  v_add_f32_dpp v24, v24, v24 row_ror:2 row_mask:0xf bank_mask:0xf
  v_add_f32_dpp v21, v21, v21 row_ror:2 row_mask:0xf bank_mask:0xf
  v_add_f32_dpp v25, v25, v25 row_ror:2 row_mask:0xf bank_mask:0xf
  v_add_f32_dpp v20, v20, v20 row_ror:1 row_mask:0xf bank_mask:0xf
  v_add_f32_dpp v24, v24, v24 row_ror:1 row_mask:0xf bank_mask:0xf
  v_add_f32_dpp v21, v21, v21 row_ror:1 row_mask:0xf bank_mask:0xf
  v_add_f32_dpp v25, v25, v25 row_ror:1 row_mask:0xf bank_mask:0xf
  v_mul_f32 v20, 0x3b000000, v20
  v_mul_f32 v24, 0x3b000000, v24
  v_mul_f32 v21, 0x3b000000, v21
  v_mul_f32 v25, 0x3b000000, v25
  v_fma_f32 v21, -v20, v20, v21
  v_fma_f32 v25, -v24, v24, v25
  v_max_f32 v21, 0, v21
  v_max_f32 v25, 0, v25
  v_add_f32 v21, 0x3727c5ac, v21
  v_add_f32 v25, 0x3727c5ac, v25
  v_rsq_f32 v21, v21
  v_rsq_f32 v25, v25
  v_mul_f32 v21, 0x3e0293ee, v21
  v_mul_f32 v25, 0x3e0293ee, v25
  v_mul_f32_e64 v20, -v20, v21
  v_mul_f32_e64 v24, -v24, v25
  v_readlane_b32 s40, v21, 0
  v_readlane_b32 s41, v20, 0
  v_readlane_b32 s44, v21, 16
  v_readlane_b32 s45, v20, 16
  v_readlane_b32 s48, v21, 32
  v_readlane_b32 s49, v20, 32
  v_readlane_b32 s52, v21, 48
  v_readlane_b32 s53, v20, 48
  v_readlane_b32 s42, v25, 0
  v_readlane_b32 s43, v24, 0
  v_readlane_b32 s46, v25, 16
  v_readlane_b32 s47, v24, 16
  v_readlane_b32 s50, v25, 32
  v_readlane_b32 s51, v24, 32
  v_readlane_b32 s54, v25, 48
  v_readlane_b32 s55, v24, 48
  v_pk_fma_f32 v[96:97], v[96:97], s[40:41], s[40:41] op_sel:[0,0,1] op_sel_hi:[1,0,1]
  v_pk_fma_f32 v[98:99], v[98:99], s[40:41], s[40:41] op_sel:[0,0,1] op_sel_hi:[1,0,1]
  v_pk_fma_f32 v[100:101], v[100:101], s[40:41], s[40:41] op_sel:[0,0,1] op_sel_hi:[1,0,1]
  v_pk_fma_f32 v[102:103], v[102:103], s[40:41], s[40:41] op_sel:[0,0,1] op_sel_hi:[1,0,1]
  v_pk_fma_f32 v[104:105], v[104:105], s[42:43], s[42:43] op_sel:[0,0,1] op_sel_hi:[1,0,1]
  v_pk_fma_f32 v[106:107], v[106:107], s[42:43], s[42:43] op_sel:[0,0,1] op_sel_hi:[1,0,1]
  v_pk_fma_f32 v[108:109], v[108:109], s[42:43], s[42:43] op_sel:[0,0,1] op_sel_hi:[1,0,1]
  v_pk_fma_f32 v[110:111], v[110:111], s[42:43], s[42:43] op_sel:[0,0,1] op_sel_hi:[1,0,1]
  v_pk_fma_f32 v[112:113], v[112:113], s[44:45], s[44:45] op_sel:[0,0,1] op_sel_hi:[1,0,1]
  v_pk_fma_f32 v[114:115], v[114:115], s[44:45], s[44:45] op_sel:[0,0,1] op_sel_hi:[1,0,1]
  v_pk_fma_f32 v[116:117], v[116:117], s[44:45], s[44:45] op_sel:[0,0,1] op_sel_hi:[1,0,1]
  v_pk_fma_f32 v[118:119], v[118:119], s[44:45], s[44:45] op_sel:[0,0,1] op_sel_hi:[1,0,1]
  v_pk_fma_f32 v[120:121], v[120:121], s[46:47], s[46:47] op_sel:[0,0,1] op_sel_hi:[1,0,1]
  v_pk_fma_f32 v[122:123], v[122:123], s[46:47], s[46:47] op_sel:[0,0,1] op_sel_hi:[1,0,1]
  v_pk_fma_f32 v[124:125], v[124:125], s[46:47], s[46:47] op_sel:[0,0,1] op_sel_hi:[1,0,1]
  v_pk_fma_f32 v[126:127], v[126:127], s[46:47], s[46:47] op_sel:[0,0,1] op_sel_hi:[1,0,1]
  v_pk_fma_f32 v[128:129], v[128:129], s[48:49], s[48:49] op_sel:[0,0,1] op_sel_hi:[1,0,1]
  v_pk_fma_f32 v[130:131], v[130:131], s[48:49], s[48:49] op_sel:[0,0,1] op_sel_hi:[1,0,1]
  v_pk_fma_f32 v[132:133], v[132:133], s[48:49], s[48:49] op_sel:[0,0,1] op_sel_hi:[1,0,1]
  v_pk_fma_f32 v[134:135], v[134:135], s[48:49], s[48:49] op_sel:[0,0,1] op_sel_hi:[1,0,1]
  v_pk_fma_f32 v[136:137], v[136:137], s[50:51], s[50:51] op_sel:[0,0,1] op_sel_hi:[1,0,1]
  v_pk_fma_f32 v[138:139], v[138:139], s[50:51], s[50:51] op_sel:[0,0,1] op_sel_hi:[1,0,1]
  v_pk_fma_f32 v[140:141], v[140:141], s[50:51], s[50:51] op_sel:[0,0,1] op_sel_hi:[1,0,1]
  v_pk_fma_f32 v[142:143], v[142:143], s[50:51], s[50:51] op_sel:[0,0,1] op_sel_hi:[1,0,1]
  v_pk_fma_f32 v[144:145], v[144:145], s[52:53], s[52:53] op_sel:[0,0,1] op_sel_hi:[1,0,1]
  v_pk_fma_f32 v[146:147], v[146:147], s[52:53], s[52:53] op_sel:[0,0,1] op_sel_hi:[1,0,1]
  v_pk_fma_f32 v[148:149], v[148:149], s[52:53], s[52:53] op_sel:[0,0,1] op_sel_hi:[1,0,1]
  v_pk_fma_f32 v[150:151], v[150:151], s[52:53], s[52:53] op_sel:[0,0,1] op_sel_hi:[1,0,1]
  v_pk_fma_f32 v[152:153], v[152:153], s[54:55], s[54:55] op_sel:[0,0,1] op_sel_hi:[1,0,1]
  v_pk_fma_f32 v[154:155], v[154:155], s[54:55], s[54:55] op_sel:[0,0,1] op_sel_hi:[1,0,1]
  v_pk_fma_f32 v[156:157], v[156:157], s[54:55], s[54:55] op_sel:[0,0,1] op_sel_hi:[1,0,1]
  v_pk_fma_f32 v[158:159], v[158:159], s[54:55], s[54:55] op_sel:[0,0,1] op_sel_hi:[1,0,1]
  s_waitcnt vmcnt(8)
  v_lshlrev_b32 v160, 16, v52
  v_and_b32 v161, s70, v52
  v_lshlrev_b32 v162, 16, v53
  v_and_b32 v163, s70, v53
  v_lshlrev_b32 v164, 16, v54
  v_and_b32 v165, s70, v54
  v_lshlrev_b32 v166, 16, v55
  v_and_b32 v167, s70, v55
  v_pk_add_f32 v[84:85], v[160:161], v[162:163]
  v_pk_mul_f32 v[88:89], v[160:161], v[160:161]
  v_pk_add_f32 v[86:87], v[164:165], v[166:167]
  v_pk_fma_f32 v[88:89], v[162:163], v[162:163], v[88:89]
  v_pk_add_f32 v[84:85], v[84:85], v[86:87]
  v_pk_fma_f32 v[88:89], v[164:165], v[164:165], v[88:89]
  v_add_f32 v52, v84, v85
  v_pk_fma_f32 v[88:89], v[166:167], v[166:167], v[88:89]
  v_add_f32 v53, v88, v89
  s_waitcnt vmcnt(7)
  v_lshlrev_b32 v168, 16, v56
  v_and_b32 v169, s70, v56
  v_lshlrev_b32 v170, 16, v57
  v_and_b32 v171, s70, v57
  v_lshlrev_b32 v172, 16, v58
  v_and_b32 v173, s70, v58
  v_lshlrev_b32 v174, 16, v59
  v_and_b32 v175, s70, v59
  v_pk_add_f32 v[84:85], v[168:169], v[170:171]
  v_pk_mul_f32 v[88:89], v[168:169], v[168:169]
  v_pk_add_f32 v[86:87], v[172:173], v[174:175]
  v_pk_fma_f32 v[88:89], v[170:171], v[170:171], v[88:89]
  v_pk_add_f32 v[84:85], v[84:85], v[86:87]
  v_pk_fma_f32 v[88:89], v[172:173], v[172:173], v[88:89]
  v_add_f32 v56, v84, v85
  v_pk_fma_f32 v[88:89], v[174:175], v[174:175], v[88:89]
  v_add_f32 v57, v88, v89
  s_waitcnt vmcnt(6)
  v_lshlrev_b32 v176, 16, v60
  v_and_b32 v177, s70, v60
  v_lshlrev_b32 v178, 16, v61
  v_and_b32 v179, s70, v61
  v_lshlrev_b32 v180, 16, v62
  v_and_b32 v181, s70, v62
  v_lshlrev_b32 v182, 16, v63
  v_and_b32 v183, s70, v63
  v_pk_add_f32 v[84:85], v[176:177], v[178:179]
  v_pk_mul_f32 v[88:89], v[176:177], v[176:177]
  v_pk_add_f32 v[86:87], v[180:181], v[182:183]
  v_pk_fma_f32 v[88:89], v[178:179], v[178:179], v[88:89]
  v_pk_add_f32 v[84:85], v[84:85], v[86:87]
  v_pk_fma_f32 v[88:89], v[180:181], v[180:181], v[88:89]
  v_add_f32 v60, v84, v85
  v_pk_fma_f32 v[88:89], v[182:183], v[182:183], v[88:89]
  v_add_f32 v61, v88, v89
  s_waitcnt vmcnt(5)
  v_lshlrev_b32 v184, 16, v64
  v_and_b32 v185, s70, v64
  v_lshlrev_b32 v186, 16, v65
  v_and_b32 v187, s70, v65
  v_lshlrev_b32 v188, 16, v66
  v_and_b32 v189, s70, v66
  v_lshlrev_b32 v190, 16, v67
  v_and_b32 v191, s70, v67
  v_pk_add_f32 v[84:85], v[184:185], v[186:187]
  v_pk_mul_f32 v[88:89], v[184:185], v[184:185]
  v_pk_add_f32 v[86:87], v[188:189], v[190:191]
  v_pk_fma_f32 v[88:89], v[186:187], v[186:187], v[88:89]
  v_pk_add_f32 v[84:85], v[84:85], v[86:87]
  v_pk_fma_f32 v[88:89], v[188:189], v[188:189], v[88:89]
  v_add_f32 v64, v84, v85
  v_pk_fma_f32 v[88:89], v[190:191], v[190:191], v[88:89]
  v_add_f32 v65, v88, v89
  buffer_load_dwordx4 v[224:227], v240, s[20:23], 0 offen offset:2048
  buffer_load_dwordx4 v[228:231], v240, s[20:23], 0 offen offset:3072
  buffer_load_dwordx4 v[232:235], v240, s[20:23], 0 offen offset:0
  buffer_load_dwordx4 v[236:239], v240, s[20:23], 0 offen offset:1024
  s_waitcnt vmcnt(8)
  v_lshlrev_b32 v192, 16, v68
  v_and_b32 v193, s70, v68
  v_lshlrev_b32 v194, 16, v69
  v_and_b32 v195, s70, v69
  v_lshlrev_b32 v196, 16, v70
  v_and_b32 v197, s70, v70
  v_lshlrev_b32 v198, 16, v71
  v_and_b32 v199, s70, v71
  v_pk_add_f32 v[84:85], v[192:193], v[194:195]
  v_pk_mul_f32 v[88:89], v[192:193], v[192:193]
  v_pk_add_f32 v[86:87], v[196:197], v[198:199]
  v_pk_fma_f32 v[88:89], v[194:195], v[194:195], v[88:89]
  v_pk_add_f32 v[84:85], v[84:85], v[86:87]
  v_pk_fma_f32 v[88:89], v[196:197], v[196:197], v[88:89]
  v_add_f32 v68, v84, v85
  v_pk_fma_f32 v[88:89], v[198:199], v[198:199], v[88:89]
  v_add_f32 v69, v88, v89
  s_waitcnt vmcnt(7)
  v_lshlrev_b32 v200, 16, v72
  v_and_b32 v201, s70, v72
  v_lshlrev_b32 v202, 16, v73
  v_and_b32 v203, s70, v73
  v_lshlrev_b32 v204, 16, v74
  v_and_b32 v205, s70, v74
  v_lshlrev_b32 v206, 16, v75
  v_and_b32 v207, s70, v75
  v_pk_add_f32 v[84:85], v[200:201], v[202:203]
  v_pk_mul_f32 v[88:89], v[200:201], v[200:201]
  v_pk_add_f32 v[86:87], v[204:205], v[206:207]
  v_pk_fma_f32 v[88:89], v[202:203], v[202:203], v[88:89]
  v_pk_add_f32 v[84:85], v[84:85], v[86:87]
  v_pk_fma_f32 v[88:89], v[204:205], v[204:205], v[88:89]
  v_add_f32 v72, v84, v85
  v_pk_fma_f32 v[88:89], v[206:207], v[206:207], v[88:89]
  v_add_f32 v73, v88, v89
  s_add_u32 m0, s26, 16384
  s_add_u32 s27, s28, 0
  buffer_load_dwordx4 v10, s[8:11], s27 offen offset:0 lds
  buffer_load_dwordx4 v11, s[8:11], s27 offen offset:1024 lds
  s_waitcnt vmcnt(8)
  v_lshlrev_b32 v208, 16, v76
  v_and_b32 v209, s70, v76
  v_lshlrev_b32 v210, 16, v77
  v_and_b32 v211, s70, v77
  v_lshlrev_b32 v212, 16, v78
  v_and_b32 v213, s70, v78
  v_lshlrev_b32 v214, 16, v79
  v_and_b32 v215, s70, v79
  v_pk_add_f32 v[84:85], v[208:209], v[210:211]
  v_pk_mul_f32 v[88:89], v[208:209], v[208:209]
  v_pk_add_f32 v[86:87], v[212:213], v[214:215]
  v_pk_fma_f32 v[88:89], v[210:211], v[210:211], v[88:89]
  v_pk_add_f32 v[84:85], v[84:85], v[86:87]
  v_pk_fma_f32 v[88:89], v[212:213], v[212:213], v[88:89]
  v_add_f32 v76, v84, v85
  v_pk_fma_f32 v[88:89], v[214:215], v[214:215], v[88:89]
  v_add_f32 v77, v88, v89
  s_waitcnt vmcnt(7)
  v_lshlrev_b32 v216, 16, v80
  v_and_b32 v217, s70, v80
  v_lshlrev_b32 v218, 16, v81
  v_and_b32 v219, s70, v81
  v_lshlrev_b32 v220, 16, v82
  v_and_b32 v221, s70, v82
  v_lshlrev_b32 v222, 16, v83
  v_and_b32 v223, s70, v83
  v_pk_add_f32 v[84:85], v[216:217], v[218:219]
  v_pk_mul_f32 v[88:89], v[216:217], v[216:217]
  v_pk_add_f32 v[86:87], v[220:221], v[222:223]
  v_pk_fma_f32 v[88:89], v[218:219], v[218:219], v[88:89]
  v_pk_add_f32 v[84:85], v[84:85], v[86:87]
  v_pk_fma_f32 v[88:89], v[220:221], v[220:221], v[88:89]
  v_add_f32 v80, v84, v85
  v_pk_fma_f32 v[88:89], v[222:223], v[222:223], v[88:89]
  v_add_f32 v81, v88, v89
  buffer_load_dwordx4 v12, s[8:11], s27 offen offset:2048 lds
  buffer_load_dwordx4 v13, s[8:11], s27 offen offset:3072 lds
  v_permlane32_swap_b32 v52, v68
  s_add_u32 m0, s26, 20480
  s_add_u32 s27, s28, 262144
  buffer_load_dwordx4 v10, s[8:11], s27 offen offset:0 lds
  v_permlane32_swap_b32 v56, v72
  v_permlane32_swap_b32 v60, v76
  v_permlane32_swap_b32 v64, v80
  v_permlane32_swap_b32 v53, v69
  v_permlane32_swap_b32 v57, v73
  v_permlane32_swap_b32 v61, v77
  v_permlane32_swap_b32 v65, v81
  v_add_f32 v52, v52, v68
  v_add_f32 v56, v56, v72
  v_add_f32 v60, v60, v76
  v_add_f32 v64, v64, v80
  buffer_load_dwordx4 v11, s[8:11], s27 offen offset:1024 lds
  v_add_f32 v53, v53, v69
  v_add_f32 v57, v57, v73
  v_add_f32 v61, v61, v77
  v_add_f32 v65, v65, v81
  v_permlane16_swap_b32 v52, v60
  v_permlane16_swap_b32 v56, v64
  v_permlane16_swap_b32 v53, v61
  v_permlane16_swap_b32 v57, v65
  v_add_f32 v52, v52, v60
  v_add_f32 v56, v56, v64
  v_add_f32 v53, v53, v61
  buffer_load_dwordx4 v12, s[8:11], s27 offen offset:2048 lds
  v_add_f32 v57, v57, v65
  v_add_f32_dpp v52, v52, v52 row_ror:8 row_mask:0xf bank_mask:0xf
  v_add_f32_dpp v56, v56, v56 row_ror:8 row_mask:0xf bank_mask:0xf
  v_add_f32_dpp v53, v53, v53 row_ror:8 row_mask:0xf bank_mask:0xf
  v_add_f32_dpp v57, v57, v57 row_ror:8 row_mask:0xf bank_mask:0xf
  v_add_f32_dpp v52, v52, v52 row_ror:4 row_mask:0xf bank_mask:0xf
  v_add_f32_dpp v56, v56, v56 row_ror:4 row_mask:0xf bank_mask:0xf
  v_add_f32_dpp v53, v53, v53 row_ror:4 row_mask:0xf bank_mask:0xf
  v_add_f32_dpp v57, v57, v57 row_ror:4 row_mask:0xf bank_mask:0xf
  v_add_f32_dpp v52, v52, v52 row_ror:2 row_mask:0xf bank_mask:0xf
  v_add_f32_dpp v56, v56, v56 row_ror:2 row_mask:0xf bank_mask:0xf
  buffer_load_dwordx4 v13, s[8:11], s27 offen offset:3072 lds
  v_add_f32_dpp v53, v53, v53 row_ror:2 row_mask:0xf bank_mask:0xf
  v_add_f32_dpp v57, v57, v57 row_ror:2 row_mask:0xf bank_mask:0xf
  v_add_f32_dpp v52, v52, v52 row_ror:1 row_mask:0xf bank_mask:0xf
  v_add_f32_dpp v56, v56, v56 row_ror:1 row_mask:0xf bank_mask:0xf
  v_add_f32_dpp v53, v53, v53 row_ror:1 row_mask:0xf bank_mask:0xf
  v_add_f32_dpp v57, v57, v57 row_ror:1 row_mask:0xf bank_mask:0xf
  v_mul_f32 v52, 0x3b000000, v52
  v_mul_f32 v56, 0x3b000000, v56
  v_mul_f32 v53, 0x3b000000, v53
  v_mul_f32 v57, 0x3b000000, v57
  v_fma_f32 v53, -v52, v52, v53
  s_add_u32 m0, s26, 0
  s_add_u32 s27, s28, 128
  buffer_load_dwordx4 v10, s[8:11], s27 offen offset:0 lds
  v_fma_f32 v57, -v56, v56, v57
  v_max_f32 v53, 0, v53
  v_max_f32 v57, 0, v57
  v_add_f32 v53, 0x3727c5ac, v53
  v_add_f32 v57, 0x3727c5ac, v57
  v_rsq_f32 v53, v53
  v_rsq_f32 v57, v57
  v_mul_f32 v53, 0x3e0293ee, v53
  v_mul_f32 v57, 0x3e0293ee, v57
  v_mul_f32_e64 v52, -v52, v53
  v_mul_f32_e64 v56, -v56, v57
  buffer_load_dwordx4 v11, s[8:11], s27 offen offset:1024 lds
  v_readlane_b32 s40, v53, 0
  v_readlane_b32 s41, v52, 0
  v_readlane_b32 s44, v53, 16
  v_readlane_b32 s45, v52, 16
  v_readlane_b32 s48, v53, 32
  v_readlane_b32 s49, v52, 32
  v_readlane_b32 s52, v53, 48
  v_readlane_b32 s53, v52, 48
  v_readlane_b32 s42, v57, 0
  v_readlane_b32 s43, v56, 0
  v_readlane_b32 s46, v57, 16
  buffer_load_dwordx4 v12, s[8:11], s27 offen offset:2048 lds
  v_readlane_b32 s47, v56, 16
  v_readlane_b32 s50, v57, 32
  v_readlane_b32 s51, v56, 32
  v_readlane_b32 s54, v57, 48
  v_readlane_b32 s55, v56, 48
  v_pk_fma_f32 v[160:161], v[160:161], s[40:41], s[40:41] op_sel:[0,0,1] op_sel_hi:[1,0,1]
  v_pk_fma_f32 v[162:163], v[162:163], s[40:41], s[40:41] op_sel:[0,0,1] op_sel_hi:[1,0,1]
  v_pk_fma_f32 v[164:165], v[164:165], s[40:41], s[40:41] op_sel:[0,0,1] op_sel_hi:[1,0,1]
  v_pk_fma_f32 v[166:167], v[166:167], s[40:41], s[40:41] op_sel:[0,0,1] op_sel_hi:[1,0,1]
  v_pk_fma_f32 v[168:169], v[168:169], s[42:43], s[42:43] op_sel:[0,0,1] op_sel_hi:[1,0,1]
  v_pk_fma_f32 v[170:171], v[170:171], s[42:43], s[42:43] op_sel:[0,0,1] op_sel_hi:[1,0,1]
  buffer_load_dwordx4 v13, s[8:11], s27 offen offset:3072 lds
  v_pk_fma_f32 v[172:173], v[172:173], s[42:43], s[42:43] op_sel:[0,0,1] op_sel_hi:[1,0,1]
  v_pk_fma_f32 v[174:175], v[174:175], s[42:43], s[42:43] op_sel:[0,0,1] op_sel_hi:[1,0,1]
  v_pk_fma_f32 v[176:177], v[176:177], s[44:45], s[44:45] op_sel:[0,0,1] op_sel_hi:[1,0,1]
  v_pk_fma_f32 v[178:179], v[178:179], s[44:45], s[44:45] op_sel:[0,0,1] op_sel_hi:[1,0,1]
  v_pk_fma_f32 v[180:181], v[180:181], s[44:45], s[44:45] op_sel:[0,0,1] op_sel_hi:[1,0,1]
  v_pk_fma_f32 v[182:183], v[182:183], s[44:45], s[44:45] op_sel:[0,0,1] op_sel_hi:[1,0,1]
  v_pk_fma_f32 v[184:185], v[184:185], s[46:47], s[46:47] op_sel:[0,0,1] op_sel_hi:[1,0,1]
  v_pk_fma_f32 v[186:187], v[186:187], s[46:47], s[46:47] op_sel:[0,0,1] op_sel_hi:[1,0,1]
  v_pk_fma_f32 v[188:189], v[188:189], s[46:47], s[46:47] op_sel:[0,0,1] op_sel_hi:[1,0,1]
  v_pk_fma_f32 v[190:191], v[190:191], s[46:47], s[46:47] op_sel:[0,0,1] op_sel_hi:[1,0,1]
  v_pk_fma_f32 v[192:193], v[192:193], s[48:49], s[48:49] op_sel:[0,0,1] op_sel_hi:[1,0,1]
  s_add_u32 m0, s26, 4096
  s_add_u32 s27, s28, 262272
  buffer_load_dwordx4 v10, s[8:11], s27 offen offset:0 lds
  v_pk_fma_f32 v[194:195], v[194:195], s[48:49], s[48:49] op_sel:[0,0,1] op_sel_hi:[1,0,1]
  v_pk_fma_f32 v[196:197], v[196:197], s[48:49], s[48:49] op_sel:[0,0,1] op_sel_hi:[1,0,1]
  v_pk_fma_f32 v[198:199], v[198:199], s[48:49], s[48:49] op_sel:[0,0,1] op_sel_hi:[1,0,1]
  v_pk_fma_f32 v[200:201], v[200:201], s[50:51], s[50:51] op_sel:[0,0,1] op_sel_hi:[1,0,1]
  v_pk_fma_f32 v[202:203], v[202:203], s[50:51], s[50:51] op_sel:[0,0,1] op_sel_hi:[1,0,1]
  v_pk_fma_f32 v[204:205], v[204:205], s[50:51], s[50:51] op_sel:[0,0,1] op_sel_hi:[1,0,1]
  v_pk_fma_f32 v[206:207], v[206:207], s[50:51], s[50:51] op_sel:[0,0,1] op_sel_hi:[1,0,1]
  v_pk_fma_f32 v[208:209], v[208:209], s[52:53], s[52:53] op_sel:[0,0,1] op_sel_hi:[1,0,1]
  v_pk_fma_f32 v[210:211], v[210:211], s[52:53], s[52:53] op_sel:[0,0,1] op_sel_hi:[1,0,1]
  v_pk_fma_f32 v[212:213], v[212:213], s[52:53], s[52:53] op_sel:[0,0,1] op_sel_hi:[1,0,1]
  v_pk_fma_f32 v[214:215], v[214:215], s[52:53], s[52:53] op_sel:[0,0,1] op_sel_hi:[1,0,1]
  buffer_load_dwordx4 v11, s[8:11], s27 offen offset:1024 lds
  v_pk_fma_f32 v[216:217], v[216:217], s[54:55], s[54:55] op_sel:[0,0,1] op_sel_hi:[1,0,1]
  v_pk_fma_f32 v[218:219], v[218:219], s[54:55], s[54:55] op_sel:[0,0,1] op_sel_hi:[1,0,1]
  v_pk_fma_f32 v[220:221], v[220:221], s[54:55], s[54:55] op_sel:[0,0,1] op_sel_hi:[1,0,1]
  v_pk_fma_f32 v[222:223], v[222:223], s[54:55], s[54:55] op_sel:[0,0,1] op_sel_hi:[1,0,1]
  s_load_dwordx2 s[40:41], s[0:1], 32
  s_mov_b32 s42, 4194304
  s_mov_b32 s43, 0x20000
  s_load_dwordx2 s[44:45], s[0:1], 48
  s_mov_b32 s46, 1835008
  s_mov_b32 s47, 0x20000
  s_load_dwordx2 s[48:49], s[0:1], 56
  s_mov_b32 s50, 1835008
  s_mov_b32 s51, 0x20000
  s_load_dwordx2 s[52:53], s[0:1], 80
  s_mov_b32 s54, 2097152
  s_mov_b32 s55, 0x20000
  s_load_dwordx2 s[56:57], s[0:1], 72
  s_mov_b32 s58, 3145728
  s_mov_b32 s59, 0x20000
  s_waitcnt vmcnt(17)
  v_xor_b32 v84, s30, v225
  v_bitop3_b32 v84, v84, v227, s30 bitop3:0xf6
  s_waitcnt vmcnt(16)
  v_bitop3_b32 v84, v84, v229, s30 bitop3:0xf6
  v_bitop3_b32 v84, v84, v231, s30 bitop3:0xf6
  s_waitcnt vmcnt(15)
  v_bitop3_b32 v84, v84, v233, s30 bitop3:0xf6
  v_bitop3_b32 v84, v84, v235, s30 bitop3:0xf6
  s_waitcnt vmcnt(14)
  v_bitop3_b32 v84, v84, v237, s30 bitop3:0xf6
  v_bitop3_b32 v84, v84, v239, s30 bitop3:0xf6
  v_cmp_ne_u32 vcc, 0, v84
  s_nop 1
  s_cbranch_vccnz Lchk1_retry
Lchk1:
  v_and_b32 v225, s70, v224
  v_lshlrev_b32 v224, 16, v224
  v_and_b32 v227, s70, v226
  v_lshlrev_b32 v226, 16, v226
  v_and_b32 v229, s70, v228
  v_lshlrev_b32 v228, 16, v228
  v_and_b32 v231, s70, v230
  v_lshlrev_b32 v230, 16, v230
  v_and_b32 v233, s70, v232
  v_lshlrev_b32 v232, 16, v232
  v_and_b32 v235, s70, v234
  v_lshlrev_b32 v234, 16, v234
  v_and_b32 v237, s70, v236
  v_lshlrev_b32 v236, 16, v236
  v_and_b32 v239, s70, v238
  v_lshlrev_b32 v238, 16, v238
  s_mov_b32 s34, 0x3e0293ee
  v_pk_mul_f32 v[232:233], v[232:233], s[34:35] op_sel_hi:[1,0]
  v_pk_mul_f32 v[234:235], v[234:235], s[34:35] op_sel_hi:[1,0]
  v_pk_mul_f32 v[236:237], v[236:237], s[34:35] op_sel_hi:[1,0]
  v_pk_mul_f32 v[238:239], v[238:239], s[34:35] op_sel_hi:[1,0]
  v_pk_fma_f32 v[96:97], v[96:97], v[224:225], v[232:233]
  v_pk_fma_f32 v[98:99], v[98:99], v[226:227], v[234:235]
  v_pk_fma_f32 v[100:101], v[100:101], v[228:229], v[236:237]
  v_pk_fma_f32 v[102:103], v[102:103], v[230:231], v[238:239]
  v_cvt_pk_bf16_f32 v68, v96, v97
  v_cvt_pk_bf16_f32 v69, v98, v99
  v_cvt_pk_bf16_f32 v70, v100, v101
  v_cvt_pk_bf16_f32 v71, v102, v103
  ds_write_b128 v90, v[68:71]
  buffer_load_dwordx4 v12, s[8:11], s27 offen offset:2048 lds
  v_pk_fma_f32 v[104:105], v[104:105], v[224:225], v[232:233]
  v_pk_fma_f32 v[106:107], v[106:107], v[226:227], v[234:235]
  v_pk_fma_f32 v[108:109], v[108:109], v[228:229], v[236:237]
  v_pk_fma_f32 v[110:111], v[110:111], v[230:231], v[238:239]
  v_cvt_pk_bf16_f32 v72, v104, v105
  v_cvt_pk_bf16_f32 v73, v106, v107
  v_cvt_pk_bf16_f32 v74, v108, v109
  v_cvt_pk_bf16_f32 v75, v110, v111
  ds_write_b128 v91, v[72:75]
  buffer_load_dwordx4 v13, s[8:11], s27 offen offset:3072 lds
  v_pk_fma_f32 v[112:113], v[112:113], v[224:225], v[232:233]
  v_pk_fma_f32 v[114:115], v[114:115], v[226:227], v[234:235]
  v_pk_fma_f32 v[116:117], v[116:117], v[228:229], v[236:237]
  v_pk_fma_f32 v[118:119], v[118:119], v[230:231], v[238:239]
  v_cvt_pk_bf16_f32 v76, v112, v113
  v_cvt_pk_bf16_f32 v77, v114, v115
  v_cvt_pk_bf16_f32 v78, v116, v117
  v_cvt_pk_bf16_f32 v79, v118, v119
  ds_write_b128 v92, v[76:79]
  s_add_u32 m0, s26, 8192
  s_add_u32 s27, s28, 524288
  buffer_load_dwordx4 v10, s[8:11], s27 offen offset:0 lds
  v_pk_fma_f32 v[120:121], v[120:121], v[224:225], v[232:233]
  v_pk_fma_f32 v[122:123], v[122:123], v[226:227], v[234:235]
  v_pk_fma_f32 v[124:125], v[124:125], v[228:229], v[236:237]
  v_pk_fma_f32 v[126:127], v[126:127], v[230:231], v[238:239]
  v_cvt_pk_bf16_f32 v80, v120, v121
  v_cvt_pk_bf16_f32 v81, v122, v123
  v_cvt_pk_bf16_f32 v82, v124, v125
  v_cvt_pk_bf16_f32 v83, v126, v127
  ds_write_b128 v93, v[80:83]
  buffer_load_dwordx4 v11, s[8:11], s27 offen offset:1024 lds
  v_pk_fma_f32 v[128:129], v[128:129], v[224:225], v[232:233]
  v_pk_fma_f32 v[130:131], v[130:131], v[226:227], v[234:235]
  v_pk_fma_f32 v[132:133], v[132:133], v[228:229], v[236:237]
  v_pk_fma_f32 v[134:135], v[134:135], v[230:231], v[238:239]
  v_cvt_pk_bf16_f32 v68, v128, v129
  v_cvt_pk_bf16_f32 v69, v130, v131
  v_cvt_pk_bf16_f32 v70, v132, v133
  v_cvt_pk_bf16_f32 v71, v134, v135
  ds_write_b128 v94, v[68:71]
  buffer_load_dwordx4 v12, s[8:11], s27 offen offset:2048 lds
  v_pk_fma_f32 v[136:137], v[136:137], v[224:225], v[232:233]
  v_pk_fma_f32 v[138:139], v[138:139], v[226:227], v[234:235]
  v_pk_fma_f32 v[140:141], v[140:141], v[228:229], v[236:237]
  v_pk_fma_f32 v[142:143], v[142:143], v[230:231], v[238:239]
  v_cvt_pk_bf16_f32 v72, v136, v137
  v_cvt_pk_bf16_f32 v73, v138, v139
  v_cvt_pk_bf16_f32 v74, v140, v141
  v_cvt_pk_bf16_f32 v75, v142, v143
  ds_write_b128 v95, v[72:75]
  buffer_load_dwordx4 v13, s[8:11], s27 offen offset:3072 lds
  v_pk_fma_f32 v[144:145], v[144:145], v[224:225], v[232:233]
  v_pk_fma_f32 v[146:147], v[146:147], v[226:227], v[234:235]
  v_pk_fma_f32 v[148:149], v[148:149], v[228:229], v[236:237]
  v_pk_fma_f32 v[150:151], v[150:151], v[230:231], v[238:239]
  v_cvt_pk_bf16_f32 v76, v144, v145
  v_cvt_pk_bf16_f32 v77, v146, v147
  v_cvt_pk_bf16_f32 v78, v148, v149
  v_cvt_pk_bf16_f32 v79, v150, v151
  ds_write_b128 v244, v[76:79]
  s_add_u32 m0, s26, 12288
  s_add_u32 s27, s28, 786432
  buffer_load_dwordx4 v10, s[8:11], s27 offen offset:0 lds
  v_pk_fma_f32 v[152:153], v[152:153], v[224:225], v[232:233]
  v_pk_fma_f32 v[154:155], v[154:155], v[226:227], v[234:235]
  v_pk_fma_f32 v[156:157], v[156:157], v[228:229], v[236:237]
  v_pk_fma_f32 v[158:159], v[158:159], v[230:231], v[238:239]
  v_cvt_pk_bf16_f32 v80, v152, v153
  v_cvt_pk_bf16_f32 v81, v154, v155
  v_cvt_pk_bf16_f32 v82, v156, v157
  v_cvt_pk_bf16_f32 v83, v158, v159
  ds_write_b128 v245, v[80:83]
  buffer_load_dwordx4 v11, s[8:11], s27 offen offset:1024 lds
  v_pk_fma_f32 v[160:161], v[160:161], v[224:225], v[232:233]
  v_pk_fma_f32 v[162:163], v[162:163], v[226:227], v[234:235]
  v_pk_fma_f32 v[164:165], v[164:165], v[228:229], v[236:237]
  v_pk_fma_f32 v[166:167], v[166:167], v[230:231], v[238:239]
  v_cvt_pk_bf16_f32 v68, v160, v161
  v_cvt_pk_bf16_f32 v69, v162, v163
  v_cvt_pk_bf16_f32 v70, v164, v165
  v_cvt_pk_bf16_f32 v71, v166, v167
  ds_write_b128 v246, v[68:71]
  buffer_load_dwordx4 v12, s[8:11], s27 offen offset:2048 lds
  v_pk_fma_f32 v[168:169], v[168:169], v[224:225], v[232:233]
  v_pk_fma_f32 v[170:171], v[170:171], v[226:227], v[234:235]
  v_pk_fma_f32 v[172:173], v[172:173], v[228:229], v[236:237]
  v_pk_fma_f32 v[174:175], v[174:175], v[230:231], v[238:239]
  v_cvt_pk_bf16_f32 v72, v168, v169
  v_cvt_pk_bf16_f32 v73, v170, v171
  v_cvt_pk_bf16_f32 v74, v172, v173
  v_cvt_pk_bf16_f32 v75, v174, v175
  ds_write_b128 v247, v[72:75]
  buffer_load_dwordx4 v13, s[8:11], s27 offen offset:3072 lds
  v_pk_fma_f32 v[176:177], v[176:177], v[224:225], v[232:233]
  v_pk_fma_f32 v[178:179], v[178:179], v[226:227], v[234:235]
  v_pk_fma_f32 v[180:181], v[180:181], v[228:229], v[236:237]
  v_pk_fma_f32 v[182:183], v[182:183], v[230:231], v[238:239]
  v_cvt_pk_bf16_f32 v76, v176, v177
  v_cvt_pk_bf16_f32 v77, v178, v179
  v_cvt_pk_bf16_f32 v78, v180, v181
  v_cvt_pk_bf16_f32 v79, v182, v183
  ds_write_b128 v248, v[76:79]
  v_pk_fma_f32 v[184:185], v[184:185], v[224:225], v[232:233]
  v_pk_fma_f32 v[186:187], v[186:187], v[226:227], v[234:235]
  v_pk_fma_f32 v[188:189], v[188:189], v[228:229], v[236:237]
  v_pk_fma_f32 v[190:191], v[190:191], v[230:231], v[238:239]
  v_cvt_pk_bf16_f32 v80, v184, v185
  v_cvt_pk_bf16_f32 v81, v186, v187
  v_cvt_pk_bf16_f32 v82, v188, v189
  v_cvt_pk_bf16_f32 v83, v190, v191
  ds_write_b128 v249, v[80:83]
  v_pk_fma_f32 v[192:193], v[192:193], v[224:225], v[232:233]
  v_pk_fma_f32 v[194:195], v[194:195], v[226:227], v[234:235]
  v_pk_fma_f32 v[196:197], v[196:197], v[228:229], v[236:237]
  v_pk_fma_f32 v[198:199], v[198:199], v[230:231], v[238:239]
  v_cvt_pk_bf16_f32 v68, v192, v193
  v_cvt_pk_bf16_f32 v69, v194, v195
  v_cvt_pk_bf16_f32 v70, v196, v197
  v_cvt_pk_bf16_f32 v71, v198, v199
  ds_write_b128 v250, v[68:71]
  v_pk_fma_f32 v[200:201], v[200:201], v[224:225], v[232:233]
  v_pk_fma_f32 v[202:203], v[202:203], v[226:227], v[234:235]
  v_pk_fma_f32 v[204:205], v[204:205], v[228:229], v[236:237]
  v_pk_fma_f32 v[206:207], v[206:207], v[230:231], v[238:239]
  v_cvt_pk_bf16_f32 v72, v200, v201
  v_cvt_pk_bf16_f32 v73, v202, v203
  v_cvt_pk_bf16_f32 v74, v204, v205
  v_cvt_pk_bf16_f32 v75, v206, v207
  ds_write_b128 v251, v[72:75]
  v_pk_fma_f32 v[208:209], v[208:209], v[224:225], v[232:233]
  v_pk_fma_f32 v[210:211], v[210:211], v[226:227], v[234:235]
  v_pk_fma_f32 v[212:213], v[212:213], v[228:229], v[236:237]
  v_pk_fma_f32 v[214:215], v[214:215], v[230:231], v[238:239]
  v_cvt_pk_bf16_f32 v76, v208, v209
  v_cvt_pk_bf16_f32 v77, v210, v211
  v_cvt_pk_bf16_f32 v78, v212, v213
  v_cvt_pk_bf16_f32 v79, v214, v215
  ds_write_b128 v252, v[76:79]
  v_pk_fma_f32 v[216:217], v[216:217], v[224:225], v[232:233]
  v_pk_fma_f32 v[218:219], v[218:219], v[226:227], v[234:235]
  v_pk_fma_f32 v[220:221], v[220:221], v[228:229], v[236:237]
  v_pk_fma_f32 v[222:223], v[222:223], v[230:231], v[238:239]
  v_cvt_pk_bf16_f32 v80, v216, v217
  v_cvt_pk_bf16_f32 v81, v218, v219
  v_cvt_pk_bf16_f32 v82, v220, v221
  v_cvt_pk_bf16_f32 v83, v222, v223
  ds_write_b128 v253, v[80:83]
  s_mov_b64 exec, 0xffffff00
  buffer_load_dword a254, v242, s[8:11], s69 offen
  s_mov_b64 exec, -1
  s_lshl_b32 s61, s99, 2
  s_add_u32 s61, s61, s3
  s_lshl_b32 s61, s61, 10
  s_and_b32 s61, s61, 0xffff
  s_lshr_b32 s60, s25, 0
  s_lshl_b32 s60, s60, 2
  s_add_u32 s60, s60, s3
  s_lshl_b32 s60, s60, 10
  v_lshlrev_b32 v17, 7, v1
  v_add_u32 v15, s61, v17
  v_min_u32 v15, L_hot_end-L_pg0, v15
  s_add_u32 s60, s60, s29
  s_add_u32 s60, s60, 393216
  s_mov_b64 exec, 0xff
  global_load_dword a251, v15, s[38:39]
  s_mov_b64 exec, 0xff
  buffer_load_dword a253, v17, s[12:15], s60 offen
  buffer_load_dword a252, v17, s[16:19], s60 offen
  s_mov_b64 exec, -1
  s_waitcnt vmcnt(20)
  ds_read_b64_tr_b16 a[0:1], v2 offset:16384
  ds_read_b64_tr_b16 a[2:3], v2 offset:16896
  ds_read_b64_tr_b16 a[8:9], v3 offset:16384
  ds_read_b64_tr_b16 a[10:11], v3 offset:16896
  ds_read_b64_tr_b16 a[16:17], v4 offset:16384
  ds_read_b64_tr_b16 a[18:19], v4 offset:16896
  ds_read_b64_tr_b16 a[24:25], v5 offset:16384
  ds_read_b64_tr_b16 a[26:27], v5 offset:16896
  ds_read_b64_tr_b16 a[4:5], v2 offset:20480
  ds_read_b64_tr_b16 a[6:7], v2 offset:20992
  ds_read_b64_tr_b16 a[12:13], v3 offset:20480
  ds_read_b64_tr_b16 a[14:15], v3 offset:20992
  ds_read_b64_tr_b16 a[20:21], v4 offset:20480
  ds_read_b64_tr_b16 a[22:23], v4 offset:20992
  ds_read_b64_tr_b16 a[28:29], v5 offset:20480
  ds_read_b64_tr_b16 a[30:31], v5 offset:20992
  s_or_b32 s34, s2, s3
  s_cbranch_scc0 L_ep
L_noep:
  s_waitcnt lgkmcnt(0)
  s_barrier
  ds_read_b128 a[64:67], v6 offset:0
  ds_read_b128 a[68:71], v6 offset:16384
  ds_read_b128 a[72:75], v6 offset:32768
  ds_read_b128 a[76:79], v6 offset:49152
  ds_read_b128 a[80:83], v7 offset:0
  ds_read_b128 a[84:87], v7 offset:16384
  ds_read_b128 a[88:91], v7 offset:32768
  ds_read_b128 a[92:95], v7 offset:49152
  s_waitcnt lgkmcnt(7)
  v_mfma_f32_16x16x32_bf16 v[128:131], a[0:3], a[64:67], 0
  s_add_u32 m0, s26, 16384
  s_waitcnt vmcnt(16)
  ds_read_b64_tr_b16 a[32:33], v2 offset:0
  s_waitcnt lgkmcnt(4)
  v_mfma_f32_16x16x32_bf16 v[128:131], a[4:7], a[80:83], v[128:131]
  s_add_u32 s27, s28, 524416
  ds_read_b64_tr_b16 a[34:35], v2 offset:512
  s_waitcnt lgkmcnt(4)
  v_mfma_f32_16x16x32_bf16 v[132:135], a[4:7], a[84:87], 0
  buffer_load_dwordx4 v10, s[8:11], s27 offen offset:0 lds
  v_mfma_f32_16x16x32_bf16 v[132:135], a[0:3], a[68:71], v[132:135]
  ds_read_b64_tr_b16 a[40:41], v3 offset:0
  v_bfe_u32 v36, v1, 2, 2
  v_mfma_f32_16x16x32_bf16 v[136:139], a[0:3], a[72:75], 0
  ds_read_b64_tr_b16 a[42:43], v3 offset:512
  v_mul_u32_u24 v36, 24576, v36
  s_waitcnt lgkmcnt(5)
  v_mfma_f32_16x16x32_bf16 v[136:139], a[4:7], a[88:91], v[136:139]
  ds_read_b64_tr_b16 a[48:49], v4 offset:0
  v_and_b32 v38, 3, v1
  s_waitcnt lgkmcnt(5)
  v_mfma_f32_16x16x32_bf16 v[140:143], a[4:7], a[92:95], 0
  buffer_load_dwordx4 v11, s[8:11], s27 offen offset:1024 lds
  v_mfma_f32_16x16x32_bf16 v[140:143], a[0:3], a[76:79], v[140:143]
  ds_read_b64_tr_b16 a[50:51], v4 offset:512
  v_lshl_add_u32 v36, v38, 8, v36
  v_mfma_f32_16x16x32_bf16 v[156:159], a[8:11], a[76:79], 0
  ds_read_b64_tr_b16 a[56:57], v5 offset:0
  v_add_u32 v36, 65536, v36
  v_mfma_f32_16x16x32_bf16 v[156:159], a[12:15], a[92:95], v[156:159]
  ds_read_b64_tr_b16 a[58:59], v5 offset:512
  v_lshrrev_b32 v37, 5, v1
  v_mfma_f32_16x16x32_bf16 v[152:155], a[12:15], a[88:91], 0
  buffer_load_dwordx4 v12, s[8:11], s27 offen offset:2048 lds
  v_mfma_f32_16x16x32_bf16 v[152:155], a[8:11], a[72:75], v[152:155]
  ds_read_b128 a[96:99], v8 offset:0
  v_bfe_u32 v38, v1, 4, 1
  v_mfma_f32_16x16x32_bf16 v[148:151], a[8:11], a[68:71], 0
  ds_read_b128 a[100:103], v8 offset:16384
  v_lshl_add_u32 v37, v38, 1, v37
  v_mfma_f32_16x16x32_bf16 v[148:151], a[12:15], a[84:87], v[148:151]
  ds_read_b128 a[104:107], v8 offset:32768
  v_and_b32 v38, 15, v1
  v_mfma_f32_16x16x32_bf16 v[144:147], a[12:15], a[80:83], 0
  buffer_load_dwordx4 v13, s[8:11], s27 offen offset:3072 lds
  v_mfma_f32_16x16x32_bf16 v[144:147], a[8:11], a[64:67], v[144:147]
  ds_read_b128 a[108:111], v8 offset:49152
  v_mfma_f32_16x16x32_bf16 v[160:163], a[16:19], a[64:67], 0
  s_add_u32 m0, s26, 20480
  s_waitcnt vmcnt(16)
  ds_read_b64_tr_b16 a[36:37], v2 offset:4096
  v_mfma_f32_16x16x32_bf16 v[160:163], a[20:23], a[80:83], v[160:163]
  s_add_u32 s27, s28, 786560
  ds_read_b64_tr_b16 a[38:39], v2 offset:4608
  v_mfma_f32_16x16x32_bf16 v[164:167], a[20:23], a[84:87], 0
  buffer_load_dwordx4 v10, s[8:11], s27 offen offset:0 lds
  v_mfma_f32_16x16x32_bf16 v[164:167], a[16:19], a[68:71], v[164:167]
  ds_read_b64_tr_b16 a[44:45], v3 offset:4096
  v_xor_b32 v37, v37, v38
  v_mfma_f32_16x16x32_bf16 v[168:171], a[16:19], a[72:75], 0
  ds_read_b64_tr_b16 a[46:47], v3 offset:4608
  v_xor_b32 v38, 0, v37
  v_mfma_f32_16x16x32_bf16 v[168:171], a[20:23], a[88:91], v[168:171]
  ds_read_b64_tr_b16 a[52:53], v4 offset:4096
  v_lshl_add_u32 v20, v38, 4, v36
  v_mfma_f32_16x16x32_bf16 v[172:175], a[20:23], a[92:95], 0
  buffer_load_dwordx4 v11, s[8:11], s27 offen offset:1024 lds
  v_mfma_f32_16x16x32_bf16 v[172:175], a[16:19], a[76:79], v[172:175]
  ds_read_b64_tr_b16 a[54:55], v4 offset:4608
  v_xor_b32 v38, 4, v37
  v_mfma_f32_16x16x32_bf16 v[188:191], a[24:27], a[76:79], 0
  ds_read_b64_tr_b16 a[60:61], v5 offset:4096
  v_lshl_add_u32 v21, v38, 4, v36
  v_mfma_f32_16x16x32_bf16 v[188:191], a[28:31], a[92:95], v[188:191]
  ds_read_b64_tr_b16 a[62:63], v5 offset:4608
  v_xor_b32 v38, 8, v37
  v_mfma_f32_16x16x32_bf16 v[184:187], a[28:31], a[88:91], 0
  buffer_load_dwordx4 v12, s[8:11], s27 offen offset:2048 lds
  v_mfma_f32_16x16x32_bf16 v[184:187], a[24:27], a[72:75], v[184:187]
  v_lshl_add_u32 v22, v38, 4, v36
  v_xor_b32 v38, 12, v37
  v_mfma_f32_16x16x32_bf16 v[180:183], a[24:27], a[68:71], 0
  v_lshl_add_u32 v23, v38, 4, v36
  v_lshrrev_b32 v36, 4, v1
  v_mfma_f32_16x16x32_bf16 v[180:183], a[28:31], a[84:87], v[180:183]
  v_mul_u32_u24 v36, 24576, v36
  v_add_u32 v36, 67584, v36
  v_mfma_f32_16x16x32_bf16 v[176:179], a[28:31], a[80:83], 0
  buffer_load_dwordx4 v13, s[8:11], s27 offen offset:3072 lds
  v_mfma_f32_16x16x32_bf16 v[176:179], a[24:27], a[64:67], v[176:179]
  v_bfe_u32 v37, v1, 2, 2
  s_waitcnt lgkmcnt(1)
  v_mfma_f32_16x16x32_bf16 v[192:195], a[32:35], a[64:67], 0
  s_add_u32 m0, s26, 0
  s_waitcnt vmcnt(16)
  ds_read_b64_tr_b16 a[0:1], v2 offset:8192
  v_mfma_f32_16x16x32_bf16 v[192:195], a[36:39], a[80:83], v[192:195]
  s_add_u32 s27, s28, 1048576
  ds_read_b64_tr_b16 a[2:3], v2 offset:8704
  v_mfma_f32_16x16x32_bf16 v[196:199], a[36:39], a[84:87], 0
  buffer_load_dwordx4 v10, s[8:11], s27 offen offset:0 lds
  v_mfma_f32_16x16x32_bf16 v[196:199], a[32:35], a[68:71], v[196:199]
  ds_read_b64_tr_b16 a[8:9], v3 offset:8192
  v_lshl_add_u32 v36, v37, 8, v36
  v_mfma_f32_16x16x32_bf16 v[200:203], a[32:35], a[72:75], 0
  ds_read_b64_tr_b16 a[10:11], v3 offset:8704
  v_and_b32 v38, 3, v1
  v_mfma_f32_16x16x32_bf16 v[200:203], a[36:39], a[88:91], v[200:203]
  ds_read_b64_tr_b16 a[16:17], v4 offset:8192
  v_lshl_add_u32 v36, v38, 3, v36
  v_mfma_f32_16x16x32_bf16 v[204:207], a[36:39], a[92:95], 0
  buffer_load_dwordx4 v11, s[8:11], s27 offen offset:1024 lds
  v_mfma_f32_16x16x32_bf16 v[204:207], a[32:35], a[76:79], v[204:207]
  ds_read_b64_tr_b16 a[18:19], v4 offset:8704
  v_bfe_u32 v37, v1, 2, 3
  v_mfma_f32_16x16x32_bf16 v[220:223], a[40:43], a[76:79], 0
  ds_read_b64_tr_b16 a[24:25], v5 offset:8192
  v_xor_b32 v38, 0, v37
  v_mfma_f32_16x16x32_bf16 v[220:223], a[44:47], a[92:95], v[220:223]
  ds_read_b64_tr_b16 a[26:27], v5 offset:8704
  v_lshl_add_u32 v24, v38, 5, v36
  v_mfma_f32_16x16x32_bf16 v[216:219], a[44:47], a[88:91], 0
  buffer_load_dwordx4 v12, s[8:11], s27 offen offset:2048 lds
  v_mfma_f32_16x16x32_bf16 v[216:219], a[40:43], a[72:75], v[216:219]
  ds_read_b128 a[112:115], v9 offset:0
  v_xor_b32 v38, 1, v37
  v_mfma_f32_16x16x32_bf16 v[212:215], a[40:43], a[68:71], 0
  ds_read_b128 a[116:119], v9 offset:16384
  v_lshl_add_u32 v25, v38, 5, v36
  v_mfma_f32_16x16x32_bf16 v[212:215], a[44:47], a[84:87], v[212:215]
  ds_read_b128 a[120:123], v9 offset:32768
  v_xor_b32 v38, 2, v37
  v_mfma_f32_16x16x32_bf16 v[208:211], a[44:47], a[80:83], 0
  buffer_load_dwordx4 v13, s[8:11], s27 offen offset:3072 lds
  v_mfma_f32_16x16x32_bf16 v[208:211], a[40:43], a[64:67], v[208:211]
  s_waitcnt lgkmcnt(7)
  ds_read_b128 a[124:127], v9 offset:49152
  v_mfma_f32_16x16x32_bf16 v[224:227], a[48:51], a[64:67], 0
  s_add_u32 m0, s26, 4096
  s_waitcnt vmcnt(16)
  ds_read_b64_tr_b16 a[4:5], v2 offset:12288
  v_mfma_f32_16x16x32_bf16 v[224:227], a[52:55], a[80:83], v[224:227]
  s_add_u32 s27, s28, 1310720
  ds_read_b64_tr_b16 a[6:7], v2 offset:12800
  v_mfma_f32_16x16x32_bf16 v[228:231], a[52:55], a[84:87], 0
  buffer_load_dwordx4 v10, s[8:11], s27 offen offset:0 lds
  v_mfma_f32_16x16x32_bf16 v[228:231], a[48:51], a[68:71], v[228:231]
  ds_read_b64_tr_b16 a[12:13], v3 offset:12288
  v_lshl_add_u32 v26, v38, 5, v36
  v_mfma_f32_16x16x32_bf16 v[232:235], a[48:51], a[72:75], 0
  ds_read_b64_tr_b16 a[14:15], v3 offset:12800
  v_xor_b32 v38, 3, v37
  v_mfma_f32_16x16x32_bf16 v[232:235], a[52:55], a[88:91], v[232:235]
  ds_read_b64_tr_b16 a[20:21], v4 offset:12288
  v_lshl_add_u32 v27, v38, 5, v36
  v_mfma_f32_16x16x32_bf16 v[236:239], a[52:55], a[92:95], 0
  buffer_load_dwordx4 v11, s[8:11], s27 offen offset:1024 lds
  v_mfma_f32_16x16x32_bf16 v[236:239], a[48:51], a[76:79], v[236:239]
  ds_read_b64_tr_b16 a[22:23], v4 offset:12800
  v_xor_b32 v38, 4, v37
  v_mfma_f32_16x16x32_bf16 v[252:255], a[56:59], a[76:79], 0
  ds_read_b64_tr_b16 a[28:29], v5 offset:12288
  v_lshl_add_u32 v28, v38, 5, v36
  v_mfma_f32_16x16x32_bf16 v[252:255], a[60:63], a[92:95], v[252:255]
  ds_read_b64_tr_b16 a[30:31], v5 offset:12800
  v_xor_b32 v38, 5, v37
  v_mfma_f32_16x16x32_bf16 v[248:251], a[60:63], a[88:91], 0
  buffer_load_dwordx4 v12, s[8:11], s27 offen offset:2048 lds
  v_mfma_f32_16x16x32_bf16 v[248:251], a[56:59], a[72:75], v[248:251]
  v_lshl_add_u32 v29, v38, 5, v36
  v_xor_b32 v38, 6, v37
  v_mfma_f32_16x16x32_bf16 v[244:247], a[56:59], a[68:71], 0
  v_lshl_add_u32 v30, v38, 5, v36
  v_xor_b32 v38, 7, v37
  v_mfma_f32_16x16x32_bf16 v[244:247], a[60:63], a[84:87], v[244:247]
  v_lshl_add_u32 v31, v38, 5, v36
  s_lshl_b32 s34, s3, 2
  v_mfma_f32_16x16x32_bf16 v[240:243], a[60:63], a[80:83], 0
  buffer_load_dwordx4 v13, s[8:11], s27 offen offset:3072 lds
  v_mfma_f32_16x16x32_bf16 v[240:243], a[56:59], a[64:67], v[240:243]
  v_lshrrev_b32 v36, 4, v1
  s_waitcnt lgkmcnt(1)
  v_mfma_f32_16x16x32_bf16 v[128:131], a[0:3], a[96:99], v[128:131]
  s_add_u32 m0, s26, 8192
  s_waitcnt vmcnt(12)
  ds_read_b64_tr_b16 a[32:33], v2 offset:16384
  v_mfma_f32_16x16x32_bf16 v[128:131], a[4:7], a[112:115], v[128:131]
  s_add_u32 s27, s28, 1048704
  ds_read_b64_tr_b16 a[34:35], v2 offset:16896
  v_mfma_f32_16x16x32_bf16 v[132:135], a[4:7], a[116:119], v[132:135]
  buffer_load_dwordx4 v10, s[8:11], s27 offen offset:0 lds
  v_mfma_f32_16x16x32_bf16 v[132:135], a[0:3], a[100:103], v[132:135]
  ds_read_b64_tr_b16 a[40:41], v3 offset:16384
  v_add_u32 v37, s34, v36
  v_mfma_f32_16x16x32_bf16 v[136:139], a[0:3], a[104:107], v[136:139]
  ds_read_b64_tr_b16 a[42:43], v3 offset:16896
  v_and_b32 v38, 15, v1
  v_mfma_f32_16x16x32_bf16 v[136:139], a[4:7], a[120:123], v[136:139]
  ds_read_b64_tr_b16 a[48:49], v4 offset:16384
  v_xor_b32 v39, v38, v37
  v_mfma_f32_16x16x32_bf16 v[140:143], a[4:7], a[124:127], v[140:143]
  buffer_load_dwordx4 v11, s[8:11], s27 offen offset:1024 lds
  v_mfma_f32_16x16x32_bf16 v[140:143], a[0:3], a[108:111], v[140:143]
  ds_read_b64_tr_b16 a[50:51], v4 offset:16896
  v_lshlrev_b32 v39, 4, v39
  v_mfma_f32_16x16x32_bf16 v[156:159], a[8:11], a[108:111], v[156:159]
  ds_read_b64_tr_b16 a[56:57], v5 offset:16384
  v_lshl_add_u32 v39, v37, 8, v39
  v_mfma_f32_16x16x32_bf16 v[156:159], a[12:15], a[124:127], v[156:159]
  ds_read_b64_tr_b16 a[58:59], v5 offset:16896
  v_add_u32 v32, 393216, v39
  v_mfma_f32_16x16x32_bf16 v[152:155], a[12:15], a[120:123], v[152:155]
  buffer_load_dwordx4 v12, s[8:11], s27 offen offset:2048 lds
  v_mfma_f32_16x16x32_bf16 v[152:155], a[8:11], a[104:107], v[152:155]
  ds_read_b128 a[64:67], v6 offset:256
  v_and_b32 v36, 7, v37
  v_mfma_f32_16x16x32_bf16 v[148:151], a[8:11], a[100:103], v[148:151]
  ds_read_b128 a[68:71], v6 offset:16640
  v_lshlrev_b32 v36, 1, v36
  v_mfma_f32_16x16x32_bf16 v[148:151], a[12:15], a[116:119], v[148:151]
  ds_read_b128 a[72:75], v6 offset:33024
  v_xor_b32 v39, v38, v36
  v_mfma_f32_16x16x32_bf16 v[144:147], a[12:15], a[112:115], v[144:147]
  buffer_load_dwordx4 v13, s[8:11], s27 offen offset:3072 lds
  v_mfma_f32_16x16x32_bf16 v[144:147], a[8:11], a[96:99], v[144:147]
  s_waitcnt lgkmcnt(7)
  ds_read_b128 a[76:79], v6 offset:49408
  v_mfma_f32_16x16x32_bf16 v[160:163], a[16:19], a[96:99], v[160:163]
  s_add_u32 m0, s26, 12288
  s_waitcnt vmcnt(12)
  ds_read_b64_tr_b16 a[36:37], v2 offset:20480
  v_mfma_f32_16x16x32_bf16 v[160:163], a[20:23], a[112:115], v[160:163]
  s_add_u32 s27, s28, 1310848
  ds_read_b64_tr_b16 a[38:39], v2 offset:20992
  v_mfma_f32_16x16x32_bf16 v[164:167], a[20:23], a[116:119], v[164:167]
  buffer_load_dwordx4 v10, s[8:11], s27 offen offset:0 lds
  v_mfma_f32_16x16x32_bf16 v[164:167], a[16:19], a[100:103], v[164:167]
  ds_read_b64_tr_b16 a[44:45], v3 offset:20480
  v_lshlrev_b32 v39, 4, v39
  v_mfma_f32_16x16x32_bf16 v[168:171], a[16:19], a[104:107], v[168:171]
  ds_read_b64_tr_b16 a[46:47], v3 offset:20992
  v_lshl_add_u32 v39, v37, 8, v39
  v_mfma_f32_16x16x32_bf16 v[168:171], a[20:23], a[120:123], v[168:171]
  ds_read_b64_tr_b16 a[52:53], v4 offset:20480
  v_add_u32 v33, 382976, v39
  v_mfma_f32_16x16x32_bf16 v[172:175], a[20:23], a[124:127], v[172:175]
  buffer_load_dwordx4 v11, s[8:11], s27 offen offset:1024 lds
  v_mfma_f32_16x16x32_bf16 v[172:175], a[16:19], a[108:111], v[172:175]
  ds_read_b64_tr_b16 a[54:55], v4 offset:20992
  v_and_b32 v36, 3, v1
  v_mfma_f32_16x16x32_bf16 v[188:191], a[24:27], a[108:111], v[188:191]
  ds_read_b64_tr_b16 a[60:61], v5 offset:20480
  v_min_u32 v36, 1, v36
  v_mfma_f32_16x16x32_bf16 v[188:191], a[28:31], a[124:127], v[188:191]
  ds_read_b64_tr_b16 a[62:63], v5 offset:20992
  v_add_u32 v36, -1, v36
  v_mfma_f32_16x16x32_bf16 v[184:187], a[28:31], a[120:123], v[184:187]
  buffer_load_dwordx4 v12, s[8:11], s27 offen offset:2048 lds
  v_mfma_f32_16x16x32_bf16 v[184:187], a[24:27], a[104:107], v[184:187]
  v_and_b32 v44, 0x3f803f80, v36
  v_and_b32 v45, 0x3f803f80, v36
  v_mfma_f32_16x16x32_bf16 v[180:183], a[24:27], a[100:103], v[180:183]
  v_and_b32 v46, 0x3f803f80, v36
  v_and_b32 v47, 0x3f803f80, v36
  v_mfma_f32_16x16x32_bf16 v[180:183], a[28:31], a[116:119], v[180:183]
  v_accvgpr_read_b32 v18, a247
  v_accvgpr_read_b32 v19, a246
  v_mfma_f32_16x16x32_bf16 v[176:179], a[28:31], a[112:115], v[176:179]
  buffer_load_dwordx4 v13, s[8:11], s27 offen offset:3072 lds
  v_mfma_f32_16x16x32_bf16 v[176:179], a[24:27], a[96:99], v[176:179]
  v_accvgpr_read_b32 v34, a245
  s_waitcnt lgkmcnt(1)
  v_mfma_f32_16x16x32_bf16 v[192:195], a[32:35], a[96:99], v[192:195]
  s_add_u32 m0, s26, 16384
  s_waitcnt vmcnt(12)
  ds_read_b64_tr_b16 a[0:1], v2 offset:0
  v_mfma_f32_16x16x32_bf16 v[192:195], a[36:39], a[112:115], v[192:195]
  s_add_u32 s27, s28, 1572864
  ds_read_b64_tr_b16 a[2:3], v2 offset:512
  v_mfma_f32_16x16x32_bf16 v[196:199], a[36:39], a[116:119], v[196:199]
  buffer_load_dwordx4 v10, s[8:11], s27 offen offset:0 lds
  v_mfma_f32_16x16x32_bf16 v[196:199], a[32:35], a[100:103], v[196:199]
  ds_read_b64_tr_b16 a[8:9], v3 offset:0
  v_accvgpr_read_b32 v35, a244
  v_mfma_f32_16x16x32_bf16 v[200:203], a[32:35], a[104:107], v[200:203]
  ds_read_b64_tr_b16 a[10:11], v3 offset:512
  s_lshr_b32 s31, s101, 1
  v_mfma_f32_16x16x32_bf16 v[200:203], a[36:39], a[120:123], v[200:203]
  ds_read_b64_tr_b16 a[16:17], v4 offset:0
  s_lshl_b32 s31, s31, 3
  v_mfma_f32_16x16x32_bf16 v[204:207], a[36:39], a[124:127], v[204:207]
  buffer_load_dwordx4 v11, s[8:11], s27 offen offset:1024 lds
  s_lshr_b32 s32, s99, 2
  v_mfma_f32_16x16x32_bf16 v[204:207], a[32:35], a[108:111], v[204:207]
  ds_read_b64_tr_b16 a[18:19], v4 offset:512
  s_add_u32 s31, s31, s32
  v_mfma_f32_16x16x32_bf16 v[220:223], a[40:43], a[108:111], v[220:223]
  ds_read_b64_tr_b16 a[24:25], v5 offset:0
  s_and_b32 s32, s101, 1
  v_mfma_f32_16x16x32_bf16 v[220:223], a[44:47], a[124:127], v[220:223]
  ds_read_b64_tr_b16 a[26:27], v5 offset:512
  s_lshl_b32 s32, s32, 2
  v_mfma_f32_16x16x32_bf16 v[216:219], a[44:47], a[120:123], v[216:219]
  buffer_load_dwordx4 v12, s[8:11], s27 offen offset:2048 lds
  s_and_b32 s35, s99, 3
  v_mfma_f32_16x16x32_bf16 v[216:219], a[40:43], a[104:107], v[216:219]
  ds_read_b128 a[80:83], v7 offset:256
  s_add_u32 s32, s32, s35
  v_mfma_f32_16x16x32_bf16 v[212:215], a[40:43], a[100:103], v[212:215]
  ds_read_b128 a[84:87], v7 offset:16640
  v_lshlrev_b32 v17, 7, v1
  v_mfma_f32_16x16x32_bf16 v[212:215], a[44:47], a[116:119], v[212:215]
  ds_read_b128 a[88:91], v7 offset:33024
  s_lshl_b32 s39, s99, 2
  v_mfma_f32_16x16x32_bf16 v[208:211], a[44:47], a[112:115], v[208:211]
  buffer_load_dwordx4 v13, s[8:11], s27 offen offset:3072 lds
  s_add_u32 s39, s39, s3
  v_mfma_f32_16x16x32_bf16 v[208:211], a[40:43], a[96:99], v[208:211]
  s_waitcnt lgkmcnt(7)
  ds_read_b128 a[92:95], v7 offset:49408
  v_mfma_f32_16x16x32_bf16 v[224:227], a[48:51], a[96:99], v[224:227]
  s_add_u32 m0, s26, 20480
  s_waitcnt vmcnt(12)
  ds_read_b64_tr_b16 a[4:5], v2 offset:4096
  v_mfma_f32_16x16x32_bf16 v[224:227], a[52:55], a[112:115], v[224:227]
  s_add_u32 s27, s28, 1835008
  ds_read_b64_tr_b16 a[6:7], v2 offset:4608
  v_mfma_f32_16x16x32_bf16 v[228:231], a[52:55], a[116:119], v[228:231]
  buffer_load_dwordx4 v10, s[8:11], s27 offen offset:0 lds
  s_lshr_b32 s34, s25, 0
  v_mfma_f32_16x16x32_bf16 v[228:231], a[48:51], a[100:103], v[228:231]
  ds_read_b64_tr_b16 a[12:13], v3 offset:4096
  s_lshl_b32 s34, s34, 2
  v_mfma_f32_16x16x32_bf16 v[232:235], a[48:51], a[104:107], v[232:235]
  ds_read_b64_tr_b16 a[14:15], v3 offset:4608
  s_add_u32 s34, s34, s3
  v_mfma_f32_16x16x32_bf16 v[232:235], a[52:55], a[120:123], v[232:235]
  ds_read_b64_tr_b16 a[20:21], v4 offset:4096
  s_lshl_b32 s34, s34, 12
  v_mfma_f32_16x16x32_bf16 v[236:239], a[52:55], a[124:127], v[236:239]
  buffer_load_dwordx4 v11, s[8:11], s27 offen offset:1024 lds
  s_add_u32 s34, s34, s29
  v_mfma_f32_16x16x32_bf16 v[236:239], a[48:51], a[108:111], v[236:239]
  ds_read_b64_tr_b16 a[22:23], v4 offset:4608
  s_mul_i32 s35, s39, 24576
  v_mfma_f32_16x16x32_bf16 v[252:255], a[56:59], a[108:111], v[252:255]
  ds_read_b64_tr_b16 a[28:29], v5 offset:4096
  s_lshl_b32 s36, s101, 9
  v_mfma_f32_16x16x32_bf16 v[252:255], a[60:63], a[124:127], v[252:255]
  ds_read_b64_tr_b16 a[30:31], v5 offset:4608
  s_add_u32 s35, s35, s36
  v_mfma_f32_16x16x32_bf16 v[248:251], a[60:63], a[120:123], v[248:251]
  buffer_load_dwordx4 v12, s[8:11], s27 offen offset:2048 lds
  s_lshl_b32 s36, s68, 1
  v_mfma_f32_16x16x32_bf16 v[248:251], a[56:59], a[104:107], v[248:251]
  s_add_u32 s36, s36, 2048
  v_lshrrev_b32 v14, 2, v1
  v_mfma_f32_16x16x32_bf16 v[244:247], a[56:59], a[100:103], v[244:247]
  v_mul_u32_u24 v14, 6144, v14
  v_and_b32 v15, 3, v1
  v_mfma_f32_16x16x32_bf16 v[244:247], a[60:63], a[116:119], v[244:247]
  v_lshl_add_u32 v14, v15, 7, v14
  v_mfma_f32_16x16x32_bf16 v[240:243], a[60:63], a[112:115], v[240:243]
  buffer_load_dwordx4 v13, s[8:11], s27 offen offset:3072 lds
  v_mfma_f32_16x16x32_bf16 v[240:243], a[56:59], a[96:99], v[240:243]
  s_waitcnt lgkmcnt(1)
  v_mfma_f32_16x16x32_bf16 v[128:131], a[0:3], a[64:67], v[128:131]
  s_add_u32 m0, s26, 0
  s_waitcnt vmcnt(12)
  ds_read_b64_tr_b16 a[32:33], v2 offset:8192
  v_mfma_f32_16x16x32_bf16 v[128:131], a[4:7], a[80:83], v[128:131]
  s_add_u32 s27, s28, 1572992
  ds_read_b64_tr_b16 a[34:35], v2 offset:8704
  v_mfma_f32_16x16x32_bf16 v[132:135], a[4:7], a[84:87], v[132:135]
  buffer_load_dwordx4 v10, s[8:11], s27 offen offset:0 lds
  v_mfma_f32_16x16x32_bf16 v[132:135], a[0:3], a[68:71], v[132:135]
  ds_read_b64_tr_b16 a[40:41], v3 offset:8192
  v_mfma_f32_16x16x32_bf16 v[136:139], a[0:3], a[72:75], v[136:139]
  ds_read_b64_tr_b16 a[42:43], v3 offset:8704
  v_mfma_f32_16x16x32_bf16 v[136:139], a[4:7], a[88:91], v[136:139]
  ds_read_b64_tr_b16 a[48:49], v4 offset:8192
  v_mfma_f32_16x16x32_bf16 v[140:143], a[4:7], a[92:95], v[140:143]
  buffer_load_dwordx4 v11, s[8:11], s27 offen offset:1024 lds
  v_mfma_f32_16x16x32_bf16 v[140:143], a[0:3], a[76:79], v[140:143]
  ds_read_b64_tr_b16 a[50:51], v4 offset:8704
  v_mfma_f32_16x16x32_bf16 v[156:159], a[8:11], a[76:79], v[156:159]
  ds_read_b64_tr_b16 a[56:57], v5 offset:8192
  v_mfma_f32_16x16x32_bf16 v[156:159], a[12:15], a[92:95], v[156:159]
  ds_read_b64_tr_b16 a[58:59], v5 offset:8704
  v_mfma_f32_16x16x32_bf16 v[152:155], a[12:15], a[88:91], v[152:155]
  buffer_load_dwordx4 v12, s[8:11], s27 offen offset:2048 lds
  v_mfma_f32_16x16x32_bf16 v[152:155], a[8:11], a[72:75], v[152:155]
  ds_read_b128 a[96:99], v8 offset:256
  v_mfma_f32_16x16x32_bf16 v[148:151], a[8:11], a[68:71], v[148:151]
  ds_read_b128 a[100:103], v8 offset:16640
  v_mfma_f32_16x16x32_bf16 v[148:151], a[12:15], a[84:87], v[148:151]
  ds_read_b128 a[104:107], v8 offset:33024
  v_mfma_f32_16x16x32_bf16 v[144:147], a[12:15], a[80:83], v[144:147]
  buffer_load_dwordx4 v13, s[8:11], s27 offen offset:3072 lds
  v_mfma_f32_16x16x32_bf16 v[144:147], a[8:11], a[64:67], v[144:147]
  s_waitcnt lgkmcnt(7)
  ds_read_b128 a[108:111], v8 offset:49408
  v_mfma_f32_16x16x32_bf16 v[160:163], a[16:19], a[64:67], v[160:163]
  s_add_u32 m0, s26, 4096
  s_waitcnt vmcnt(12)
  ds_read_b64_tr_b16 a[36:37], v2 offset:12288
  v_mfma_f32_16x16x32_bf16 v[160:163], a[20:23], a[80:83], v[160:163]
  s_add_u32 s27, s28, 1835136
  ds_read_b64_tr_b16 a[38:39], v2 offset:12800
  v_mfma_f32_16x16x32_bf16 v[164:167], a[20:23], a[84:87], v[164:167]
  buffer_load_dwordx4 v10, s[8:11], s27 offen offset:0 lds
  v_mfma_f32_16x16x32_bf16 v[164:167], a[16:19], a[68:71], v[164:167]
  ds_read_b64_tr_b16 a[44:45], v3 offset:12288
  v_mfma_f32_16x16x32_bf16 v[168:171], a[16:19], a[72:75], v[168:171]
  ds_read_b64_tr_b16 a[46:47], v3 offset:12800
  v_mfma_f32_16x16x32_bf16 v[168:171], a[20:23], a[88:91], v[168:171]
  ds_read_b64_tr_b16 a[52:53], v4 offset:12288
  v_mfma_f32_16x16x32_bf16 v[172:175], a[20:23], a[92:95], v[172:175]
  buffer_load_dwordx4 v11, s[8:11], s27 offen offset:1024 lds
  v_mfma_f32_16x16x32_bf16 v[172:175], a[16:19], a[76:79], v[172:175]
  ds_read_b64_tr_b16 a[54:55], v4 offset:12800
  v_mfma_f32_16x16x32_bf16 v[188:191], a[24:27], a[76:79], v[188:191]
  ds_read_b64_tr_b16 a[60:61], v5 offset:12288
  v_mfma_f32_16x16x32_bf16 v[188:191], a[28:31], a[92:95], v[188:191]
  ds_read_b64_tr_b16 a[62:63], v5 offset:12800
  v_mfma_f32_16x16x32_bf16 v[184:187], a[28:31], a[88:91], v[184:187]
  buffer_load_dwordx4 v12, s[8:11], s27 offen offset:2048 lds
  v_mfma_f32_16x16x32_bf16 v[184:187], a[24:27], a[72:75], v[184:187]
  v_mfma_f32_16x16x32_bf16 v[180:183], a[24:27], a[68:71], v[180:183]
  v_mfma_f32_16x16x32_bf16 v[180:183], a[28:31], a[84:87], v[180:183]
  v_mfma_f32_16x16x32_bf16 v[176:179], a[28:31], a[80:83], v[176:179]
  buffer_load_dwordx4 v13, s[8:11], s27 offen offset:3072 lds
  v_mfma_f32_16x16x32_bf16 v[176:179], a[24:27], a[64:67], v[176:179]
  s_waitcnt lgkmcnt(1)
  v_mfma_f32_16x16x32_bf16 v[192:195], a[32:35], a[64:67], v[192:195]
  s_add_u32 m0, s26, 8192
  s_waitcnt vmcnt(12)
  ds_read_b64_tr_b16 a[0:1], v2 offset:16384
  v_mfma_f32_16x16x32_bf16 v[192:195], a[36:39], a[80:83], v[192:195]
  s_add_u32 s27, s28, 2097152
  ds_read_b64_tr_b16 a[2:3], v2 offset:16896
  v_mfma_f32_16x16x32_bf16 v[196:199], a[36:39], a[84:87], v[196:199]
  buffer_load_dwordx4 v10, s[8:11], s27 offen offset:0 lds
  v_mfma_f32_16x16x32_bf16 v[196:199], a[32:35], a[68:71], v[196:199]
  ds_read_b64_tr_b16 a[8:9], v3 offset:16384
  v_mfma_f32_16x16x32_bf16 v[200:203], a[32:35], a[72:75], v[200:203]
  ds_read_b64_tr_b16 a[10:11], v3 offset:16896
  v_mfma_f32_16x16x32_bf16 v[200:203], a[36:39], a[88:91], v[200:203]
  ds_read_b64_tr_b16 a[16:17], v4 offset:16384
  v_mfma_f32_16x16x32_bf16 v[204:207], a[36:39], a[92:95], v[204:207]
  buffer_load_dwordx4 v11, s[8:11], s27 offen offset:1024 lds
  v_mfma_f32_16x16x32_bf16 v[204:207], a[32:35], a[76:79], v[204:207]
  ds_read_b64_tr_b16 a[18:19], v4 offset:16896
  v_mfma_f32_16x16x32_bf16 v[220:223], a[40:43], a[76:79], v[220:223]
  ds_read_b64_tr_b16 a[24:25], v5 offset:16384
  v_mfma_f32_16x16x32_bf16 v[220:223], a[44:47], a[92:95], v[220:223]
  ds_read_b64_tr_b16 a[26:27], v5 offset:16896
  v_mfma_f32_16x16x32_bf16 v[216:219], a[44:47], a[88:91], v[216:219]
  buffer_load_dwordx4 v12, s[8:11], s27 offen offset:2048 lds
  v_mfma_f32_16x16x32_bf16 v[216:219], a[40:43], a[72:75], v[216:219]
  ds_read_b128 a[112:115], v9 offset:256
  v_mfma_f32_16x16x32_bf16 v[212:215], a[40:43], a[68:71], v[212:215]
  ds_read_b128 a[116:119], v9 offset:16640
  v_mfma_f32_16x16x32_bf16 v[212:215], a[44:47], a[84:87], v[212:215]
  ds_read_b128 a[120:123], v9 offset:33024
  v_mfma_f32_16x16x32_bf16 v[208:211], a[44:47], a[80:83], v[208:211]
  buffer_load_dwordx4 v13, s[8:11], s27 offen offset:3072 lds
  v_mfma_f32_16x16x32_bf16 v[208:211], a[40:43], a[64:67], v[208:211]
  s_waitcnt lgkmcnt(7)
  ds_read_b128 a[124:127], v9 offset:49408
  v_mfma_f32_16x16x32_bf16 v[224:227], a[48:51], a[64:67], v[224:227]
  s_add_u32 m0, s26, 12288
  s_waitcnt vmcnt(12)
  ds_read_b64_tr_b16 a[4:5], v2 offset:20480
  v_mfma_f32_16x16x32_bf16 v[224:227], a[52:55], a[80:83], v[224:227]
  s_add_u32 s27, s28, 2359296
  ds_read_b64_tr_b16 a[6:7], v2 offset:20992
  v_mfma_f32_16x16x32_bf16 v[228:231], a[52:55], a[84:87], v[228:231]
  buffer_load_dwordx4 v10, s[8:11], s27 offen offset:0 lds
  v_mfma_f32_16x16x32_bf16 v[228:231], a[48:51], a[68:71], v[228:231]
  ds_read_b64_tr_b16 a[12:13], v3 offset:20480
  v_mfma_f32_16x16x32_bf16 v[232:235], a[48:51], a[72:75], v[232:235]
  ds_read_b64_tr_b16 a[14:15], v3 offset:20992
  v_mfma_f32_16x16x32_bf16 v[232:235], a[52:55], a[88:91], v[232:235]
  ds_read_b64_tr_b16 a[20:21], v4 offset:20480
  v_mfma_f32_16x16x32_bf16 v[236:239], a[52:55], a[92:95], v[236:239]
  buffer_load_dwordx4 v11, s[8:11], s27 offen offset:1024 lds
  v_mfma_f32_16x16x32_bf16 v[236:239], a[48:51], a[76:79], v[236:239]
  ds_read_b64_tr_b16 a[22:23], v4 offset:20992
  v_mfma_f32_16x16x32_bf16 v[252:255], a[56:59], a[76:79], v[252:255]
  ds_read_b64_tr_b16 a[28:29], v5 offset:20480
  v_mfma_f32_16x16x32_bf16 v[252:255], a[60:63], a[92:95], v[252:255]
  ds_read_b64_tr_b16 a[30:31], v5 offset:20992
  v_mfma_f32_16x16x32_bf16 v[248:251], a[60:63], a[88:91], v[248:251]
  buffer_load_dwordx4 v12, s[8:11], s27 offen offset:2048 lds
  v_mfma_f32_16x16x32_bf16 v[248:251], a[56:59], a[72:75], v[248:251]
  v_mfma_f32_16x16x32_bf16 v[244:247], a[56:59], a[68:71], v[244:247]
  v_mfma_f32_16x16x32_bf16 v[244:247], a[60:63], a[84:87], v[244:247]
  v_mfma_f32_16x16x32_bf16 v[240:243], a[60:63], a[80:83], v[240:243]
  buffer_load_dwordx4 v13, s[8:11], s27 offen offset:3072 lds
  v_mfma_f32_16x16x32_bf16 v[240:243], a[56:59], a[64:67], v[240:243]
  s_waitcnt lgkmcnt(1)
  v_mfma_f32_16x16x32_bf16 v[128:131], a[0:3], a[96:99], v[128:131]
  s_add_u32 m0, s26, 16384
  s_waitcnt vmcnt(12)
  ds_read_b64_tr_b16 a[32:33], v2 offset:0
  v_mfma_f32_16x16x32_bf16 v[128:131], a[4:7], a[112:115], v[128:131]
  s_add_u32 s27, s28, 2097280
  ds_read_b64_tr_b16 a[34:35], v2 offset:512
  v_mfma_f32_16x16x32_bf16 v[132:135], a[4:7], a[116:119], v[132:135]
  buffer_load_dwordx4 v10, s[8:11], s27 offen offset:0 lds
  v_mfma_f32_16x16x32_bf16 v[132:135], a[0:3], a[100:103], v[132:135]
  ds_read_b64_tr_b16 a[40:41], v3 offset:0
  v_mfma_f32_16x16x32_bf16 v[136:139], a[0:3], a[104:107], v[136:139]
  ds_read_b64_tr_b16 a[42:43], v3 offset:512
  v_mfma_f32_16x16x32_bf16 v[136:139], a[4:7], a[120:123], v[136:139]
  ds_read_b64_tr_b16 a[48:49], v4 offset:0
  v_mfma_f32_16x16x32_bf16 v[140:143], a[4:7], a[124:127], v[140:143]
  buffer_load_dwordx4 v11, s[8:11], s27 offen offset:1024 lds
  v_mfma_f32_16x16x32_bf16 v[140:143], a[0:3], a[108:111], v[140:143]
  ds_read_b64_tr_b16 a[50:51], v4 offset:512
  v_mfma_f32_16x16x32_bf16 v[156:159], a[8:11], a[108:111], v[156:159]
  ds_read_b64_tr_b16 a[56:57], v5 offset:0
  v_mfma_f32_16x16x32_bf16 v[156:159], a[12:15], a[124:127], v[156:159]
  ds_read_b64_tr_b16 a[58:59], v5 offset:512
  v_mfma_f32_16x16x32_bf16 v[152:155], a[12:15], a[120:123], v[152:155]
  buffer_load_dwordx4 v12, s[8:11], s27 offen offset:2048 lds
  v_mfma_f32_16x16x32_bf16 v[152:155], a[8:11], a[104:107], v[152:155]
  ds_read_b128 a[64:67], v6 offset:512
  v_mfma_f32_16x16x32_bf16 v[148:151], a[8:11], a[100:103], v[148:151]
  ds_read_b128 a[68:71], v6 offset:16896
  v_mfma_f32_16x16x32_bf16 v[148:151], a[12:15], a[116:119], v[148:151]
  ds_read_b128 a[72:75], v6 offset:33280
  v_mfma_f32_16x16x32_bf16 v[144:147], a[12:15], a[112:115], v[144:147]
  buffer_load_dwordx4 v13, s[8:11], s27 offen offset:3072 lds
  v_mfma_f32_16x16x32_bf16 v[144:147], a[8:11], a[96:99], v[144:147]
  s_waitcnt lgkmcnt(7)
  ds_read_b128 a[76:79], v6 offset:49664
  v_mfma_f32_16x16x32_bf16 v[160:163], a[16:19], a[96:99], v[160:163]
  s_add_u32 m0, s26, 20480
  s_waitcnt vmcnt(12)
  ds_read_b64_tr_b16 a[36:37], v2 offset:4096
  v_mfma_f32_16x16x32_bf16 v[160:163], a[20:23], a[112:115], v[160:163]
  s_add_u32 s27, s28, 2359424
  ds_read_b64_tr_b16 a[38:39], v2 offset:4608
  v_mfma_f32_16x16x32_bf16 v[164:167], a[20:23], a[116:119], v[164:167]
  buffer_load_dwordx4 v10, s[8:11], s27 offen offset:0 lds
  v_mfma_f32_16x16x32_bf16 v[164:167], a[16:19], a[100:103], v[164:167]
  ds_read_b64_tr_b16 a[44:45], v3 offset:4096
  v_mfma_f32_16x16x32_bf16 v[168:171], a[16:19], a[104:107], v[168:171]
  ds_read_b64_tr_b16 a[46:47], v3 offset:4608
  v_mfma_f32_16x16x32_bf16 v[168:171], a[20:23], a[120:123], v[168:171]
  ds_read_b64_tr_b16 a[52:53], v4 offset:4096
  v_mfma_f32_16x16x32_bf16 v[172:175], a[20:23], a[124:127], v[172:175]
  buffer_load_dwordx4 v11, s[8:11], s27 offen offset:1024 lds
  v_mfma_f32_16x16x32_bf16 v[172:175], a[16:19], a[108:111], v[172:175]
  ds_read_b64_tr_b16 a[54:55], v4 offset:4608
  v_mfma_f32_16x16x32_bf16 v[188:191], a[24:27], a[108:111], v[188:191]
  ds_read_b64_tr_b16 a[60:61], v5 offset:4096
  v_mfma_f32_16x16x32_bf16 v[188:191], a[28:31], a[124:127], v[188:191]
  ds_read_b64_tr_b16 a[62:63], v5 offset:4608
  v_mfma_f32_16x16x32_bf16 v[184:187], a[28:31], a[120:123], v[184:187]
  buffer_load_dwordx4 v12, s[8:11], s27 offen offset:2048 lds
  v_mfma_f32_16x16x32_bf16 v[184:187], a[24:27], a[104:107], v[184:187]
  v_mfma_f32_16x16x32_bf16 v[180:183], a[24:27], a[100:103], v[180:183]
  v_mfma_f32_16x16x32_bf16 v[180:183], a[28:31], a[116:119], v[180:183]
  v_mfma_f32_16x16x32_bf16 v[176:179], a[28:31], a[112:115], v[176:179]
  buffer_load_dwordx4 v13, s[8:11], s27 offen offset:3072 lds
  v_mfma_f32_16x16x32_bf16 v[176:179], a[24:27], a[96:99], v[176:179]
  s_waitcnt lgkmcnt(1)
  v_mfma_f32_16x16x32_bf16 v[192:195], a[32:35], a[96:99], v[192:195]
  s_add_u32 m0, s26, 0
  s_waitcnt vmcnt(12)
  ds_read_b64_tr_b16 a[0:1], v2 offset:8192
  v_mfma_f32_16x16x32_bf16 v[192:195], a[36:39], a[112:115], v[192:195]
  s_add_u32 s27, s28, 2621440
  ds_read_b64_tr_b16 a[2:3], v2 offset:8704
  v_mfma_f32_16x16x32_bf16 v[196:199], a[36:39], a[116:119], v[196:199]
  buffer_load_dwordx4 v10, s[8:11], s27 offen offset:0 lds
  v_mfma_f32_16x16x32_bf16 v[196:199], a[32:35], a[100:103], v[196:199]
  ds_read_b64_tr_b16 a[8:9], v3 offset:8192
  v_mfma_f32_16x16x32_bf16 v[200:203], a[32:35], a[104:107], v[200:203]
  ds_read_b64_tr_b16 a[10:11], v3 offset:8704
  v_mfma_f32_16x16x32_bf16 v[200:203], a[36:39], a[120:123], v[200:203]
  ds_read_b64_tr_b16 a[16:17], v4 offset:8192
  v_mfma_f32_16x16x32_bf16 v[204:207], a[36:39], a[124:127], v[204:207]
  buffer_load_dwordx4 v11, s[8:11], s27 offen offset:1024 lds
  v_mfma_f32_16x16x32_bf16 v[204:207], a[32:35], a[108:111], v[204:207]
  ds_read_b64_tr_b16 a[18:19], v4 offset:8704
  v_mfma_f32_16x16x32_bf16 v[220:223], a[40:43], a[108:111], v[220:223]
  ds_read_b64_tr_b16 a[24:25], v5 offset:8192
  v_mfma_f32_16x16x32_bf16 v[220:223], a[44:47], a[124:127], v[220:223]
  ds_read_b64_tr_b16 a[26:27], v5 offset:8704
  v_mfma_f32_16x16x32_bf16 v[216:219], a[44:47], a[120:123], v[216:219]
  buffer_load_dwordx4 v12, s[8:11], s27 offen offset:2048 lds
  v_mfma_f32_16x16x32_bf16 v[216:219], a[40:43], a[104:107], v[216:219]
  ds_read_b128 a[80:83], v7 offset:512
  v_mfma_f32_16x16x32_bf16 v[212:215], a[40:43], a[100:103], v[212:215]
  ds_read_b128 a[84:87], v7 offset:16896
  v_mfma_f32_16x16x32_bf16 v[212:215], a[44:47], a[116:119], v[212:215]
  ds_read_b128 a[88:91], v7 offset:33280
  v_mfma_f32_16x16x32_bf16 v[208:211], a[44:47], a[112:115], v[208:211]
  buffer_load_dwordx4 v13, s[8:11], s27 offen offset:3072 lds
  v_mfma_f32_16x16x32_bf16 v[208:211], a[40:43], a[96:99], v[208:211]
  s_waitcnt lgkmcnt(7)
  ds_read_b128 a[92:95], v7 offset:49664
  v_mfma_f32_16x16x32_bf16 v[224:227], a[48:51], a[96:99], v[224:227]
  s_add_u32 m0, s26, 4096
  s_waitcnt vmcnt(12)
  ds_read_b64_tr_b16 a[4:5], v2 offset:12288
  v_mfma_f32_16x16x32_bf16 v[224:227], a[52:55], a[112:115], v[224:227]
  s_add_u32 s27, s28, 2883584
  ds_read_b64_tr_b16 a[6:7], v2 offset:12800
  v_mfma_f32_16x16x32_bf16 v[228:231], a[52:55], a[116:119], v[228:231]
  buffer_load_dwordx4 v10, s[8:11], s27 offen offset:0 lds
  v_mfma_f32_16x16x32_bf16 v[228:231], a[48:51], a[100:103], v[228:231]
  ds_read_b64_tr_b16 a[12:13], v3 offset:12288
  v_mfma_f32_16x16x32_bf16 v[232:235], a[48:51], a[104:107], v[232:235]
  ds_read_b64_tr_b16 a[14:15], v3 offset:12800
  v_mfma_f32_16x16x32_bf16 v[232:235], a[52:55], a[120:123], v[232:235]
  ds_read_b64_tr_b16 a[20:21], v4 offset:12288
  v_mfma_f32_16x16x32_bf16 v[236:239], a[52:55], a[124:127], v[236:239]
  buffer_load_dwordx4 v11, s[8:11], s27 offen offset:1024 lds
  v_mfma_f32_16x16x32_bf16 v[236:239], a[48:51], a[108:111], v[236:239]
  ds_read_b64_tr_b16 a[22:23], v4 offset:12800
  v_mfma_f32_16x16x32_bf16 v[252:255], a[56:59], a[108:111], v[252:255]
  ds_read_b64_tr_b16 a[28:29], v5 offset:12288
  v_mfma_f32_16x16x32_bf16 v[252:255], a[60:63], a[124:127], v[252:255]
  ds_read_b64_tr_b16 a[30:31], v5 offset:12800
  v_mfma_f32_16x16x32_bf16 v[248:251], a[60:63], a[120:123], v[248:251]
  buffer_load_dwordx4 v12, s[8:11], s27 offen offset:2048 lds
  v_mfma_f32_16x16x32_bf16 v[248:251], a[56:59], a[104:107], v[248:251]
  v_mfma_f32_16x16x32_bf16 v[244:247], a[56:59], a[100:103], v[244:247]
  v_mfma_f32_16x16x32_bf16 v[244:247], a[60:63], a[116:119], v[244:247]
  v_mfma_f32_16x16x32_bf16 v[240:243], a[60:63], a[112:115], v[240:243]
  buffer_load_dwordx4 v13, s[8:11], s27 offen offset:3072 lds
  v_mfma_f32_16x16x32_bf16 v[240:243], a[56:59], a[96:99], v[240:243]
  s_waitcnt lgkmcnt(1)
  v_mfma_f32_16x16x32_bf16 v[128:131], a[0:3], a[64:67], v[128:131]
  s_add_u32 m0, s26, 8192
  s_waitcnt vmcnt(12)
  ds_read_b64_tr_b16 a[32:33], v2 offset:16384
  v_mfma_f32_16x16x32_bf16 v[128:131], a[4:7], a[80:83], v[128:131]
  s_add_u32 s27, s28, 2621568
  ds_read_b64_tr_b16 a[34:35], v2 offset:16896
  v_mfma_f32_16x16x32_bf16 v[132:135], a[4:7], a[84:87], v[132:135]
  buffer_load_dwordx4 v10, s[8:11], s27 offen offset:0 lds
  v_mfma_f32_16x16x32_bf16 v[132:135], a[0:3], a[68:71], v[132:135]
  ds_read_b64_tr_b16 a[40:41], v3 offset:16384
  v_mfma_f32_16x16x32_bf16 v[136:139], a[0:3], a[72:75], v[136:139]
  ds_read_b64_tr_b16 a[42:43], v3 offset:16896
  v_mfma_f32_16x16x32_bf16 v[136:139], a[4:7], a[88:91], v[136:139]
  ds_read_b64_tr_b16 a[48:49], v4 offset:16384
  v_mfma_f32_16x16x32_bf16 v[140:143], a[4:7], a[92:95], v[140:143]
  buffer_load_dwordx4 v11, s[8:11], s27 offen offset:1024 lds
  v_mfma_f32_16x16x32_bf16 v[140:143], a[0:3], a[76:79], v[140:143]
  ds_read_b64_tr_b16 a[50:51], v4 offset:16896
  v_mfma_f32_16x16x32_bf16 v[156:159], a[8:11], a[76:79], v[156:159]
  ds_read_b64_tr_b16 a[56:57], v5 offset:16384
  v_mfma_f32_16x16x32_bf16 v[156:159], a[12:15], a[92:95], v[156:159]
  ds_read_b64_tr_b16 a[58:59], v5 offset:16896
  v_mfma_f32_16x16x32_bf16 v[152:155], a[12:15], a[88:91], v[152:155]
  buffer_load_dwordx4 v12, s[8:11], s27 offen offset:2048 lds
  v_mfma_f32_16x16x32_bf16 v[152:155], a[8:11], a[72:75], v[152:155]
  ds_read_b128 a[96:99], v8 offset:512
  v_mfma_f32_16x16x32_bf16 v[148:151], a[8:11], a[68:71], v[148:151]
  ds_read_b128 a[100:103], v8 offset:16896
  v_mfma_f32_16x16x32_bf16 v[148:151], a[12:15], a[84:87], v[148:151]
  ds_read_b128 a[104:107], v8 offset:33280
  v_mfma_f32_16x16x32_bf16 v[144:147], a[12:15], a[80:83], v[144:147]
  buffer_load_dwordx4 v13, s[8:11], s27 offen offset:3072 lds
  v_mfma_f32_16x16x32_bf16 v[144:147], a[8:11], a[64:67], v[144:147]
  s_waitcnt lgkmcnt(7)
  ds_read_b128 a[108:111], v8 offset:49664
  v_mfma_f32_16x16x32_bf16 v[160:163], a[16:19], a[64:67], v[160:163]
  s_add_u32 m0, s26, 12288
  s_waitcnt vmcnt(12)
  ds_read_b64_tr_b16 a[36:37], v2 offset:20480
  v_mfma_f32_16x16x32_bf16 v[160:163], a[20:23], a[80:83], v[160:163]
  s_add_u32 s27, s28, 2883712
  ds_read_b64_tr_b16 a[38:39], v2 offset:20992
  v_mfma_f32_16x16x32_bf16 v[164:167], a[20:23], a[84:87], v[164:167]
  buffer_load_dwordx4 v10, s[8:11], s27 offen offset:0 lds
  v_mfma_f32_16x16x32_bf16 v[164:167], a[16:19], a[68:71], v[164:167]
  ds_read_b64_tr_b16 a[44:45], v3 offset:20480
  v_mfma_f32_16x16x32_bf16 v[168:171], a[16:19], a[72:75], v[168:171]
  ds_read_b64_tr_b16 a[46:47], v3 offset:20992
  v_mfma_f32_16x16x32_bf16 v[168:171], a[20:23], a[88:91], v[168:171]
  ds_read_b64_tr_b16 a[52:53], v4 offset:20480
  v_mfma_f32_16x16x32_bf16 v[172:175], a[20:23], a[92:95], v[172:175]
  buffer_load_dwordx4 v11, s[8:11], s27 offen offset:1024 lds
  v_mfma_f32_16x16x32_bf16 v[172:175], a[16:19], a[76:79], v[172:175]
  ds_read_b64_tr_b16 a[54:55], v4 offset:20992
  v_mfma_f32_16x16x32_bf16 v[188:191], a[24:27], a[76:79], v[188:191]
  ds_read_b64_tr_b16 a[60:61], v5 offset:20480
  v_mfma_f32_16x16x32_bf16 v[188:191], a[28:31], a[92:95], v[188:191]
  ds_read_b64_tr_b16 a[62:63], v5 offset:20992
  v_mfma_f32_16x16x32_bf16 v[184:187], a[28:31], a[88:91], v[184:187]
  buffer_load_dwordx4 v12, s[8:11], s27 offen offset:2048 lds
  v_mfma_f32_16x16x32_bf16 v[184:187], a[24:27], a[72:75], v[184:187]
  v_mfma_f32_16x16x32_bf16 v[180:183], a[24:27], a[68:71], v[180:183]
  v_mfma_f32_16x16x32_bf16 v[180:183], a[28:31], a[84:87], v[180:183]
  v_mfma_f32_16x16x32_bf16 v[176:179], a[28:31], a[80:83], v[176:179]
  buffer_load_dwordx4 v13, s[8:11], s27 offen offset:3072 lds
  v_mfma_f32_16x16x32_bf16 v[176:179], a[24:27], a[64:67], v[176:179]
  s_waitcnt lgkmcnt(1)
  v_mfma_f32_16x16x32_bf16 v[192:195], a[32:35], a[64:67], v[192:195]
  s_add_u32 m0, s26, 16384
  s_waitcnt vmcnt(12)
  ds_read_b64_tr_b16 a[0:1], v2 offset:0
  v_mfma_f32_16x16x32_bf16 v[192:195], a[36:39], a[80:83], v[192:195]
  s_add_u32 s27, s28, 3145728
  ds_read_b64_tr_b16 a[2:3], v2 offset:512
  v_mfma_f32_16x16x32_bf16 v[196:199], a[36:39], a[84:87], v[196:199]
  buffer_load_dwordx4 v10, s[8:11], s27 offen offset:0 lds
  v_mfma_f32_16x16x32_bf16 v[196:199], a[32:35], a[68:71], v[196:199]
  ds_read_b64_tr_b16 a[8:9], v3 offset:0
  v_mfma_f32_16x16x32_bf16 v[200:203], a[32:35], a[72:75], v[200:203]
  ds_read_b64_tr_b16 a[10:11], v3 offset:512
  v_mfma_f32_16x16x32_bf16 v[200:203], a[36:39], a[88:91], v[200:203]
  ds_read_b64_tr_b16 a[16:17], v4 offset:0
  v_mfma_f32_16x16x32_bf16 v[204:207], a[36:39], a[92:95], v[204:207]
  buffer_load_dwordx4 v11, s[8:11], s27 offen offset:1024 lds
  v_mfma_f32_16x16x32_bf16 v[204:207], a[32:35], a[76:79], v[204:207]
  ds_read_b64_tr_b16 a[18:19], v4 offset:512
  v_mfma_f32_16x16x32_bf16 v[220:223], a[40:43], a[76:79], v[220:223]
  ds_read_b64_tr_b16 a[24:25], v5 offset:0
  v_mfma_f32_16x16x32_bf16 v[220:223], a[44:47], a[92:95], v[220:223]
  ds_read_b64_tr_b16 a[26:27], v5 offset:512
  v_mfma_f32_16x16x32_bf16 v[216:219], a[44:47], a[88:91], v[216:219]
  buffer_load_dwordx4 v12, s[8:11], s27 offen offset:2048 lds
  v_mfma_f32_16x16x32_bf16 v[216:219], a[40:43], a[72:75], v[216:219]
  ds_read_b128 a[112:115], v9 offset:512
  v_mfma_f32_16x16x32_bf16 v[212:215], a[40:43], a[68:71], v[212:215]
  ds_read_b128 a[116:119], v9 offset:16896
  v_mfma_f32_16x16x32_bf16 v[212:215], a[44:47], a[84:87], v[212:215]
  ds_read_b128 a[120:123], v9 offset:33280
  v_mfma_f32_16x16x32_bf16 v[208:211], a[44:47], a[80:83], v[208:211]
  buffer_load_dwordx4 v13, s[8:11], s27 offen offset:3072 lds
  v_mfma_f32_16x16x32_bf16 v[208:211], a[40:43], a[64:67], v[208:211]
  s_waitcnt lgkmcnt(7)
  ds_read_b128 a[124:127], v9 offset:49664
  v_mfma_f32_16x16x32_bf16 v[224:227], a[48:51], a[64:67], v[224:227]
  s_add_u32 m0, s26, 20480
  s_waitcnt vmcnt(12)
  ds_read_b64_tr_b16 a[4:5], v2 offset:4096
  v_mfma_f32_16x16x32_bf16 v[224:227], a[52:55], a[80:83], v[224:227]
  s_add_u32 s27, s28, 3407872
  ds_read_b64_tr_b16 a[6:7], v2 offset:4608
  v_mfma_f32_16x16x32_bf16 v[228:231], a[52:55], a[84:87], v[228:231]
  buffer_load_dwordx4 v10, s[8:11], s27 offen offset:0 lds
  v_mfma_f32_16x16x32_bf16 v[228:231], a[48:51], a[68:71], v[228:231]
  ds_read_b64_tr_b16 a[12:13], v3 offset:4096
  v_mfma_f32_16x16x32_bf16 v[232:235], a[48:51], a[72:75], v[232:235]
  ds_read_b64_tr_b16 a[14:15], v3 offset:4608
  v_mfma_f32_16x16x32_bf16 v[232:235], a[52:55], a[88:91], v[232:235]
  ds_read_b64_tr_b16 a[20:21], v4 offset:4096
  v_mfma_f32_16x16x32_bf16 v[236:239], a[52:55], a[92:95], v[236:239]
  buffer_load_dwordx4 v11, s[8:11], s27 offen offset:1024 lds
  v_mfma_f32_16x16x32_bf16 v[236:239], a[48:51], a[76:79], v[236:239]
  ds_read_b64_tr_b16 a[22:23], v4 offset:4608
  v_mfma_f32_16x16x32_bf16 v[252:255], a[56:59], a[76:79], v[252:255]
  ds_read_b64_tr_b16 a[28:29], v5 offset:4096
  v_mfma_f32_16x16x32_bf16 v[252:255], a[60:63], a[92:95], v[252:255]
  ds_read_b64_tr_b16 a[30:31], v5 offset:4608
  v_mfma_f32_16x16x32_bf16 v[248:251], a[60:63], a[88:91], v[248:251]
  buffer_load_dwordx4 v12, s[8:11], s27 offen offset:2048 lds
  v_mfma_f32_16x16x32_bf16 v[248:251], a[56:59], a[72:75], v[248:251]
  v_mfma_f32_16x16x32_bf16 v[244:247], a[56:59], a[68:71], v[244:247]
  v_mfma_f32_16x16x32_bf16 v[244:247], a[60:63], a[84:87], v[244:247]
  v_mfma_f32_16x16x32_bf16 v[240:243], a[60:63], a[80:83], v[240:243]
  buffer_load_dwordx4 v13, s[8:11], s27 offen offset:3072 lds
  v_mfma_f32_16x16x32_bf16 v[240:243], a[56:59], a[64:67], v[240:243]
  s_waitcnt lgkmcnt(1)
  v_mfma_f32_16x16x32_bf16 v[128:131], a[0:3], a[96:99], v[128:131]
  s_add_u32 m0, s26, 0
  s_waitcnt vmcnt(12)
  ds_read_b64_tr_b16 a[32:33], v2 offset:8192
  v_mfma_f32_16x16x32_bf16 v[128:131], a[4:7], a[112:115], v[128:131]
  s_add_u32 s27, s28, 3670016
  ds_read_b64_tr_b16 a[34:35], v2 offset:8704
  v_mfma_f32_16x16x32_bf16 v[132:135], a[4:7], a[116:119], v[132:135]
  buffer_load_dwordx4 v10, s[8:11], s27 offen offset:0 lds
  v_mfma_f32_16x16x32_bf16 v[132:135], a[0:3], a[100:103], v[132:135]
  ds_read_b64_tr_b16 a[40:41], v3 offset:8192
  v_mfma_f32_16x16x32_bf16 v[136:139], a[0:3], a[104:107], v[136:139]
  ds_read_b64_tr_b16 a[42:43], v3 offset:8704
  v_mfma_f32_16x16x32_bf16 v[136:139], a[4:7], a[120:123], v[136:139]
  ds_read_b64_tr_b16 a[48:49], v4 offset:8192
  v_mfma_f32_16x16x32_bf16 v[140:143], a[4:7], a[124:127], v[140:143]
  buffer_load_dwordx4 v11, s[8:11], s27 offen offset:1024 lds
  v_mfma_f32_16x16x32_bf16 v[140:143], a[0:3], a[108:111], v[140:143]
  ds_read_b64_tr_b16 a[50:51], v4 offset:8704
  v_mfma_f32_16x16x32_bf16 v[156:159], a[8:11], a[108:111], v[156:159]
  ds_read_b64_tr_b16 a[56:57], v5 offset:8192
  v_mfma_f32_16x16x32_bf16 v[156:159], a[12:15], a[124:127], v[156:159]
  ds_read_b64_tr_b16 a[58:59], v5 offset:8704
  v_mfma_f32_16x16x32_bf16 v[152:155], a[12:15], a[120:123], v[152:155]
  buffer_load_dwordx4 v12, s[8:11], s27 offen offset:2048 lds
  v_mfma_f32_16x16x32_bf16 v[152:155], a[8:11], a[104:107], v[152:155]
  ds_read_b128 a[64:67], v6 offset:768
  v_mfma_f32_16x16x32_bf16 v[148:151], a[8:11], a[100:103], v[148:151]
  ds_read_b128 a[68:71], v6 offset:17152
  v_mfma_f32_16x16x32_bf16 v[148:151], a[12:15], a[116:119], v[148:151]
  ds_read_b128 a[72:75], v6 offset:33536
  v_mfma_f32_16x16x32_bf16 v[144:147], a[12:15], a[112:115], v[144:147]
  buffer_load_dwordx4 v13, s[8:11], s27 offen offset:3072 lds
  v_mfma_f32_16x16x32_bf16 v[144:147], a[8:11], a[96:99], v[144:147]
  s_waitcnt lgkmcnt(7)
  ds_read_b128 a[76:79], v6 offset:49920
  v_mfma_f32_16x16x32_bf16 v[160:163], a[16:19], a[96:99], v[160:163]
  s_add_u32 m0, s26, 4096
  s_waitcnt vmcnt(12)
  ds_read_b64_tr_b16 a[36:37], v2 offset:12288
  v_mfma_f32_16x16x32_bf16 v[160:163], a[20:23], a[112:115], v[160:163]
  s_add_u32 s27, s28, 3932160
  ds_read_b64_tr_b16 a[38:39], v2 offset:12800
  v_mfma_f32_16x16x32_bf16 v[164:167], a[20:23], a[116:119], v[164:167]
  buffer_load_dwordx4 v10, s[8:11], s27 offen offset:0 lds
  v_mfma_f32_16x16x32_bf16 v[164:167], a[16:19], a[100:103], v[164:167]
  ds_read_b64_tr_b16 a[44:45], v3 offset:12288
  v_mfma_f32_16x16x32_bf16 v[168:171], a[16:19], a[104:107], v[168:171]
  ds_read_b64_tr_b16 a[46:47], v3 offset:12800
  v_mfma_f32_16x16x32_bf16 v[168:171], a[20:23], a[120:123], v[168:171]
  ds_read_b64_tr_b16 a[52:53], v4 offset:12288
  v_mfma_f32_16x16x32_bf16 v[172:175], a[20:23], a[124:127], v[172:175]
  buffer_load_dwordx4 v11, s[8:11], s27 offen offset:1024 lds
  v_mfma_f32_16x16x32_bf16 v[172:175], a[16:19], a[108:111], v[172:175]
  ds_read_b64_tr_b16 a[54:55], v4 offset:12800
  v_mfma_f32_16x16x32_bf16 v[188:191], a[24:27], a[108:111], v[188:191]
  ds_read_b64_tr_b16 a[60:61], v5 offset:12288
  v_mfma_f32_16x16x32_bf16 v[188:191], a[28:31], a[124:127], v[188:191]
  ds_read_b64_tr_b16 a[62:63], v5 offset:12800
  v_mfma_f32_16x16x32_bf16 v[184:187], a[28:31], a[120:123], v[184:187]
  buffer_load_dwordx4 v12, s[8:11], s27 offen offset:2048 lds
  v_mfma_f32_16x16x32_bf16 v[184:187], a[24:27], a[104:107], v[184:187]
  v_mfma_f32_16x16x32_bf16 v[180:183], a[24:27], a[100:103], v[180:183]
  v_mfma_f32_16x16x32_bf16 v[180:183], a[28:31], a[116:119], v[180:183]
  v_mfma_f32_16x16x32_bf16 v[176:179], a[28:31], a[112:115], v[176:179]
  buffer_load_dwordx4 v13, s[8:11], s27 offen offset:3072 lds
  v_mfma_f32_16x16x32_bf16 v[176:179], a[24:27], a[96:99], v[176:179]
  s_waitcnt lgkmcnt(1)
  v_mfma_f32_16x16x32_bf16 v[192:195], a[32:35], a[96:99], v[192:195]
  s_add_u32 m0, s26, 8192
  s_waitcnt vmcnt(12)
  ds_read_b64_tr_b16 a[0:1], v2 offset:16384
  v_mfma_f32_16x16x32_bf16 v[192:195], a[36:39], a[112:115], v[192:195]
  s_add_u32 s27, s28, 3145856
  ds_read_b64_tr_b16 a[2:3], v2 offset:16896
  v_mfma_f32_16x16x32_bf16 v[196:199], a[36:39], a[116:119], v[196:199]
  buffer_load_dwordx4 v10, s[8:11], s27 offen offset:0 lds
  v_mfma_f32_16x16x32_bf16 v[196:199], a[32:35], a[100:103], v[196:199]
  ds_read_b64_tr_b16 a[8:9], v3 offset:16384
  v_mfma_f32_16x16x32_bf16 v[200:203], a[32:35], a[104:107], v[200:203]
  ds_read_b64_tr_b16 a[10:11], v3 offset:16896
  v_mfma_f32_16x16x32_bf16 v[200:203], a[36:39], a[120:123], v[200:203]
  ds_read_b64_tr_b16 a[16:17], v4 offset:16384
  v_mfma_f32_16x16x32_bf16 v[204:207], a[36:39], a[124:127], v[204:207]
  buffer_load_dwordx4 v11, s[8:11], s27 offen offset:1024 lds
  v_mfma_f32_16x16x32_bf16 v[204:207], a[32:35], a[108:111], v[204:207]
  ds_read_b64_tr_b16 a[18:19], v4 offset:16896
  v_mfma_f32_16x16x32_bf16 v[220:223], a[40:43], a[108:111], v[220:223]
  ds_read_b64_tr_b16 a[24:25], v5 offset:16384
  v_mfma_f32_16x16x32_bf16 v[220:223], a[44:47], a[124:127], v[220:223]
  ds_read_b64_tr_b16 a[26:27], v5 offset:16896
  v_mfma_f32_16x16x32_bf16 v[216:219], a[44:47], a[120:123], v[216:219]
  buffer_load_dwordx4 v12, s[8:11], s27 offen offset:2048 lds
  v_mfma_f32_16x16x32_bf16 v[216:219], a[40:43], a[104:107], v[216:219]
  ds_read_b128 a[80:83], v7 offset:768
  v_mfma_f32_16x16x32_bf16 v[212:215], a[40:43], a[100:103], v[212:215]
  ds_read_b128 a[84:87], v7 offset:17152
  v_mfma_f32_16x16x32_bf16 v[212:215], a[44:47], a[116:119], v[212:215]
  ds_read_b128 a[88:91], v7 offset:33536
  v_mfma_f32_16x16x32_bf16 v[208:211], a[44:47], a[112:115], v[208:211]
  buffer_load_dwordx4 v13, s[8:11], s27 offen offset:3072 lds
  v_mfma_f32_16x16x32_bf16 v[208:211], a[40:43], a[96:99], v[208:211]
  s_waitcnt lgkmcnt(7)
  ds_read_b128 a[92:95], v7 offset:49920
  v_mfma_f32_16x16x32_bf16 v[224:227], a[48:51], a[96:99], v[224:227]
  s_add_u32 m0, s26, 12288
  s_waitcnt vmcnt(12)
  ds_read_b64_tr_b16 a[4:5], v2 offset:20480
  v_mfma_f32_16x16x32_bf16 v[224:227], a[52:55], a[112:115], v[224:227]
  s_add_u32 s27, s28, 3408000
  ds_read_b64_tr_b16 a[6:7], v2 offset:20992
  v_mfma_f32_16x16x32_bf16 v[228:231], a[52:55], a[116:119], v[228:231]
  buffer_load_dwordx4 v10, s[8:11], s27 offen offset:0 lds
  v_mfma_f32_16x16x32_bf16 v[228:231], a[48:51], a[100:103], v[228:231]
  ds_read_b64_tr_b16 a[12:13], v3 offset:20480
  v_mfma_f32_16x16x32_bf16 v[232:235], a[48:51], a[104:107], v[232:235]
  ds_read_b64_tr_b16 a[14:15], v3 offset:20992
  v_mfma_f32_16x16x32_bf16 v[232:235], a[52:55], a[120:123], v[232:235]
  ds_read_b64_tr_b16 a[20:21], v4 offset:20480
  v_mfma_f32_16x16x32_bf16 v[236:239], a[52:55], a[124:127], v[236:239]
  buffer_load_dwordx4 v11, s[8:11], s27 offen offset:1024 lds
  v_mfma_f32_16x16x32_bf16 v[236:239], a[48:51], a[108:111], v[236:239]
  ds_read_b64_tr_b16 a[22:23], v4 offset:20992
  v_mfma_f32_16x16x32_bf16 v[252:255], a[56:59], a[108:111], v[252:255]
  ds_read_b64_tr_b16 a[28:29], v5 offset:20480
  v_mfma_f32_16x16x32_bf16 v[252:255], a[60:63], a[124:127], v[252:255]
  ds_read_b64_tr_b16 a[30:31], v5 offset:20992
  v_mfma_f32_16x16x32_bf16 v[248:251], a[60:63], a[120:123], v[248:251]
  buffer_load_dwordx4 v12, s[8:11], s27 offen offset:2048 lds
  v_mfma_f32_16x16x32_bf16 v[248:251], a[56:59], a[104:107], v[248:251]
  v_mfma_f32_16x16x32_bf16 v[244:247], a[56:59], a[100:103], v[244:247]
  v_mfma_f32_16x16x32_bf16 v[244:247], a[60:63], a[116:119], v[244:247]
  v_mfma_f32_16x16x32_bf16 v[240:243], a[60:63], a[112:115], v[240:243]
  buffer_load_dwordx4 v13, s[8:11], s27 offen offset:3072 lds
  v_mfma_f32_16x16x32_bf16 v[240:243], a[56:59], a[96:99], v[240:243]
  s_waitcnt lgkmcnt(1)
  v_mfma_f32_16x16x32_bf16 v[128:131], a[0:3], a[64:67], v[128:131]
  s_add_u32 m0, s26, 16384
  s_waitcnt vmcnt(12)
  ds_read_b64_tr_b16 a[32:33], v2 offset:0
  v_mfma_f32_16x16x32_bf16 v[128:131], a[4:7], a[80:83], v[128:131]
  s_add_u32 s27, s28, 3670144
  ds_read_b64_tr_b16 a[34:35], v2 offset:512
  v_mfma_f32_16x16x32_bf16 v[132:135], a[4:7], a[84:87], v[132:135]
  buffer_load_dwordx4 v10, s[8:11], s27 offen offset:0 lds
  v_mfma_f32_16x16x32_bf16 v[132:135], a[0:3], a[68:71], v[132:135]
  ds_read_b64_tr_b16 a[40:41], v3 offset:0
  v_mfma_f32_16x16x32_bf16 v[136:139], a[0:3], a[72:75], v[136:139]
  ds_read_b64_tr_b16 a[42:43], v3 offset:512
  v_mfma_f32_16x16x32_bf16 v[136:139], a[4:7], a[88:91], v[136:139]
  ds_read_b64_tr_b16 a[48:49], v4 offset:0
  v_mfma_f32_16x16x32_bf16 v[140:143], a[4:7], a[92:95], v[140:143]
  buffer_load_dwordx4 v11, s[8:11], s27 offen offset:1024 lds
  v_mfma_f32_16x16x32_bf16 v[140:143], a[0:3], a[76:79], v[140:143]
  ds_read_b64_tr_b16 a[50:51], v4 offset:512
  v_mfma_f32_16x16x32_bf16 v[156:159], a[8:11], a[76:79], v[156:159]
  ds_read_b64_tr_b16 a[56:57], v5 offset:0
  v_mfma_f32_16x16x32_bf16 v[156:159], a[12:15], a[92:95], v[156:159]
  ds_read_b64_tr_b16 a[58:59], v5 offset:512
  v_mfma_f32_16x16x32_bf16 v[152:155], a[12:15], a[88:91], v[152:155]
  buffer_load_dwordx4 v12, s[8:11], s27 offen offset:2048 lds
  v_mfma_f32_16x16x32_bf16 v[152:155], a[8:11], a[72:75], v[152:155]
  ds_read_b128 a[96:99], v8 offset:768
  v_mfma_f32_16x16x32_bf16 v[148:151], a[8:11], a[68:71], v[148:151]
  ds_read_b128 a[112:115], v9 offset:768
  v_mfma_f32_16x16x32_bf16 v[148:151], a[12:15], a[84:87], v[148:151]
  ds_read_b128 a[100:103], v8 offset:17152
  v_mfma_f32_16x16x32_bf16 v[144:147], a[12:15], a[80:83], v[144:147]
  buffer_load_dwordx4 v13, s[8:11], s27 offen offset:3072 lds
  v_mfma_f32_16x16x32_bf16 v[144:147], a[8:11], a[64:67], v[144:147]
  s_waitcnt lgkmcnt(7)
  ds_read_b128 a[116:119], v9 offset:17152
  v_mfma_f32_16x16x32_bf16 v[160:163], a[16:19], a[64:67], v[160:163]
  s_add_u32 m0, s26, 20480
  ds_read_b128 a[104:107], v8 offset:33536
  v_mfma_f32_16x16x32_bf16 v[160:163], a[20:23], a[80:83], v[160:163]
  s_add_u32 s27, s28, 3932288
  ds_read_b128 a[120:123], v9 offset:33536
  v_mfma_f32_16x16x32_bf16 v[164:167], a[20:23], a[84:87], v[164:167]
  buffer_load_dwordx4 v10, s[8:11], s27 offen offset:0 lds
  v_mfma_f32_16x16x32_bf16 v[164:167], a[16:19], a[68:71], v[164:167]
  ds_read_b128 a[108:111], v8 offset:49920
  v_mfma_f32_16x16x32_bf16 v[168:171], a[16:19], a[72:75], v[168:171]
  ds_read_b128 a[124:127], v9 offset:49920
  v_mfma_f32_16x16x32_bf16 v[168:171], a[20:23], a[88:91], v[168:171]
  s_waitcnt vmcnt(13)
  ds_read_b64_tr_b16 a[36:37], v2 offset:4096
  v_mfma_f32_16x16x32_bf16 v[172:175], a[20:23], a[92:95], v[172:175]
  buffer_load_dwordx4 v11, s[8:11], s27 offen offset:1024 lds
  v_mfma_f32_16x16x32_bf16 v[172:175], a[16:19], a[76:79], v[172:175]
  ds_read_b64_tr_b16 a[38:39], v2 offset:4608
  v_mfma_f32_16x16x32_bf16 v[188:191], a[24:27], a[76:79], v[188:191]
  ds_read_b64_tr_b16 a[44:45], v3 offset:4096
  v_mfma_f32_16x16x32_bf16 v[188:191], a[28:31], a[92:95], v[188:191]
  ds_read_b64_tr_b16 a[46:47], v3 offset:4608
  v_mfma_f32_16x16x32_bf16 v[184:187], a[28:31], a[88:91], v[184:187]
  buffer_load_dwordx4 v12, s[8:11], s27 offen offset:2048 lds
  v_mfma_f32_16x16x32_bf16 v[184:187], a[24:27], a[72:75], v[184:187]
  ds_read_b64_tr_b16 a[52:53], v4 offset:4096
  v_mfma_f32_16x16x32_bf16 v[180:183], a[24:27], a[68:71], v[180:183]
  ds_read_b64_tr_b16 a[54:55], v4 offset:4608
  v_mfma_f32_16x16x32_bf16 v[180:183], a[28:31], a[84:87], v[180:183]
  ds_read_b64_tr_b16 a[60:61], v5 offset:4096
  v_mfma_f32_16x16x32_bf16 v[176:179], a[28:31], a[80:83], v[176:179]
  buffer_load_dwordx4 v13, s[8:11], s27 offen offset:3072 lds
  v_mfma_f32_16x16x32_bf16 v[176:179], a[24:27], a[64:67], v[176:179]
  ds_read_b64_tr_b16 a[62:63], v5 offset:4608
  s_waitcnt lgkmcnt(5)
  v_mfma_f32_16x16x32_bf16 v[128:131], a[32:35], a[96:99], v[128:131]
  s_add_u32 m0, s26, 0
  s_waitcnt vmcnt(12)
  ds_read_b64_tr_b16 a[0:1], v2 offset:8192
  v_mfma_f32_16x16x32_bf16 v[128:131], a[36:39], a[112:115], v[128:131]
  s_add_u32 s27, s29, 0
  ds_read_b64_tr_b16 a[2:3], v2 offset:8704
  v_mfma_f32_16x16x32_bf16 v[132:135], a[36:39], a[116:119], v[132:135]
  buffer_load_dwordx4 v32, s[12:15], s27 offen offset:0 lds
  v_mfma_f32_16x16x32_bf16 v[132:135], a[32:35], a[100:103], v[132:135]
  ds_read_b64_tr_b16 a[8:9], v3 offset:8192
  v_mfma_f32_16x16x32_bf16 v[136:139], a[32:35], a[104:107], v[136:139]
  ds_read_b64_tr_b16 a[10:11], v3 offset:8704
  v_mfma_f32_16x16x32_bf16 v[136:139], a[36:39], a[120:123], v[136:139]
  s_add_u32 s27, s29, 3072
  ds_read_b64_tr_b16 a[16:17], v4 offset:8192
  v_mfma_f32_16x16x32_bf16 v[140:143], a[36:39], a[124:127], v[140:143]
  buffer_load_dwordx4 v32, s[12:15], s27 offen offset:1024 lds
  v_mfma_f32_16x16x32_bf16 v[140:143], a[32:35], a[108:111], v[140:143]
  s_waitcnt lgkmcnt(5)
  ds_read_b64_tr_b16 a[18:19], v4 offset:8704
  v_mfma_f32_16x16x32_bf16 v[156:159], a[40:43], a[108:111], v[156:159]
  s_add_u32 m0, s26, 4096
  ds_read_b64_tr_b16 a[24:25], v5 offset:8192
  v_mfma_f32_16x16x32_bf16 v[156:159], a[44:47], a[124:127], v[156:159]
  s_add_u32 s27, s29, 8192
  ds_read_b64_tr_b16 a[26:27], v5 offset:8704
  v_mfma_f32_16x16x32_bf16 v[152:155], a[44:47], a[120:123], v[152:155]
  buffer_load_dwordx4 v32, s[12:15], s27 offen offset:0 lds
  v_mfma_f32_16x16x32_bf16 v[152:155], a[40:43], a[104:107], v[152:155]
  s_waitcnt vmcnt(11)
  ds_read_b64_tr_b16 a[4:5], v2 offset:12288
  v_mfma_f32_16x16x32_bf16 v[148:151], a[40:43], a[100:103], v[148:151]
  ds_read_b64_tr_b16 a[6:7], v2 offset:12800
  v_mfma_f32_16x16x32_bf16 v[148:151], a[44:47], a[116:119], v[148:151]
  ds_read_b64_tr_b16 a[12:13], v3 offset:12288
  v_mfma_f32_16x16x32_bf16 v[144:147], a[44:47], a[112:115], v[144:147]
  buffer_load_dwordx4 v33, s[16:19], s27 offen offset:2048 lds
  v_mfma_f32_16x16x32_bf16 v[144:147], a[40:43], a[96:99], v[144:147]
  ds_read_b64_tr_b16 a[14:15], v3 offset:12800
  v_mfma_f32_16x16x32_bf16 v[160:163], a[48:51], a[96:99], v[160:163]
  ds_read_b64_tr_b16 a[20:21], v4 offset:12288
  v_mfma_f32_16x16x32_bf16 v[160:163], a[52:55], a[112:115], v[160:163]
  s_add_u32 s27, s29, 11264
  ds_read_b64_tr_b16 a[22:23], v4 offset:12800
  v_mfma_f32_16x16x32_bf16 v[164:167], a[52:55], a[116:119], v[164:167]
  buffer_load_dwordx4 v32, s[12:15], s27 offen offset:1024 lds
  v_mfma_f32_16x16x32_bf16 v[164:167], a[48:51], a[100:103], v[164:167]
  ds_read_b64_tr_b16 a[28:29], v5 offset:12288
  v_cvt_pk_bf16_f32 v128, v128, v129
  v_mfma_f32_16x16x32_bf16 v[168:171], a[48:51], a[104:107], v[168:171]
  ds_read_b64_tr_b16 a[30:31], v5 offset:12800
  v_cvt_pk_bf16_f32 v129, v130, v131
  v_mfma_f32_16x16x32_bf16 v[168:171], a[52:55], a[120:123], v[168:171]
  v_cvt_pk_bf16_f32 v130, v144, v145
  v_cvt_pk_bf16_f32 v131, v146, v147
  v_mfma_f32_16x16x32_bf16 v[172:175], a[52:55], a[124:127], v[172:175]
  buffer_load_dwordx4 v33, s[16:19], s27 offen offset:3072 lds
  v_mfma_f32_16x16x32_bf16 v[172:175], a[48:51], a[108:111], v[172:175]
  v_cvt_pk_bf16_f32 v132, v132, v133
  v_cvt_pk_bf16_f32 v133, v134, v135
  v_mfma_f32_16x16x32_bf16 v[188:191], a[56:59], a[108:111], v[188:191]
  v_cvt_pk_bf16_f32 v134, v148, v149
  v_cvt_pk_bf16_f32 v135, v150, v151
  v_mfma_f32_16x16x32_bf16 v[188:191], a[60:63], a[124:127], v[188:191]
  v_permlane16_swap_b32 v128, v130
  v_mfma_f32_16x16x32_bf16 v[184:187], a[60:63], a[120:123], v[184:187]
  v_permlane16_swap_b32 v129, v131
  v_mfma_f32_16x16x32_bf16 v[184:187], a[56:59], a[104:107], v[184:187]
  v_accvgpr_write_b32 a128, v128
  v_accvgpr_write_b32 a129, v129
  v_mfma_f32_16x16x32_bf16 v[180:183], a[56:59], a[100:103], v[180:183]
  v_accvgpr_write_b32 a130, v130
  v_accvgpr_write_b32 a131, v131
  v_mfma_f32_16x16x32_bf16 v[180:183], a[60:63], a[116:119], v[180:183]
  v_cvt_pk_bf16_f32 v136, v136, v137
  v_cvt_pk_bf16_f32 v137, v138, v139
  v_mfma_f32_16x16x32_bf16 v[176:179], a[60:63], a[112:115], v[176:179]
  v_cvt_pk_bf16_f32 v138, v152, v153
  v_cvt_pk_bf16_f32 v139, v154, v155
  v_mfma_f32_16x16x32_bf16 v[176:179], a[56:59], a[96:99], v[176:179]
  s_waitcnt lgkmcnt(0)
  v_mfma_f32_16x16x32_bf16 v[192:195], a[0:3], a[64:67], v[192:195]
  s_add_u32 m0, s26, 8192
  s_waitcnt vmcnt(10)
  ds_read_b64_tr_b16 a[32:33], v2 offset:16384
  v_mfma_f32_16x16x32_bf16 v[192:195], a[4:7], a[80:83], v[192:195]
  s_add_u32 s27, s29, 16384
  ds_read_b64_tr_b16 a[34:35], v2 offset:16896
  v_mfma_f32_16x16x32_bf16 v[196:199], a[4:7], a[84:87], v[196:199]
  buffer_load_dwordx4 v32, s[12:15], s27 offen offset:0 lds
  v_mfma_f32_16x16x32_bf16 v[196:199], a[0:3], a[68:71], v[196:199]
  ds_read_b64_tr_b16 a[40:41], v3 offset:16384
  v_mfma_f32_16x16x32_bf16 v[200:203], a[0:3], a[72:75], v[200:203]
  ds_read_b64_tr_b16 a[42:43], v3 offset:16896
  v_mfma_f32_16x16x32_bf16 v[200:203], a[4:7], a[88:91], v[200:203]
  ds_read_b64_tr_b16 a[48:49], v4 offset:16384
  v_mfma_f32_16x16x32_bf16 v[204:207], a[4:7], a[92:95], v[204:207]
  buffer_load_dwordx4 v33, s[16:19], s27 offen offset:2048 lds
  v_mfma_f32_16x16x32_bf16 v[204:207], a[0:3], a[76:79], v[204:207]
  ds_read_b64_tr_b16 a[50:51], v4 offset:16896
  v_mfma_f32_16x16x32_bf16 v[220:223], a[8:11], a[76:79], v[220:223]
  ds_read_b64_tr_b16 a[56:57], v5 offset:16384
  v_mfma_f32_16x16x32_bf16 v[220:223], a[12:15], a[92:95], v[220:223]
  s_add_u32 s27, s29, 19456
  ds_read_b64_tr_b16 a[58:59], v5 offset:16896
  v_mfma_f32_16x16x32_bf16 v[216:219], a[12:15], a[88:91], v[216:219]
  buffer_load_dwordx4 v32, s[12:15], s27 offen offset:1024 lds
  v_mfma_f32_16x16x32_bf16 v[216:219], a[8:11], a[72:75], v[216:219]
  s_waitcnt vmcnt(9)
  ds_read_b64_tr_b16 a[36:37], v2 offset:20480
  v_mfma_f32_16x16x32_bf16 v[212:215], a[8:11], a[68:71], v[212:215]
  ds_read_b64_tr_b16 a[38:39], v2 offset:20992
  v_mfma_f32_16x16x32_bf16 v[212:215], a[12:15], a[84:87], v[212:215]
  ds_read_b64_tr_b16 a[44:45], v3 offset:20480
  v_mfma_f32_16x16x32_bf16 v[208:211], a[12:15], a[80:83], v[208:211]
  buffer_load_dwordx4 v33, s[16:19], s27 offen offset:3072 lds
  v_mfma_f32_16x16x32_bf16 v[208:211], a[8:11], a[64:67], v[208:211]
  ds_read_b64_tr_b16 a[46:47], v3 offset:20992
  v_mfma_f32_16x16x32_bf16 v[224:227], a[16:19], a[64:67], v[224:227]
  s_add_u32 m0, s26, 12288
  ds_read_b64_tr_b16 a[52:53], v4 offset:20480
  v_mfma_f32_16x16x32_bf16 v[224:227], a[20:23], a[80:83], v[224:227]
  s_add_u32 s27, s29, 24576
  ds_read_b64_tr_b16 a[54:55], v4 offset:20992
  v_mfma_f32_16x16x32_bf16 v[228:231], a[20:23], a[84:87], v[228:231]
  buffer_load_dwordx4 v32, s[12:15], s27 offen offset:0 lds
  v_mfma_f32_16x16x32_bf16 v[228:231], a[16:19], a[68:71], v[228:231]
  ds_read_b64_tr_b16 a[60:61], v5 offset:20480
  v_mfma_f32_16x16x32_bf16 v[232:235], a[16:19], a[72:75], v[232:235]
  ds_read_b64_tr_b16 a[62:63], v5 offset:20992
  v_mfma_f32_16x16x32_bf16 v[232:235], a[20:23], a[88:91], v[232:235]
  v_permlane16_swap_b32 v132, v134
  v_mfma_f32_16x16x32_bf16 v[236:239], a[20:23], a[92:95], v[236:239]
  buffer_load_dwordx4 v33, s[16:19], s27 offen offset:2048 lds
  v_mfma_f32_16x16x32_bf16 v[236:239], a[16:19], a[76:79], v[236:239]
  v_permlane16_swap_b32 v133, v135
  v_mfma_f32_16x16x32_bf16 v[252:255], a[24:27], a[76:79], v[252:255]
  v_accvgpr_write_b32 a144, v132
  v_accvgpr_write_b32 a145, v133
  v_mfma_f32_16x16x32_bf16 v[252:255], a[28:31], a[92:95], v[252:255]
  s_add_u32 s27, s29, 27648
  v_accvgpr_write_b32 a146, v134
  v_mfma_f32_16x16x32_bf16 v[248:251], a[28:31], a[88:91], v[248:251]
  buffer_load_dwordx4 v32, s[12:15], s27 offen offset:1024 lds
  v_mfma_f32_16x16x32_bf16 v[248:251], a[24:27], a[72:75], v[248:251]
  v_accvgpr_write_b32 a147, v135
  v_cvt_pk_bf16_f32 v140, v140, v141
  v_mfma_f32_16x16x32_bf16 v[244:247], a[24:27], a[68:71], v[244:247]
  v_cvt_pk_bf16_f32 v141, v142, v143
  v_cvt_pk_bf16_f32 v142, v156, v157
  v_mfma_f32_16x16x32_bf16 v[244:247], a[28:31], a[84:87], v[244:247]
  v_cvt_pk_bf16_f32 v143, v158, v159
  v_mfma_f32_16x16x32_bf16 v[240:243], a[28:31], a[80:83], v[240:243]
  buffer_load_dwordx4 v33, s[16:19], s27 offen offset:3072 lds
  v_mfma_f32_16x16x32_bf16 v[240:243], a[24:27], a[64:67], v[240:243]
  s_waitcnt lgkmcnt(0)
  v_mfma_f32_16x16x32_bf16 v[192:195], a[32:35], a[96:99], v[192:195]
  s_mov_b64 exec, 0xffffffff
  buffer_load_dword a64, v17, s[40:43], s34 offen
  s_mov_b64 exec, -1
  v_mfma_f32_16x16x32_bf16 v[192:195], a[36:39], a[112:115], v[192:195]
  v_mfma_f32_16x16x32_bf16 v[196:199], a[36:39], a[116:119], v[196:199]
  s_mov_b64 exec, 0xffff
  buffer_load_dword a65, v14, s[56:59], s35 offen offset:2048
  s_mov_b64 exec, -1
  v_mfma_f32_16x16x32_bf16 v[196:199], a[32:35], a[100:103], v[196:199]
  v_permlane16_swap_b32 v136, v138
  v_mfma_f32_16x16x32_bf16 v[200:203], a[32:35], a[104:107], v[200:203]
  v_permlane16_swap_b32 v137, v139
  v_mfma_f32_16x16x32_bf16 v[200:203], a[36:39], a[120:123], v[200:203]
  v_accvgpr_write_b32 a160, v136
  v_accvgpr_write_b32 a161, v137
  v_mfma_f32_16x16x32_bf16 v[204:207], a[36:39], a[124:127], v[204:207]
  v_accvgpr_write_b32 a162, v138
  v_accvgpr_write_b32 a163, v139
  v_mfma_f32_16x16x32_bf16 v[204:207], a[32:35], a[108:111], v[204:207]
  v_cvt_pk_bf16_f32 v160, v160, v161
  v_cvt_pk_bf16_f32 v161, v162, v163
  v_mfma_f32_16x16x32_bf16 v[220:223], a[40:43], a[108:111], v[220:223]
  v_cvt_pk_bf16_f32 v162, v176, v177
  v_cvt_pk_bf16_f32 v163, v178, v179
  v_mfma_f32_16x16x32_bf16 v[220:223], a[44:47], a[124:127], v[220:223]
  s_waitcnt vmcnt(10)
  s_barrier
  v_mfma_f32_16x16x32_bf16 v[216:219], a[44:47], a[120:123], v[216:219]
  ds_read_b128 a[192:195], v20 offset:0
  v_mfma_f32_16x16x32_bf16 v[216:219], a[40:43], a[104:107], v[216:219]
  ds_read_b128 a[196:199], v21 offset:0
  v_mfma_f32_16x16x32_bf16 v[212:215], a[40:43], a[100:103], v[212:215]
  ds_read_b128 a[208:211], v20 offset:1024
  v_mfma_f32_16x16x32_bf16 v[212:215], a[44:47], a[116:119], v[212:215]
  ds_read_b128 a[212:215], v21 offset:1024
  v_mfma_f32_16x16x32_bf16 v[208:211], a[44:47], a[112:115], v[208:211]
  v_permlane16_swap_b32 v140, v142
  v_mfma_f32_16x16x32_bf16 v[208:211], a[40:43], a[96:99], v[208:211]
  ds_read_b128 a[200:203], v22 offset:0
  v_mfma_f32_16x16x32_bf16 v[224:227], a[48:51], a[96:99], v[224:227]
  ds_read_b128 a[204:207], v23 offset:0
  v_mfma_f32_16x16x32_bf16 v[224:227], a[52:55], a[112:115], v[224:227]
  v_permlane16_swap_b32 v141, v143
  v_mfma_f32_16x16x32_bf16 v[228:231], a[52:55], a[116:119], v[228:231]
  v_accvgpr_write_b32 a176, v140
  v_accvgpr_write_b32 a177, v141
  v_mfma_f32_16x16x32_bf16 v[228:231], a[48:51], a[100:103], v[228:231]
  v_accvgpr_write_b32 a178, v142
  v_accvgpr_write_b32 a179, v143
  v_mfma_f32_16x16x32_bf16 v[232:235], a[48:51], a[104:107], v[232:235]
  v_cvt_pk_bf16_f32 v164, v164, v165
  v_cvt_pk_bf16_f32 v165, v166, v167
  v_mfma_f32_16x16x32_bf16 v[232:235], a[52:55], a[120:123], v[232:235]
  v_cvt_pk_bf16_f32 v166, v180, v181
  v_cvt_pk_bf16_f32 v167, v182, v183
  v_mfma_f32_16x16x32_bf16 v[236:239], a[52:55], a[124:127], v[236:239]
  v_permlane16_swap_b32 v160, v162
  v_mfma_f32_16x16x32_bf16 v[236:239], a[48:51], a[108:111], v[236:239]
  v_permlane16_swap_b32 v161, v163
  v_mfma_f32_16x16x32_bf16 v[252:255], a[56:59], a[108:111], v[252:255]
  v_accvgpr_write_b32 a132, v160
  v_accvgpr_write_b32 a133, v161
  v_mfma_f32_16x16x32_bf16 v[252:255], a[60:63], a[124:127], v[252:255]
  v_accvgpr_write_b32 a134, v162
  v_accvgpr_write_b32 a135, v163
  v_mfma_f32_16x16x32_bf16 v[248:251], a[60:63], a[120:123], v[248:251]
  v_cvt_pk_bf16_f32 v168, v168, v169
  v_cvt_pk_bf16_f32 v169, v170, v171
  v_mfma_f32_16x16x32_bf16 v[248:251], a[56:59], a[104:107], v[248:251]
  v_cvt_pk_bf16_f32 v170, v184, v185
  v_cvt_pk_bf16_f32 v171, v186, v187
  v_mfma_f32_16x16x32_bf16 v[244:247], a[56:59], a[100:103], v[244:247]
  v_permlane16_swap_b32 v164, v166
  v_mfma_f32_16x16x32_bf16 v[244:247], a[60:63], a[116:119], v[244:247]
  v_permlane16_swap_b32 v165, v167
  v_mfma_f32_16x16x32_bf16 v[240:243], a[60:63], a[112:115], v[240:243]
  v_accvgpr_write_b32 a148, v164
  v_accvgpr_write_b32 a149, v165
  v_mfma_f32_16x16x32_bf16 v[240:243], a[56:59], a[96:99], v[240:243]
  v_accvgpr_write_b32 a150, v166
  s_waitcnt lgkmcnt(0)
  v_mfma_f32_16x16x32_bf16 v[48:51], a[192:195], a[128:131], 0
  v_accvgpr_write_b32 a151, v167
  v_cvt_pk_bf16_f32 v172, v172, v173
  v_mfma_f32_16x16x32_bf16 v[48:51], a[196:199], a[132:135], v[48:51]
  v_cvt_pk_bf16_f32 v173, v174, v175
  v_cvt_pk_bf16_f32 v174, v188, v189
  v_mfma_f32_16x16x32_bf16 v[52:55], a[208:211], a[128:131], 0
  ds_read_b128 a[216:219], v22 offset:1024
  v_cvt_pk_bf16_f32 v175, v190, v191
  v_mfma_f32_16x16x32_bf16 v[52:55], a[212:215], a[132:135], v[52:55]
  v_permlane16_swap_b32 v168, v170
  v_mfma_f32_16x16x32_bf16 v[56:59], a[192:195], a[144:147], 0
  v_permlane16_swap_b32 v169, v171
  v_mfma_f32_16x16x32_bf16 v[56:59], a[196:199], a[148:151], v[56:59]
  v_accvgpr_write_b32 a164, v168
  v_accvgpr_write_b32 a165, v169
  v_mfma_f32_16x16x32_bf16 v[60:63], a[208:211], a[144:147], 0
  v_accvgpr_write_b32 a166, v170
  v_accvgpr_write_b32 a167, v171
  v_mfma_f32_16x16x32_bf16 v[60:63], a[212:215], a[148:151], v[60:63]
  ds_read_b128 a[220:223], v23 offset:1024
  v_cvt_pk_bf16_f32 v192, v192, v193
  v_mfma_f32_16x16x32_bf16 v[64:67], a[192:195], a[160:163], 0
  v_cvt_pk_bf16_f32 v193, v194, v195
  v_cvt_pk_bf16_f32 v194, v208, v209
  v_mfma_f32_16x16x32_bf16 v[64:67], a[196:199], a[164:167], v[64:67]
  v_cvt_pk_bf16_f32 v195, v210, v211
  v_cvt_pk_bf16_f32 v224, v224, v225
  v_mfma_f32_16x16x32_bf16 v[68:71], a[208:211], a[160:163], 0
  v_permlane16_swap_b32 v172, v174
  v_mfma_f32_16x16x32_bf16 v[68:71], a[212:215], a[164:167], v[68:71]
  v_permlane16_swap_b32 v173, v175
  v_mfma_f32_16x16x32_bf16 v[72:75], a[192:195], a[176:179], 0
  v_accvgpr_write_b32 a180, v172
  v_accvgpr_write_b32 a181, v173
  v_accvgpr_write_b32 a182, v174
  v_accvgpr_write_b32 a183, v175
  s_nop 1
  v_mfma_f32_16x16x32_bf16 v[72:75], a[196:199], a[180:183], v[72:75]
  v_cvt_pk_bf16_f32 v196, v196, v197
  v_cvt_pk_bf16_f32 v197, v198, v199
  v_mfma_f32_16x16x32_bf16 v[76:79], a[208:211], a[176:179], 0
  v_cvt_pk_bf16_f32 v198, v212, v213
  v_cvt_pk_bf16_f32 v199, v214, v215
  v_mfma_f32_16x16x32_bf16 v[76:79], a[212:215], a[180:183], v[76:79]
  v_permlane16_swap_b32 v192, v194
  v_permlane16_swap_b32 v193, v195
  v_accvgpr_write_b32 a136, v192
  v_accvgpr_write_b32 a137, v193
  v_accvgpr_write_b32 a138, v194
  v_accvgpr_write_b32 a139, v195
  s_nop 1
  v_mfma_f32_16x16x32_bf16 v[48:51], a[200:203], a[136:139], v[48:51]
  v_cvt_pk_bf16_f32 v225, v226, v227
  v_cvt_pk_bf16_f32 v226, v240, v241
  v_cvt_pk_bf16_f32 v227, v242, v243
  v_cvt_pk_bf16_f32 v228, v228, v229
  v_cvt_pk_bf16_f32 v229, v230, v231
  v_cvt_pk_bf16_f32 v230, v244, v245
  v_cvt_pk_bf16_f32 v231, v246, v247
  v_permlane16_swap_b32 v224, v226
  v_permlane16_swap_b32 v225, v227
  v_accvgpr_write_b32 a140, v224
  v_accvgpr_write_b32 a141, v225
  v_accvgpr_write_b32 a142, v226
  v_accvgpr_write_b32 a143, v227
  s_nop 1
  v_mfma_f32_16x16x32_bf16 v[48:51], a[204:207], a[140:143], v[48:51]
  v_cvt_pk_bf16_f32 v200, v200, v201
  v_cvt_pk_bf16_f32 v201, v202, v203
  s_waitcnt lgkmcnt(0)
  v_mfma_f32_16x16x32_bf16 v[52:55], a[216:219], a[136:139], v[52:55]
  v_cvt_pk_bf16_f32 v202, v216, v217
  v_cvt_pk_bf16_f32 v203, v218, v219
  v_mfma_f32_16x16x32_bf16 v[52:55], a[220:223], a[140:143], v[52:55]
  v_permlane16_swap_b32 v196, v198
  v_permlane16_swap_b32 v197, v199
  v_accvgpr_write_b32 a152, v196
  v_accvgpr_write_b32 a153, v197
  v_accvgpr_write_b32 a154, v198
  v_accvgpr_write_b32 a155, v199
  s_nop 1
  v_mfma_f32_16x16x32_bf16 v[56:59], a[200:203], a[152:155], v[56:59]
  v_cvt_pk_bf16_f32 v232, v232, v233
  v_cvt_pk_bf16_f32 v233, v234, v235
  v_cvt_pk_bf16_f32 v234, v248, v249
  v_cvt_pk_bf16_f32 v235, v250, v251
  v_permlane16_swap_b32 v228, v230
  v_permlane16_swap_b32 v229, v231
  v_accvgpr_write_b32 a156, v228
  v_accvgpr_write_b32 a157, v229
  v_accvgpr_write_b32 a158, v230
  v_accvgpr_write_b32 a159, v231
  s_nop 1
  v_mfma_f32_16x16x32_bf16 v[56:59], a[204:207], a[156:159], v[56:59]
  v_cvt_pk_bf16_f32 v204, v204, v205
  v_cvt_pk_bf16_f32 v205, v206, v207
  v_mfma_f32_16x16x32_bf16 v[60:63], a[216:219], a[152:155], v[60:63]
  v_cvt_pk_bf16_f32 v206, v220, v221
  v_cvt_pk_bf16_f32 v207, v222, v223
  v_mfma_f32_16x16x32_bf16 v[60:63], a[220:223], a[156:159], v[60:63]
  v_permlane16_swap_b32 v200, v202
  v_permlane16_swap_b32 v201, v203
  v_accvgpr_write_b32 a168, v200
  v_accvgpr_write_b32 a169, v201
  v_accvgpr_write_b32 a170, v202
  v_accvgpr_write_b32 a171, v203
  s_nop 1
  v_mfma_f32_16x16x32_bf16 v[64:67], a[200:203], a[168:171], v[64:67]
  v_cvt_pk_bf16_f32 v236, v236, v237
  v_cvt_pk_bf16_f32 v237, v238, v239
  v_cvt_pk_bf16_f32 v238, v252, v253
  v_cvt_pk_bf16_f32 v239, v254, v255
  v_permlane16_swap_b32 v232, v234
  v_permlane16_swap_b32 v233, v235
  v_accvgpr_write_b32 a172, v232
  v_accvgpr_write_b32 a173, v233
  v_accvgpr_write_b32 a174, v234
  v_accvgpr_write_b32 a175, v235
  s_nop 1
  v_mfma_f32_16x16x32_bf16 v[64:67], a[204:207], a[172:175], v[64:67]
  ds_read_b64_tr_b16 a[224:225], v24 offset:4096
  ds_read_b64_tr_b16 a[226:227], v24 offset:5120
  v_mfma_f32_16x16x32_bf16 v[68:71], a[216:219], a[168:171], v[68:71]
  ds_read_b64_tr_b16 a[228:229], v25 offset:4096
  ds_read_b64_tr_b16 a[230:231], v25 offset:5120
  v_mfma_f32_16x16x32_bf16 v[68:71], a[220:223], a[172:175], v[68:71]
  ds_read_b64_tr_b16 a[232:233], v26 offset:4096
  ds_read_b64_tr_b16 a[234:235], v26 offset:5120
  v_permlane16_swap_b32 v204, v206
  v_permlane16_swap_b32 v205, v207
  v_accvgpr_write_b32 a184, v204
  v_accvgpr_write_b32 a185, v205
  v_accvgpr_write_b32 a186, v206
  v_accvgpr_write_b32 a187, v207
  s_nop 1
  v_mfma_f32_16x16x32_bf16 v[72:75], a[200:203], a[184:187], v[72:75]
  ds_read_b64_tr_b16 a[236:237], v27 offset:4096
  ds_read_b64_tr_b16 a[238:239], v27 offset:5120
  v_permlane16_swap_b32 v236, v238
  v_permlane16_swap_b32 v237, v239
  v_accvgpr_write_b32 a188, v236
  v_accvgpr_write_b32 a189, v237
  v_accvgpr_write_b32 a190, v238
  v_accvgpr_write_b32 a191, v239
  s_nop 1
  v_mfma_f32_16x16x32_bf16 v[72:75], a[204:207], a[188:191], v[72:75]
  ds_read_b64_tr_b16 a[240:241], v28 offset:4096
  ds_read_b64_tr_b16 a[242:243], v28 offset:5120
  v_mfma_f32_16x16x32_bf16 v[76:79], a[216:219], a[184:187], v[76:79]
  ds_read_b64_tr_b16 a[244:245], v29 offset:4096
  ds_read_b64_tr_b16 a[246:247], v29 offset:5120
  v_mfma_f32_16x16x32_bf16 v[76:79], a[220:223], a[188:191], v[76:79]
  ds_read_b64_tr_b16 a[248:249], v30 offset:4096
  ds_read_b64_tr_b16 a[250:251], v30 offset:5120
  v_max3_f32 v36, v48, v49, v50
  v_max3_f32 v37, v51, v52, v53
  v_max3_f32 v36, v36, v54, v55
  v_max_f32 v36, v36, v37
  v_mov_b32 v37, v36
  s_nop 1
  v_permlane16_swap_b32 v36, v37
  v_max_f32 v36, v36, v37
  v_mov_b32 v37, v36
  s_nop 1
  v_permlane32_swap_b32 v36, v37
  v_max_f32 v36, v36, v37
  v_sub_f32 v48, v48, v36
  v_sub_f32 v49, v49, v36
  v_sub_f32 v50, v50, v36
  v_sub_f32 v51, v51, v36
  v_sub_f32 v52, v52, v36
  v_sub_f32 v53, v53, v36
  v_sub_f32 v54, v54, v36
  v_sub_f32 v55, v55, v36
  v_exp_f32 v48, v48
  v_exp_f32 v49, v49
  v_exp_f32 v50, v50
  v_cvt_pk_bf16_f32 v80, v48, v49
  v_exp_f32 v51, v51
  v_exp_f32 v52, v52
  v_cvt_pk_bf16_f32 v81, v50, v51
  v_exp_f32 v53, v53
  v_exp_f32 v54, v54
  v_cvt_pk_bf16_f32 v82, v52, v53
  v_exp_f32 v55, v55
  s_nop 0
  v_cvt_pk_bf16_f32 v83, v54, v55
  s_nop 1
  v_mfma_f32_16x16x32_bf16 v[112:115], v[44:47], v[80:83], 0
  ds_read_b64_tr_b16 a[252:253], v31 offset:4096
  ds_read_b64_tr_b16 a[254:255], v31 offset:5120
  s_waitcnt lgkmcnt(2)
  v_mfma_f32_16x16x32_bf16 v[128:131], a[224:227], v[80:83], 0
  v_max3_f32 v38, v56, v57, v58
  v_max3_f32 v39, v59, v60, v61
  v_mfma_f32_16x16x32_bf16 v[132:135], a[228:231], v[80:83], 0
  v_max3_f32 v38, v38, v62, v63
  v_max_f32 v38, v38, v39
  v_mfma_f32_16x16x32_bf16 v[136:139], a[232:235], v[80:83], 0
  ds_read_b128 a[192:195], v20 offset:4096
  v_mov_b32 v39, v38
  v_mfma_f32_16x16x32_bf16 v[140:143], a[236:239], v[80:83], 0
  s_nop 0
  v_permlane16_swap_b32 v38, v39
  v_mfma_f32_16x16x32_bf16 v[144:147], a[240:243], v[80:83], 0
  v_max_f32 v38, v38, v39
  v_mov_b32 v39, v38
  v_mfma_f32_16x16x32_bf16 v[148:151], a[244:247], v[80:83], 0
  s_nop 0
  v_permlane32_swap_b32 v38, v39
  v_mfma_f32_16x16x32_bf16 v[152:155], a[248:251], v[80:83], 0
  v_max_f32 v38, v38, v39
  v_sub_f32 v56, v56, v38
  s_waitcnt lgkmcnt(1)
  v_mfma_f32_16x16x32_bf16 v[156:159], a[252:255], v[80:83], 0
  v_sub_f32 v57, v57, v38
  v_sub_f32 v58, v58, v38
  v_sub_f32 v59, v59, v38
  v_sub_f32 v60, v60, v38
  v_sub_f32 v61, v61, v38
  v_sub_f32 v62, v62, v38
  v_sub_f32 v63, v63, v38
  v_exp_f32 v56, v56
  v_exp_f32 v57, v57
  v_exp_f32 v58, v58
  v_cvt_pk_bf16_f32 v84, v56, v57
  v_exp_f32 v59, v59
  v_exp_f32 v60, v60
  v_cvt_pk_bf16_f32 v85, v58, v59
  v_exp_f32 v61, v61
  v_exp_f32 v62, v62
  v_cvt_pk_bf16_f32 v86, v60, v61
  v_exp_f32 v63, v63
  s_nop 0
  v_cvt_pk_bf16_f32 v87, v62, v63
  s_nop 1
  v_mfma_f32_16x16x32_bf16 v[116:119], v[44:47], v[84:87], 0
  ds_read_b128 a[196:199], v21 offset:4096
  v_sub_f32 v96, 0, v36
  v_mfma_f32_16x16x32_bf16 v[160:163], a[224:227], v[84:87], 0
  ds_read_b128 a[200:203], v22 offset:4096
  v_sub_f32 v97, 0, v36
  v_mfma_f32_16x16x32_bf16 v[164:167], a[228:231], v[84:87], 0
  ds_read_b128 a[204:207], v23 offset:4096
  v_sub_f32 v98, 0, v36
  v_mfma_f32_16x16x32_bf16 v[168:171], a[232:235], v[84:87], 0
  ds_read_b128 a[220:223], v23 offset:5120
  v_sub_f32 v99, 0, v36
  v_mfma_f32_16x16x32_bf16 v[172:175], a[236:239], v[84:87], 0
  ds_read_b128 a[216:219], v22 offset:5120
  v_sub_f32 v100, 0, v38
  v_mfma_f32_16x16x32_bf16 v[176:179], a[240:243], v[84:87], 0
  ds_read_b128 a[212:215], v21 offset:5120
  v_sub_f32 v101, 0, v38
  v_mfma_f32_16x16x32_bf16 v[180:183], a[244:247], v[84:87], 0
  ds_read_b128 a[208:211], v20 offset:5120
  v_sub_f32 v102, 0, v38
  v_mfma_f32_16x16x32_bf16 v[184:187], a[248:251], v[84:87], 0
  v_sub_f32 v103, 0, v38
  v_max3_f32 v40, v64, v65, v66
  v_mfma_f32_16x16x32_bf16 v[188:191], a[252:255], v[84:87], 0
  v_max3_f32 v41, v67, v68, v69
  v_max3_f32 v40, v40, v70, v71
  s_waitcnt lgkmcnt(7)
  v_mfma_f32_16x16x32_bf16 v[48:51], a[192:195], a[128:131], v[96:99]
  v_max_f32 v40, v40, v41
  v_mov_b32 v41, v40
  s_waitcnt lgkmcnt(6)
  v_mfma_f32_16x16x32_bf16 v[48:51], a[196:199], a[132:135], v[48:51]
  v_permlane16_swap_b32 v40, v41
  s_waitcnt lgkmcnt(5)
  v_mfma_f32_16x16x32_bf16 v[48:51], a[200:203], a[136:139], v[48:51]
  v_max_f32 v40, v40, v41
  v_mov_b32 v41, v40
  s_waitcnt lgkmcnt(4)
  v_mfma_f32_16x16x32_bf16 v[48:51], a[204:207], a[140:143], v[48:51]
  v_permlane32_swap_b32 v40, v41
  s_waitcnt lgkmcnt(3)
  v_mfma_f32_16x16x32_bf16 v[52:55], a[220:223], a[140:143], v[96:99]
  v_max_f32 v40, v40, v41
  v_sub_f32 v64, v64, v40
  s_waitcnt lgkmcnt(2)
  v_mfma_f32_16x16x32_bf16 v[52:55], a[216:219], a[136:139], v[52:55]
  v_sub_f32 v65, v65, v40
  v_sub_f32 v66, v66, v40
  s_waitcnt lgkmcnt(1)
  v_mfma_f32_16x16x32_bf16 v[52:55], a[212:215], a[132:135], v[52:55]
  v_sub_f32 v67, v67, v40
  v_sub_f32 v68, v68, v40
  s_waitcnt lgkmcnt(0)
  v_mfma_f32_16x16x32_bf16 v[52:55], a[208:211], a[128:131], v[52:55]
  v_sub_f32 v69, v69, v40
  v_sub_f32 v70, v70, v40
  v_mfma_f32_16x16x32_bf16 v[60:63], a[208:211], a[144:147], v[100:103]
  v_sub_f32 v71, v71, v40
  v_mfma_f32_16x16x32_bf16 v[60:63], a[212:215], a[148:151], v[60:63]
  v_exp_f32 v64, v64
  v_mfma_f32_16x16x32_bf16 v[60:63], a[216:219], a[152:155], v[60:63]
  v_exp_f32 v65, v65
  v_mfma_f32_16x16x32_bf16 v[60:63], a[220:223], a[156:159], v[60:63]
  v_exp_f32 v66, v66
  v_mfma_f32_16x16x32_bf16 v[56:59], a[204:207], a[156:159], v[100:103]
  v_cvt_pk_bf16_f32 v88, v64, v65
  v_mfma_f32_16x16x32_bf16 v[56:59], a[200:203], a[152:155], v[56:59]
  v_exp_f32 v67, v67
  v_mfma_f32_16x16x32_bf16 v[56:59], a[196:199], a[148:151], v[56:59]
  v_exp_f32 v68, v68
  v_mfma_f32_16x16x32_bf16 v[56:59], a[192:195], a[144:147], v[56:59]
  s_waitcnt vmcnt(2)
  s_barrier
  v_cvt_pk_bf16_f32 v89, v66, v67
  v_exp_f32 v69, v69
  v_exp_f32 v70, v70
  v_cvt_pk_bf16_f32 v90, v68, v69
  v_exp_f32 v71, v71
  s_nop 0
  v_cvt_pk_bf16_f32 v91, v70, v71
  s_nop 1
  v_mfma_f32_16x16x32_bf16 v[120:123], v[44:47], v[88:91], 0
  v_max3_f32 v42, v72, v73, v74
  v_max3_f32 v43, v75, v76, v77
  v_mfma_f32_16x16x32_bf16 v[192:195], a[224:227], v[88:91], 0
  v_max3_f32 v42, v42, v78, v79
  v_max_f32 v42, v42, v43
  v_mfma_f32_16x16x32_bf16 v[196:199], a[228:231], v[88:91], 0
  v_mov_b32 v43, v42
  v_mfma_f32_16x16x32_bf16 v[200:203], a[232:235], v[88:91], 0
  s_nop 0
  v_permlane16_swap_b32 v42, v43
  v_mfma_f32_16x16x32_bf16 v[204:207], a[236:239], v[88:91], 0
  v_max_f32 v42, v42, v43
  v_mov_b32 v43, v42
  v_mfma_f32_16x16x32_bf16 v[208:211], a[240:243], v[88:91], 0
  s_nop 0
  v_permlane32_swap_b32 v42, v43
  v_mfma_f32_16x16x32_bf16 v[212:215], a[244:247], v[88:91], 0
  v_max_f32 v42, v42, v43
  v_sub_f32 v72, v72, v42
  v_mfma_f32_16x16x32_bf16 v[216:219], a[248:251], v[88:91], 0
  v_sub_f32 v73, v73, v42
  v_sub_f32 v74, v74, v42
  v_mfma_f32_16x16x32_bf16 v[220:223], a[252:255], v[88:91], 0
  v_sub_f32 v75, v75, v42
  v_sub_f32 v76, v76, v42
  v_sub_f32 v77, v77, v42
  v_sub_f32 v78, v78, v42
  v_sub_f32 v79, v79, v42
  v_exp_f32 v72, v72
  v_exp_f32 v73, v73
  v_exp_f32 v74, v74
  v_cvt_pk_bf16_f32 v92, v72, v73
  v_exp_f32 v75, v75
  v_exp_f32 v76, v76
  v_cvt_pk_bf16_f32 v93, v74, v75
  v_exp_f32 v77, v77
  v_exp_f32 v78, v78
  v_cvt_pk_bf16_f32 v94, v76, v77
  v_exp_f32 v79, v79
  s_nop 0
  v_cvt_pk_bf16_f32 v95, v78, v79
  s_nop 1
  v_mfma_f32_16x16x32_bf16 v[124:127], v[44:47], v[92:95], 0
  v_exp_f32 v48, v48
  v_mfma_f32_16x16x32_bf16 v[224:227], a[224:227], v[92:95], 0
  v_exp_f32 v49, v49
  v_mfma_f32_16x16x32_bf16 v[228:231], a[228:231], v[92:95], 0
  v_exp_f32 v50, v50
  v_mfma_f32_16x16x32_bf16 v[232:235], a[232:235], v[92:95], 0
  v_exp_f32 v51, v51
  v_mfma_f32_16x16x32_bf16 v[236:239], a[236:239], v[92:95], 0
  v_sub_f32 v104, 0, v40
  v_sub_f32 v105, 0, v40
  v_mfma_f32_16x16x32_bf16 v[240:243], a[240:243], v[92:95], 0
  v_sub_f32 v106, 0, v40
  v_sub_f32 v107, 0, v40
  v_mfma_f32_16x16x32_bf16 v[244:247], a[244:247], v[92:95], 0
  v_exp_f32 v52, v52
  v_mfma_f32_16x16x32_bf16 v[248:251], a[248:251], v[92:95], 0
  v_exp_f32 v53, v53
  v_mfma_f32_16x16x32_bf16 v[252:255], a[252:255], v[92:95], 0
  v_exp_f32 v54, v54
  v_mfma_f32_16x16x32_bf16 v[64:67], a[192:195], a[160:163], v[104:107]
  v_exp_f32 v55, v55
  v_mfma_f32_16x16x32_bf16 v[64:67], a[196:199], a[164:167], v[64:67]
  v_sub_f32 v108, 0, v42
  v_sub_f32 v109, 0, v42
  v_mfma_f32_16x16x32_bf16 v[64:67], a[200:203], a[168:171], v[64:67]
  v_sub_f32 v110, 0, v42
  v_sub_f32 v111, 0, v42
  v_mfma_f32_16x16x32_bf16 v[64:67], a[204:207], a[172:175], v[64:67]
  ds_read_b64_tr_b16 a[224:225], v24 offset:8192
  v_cvt_pk_bf16_f32 v80, v48, v49
  v_mfma_f32_16x16x32_bf16 v[68:71], a[220:223], a[172:175], v[104:107]
  ds_read_b64_tr_b16 a[226:227], v24 offset:9216
  v_cvt_pk_bf16_f32 v81, v50, v51
  v_mfma_f32_16x16x32_bf16 v[68:71], a[216:219], a[168:171], v[68:71]
  v_exp_f32 v60, v60
  v_mfma_f32_16x16x32_bf16 v[68:71], a[212:215], a[164:167], v[68:71]
  ds_read_b64_tr_b16 a[228:229], v25 offset:8192
  v_cvt_pk_bf16_f32 v82, v52, v53
  v_mfma_f32_16x16x32_bf16 v[68:71], a[208:211], a[160:163], v[68:71]
  ds_read_b64_tr_b16 a[230:231], v25 offset:9216
  v_cvt_pk_bf16_f32 v83, v54, v55
  v_mfma_f32_16x16x32_bf16 v[76:79], a[208:211], a[176:179], v[108:111]
  v_exp_f32 v61, v61
  v_mfma_f32_16x16x32_bf16 v[76:79], a[212:215], a[180:183], v[76:79]
  ds_read_b64_tr_b16 a[232:233], v26 offset:8192
  v_cvt_pk_bf16_f32 v86, v60, v61
  v_mfma_f32_16x16x32_bf16 v[76:79], a[216:219], a[184:187], v[76:79]
  ds_read_b64_tr_b16 a[234:235], v26 offset:9216
  v_mfma_f32_16x16x32_bf16 v[76:79], a[220:223], a[188:191], v[76:79]
  ds_read_b128 a[208:211], v20 offset:9216
  v_mfma_f32_16x16x32_bf16 v[72:75], a[204:207], a[188:191], v[108:111]
  v_exp_f32 v62, v62
  v_exp_f32 v63, v63
  v_exp_f32 v56, v56
  v_exp_f32 v57, v57
  v_exp_f32 v58, v58
  v_exp_f32 v59, v59
  v_mfma_f32_16x16x32_bf16 v[72:75], a[200:203], a[184:187], v[72:75]
  ds_read_b64_tr_b16 a[236:237], v27 offset:8192
  v_cvt_pk_bf16_f32 v87, v62, v63
  v_mfma_f32_16x16x32_bf16 v[72:75], a[196:199], a[180:183], v[72:75]
  ds_read_b64_tr_b16 a[238:239], v27 offset:9216
  ds_read_b128 a[212:215], v21 offset:9216
  v_cvt_pk_bf16_f32 v84, v56, v57
  v_cvt_pk_bf16_f32 v85, v58, v59
  v_mfma_f32_16x16x32_bf16 v[72:75], a[192:195], a[176:179], v[72:75]
  ds_read_b64_tr_b16 a[240:241], v28 offset:8192
  s_waitcnt lgkmcnt(4)
  v_mfma_f32_16x16x32_bf16 v[128:131], a[224:227], v[80:83], v[128:131]
  ds_read_b64_tr_b16 a[242:243], v28 offset:9216
  ds_read_b128 a[216:219], v22 offset:9216
  v_mfma_f32_16x16x32_bf16 v[160:163], a[224:227], v[84:87], v[160:163]
  ds_read_b64_tr_b16 a[244:245], v29 offset:8192
  v_mfma_f32_16x16x32_bf16 v[164:167], a[228:231], v[84:87], v[164:167]
  ds_read_b64_tr_b16 a[246:247], v29 offset:9216
  ds_read_b128 a[220:223], v23 offset:9216
  v_mfma_f32_16x16x32_bf16 v[132:135], a[228:231], v[80:83], v[132:135]
  ds_read_b64_tr_b16 a[248:249], v30 offset:8192
  v_mfma_f32_16x16x32_bf16 v[136:139], a[232:235], v[80:83], v[136:139]
  ds_read_b64_tr_b16 a[250:251], v30 offset:9216
  ds_read_b128 a[204:207], v23 offset:8192
  v_mfma_f32_16x16x32_bf16 v[168:171], a[232:235], v[84:87], v[168:171]
  ds_read_b64_tr_b16 a[252:253], v31 offset:8192
  s_waitcnt lgkmcnt(10)
  v_mfma_f32_16x16x32_bf16 v[172:175], a[236:239], v[84:87], v[172:175]
  ds_read_b64_tr_b16 a[254:255], v31 offset:9216
  ds_read_b128 a[200:203], v22 offset:8192
  v_mfma_f32_16x16x32_bf16 v[140:143], a[236:239], v[80:83], v[140:143]
  ds_read_b128 a[196:199], v21 offset:8192
  s_waitcnt lgkmcnt(11)
  v_mfma_f32_16x16x32_bf16 v[144:147], a[240:243], v[80:83], v[144:147]
  ds_read_b128 a[192:195], v20 offset:8192
  s_waitcnt lgkmcnt(10)
  v_mfma_f32_16x16x32_bf16 v[176:179], a[240:243], v[84:87], v[176:179]
  v_exp_f32 v64, v64
  s_waitcnt lgkmcnt(9)
  v_mfma_f32_16x16x32_bf16 v[180:183], a[244:247], v[84:87], v[180:183]
  v_exp_f32 v65, v65
  v_mfma_f32_16x16x32_bf16 v[148:151], a[244:247], v[80:83], v[148:151]
  v_exp_f32 v66, v66
  s_waitcnt lgkmcnt(6)
  v_mfma_f32_16x16x32_bf16 v[152:155], a[248:251], v[80:83], v[152:155]
  v_exp_f32 v67, v67
  v_mfma_f32_16x16x32_bf16 v[184:187], a[248:251], v[84:87], v[184:187]
  v_exp_f32 v68, v68
  s_waitcnt lgkmcnt(3)
  v_mfma_f32_16x16x32_bf16 v[188:191], a[252:255], v[84:87], v[188:191]
  v_exp_f32 v69, v69
  v_mfma_f32_16x16x32_bf16 v[156:159], a[252:255], v[80:83], v[156:159]
  v_exp_f32 v70, v70
  v_mfma_f32_16x16x32_bf16 v[112:115], v[44:47], v[80:83], v[112:115]
  v_exp_f32 v71, v71
  v_mfma_f32_16x16x32_bf16 v[116:119], v[44:47], v[84:87], v[116:119]
  s_add_u32 m0, s26, 0
  v_cvt_pk_bf16_f32 v88, v64, v65
  s_waitcnt lgkmcnt(0)
  v_mfma_f32_16x16x32_bf16 v[48:51], a[192:195], a[128:131], v[96:99]
  v_exp_f32 v76, v76
  v_mfma_f32_16x16x32_bf16 v[48:51], a[196:199], a[132:135], v[48:51]
  s_add_u32 s27, s29, 32768
  buffer_load_dwordx4 v32, s[12:15], s27 offen offset:0 lds
  v_mfma_f32_16x16x32_bf16 v[48:51], a[200:203], a[136:139], v[48:51]
  v_exp_f32 v77, v77
  v_mfma_f32_16x16x32_bf16 v[48:51], a[204:207], a[140:143], v[48:51]
  v_cvt_pk_bf16_f32 v89, v66, v67
  v_cvt_pk_bf16_f32 v90, v68, v69
  v_mfma_f32_16x16x32_bf16 v[52:55], a[220:223], a[140:143], v[96:99]
  v_exp_f32 v78, v78
  v_mfma_f32_16x16x32_bf16 v[52:55], a[216:219], a[136:139], v[52:55]
  buffer_load_dwordx4 v33, s[16:19], s27 offen offset:2048 lds
  s_lshl_b32 s34, s2, 2
  v_mfma_f32_16x16x32_bf16 v[52:55], a[212:215], a[132:135], v[52:55]
  v_exp_f32 v79, v79
  v_mfma_f32_16x16x32_bf16 v[52:55], a[208:211], a[128:131], v[52:55]
  v_exp_f32 v72, v72
  v_mfma_f32_16x16x32_bf16 v[60:63], a[208:211], a[144:147], v[100:103]
  v_exp_f32 v73, v73
  v_mfma_f32_16x16x32_bf16 v[60:63], a[212:215], a[148:151], v[60:63]
  s_add_u32 s27, s29, 35840
  buffer_load_dwordx4 v32, s[12:15], s27 offen offset:1024 lds
  v_mfma_f32_16x16x32_bf16 v[60:63], a[216:219], a[152:155], v[60:63]
  v_exp_f32 v74, v74
  v_mfma_f32_16x16x32_bf16 v[60:63], a[220:223], a[156:159], v[60:63]
  v_exp_f32 v75, v75
  v_mfma_f32_16x16x32_bf16 v[56:59], a[204:207], a[156:159], v[100:103]
  v_cvt_pk_bf16_f32 v91, v70, v71
  v_cvt_pk_bf16_f32 v94, v76, v77
  v_mfma_f32_16x16x32_bf16 v[56:59], a[200:203], a[152:155], v[56:59]
  buffer_load_dwordx4 v33, s[16:19], s27 offen offset:3072 lds
  v_cvt_pk_bf16_f32 v95, v78, v79
  v_mfma_f32_16x16x32_bf16 v[56:59], a[196:199], a[148:151], v[56:59]
  v_cvt_pk_bf16_f32 v92, v72, v73
  v_cvt_pk_bf16_f32 v93, v74, v75
  v_mfma_f32_16x16x32_bf16 v[56:59], a[192:195], a[144:147], v[56:59]
  s_add_u32 m0, s26, 4096
  s_barrier
  v_exp_f32 v48, v48
  v_mfma_f32_16x16x32_bf16 v[192:195], a[224:227], v[88:91], v[192:195]
  v_exp_f32 v49, v49
  v_mfma_f32_16x16x32_bf16 v[224:227], a[224:227], v[92:95], v[224:227]
  s_add_u32 s27, s29, 40960
  buffer_load_dwordx4 v32, s[12:15], s27 offen offset:0 lds
  v_mfma_f32_16x16x32_bf16 v[228:231], a[228:231], v[92:95], v[228:231]
  v_exp_f32 v50, v50
  v_mfma_f32_16x16x32_bf16 v[196:199], a[228:231], v[88:91], v[196:199]
  v_exp_f32 v51, v51
  v_mfma_f32_16x16x32_bf16 v[200:203], a[232:235], v[88:91], v[200:203]
  v_exp_f32 v52, v52
  v_mfma_f32_16x16x32_bf16 v[232:235], a[232:235], v[92:95], v[232:235]
  buffer_load_dwordx4 v33, s[16:19], s27 offen offset:2048 lds
  s_add_u32 s34, s34, s3
  v_mfma_f32_16x16x32_bf16 v[236:239], a[236:239], v[92:95], v[236:239]
  v_exp_f32 v53, v53
  v_mfma_f32_16x16x32_bf16 v[204:207], a[236:239], v[88:91], v[204:207]
  ds_read_b64_tr_b16 a[224:225], v24 offset:12288
  s_mul_i32 s34, s34, 1792
  v_mfma_f32_16x16x32_bf16 v[208:211], a[240:243], v[88:91], v[208:211]
  v_exp_f32 v54, v54
  v_mfma_f32_16x16x32_bf16 v[240:243], a[240:243], v[92:95], v[240:243]
  s_add_u32 s27, s29, 44032
  buffer_load_dwordx4 v32, s[12:15], s27 offen offset:1024 lds
  v_mfma_f32_16x16x32_bf16 v[244:247], a[244:247], v[92:95], v[244:247]
  ds_read_b64_tr_b16 a[226:227], v24 offset:13312
  v_cvt_pk_bf16_f32 v80, v48, v49
  v_mfma_f32_16x16x32_bf16 v[212:215], a[244:247], v[88:91], v[212:215]
  v_exp_f32 v55, v55
  v_mfma_f32_16x16x32_bf16 v[216:219], a[248:251], v[88:91], v[216:219]
  ds_read_b64_tr_b16 a[228:229], v25 offset:12288
  v_cvt_pk_bf16_f32 v81, v50, v51
  v_mfma_f32_16x16x32_bf16 v[248:251], a[248:251], v[92:95], v[248:251]
  buffer_load_dwordx4 v33, s[16:19], s27 offen offset:3072 lds
  v_mfma_f32_16x16x32_bf16 v[252:255], a[252:255], v[92:95], v[252:255]
  v_exp_f32 v60, v60
  v_mfma_f32_16x16x32_bf16 v[220:223], a[252:255], v[88:91], v[220:223]
  ds_read_b64_tr_b16 a[230:231], v25 offset:13312
  v_cvt_pk_bf16_f32 v82, v52, v53
  v_mfma_f32_16x16x32_bf16 v[120:123], v[44:47], v[88:91], v[120:123]
  v_exp_f32 v61, v61
  v_mfma_f32_16x16x32_bf16 v[124:127], v[44:47], v[92:95], v[124:127]
  ds_read_b64_tr_b16 a[232:233], v26 offset:12288
  v_cvt_pk_bf16_f32 v83, v54, v55
  v_mfma_f32_16x16x32_bf16 v[64:67], a[192:195], a[160:163], v[104:107]
  v_exp_f32 v62, v62
  v_mfma_f32_16x16x32_bf16 v[64:67], a[196:199], a[164:167], v[64:67]
  ds_read_b64_tr_b16 a[234:235], v26 offset:13312
  v_cvt_pk_bf16_f32 v86, v60, v61
  v_mfma_f32_16x16x32_bf16 v[64:67], a[200:203], a[168:171], v[64:67]
  v_exp_f32 v63, v63
  v_mfma_f32_16x16x32_bf16 v[64:67], a[204:207], a[172:175], v[64:67]
  ds_read_b64_tr_b16 a[236:237], v27 offset:12288
  s_mov_b64 exec, 0x3fff
  buffer_load_dword a66, v17, s[44:47], s34 offen
  buffer_load_dword a67, v17, s[48:51], s34 offen
  s_mov_b64 exec, -1
  v_mfma_f32_16x16x32_bf16 v[68:71], a[220:223], a[172:175], v[104:107]
  v_exp_f32 v56, v56
  v_mfma_f32_16x16x32_bf16 v[68:71], a[216:219], a[168:171], v[68:71]
  ds_read_b64_tr_b16 a[238:239], v27 offset:13312
  v_lshrrev_b32 v14, 3, v1
  v_mfma_f32_16x16x32_bf16 v[68:71], a[212:215], a[164:167], v[68:71]
  v_exp_f32 v57, v57
  v_mfma_f32_16x16x32_bf16 v[68:71], a[208:211], a[160:163], v[68:71]
  ds_read_b64_tr_b16 a[240:241], v28 offset:12288
  v_mul_u32_u24 v14, 1024, v14
  v_mfma_f32_16x16x32_bf16 v[76:79], a[208:211], a[176:179], v[108:111]
  v_exp_f32 v58, v58
  v_mfma_f32_16x16x32_bf16 v[76:79], a[212:215], a[180:183], v[76:79]
  ds_read_b64_tr_b16 a[242:243], v28 offset:13312
  v_cvt_pk_bf16_f32 v87, v62, v63
  v_mfma_f32_16x16x32_bf16 v[76:79], a[216:219], a[184:187], v[76:79]
  v_exp_f32 v59, v59
  v_mfma_f32_16x16x32_bf16 v[76:79], a[220:223], a[188:191], v[76:79]
  ds_read_b64_tr_b16 a[244:245], v29 offset:12288
  v_and_b32 v15, 1, v1
  v_mfma_f32_16x16x32_bf16 v[72:75], a[204:207], a[188:191], v[108:111]
  ds_read_b128 a[208:211], v20 offset:13312
  v_cvt_pk_bf16_f32 v84, v56, v57
  v_mfma_f32_16x16x32_bf16 v[72:75], a[200:203], a[184:187], v[72:75]
  ds_read_b64_tr_b16 a[246:247], v29 offset:13312
  v_cvt_pk_bf16_f32 v85, v58, v59
  v_mfma_f32_16x16x32_bf16 v[72:75], a[196:199], a[180:183], v[72:75]
  ds_read_b128 a[212:215], v21 offset:13312
  v_lshl_add_u32 v14, v15, 4, v14
  v_mfma_f32_16x16x32_bf16 v[72:75], a[192:195], a[176:179], v[72:75]
  v_exp_f32 v64, v64
  s_waitcnt lgkmcnt(6)
  v_mfma_f32_16x16x32_bf16 v[128:131], a[224:227], v[80:83], v[128:131]
  ds_read_b64_tr_b16 a[248:249], v30 offset:12288
  ds_read_b128 a[216:219], v22 offset:13312
  v_mfma_f32_16x16x32_bf16 v[160:163], a[224:227], v[84:87], v[160:163]
  v_exp_f32 v65, v65
  v_bfe_u32 v15, v1, 1, 2
  v_mfma_f32_16x16x32_bf16 v[164:167], a[228:231], v[84:87], v[164:167]
  ds_read_b64_tr_b16 a[250:251], v30 offset:13312
  ds_read_b128 a[220:223], v23 offset:13312
  v_mfma_f32_16x16x32_bf16 v[132:135], a[228:231], v[80:83], v[132:135]
  v_exp_f32 v66, v66
  v_bfe_u32 v16, v1, 4, 2
  v_mfma_f32_16x16x32_bf16 v[136:139], a[232:235], v[80:83], v[136:139]
  ds_read_b64_tr_b16 a[252:253], v31 offset:12288
  ds_read_b128 a[204:207], v23 offset:12288
  v_mfma_f32_16x16x32_bf16 v[168:171], a[232:235], v[84:87], v[168:171]
  v_exp_f32 v67, v67
  v_xor_b32 v15, v15, v16
  v_mfma_f32_16x16x32_bf16 v[172:175], a[236:239], v[84:87], v[172:175]
  ds_read_b64_tr_b16 a[254:255], v31 offset:13312
  ds_read_b128 a[200:203], v22 offset:12288
  v_mfma_f32_16x16x32_bf16 v[140:143], a[236:239], v[80:83], v[140:143]
  v_exp_f32 v68, v68
  v_lshl_add_u32 v10, v15, 5, v14
  s_waitcnt lgkmcnt(8)
  v_mfma_f32_16x16x32_bf16 v[144:147], a[240:243], v[80:83], v[144:147]
  ds_read_b128 a[196:199], v21 offset:12288
  v_add_u32 v11, 7168, v10
  v_mfma_f32_16x16x32_bf16 v[176:179], a[240:243], v[84:87], v[176:179]
  v_exp_f32 v69, v69
  v_mfma_f32_16x16x32_bf16 v[180:183], a[244:247], v[84:87], v[180:183]
  ds_read_b128 a[192:195], v20 offset:12288
  v_add_u32 v12, 14336, v10
  v_mfma_f32_16x16x32_bf16 v[148:151], a[244:247], v[80:83], v[148:151]
  v_exp_f32 v70, v70
  s_waitcnt lgkmcnt(7)
  v_mfma_f32_16x16x32_bf16 v[152:155], a[248:251], v[80:83], v[152:155]
  v_exp_f32 v71, v71
  v_mfma_f32_16x16x32_bf16 v[184:187], a[248:251], v[84:87], v[184:187]
  v_add_u32 v13, 21504, v10
  v_lshrrev_b32 v14, 4, v1
  s_waitcnt lgkmcnt(3)
  v_mfma_f32_16x16x32_bf16 v[188:191], a[252:255], v[84:87], v[188:191]
  v_exp_f32 v76, v76
  v_mfma_f32_16x16x32_bf16 v[156:159], a[252:255], v[80:83], v[156:159]
  v_exp_f32 v77, v77
  v_mfma_f32_16x16x32_bf16 v[112:115], v[44:47], v[80:83], v[112:115]
  v_lshlrev_b32 v14, 9, v14
  v_sub_u32 v2, v2, v14
  v_mfma_f32_16x16x32_bf16 v[116:119], v[44:47], v[84:87], v[116:119]
  v_exp_f32 v78, v78
  s_waitcnt lgkmcnt(0)
  v_mfma_f32_16x16x32_bf16 v[48:51], a[192:195], a[128:131], v[96:99]
  s_lshl_b32 s11, s3, 13
  v_sub_u32 v3, v3, v14
  v_mfma_f32_16x16x32_bf16 v[48:51], a[196:199], a[132:135], v[48:51]
  s_add_u32 s11, s11, 16384
  v_sub_u32 v4, v4, v14
  v_mfma_f32_16x16x32_bf16 v[48:51], a[200:203], a[136:139], v[48:51]
  v_exp_f32 v79, v79
  v_mfma_f32_16x16x32_bf16 v[48:51], a[204:207], a[140:143], v[48:51]
  v_exp_f32 v72, v72
  v_mfma_f32_16x16x32_bf16 v[52:55], a[220:223], a[140:143], v[96:99]
  v_exp_f32 v73, v73
  v_mfma_f32_16x16x32_bf16 v[52:55], a[216:219], a[136:139], v[52:55]
  v_sub_u32 v5, v5, v14
  s_lshl_b32 s28, s24, 19
  v_mfma_f32_16x16x32_bf16 v[52:55], a[212:215], a[132:135], v[52:55]
  v_exp_f32 v74, v74
  v_mfma_f32_16x16x32_bf16 v[52:55], a[208:211], a[128:131], v[52:55]
  v_exp_f32 v75, v75
  v_mfma_f32_16x16x32_bf16 v[60:63], a[208:211], a[144:147], v[100:103]
  v_cvt_pk_bf16_f32 v88, v64, v65
  v_cvt_pk_bf16_f32 v89, v66, v67
  v_mfma_f32_16x16x32_bf16 v[60:63], a[212:215], a[148:151], v[60:63]
  s_lshl_b32 s34, s3, 8
  v_cvt_pk_bf16_f32 v90, v68, v69
  v_mfma_f32_16x16x32_bf16 v[60:63], a[216:219], a[152:155], v[60:63]
  v_cvt_pk_bf16_f32 v91, v70, v71
  v_cvt_pk_bf16_f32 v94, v76, v77
  v_mfma_f32_16x16x32_bf16 v[60:63], a[220:223], a[156:159], v[60:63]
  v_cvt_pk_bf16_f32 v95, v78, v79
  s_add_u32 s28, s28, s34
  v_mfma_f32_16x16x32_bf16 v[56:59], a[204:207], a[156:159], v[100:103]
  v_cvt_pk_bf16_f32 v92, v72, v73
  v_cvt_pk_bf16_f32 v93, v74, v75
  v_mfma_f32_16x16x32_bf16 v[56:59], a[200:203], a[152:155], v[56:59]
  v_exp_f32 v48, v48
  v_mfma_f32_16x16x32_bf16 v[56:59], a[196:199], a[148:151], v[56:59]
  v_exp_f32 v49, v49
  v_mfma_f32_16x16x32_bf16 v[56:59], a[192:195], a[144:147], v[56:59]
  s_waitcnt vmcnt(6)
  s_barrier
  v_mfma_f32_16x16x32_bf16 v[192:195], a[224:227], v[88:91], v[192:195]
  v_exp_f32 v50, v50
  v_mfma_f32_16x16x32_bf16 v[224:227], a[224:227], v[92:95], v[224:227]
  s_add_u32 m0, s26, 16384
  ds_read_b64_tr_b16 a[224:225], v24 offset:0
  v_mfma_f32_16x16x32_bf16 v[228:231], a[228:231], v[92:95], v[228:231]
  v_exp_f32 v51, v51
  v_mfma_f32_16x16x32_bf16 v[196:199], a[228:231], v[88:91], v[196:199]
  s_add_u32 s27, s28, 0
  buffer_load_dwordx4 v10, s[40:43], s27 offen offset:0 lds
  v_mfma_f32_16x16x32_bf16 v[200:203], a[232:235], v[88:91], v[200:203]
  v_exp_f32 v52, v52
  v_mfma_f32_16x16x32_bf16 v[232:235], a[232:235], v[92:95], v[232:235]
  v_exp_f32 v53, v53
  v_mfma_f32_16x16x32_bf16 v[236:239], a[236:239], v[92:95], v[236:239]
  v_exp_f32 v54, v54
  v_mfma_f32_16x16x32_bf16 v[204:207], a[236:239], v[88:91], v[204:207]
  ds_read_b64_tr_b16 a[226:227], v24 offset:1024
  v_cvt_pk_bf16_f32 v80, v48, v49
  v_mfma_f32_16x16x32_bf16 v[208:211], a[240:243], v[88:91], v[208:211]
  v_exp_f32 v55, v55
  v_mfma_f32_16x16x32_bf16 v[240:243], a[240:243], v[92:95], v[240:243]
  buffer_load_dwordx4 v11, s[40:43], s27 offen offset:1024 lds
  v_mfma_f32_16x16x32_bf16 v[244:247], a[244:247], v[92:95], v[244:247]
  ds_read_b64_tr_b16 a[228:229], v25 offset:0
  v_cvt_pk_bf16_f32 v81, v50, v51
  v_mfma_f32_16x16x32_bf16 v[212:215], a[244:247], v[88:91], v[212:215]
  v_exp_f32 v60, v60
  v_mfma_f32_16x16x32_bf16 v[216:219], a[248:251], v[88:91], v[216:219]
  ds_read_b64_tr_b16 a[230:231], v25 offset:1024
  v_cvt_pk_bf16_f32 v82, v52, v53
  v_mfma_f32_16x16x32_bf16 v[248:251], a[248:251], v[92:95], v[248:251]
  v_exp_f32 v61, v61
  v_mfma_f32_16x16x32_bf16 v[252:255], a[252:255], v[92:95], v[252:255]
  ds_read_b64_tr_b16 a[232:233], v26 offset:0
  v_cvt_pk_bf16_f32 v83, v54, v55
  v_mfma_f32_16x16x32_bf16 v[220:223], a[252:255], v[88:91], v[220:223]
  buffer_load_dwordx4 v12, s[40:43], s27 offen offset:2048 lds
  v_mfma_f32_16x16x32_bf16 v[120:123], v[44:47], v[88:91], v[120:123]
  v_exp_f32 v62, v62
  v_mfma_f32_16x16x32_bf16 v[124:127], v[44:47], v[92:95], v[124:127]
  ds_read_b64_tr_b16 a[234:235], v26 offset:1024
  v_cvt_pk_bf16_f32 v86, v60, v61
  v_mfma_f32_16x16x32_bf16 v[64:67], a[192:195], a[160:163], v[104:107]
  v_exp_f32 v63, v63
  v_mfma_f32_16x16x32_bf16 v[64:67], a[196:199], a[164:167], v[64:67]
  ds_read_b64_tr_b16 a[236:237], v27 offset:0
  v_cvt_pk_bf16_f32 v87, v62, v63
  v_mfma_f32_16x16x32_bf16 v[64:67], a[200:203], a[168:171], v[64:67]
  v_exp_f32 v56, v56
  v_mfma_f32_16x16x32_bf16 v[64:67], a[204:207], a[172:175], v[64:67]
  buffer_load_dwordx4 v13, s[40:43], s27 offen offset:3072 lds
  v_mfma_f32_16x16x32_bf16 v[68:71], a[220:223], a[172:175], v[104:107]
  ds_read_b64_tr_b16 a[238:239], v27 offset:1024
  v_mfma_f32_16x16x32_bf16 v[68:71], a[216:219], a[168:171], v[68:71]
  v_exp_f32 v57, v57
  v_mfma_f32_16x16x32_bf16 v[68:71], a[212:215], a[164:167], v[68:71]
  ds_read_b64_tr_b16 a[240:241], v28 offset:0
  v_cvt_pk_bf16_f32 v84, v56, v57
  v_mfma_f32_16x16x32_bf16 v[68:71], a[208:211], a[160:163], v[68:71]
  s_add_u32 m0, s26, 20480
  ds_read_b64_tr_b16 a[242:243], v28 offset:1024
  v_mfma_f32_16x16x32_bf16 v[76:79], a[208:211], a[176:179], v[108:111]
  v_exp_f32 v58, v58
  v_mfma_f32_16x16x32_bf16 v[76:79], a[212:215], a[180:183], v[76:79]
  s_add_u32 s27, s28, 32768
  buffer_load_dwordx4 v10, s[40:43], s27 offen offset:0 lds
  v_mfma_f32_16x16x32_bf16 v[76:79], a[216:219], a[184:187], v[76:79]
  v_exp_f32 v59, v59
  v_mfma_f32_16x16x32_bf16 v[76:79], a[220:223], a[188:191], v[76:79]
  ds_read_b64_tr_b16 a[244:245], v29 offset:0
  v_cvt_pk_bf16_f32 v85, v58, v59
  v_mfma_f32_16x16x32_bf16 v[72:75], a[204:207], a[188:191], v[108:111]
  ds_read_b128 a[208:211], v20 offset:1024
  v_mfma_f32_16x16x32_bf16 v[72:75], a[200:203], a[184:187], v[72:75]
  ds_read_b64_tr_b16 a[246:247], v29 offset:1024
  v_mfma_f32_16x16x32_bf16 v[72:75], a[196:199], a[180:183], v[72:75]
  ds_read_b128 a[212:215], v21 offset:1024
  s_waitcnt lgkmcnt(4)
  v_mfma_f32_16x16x32_bf16 v[72:75], a[192:195], a[176:179], v[72:75]
  buffer_load_dwordx4 v11, s[40:43], s27 offen offset:1024 lds
  v_exp_f32 v64, v64
  v_mfma_f32_16x16x32_bf16 v[128:131], a[224:227], v[80:83], v[128:131]
  ds_read_b64_tr_b16 a[248:249], v30 offset:0
  ds_read_b128 a[216:219], v22 offset:1024
  v_mfma_f32_16x16x32_bf16 v[160:163], a[224:227], v[84:87], v[160:163]
  v_exp_f32 v65, v65
  v_mfma_f32_16x16x32_bf16 v[164:167], a[228:231], v[84:87], v[164:167]
  ds_read_b64_tr_b16 a[250:251], v30 offset:1024
  ds_read_b128 a[220:223], v23 offset:1024
  v_mfma_f32_16x16x32_bf16 v[132:135], a[228:231], v[80:83], v[132:135]
  v_exp_f32 v66, v66
  v_mfma_f32_16x16x32_bf16 v[136:139], a[232:235], v[80:83], v[136:139]
  ds_read_b64_tr_b16 a[252:253], v31 offset:0
  ds_read_b128 a[204:207], v23 offset:0
  v_mfma_f32_16x16x32_bf16 v[168:171], a[232:235], v[84:87], v[168:171]
  buffer_load_dwordx4 v12, s[40:43], s27 offen offset:2048 lds
  v_exp_f32 v67, v67
  v_mfma_f32_16x16x32_bf16 v[172:175], a[236:239], v[84:87], v[172:175]
  ds_read_b64_tr_b16 a[254:255], v31 offset:1024
  ds_read_b128 a[200:203], v22 offset:0
  v_mfma_f32_16x16x32_bf16 v[140:143], a[236:239], v[80:83], v[140:143]
  v_exp_f32 v68, v68
  v_mfma_f32_16x16x32_bf16 v[144:147], a[240:243], v[80:83], v[144:147]
  ds_read_b128 a[196:199], v21 offset:0
  v_cvt_pk_bf16_f32 v88, v64, v65
  v_mfma_f32_16x16x32_bf16 v[176:179], a[240:243], v[84:87], v[176:179]
  v_exp_f32 v69, v69
  s_waitcnt lgkmcnt(9)
  v_mfma_f32_16x16x32_bf16 v[180:183], a[244:247], v[84:87], v[180:183]
  ds_read_b128 a[192:195], v20 offset:0
  v_cvt_pk_bf16_f32 v89, v66, v67
  v_mfma_f32_16x16x32_bf16 v[148:151], a[244:247], v[80:83], v[148:151]
  buffer_load_dwordx4 v13, s[40:43], s27 offen offset:3072 lds
  v_exp_f32 v70, v70
  s_waitcnt lgkmcnt(7)
  v_mfma_f32_16x16x32_bf16 v[152:155], a[248:251], v[80:83], v[152:155]
  v_exp_f32 v71, v71
  v_mfma_f32_16x16x32_bf16 v[184:187], a[248:251], v[84:87], v[184:187]
  v_exp_f32 v76, v76
  s_waitcnt lgkmcnt(3)
  v_mfma_f32_16x16x32_bf16 v[188:191], a[252:255], v[84:87], v[188:191]
  v_exp_f32 v77, v77
  v_mfma_f32_16x16x32_bf16 v[156:159], a[252:255], v[80:83], v[156:159]
  v_exp_f32 v78, v78
  v_mfma_f32_16x16x32_bf16 v[112:115], v[44:47], v[80:83], v[112:115]
  v_exp_f32 v79, v79
  v_mfma_f32_16x16x32_bf16 v[116:119], v[44:47], v[84:87], v[116:119]
  s_add_u32 m0, s26, 8192
  v_cvt_pk_bf16_f32 v90, v68, v69
  s_waitcnt lgkmcnt(0)
  v_mfma_f32_16x16x32_bf16 v[48:51], a[192:195], a[128:131], v[96:99]
  v_exp_f32 v72, v72
  v_mfma_f32_16x16x32_bf16 v[48:51], a[196:199], a[132:135], v[48:51]
  s_add_u32 s27, s29, 49152
  buffer_load_dwordx4 v32, s[12:15], s27 offen offset:0 lds
  v_mfma_f32_16x16x32_bf16 v[48:51], a[200:203], a[136:139], v[48:51]
  v_exp_f32 v73, v73
  v_mfma_f32_16x16x32_bf16 v[48:51], a[204:207], a[140:143], v[48:51]
  v_exp_f32 v74, v74
  v_mfma_f32_16x16x32_bf16 v[52:55], a[220:223], a[140:143], v[96:99]
  v_exp_f32 v75, v75
  v_mfma_f32_16x16x32_bf16 v[52:55], a[216:219], a[136:139], v[52:55]
  buffer_load_dwordx4 v33, s[16:19], s27 offen offset:2048 lds
  v_mfma_f32_16x16x32_bf16 v[52:55], a[212:215], a[132:135], v[52:55]
  v_cvt_pk_bf16_f32 v91, v70, v71
  v_cvt_pk_bf16_f32 v94, v76, v77
  v_mfma_f32_16x16x32_bf16 v[52:55], a[208:211], a[128:131], v[52:55]
  v_cvt_pk_bf16_f32 v95, v78, v79
  v_cvt_pk_bf16_f32 v92, v72, v73
  v_mfma_f32_16x16x32_bf16 v[60:63], a[208:211], a[144:147], v[100:103]
  v_cvt_pk_bf16_f32 v93, v74, v75
  v_mfma_f32_16x16x32_bf16 v[60:63], a[212:215], a[148:151], v[60:63]
  s_add_u32 s27, s29, 52224
  buffer_load_dwordx4 v32, s[12:15], s27 offen offset:1024 lds
  v_mfma_f32_16x16x32_bf16 v[60:63], a[216:219], a[152:155], v[60:63]
  v_exp_f32 v48, v48
  v_mfma_f32_16x16x32_bf16 v[60:63], a[220:223], a[156:159], v[60:63]
  v_exp_f32 v49, v49
  v_mfma_f32_16x16x32_bf16 v[56:59], a[204:207], a[156:159], v[100:103]
  v_exp_f32 v50, v50
  v_mfma_f32_16x16x32_bf16 v[56:59], a[200:203], a[152:155], v[56:59]
  buffer_load_dwordx4 v33, s[16:19], s27 offen offset:3072 lds
  v_mfma_f32_16x16x32_bf16 v[56:59], a[196:199], a[148:151], v[56:59]
  v_exp_f32 v51, v51
  v_mfma_f32_16x16x32_bf16 v[56:59], a[192:195], a[144:147], v[56:59]
  s_add_u32 m0, s26, 12288
  s_waitcnt vmcnt(14)
  s_barrier
  v_mfma_f32_16x16x32_bf16 v[192:195], a[224:227], v[88:91], v[192:195]
  v_exp_f32 v52, v52
  v_mfma_f32_16x16x32_bf16 v[224:227], a[224:227], v[92:95], v[224:227]
  s_add_u32 s27, s29, 57344
  buffer_load_dwordx4 v32, s[12:15], s27 offen offset:0 lds
  v_mfma_f32_16x16x32_bf16 v[228:231], a[228:231], v[92:95], v[228:231]
  v_exp_f32 v53, v53
  v_mfma_f32_16x16x32_bf16 v[196:199], a[228:231], v[88:91], v[196:199]
  s_waitcnt vmcnt(5)
  ds_read_b64_tr_b16 a[224:225], v24 offset:4096
  v_cvt_pk_bf16_f32 v80, v48, v49
  v_mfma_f32_16x16x32_bf16 v[200:203], a[232:235], v[88:91], v[200:203]
  v_exp_f32 v54, v54
  v_mfma_f32_16x16x32_bf16 v[232:235], a[232:235], v[92:95], v[232:235]
  buffer_load_dwordx4 v33, s[16:19], s27 offen offset:2048 lds
  v_mfma_f32_16x16x32_bf16 v[236:239], a[236:239], v[92:95], v[236:239]
  ds_read_b64_tr_b16 a[226:227], v24 offset:5120
  v_cvt_pk_bf16_f32 v81, v50, v51
  v_mfma_f32_16x16x32_bf16 v[204:207], a[236:239], v[88:91], v[204:207]
  ds_read_b64_tr_b16 a[0:1], v2 offset:16384
  v_cvt_pk_bf16_f32 v82, v52, v53
  v_mfma_f32_16x16x32_bf16 v[208:211], a[240:243], v[88:91], v[208:211]
  v_exp_f32 v55, v55
  v_mfma_f32_16x16x32_bf16 v[240:243], a[240:243], v[92:95], v[240:243]
  s_add_u32 s27, s29, 60416
  buffer_load_dwordx4 v32, s[12:15], s27 offen offset:1024 lds
  v_mfma_f32_16x16x32_bf16 v[244:247], a[244:247], v[92:95], v[244:247]
  ds_read_b64_tr_b16 a[228:229], v25 offset:4096
  v_cvt_pk_bf16_f32 v83, v54, v55
  v_mfma_f32_16x16x32_bf16 v[212:215], a[244:247], v[88:91], v[212:215]
  v_exp_f32 v60, v60
  v_mfma_f32_16x16x32_bf16 v[216:219], a[248:251], v[88:91], v[216:219]
  ds_read_b64_tr_b16 a[230:231], v25 offset:5120
  v_mfma_f32_16x16x32_bf16 v[248:251], a[248:251], v[92:95], v[248:251]
  buffer_load_dwordx4 v33, s[16:19], s27 offen offset:3072 lds
  v_mfma_f32_16x16x32_bf16 v[252:255], a[252:255], v[92:95], v[252:255]
  v_exp_f32 v61, v61
  v_mfma_f32_16x16x32_bf16 v[220:223], a[252:255], v[88:91], v[220:223]
  ds_read_b64_tr_b16 a[2:3], v2 offset:18432
  v_cvt_pk_bf16_f32 v86, v60, v61
  v_mfma_f32_16x16x32_bf16 v[120:123], v[44:47], v[88:91], v[120:123]
  ds_read_b64_tr_b16 a[232:233], v26 offset:4096
  v_mfma_f32_16x16x32_bf16 v[124:127], v[44:47], v[92:95], v[124:127]
  v_exp_f32 v62, v62
  v_mfma_f32_16x16x32_bf16 v[64:67], a[192:195], a[160:163], v[104:107]
  ds_read_b64_tr_b16 a[234:235], v26 offset:5120
  v_mfma_f32_16x16x32_bf16 v[64:67], a[196:199], a[164:167], v[64:67]
  v_exp_f32 v63, v63
  v_mfma_f32_16x16x32_bf16 v[64:67], a[200:203], a[168:171], v[64:67]
  ds_read_b64_tr_b16 a[236:237], v27 offset:4096
  v_cvt_pk_bf16_f32 v87, v62, v63
  v_mfma_f32_16x16x32_bf16 v[64:67], a[204:207], a[172:175], v[64:67]
  ds_read_b64_tr_b16 a[8:9], v3 offset:16384
  v_mfma_f32_16x16x32_bf16 v[68:71], a[220:223], a[172:175], v[104:107]
  v_exp_f32 v56, v56
  v_mfma_f32_16x16x32_bf16 v[68:71], a[216:219], a[168:171], v[68:71]
  ds_read_b64_tr_b16 a[238:239], v27 offset:5120
  v_mfma_f32_16x16x32_bf16 v[68:71], a[212:215], a[164:167], v[68:71]
  v_exp_f32 v57, v57
  v_mfma_f32_16x16x32_bf16 v[68:71], a[208:211], a[160:163], v[68:71]
  buffer_load_dwordx4 v[36:39], v18, s[56:59], s36 offen
  v_mfma_f32_16x16x32_bf16 v[76:79], a[208:211], a[176:179], v[108:111]
  ds_read_b64_tr_b16 a[240:241], v28 offset:4096
  v_cvt_pk_bf16_f32 v84, v56, v57
  v_mfma_f32_16x16x32_bf16 v[76:79], a[212:215], a[180:183], v[76:79]
  ds_read_b64_tr_b16 a[10:11], v3 offset:18432
  v_exp_f32 v58, v58
  v_mfma_f32_16x16x32_bf16 v[76:79], a[216:219], a[184:187], v[76:79]
  ds_read_b64_tr_b16 a[242:243], v28 offset:5120
  s_waitcnt lgkmcnt(4)
  v_mfma_f32_16x16x32_bf16 v[76:79], a[220:223], a[188:191], v[76:79]
  v_exp_f32 v59, v59
  v_mfma_f32_16x16x32_bf16 v[72:75], a[204:207], a[188:191], v[108:111]
  ds_read_b64_tr_b16 a[244:245], v29 offset:4096
  ds_read_b128 a[208:211], v20 offset:5120
  v_mfma_f32_16x16x32_bf16 v[72:75], a[200:203], a[184:187], v[72:75]
  ds_read_b64_tr_b16 a[246:247], v29 offset:5120
  v_cvt_pk_bf16_f32 v85, v58, v59
  v_mfma_f32_16x16x32_bf16 v[72:75], a[196:199], a[180:183], v[72:75]
  ds_read_b128 a[212:215], v21 offset:5120
  ds_read_b64_tr_b16 a[16:17], v4 offset:16384
  v_mfma_f32_16x16x32_bf16 v[72:75], a[192:195], a[176:179], v[72:75]
  v_exp_f32 v64, v64
  v_mfma_f32_16x16x32_bf16 v[128:131], a[224:227], v[80:83], v[128:131]
  ds_read_b64_tr_b16 a[248:249], v30 offset:4096
  ds_read_b128 a[216:219], v22 offset:5120
  v_mfma_f32_16x16x32_bf16 v[160:163], a[224:227], v[84:87], v[160:163]
  v_exp_f32 v65, v65
  v_mfma_f32_16x16x32_bf16 v[164:167], a[228:231], v[84:87], v[164:167]
  ds_read_b64_tr_b16 a[250:251], v30 offset:5120
  ds_read_b128 a[220:223], v23 offset:5120
  v_mfma_f32_16x16x32_bf16 v[132:135], a[228:231], v[80:83], v[132:135]
  ds_read_b64_tr_b16 a[18:19], v4 offset:18432
  v_exp_f32 v66, v66
  v_mfma_f32_16x16x32_bf16 v[136:139], a[232:235], v[80:83], v[136:139]
  ds_read_b64_tr_b16 a[252:253], v31 offset:4096
  ds_read_b128 a[204:207], v23 offset:4096
  v_mfma_f32_16x16x32_bf16 v[168:171], a[232:235], v[84:87], v[168:171]
  v_exp_f32 v67, v67
  v_mfma_f32_16x16x32_bf16 v[172:175], a[236:239], v[84:87], v[172:175]
  ds_read_b64_tr_b16 a[254:255], v31 offset:5120
  ds_read_b128 a[200:203], v22 offset:4096
  v_mfma_f32_16x16x32_bf16 v[140:143], a[236:239], v[80:83], v[140:143]
  v_exp_f32 v68, v68
  s_waitcnt lgkmcnt(11)
  v_mfma_f32_16x16x32_bf16 v[144:147], a[240:243], v[80:83], v[144:147]
  ds_read_b128 a[196:199], v21 offset:4096
  ds_read_b64_tr_b16 a[24:25], v5 offset:16384
  v_mfma_f32_16x16x32_bf16 v[176:179], a[240:243], v[84:87], v[176:179]
  v_exp_f32 v69, v69
  v_mfma_f32_16x16x32_bf16 v[180:183], a[244:247], v[84:87], v[180:183]
  ds_read_b128 a[192:195], v20 offset:4096
  v_cvt_pk_bf16_f32 v88, v64, v65
  v_mfma_f32_16x16x32_bf16 v[148:151], a[244:247], v[80:83], v[148:151]
  v_exp_f32 v70, v70
  s_waitcnt lgkmcnt(9)
  v_mfma_f32_16x16x32_bf16 v[152:155], a[248:251], v[80:83], v[152:155]
  v_exp_f32 v71, v71
  v_mfma_f32_16x16x32_bf16 v[184:187], a[248:251], v[84:87], v[184:187]
  ds_read_b64_tr_b16 a[26:27], v5 offset:18432
  v_cvt_pk_bf16_f32 v89, v66, v67
  s_waitcnt lgkmcnt(5)
  v_mfma_f32_16x16x32_bf16 v[188:191], a[252:255], v[84:87], v[188:191]
  v_exp_f32 v76, v76
  v_mfma_f32_16x16x32_bf16 v[156:159], a[252:255], v[80:83], v[156:159]
  v_exp_f32 v77, v77
  v_mfma_f32_16x16x32_bf16 v[112:115], v[44:47], v[80:83], v[112:115]
  ds_read_b64_tr_b16 a[4:5], v2 offset:20480
  v_cvt_pk_bf16_f32 v90, v68, v69
  v_mfma_f32_16x16x32_bf16 v[116:119], v[44:47], v[84:87], v[116:119]
  s_add_u32 m0, s26, 0
  ds_read_b64_tr_b16 a[6:7], v2 offset:22528
  s_waitcnt lgkmcnt(3)
  v_mfma_f32_16x16x32_bf16 v[48:51], a[192:195], a[128:131], v[96:99]
  v_exp_f32 v78, v78
  v_mfma_f32_16x16x32_bf16 v[48:51], a[196:199], a[132:135], v[48:51]
  s_add_u32 s27, s29, 65536
  buffer_load_dwordx4 v32, s[12:15], s27 offen offset:0 lds
  v_mfma_f32_16x16x32_bf16 v[48:51], a[200:203], a[136:139], v[48:51]
  v_exp_f32 v79, v79
  v_mfma_f32_16x16x32_bf16 v[48:51], a[204:207], a[140:143], v[48:51]
  v_exp_f32 v72, v72
  v_mfma_f32_16x16x32_bf16 v[52:55], a[220:223], a[140:143], v[96:99]
  v_exp_f32 v73, v73
  v_mfma_f32_16x16x32_bf16 v[52:55], a[216:219], a[136:139], v[52:55]
  buffer_load_dwordx4 v33, s[16:19], s27 offen offset:2048 lds
  v_mfma_f32_16x16x32_bf16 v[52:55], a[212:215], a[132:135], v[52:55]
  v_exp_f32 v74, v74
  v_mfma_f32_16x16x32_bf16 v[52:55], a[208:211], a[128:131], v[52:55]
  ds_read_b64_tr_b16 a[12:13], v3 offset:20480
  v_cvt_pk_bf16_f32 v91, v70, v71
  v_mfma_f32_16x16x32_bf16 v[60:63], a[208:211], a[144:147], v[100:103]
  v_exp_f32 v75, v75
  v_mfma_f32_16x16x32_bf16 v[60:63], a[212:215], a[148:151], v[60:63]
  s_add_u32 s27, s29, 68608
  buffer_load_dwordx4 v32, s[12:15], s27 offen offset:1024 lds
  v_mfma_f32_16x16x32_bf16 v[60:63], a[216:219], a[152:155], v[60:63]
  v_cvt_pk_bf16_f32 v94, v76, v77
  v_cvt_pk_bf16_f32 v95, v78, v79
  v_mfma_f32_16x16x32_bf16 v[60:63], a[220:223], a[156:159], v[60:63]
  v_cvt_pk_bf16_f32 v92, v72, v73
  v_cvt_pk_bf16_f32 v93, v74, v75
  v_mfma_f32_16x16x32_bf16 v[56:59], a[204:207], a[156:159], v[100:103]
  v_exp_f32 v48, v48
  v_mfma_f32_16x16x32_bf16 v[56:59], a[200:203], a[152:155], v[56:59]
  buffer_load_dwordx4 v33, s[16:19], s27 offen offset:3072 lds
  v_mfma_f32_16x16x32_bf16 v[56:59], a[196:199], a[148:151], v[56:59]
  ds_read_b64_tr_b16 a[14:15], v3 offset:22528
  v_mfma_f32_16x16x32_bf16 v[56:59], a[192:195], a[144:147], v[56:59]
  s_waitcnt vmcnt(9)
  s_barrier
  v_mfma_f32_16x16x32_bf16 v[192:195], a[224:227], v[88:91], v[192:195]
  v_exp_f32 v49, v49
  v_mfma_f32_16x16x32_bf16 v[224:227], a[224:227], v[92:95], v[224:227]
  v_exp_f32 v50, v50
  v_mfma_f32_16x16x32_bf16 v[228:231], a[228:231], v[92:95], v[228:231]
  buffer_load_dwordx4 v[40:43], v19, s[56:59], s36 offen
  v_mfma_f32_16x16x32_bf16 v[196:199], a[228:231], v[88:91], v[196:199]
  ds_read_b64_tr_b16 a[20:21], v4 offset:20480
  v_cvt_pk_bf16_f32 v80, v48, v49
  v_mfma_f32_16x16x32_bf16 v[200:203], a[232:235], v[88:91], v[200:203]
  v_exp_f32 v51, v51
  v_mfma_f32_16x16x32_bf16 v[232:235], a[232:235], v[92:95], v[232:235]
  v_exp_f32 v52, v52
  v_mfma_f32_16x16x32_bf16 v[236:239], a[236:239], v[92:95], v[236:239]
  v_exp_f32 v53, v53
  v_mfma_f32_16x16x32_bf16 v[204:207], a[236:239], v[88:91], v[204:207]
  ds_read_b64_tr_b16 a[22:23], v4 offset:22528
  v_cvt_pk_bf16_f32 v81, v50, v51
  v_mfma_f32_16x16x32_bf16 v[208:211], a[240:243], v[88:91], v[208:211]
  ds_read_b64_tr_b16 a[224:225], v24 offset:8192
  v_cvt_pk_bf16_f32 v82, v52, v53
  v_mfma_f32_16x16x32_bf16 v[240:243], a[240:243], v[92:95], v[240:243]
  v_exp_f32 v54, v54
  v_mfma_f32_16x16x32_bf16 v[244:247], a[244:247], v[92:95], v[244:247]
  ds_read_b64_tr_b16 a[226:227], v24 offset:9216
  v_mfma_f32_16x16x32_bf16 v[212:215], a[244:247], v[88:91], v[212:215]
  v_exp_f32 v55, v55
  v_mfma_f32_16x16x32_bf16 v[216:219], a[248:251], v[88:91], v[216:219]
  ds_read_b64_tr_b16 a[228:229], v25 offset:8192
  v_cvt_pk_bf16_f32 v83, v54, v55
  v_mfma_f32_16x16x32_bf16 v[248:251], a[248:251], v[92:95], v[248:251]
  ds_read_b64_tr_b16 a[28:29], v5 offset:20480
  v_mfma_f32_16x16x32_bf16 v[252:255], a[252:255], v[92:95], v[252:255]
  v_exp_f32 v60, v60
  v_mfma_f32_16x16x32_bf16 v[220:223], a[252:255], v[88:91], v[220:223]
  ds_read_b64_tr_b16 a[230:231], v25 offset:9216
  v_mfma_f32_16x16x32_bf16 v[120:123], v[44:47], v[88:91], v[120:123]
  v_exp_f32 v61, v61
  v_mfma_f32_16x16x32_bf16 v[124:127], v[44:47], v[92:95], v[124:127]
  ds_read_b64_tr_b16 a[232:233], v26 offset:8192
  v_cvt_pk_bf16_f32 v86, v60, v61
  v_mfma_f32_16x16x32_bf16 v[64:67], a[192:195], a[160:163], v[104:107]
  v_exp_f32 v62, v62
  v_mfma_f32_16x16x32_bf16 v[64:67], a[196:199], a[164:167], v[64:67]
  ds_read_b64_tr_b16 a[30:31], v5 offset:22528
  v_mfma_f32_16x16x32_bf16 v[64:67], a[200:203], a[168:171], v[64:67]
  ds_read_b64_tr_b16 a[234:235], v26 offset:9216
  v_mfma_f32_16x16x32_bf16 v[64:67], a[204:207], a[172:175], v[64:67]
  v_exp_f32 v63, v63
  v_mfma_f32_16x16x32_bf16 v[68:71], a[220:223], a[172:175], v[104:107]
  ds_read_b64_tr_b16 a[236:237], v27 offset:8192
  v_cvt_pk_bf16_f32 v87, v62, v63
  v_mfma_f32_16x16x32_bf16 v[68:71], a[216:219], a[168:171], v[68:71]
  v_exp_f32 v56, v56
  v_mfma_f32_16x16x32_bf16 v[68:71], a[212:215], a[164:167], v[68:71]
  ds_read_b64_tr_b16 a[238:239], v27 offset:9216
  v_mfma_f32_16x16x32_bf16 v[68:71], a[208:211], a[160:163], v[68:71]
  s_add_u32 m0, s26, 16384
  v_exp_f32 v57, v57
  v_mfma_f32_16x16x32_bf16 v[76:79], a[208:211], a[176:179], v[108:111]
  ds_read_b64_tr_b16 a[240:241], v28 offset:8192
  v_cvt_pk_bf16_f32 v84, v56, v57
  v_mfma_f32_16x16x32_bf16 v[76:79], a[212:215], a[180:183], v[76:79]
  s_waitcnt lgkmcnt(4)
  s_add_u32 s27, s28, 65536
  buffer_load_dwordx4 v10, s[40:43], s27 offen offset:0 lds
  v_exp_f32 v58, v58
  v_mfma_f32_16x16x32_bf16 v[76:79], a[216:219], a[184:187], v[76:79]
  ds_read_b64_tr_b16 a[242:243], v28 offset:9216
  v_mfma_f32_16x16x32_bf16 v[76:79], a[220:223], a[188:191], v[76:79]
  v_exp_f32 v59, v59
  v_mfma_f32_16x16x32_bf16 v[72:75], a[204:207], a[188:191], v[108:111]
  ds_read_b64_tr_b16 a[244:245], v29 offset:8192
  ds_read_b128 a[208:211], v20 offset:9216
  v_mfma_f32_16x16x32_bf16 v[72:75], a[200:203], a[184:187], v[72:75]
  ds_read_b64_tr_b16 a[246:247], v29 offset:9216
  v_cvt_pk_bf16_f32 v85, v58, v59
  v_mfma_f32_16x16x32_bf16 v[72:75], a[196:199], a[180:183], v[72:75]
  ds_read_b128 a[212:215], v21 offset:9216
  s_waitcnt lgkmcnt(6)
  v_mfma_f32_16x16x32_bf16 v[72:75], a[192:195], a[176:179], v[72:75]
  buffer_load_dwordx4 v11, s[40:43], s27 offen offset:1024 lds
  v_exp_f32 v64, v64
  v_mfma_f32_16x16x32_bf16 v[128:131], a[224:227], v[80:83], v[128:131]
  ds_read_b64_tr_b16 a[248:249], v30 offset:8192
  ds_read_b128 a[216:219], v22 offset:9216
  v_mfma_f32_16x16x32_bf16 v[160:163], a[224:227], v[84:87], v[160:163]
  v_exp_f32 v65, v65
  v_mfma_f32_16x16x32_bf16 v[164:167], a[228:231], v[84:87], v[164:167]
  ds_read_b64_tr_b16 a[250:251], v30 offset:9216
  ds_read_b128 a[220:223], v23 offset:9216
  v_mfma_f32_16x16x32_bf16 v[132:135], a[228:231], v[80:83], v[132:135]
  v_exp_f32 v66, v66
  v_mfma_f32_16x16x32_bf16 v[136:139], a[232:235], v[80:83], v[136:139]
  ds_read_b64_tr_b16 a[252:253], v31 offset:8192
  ds_read_b128 a[204:207], v23 offset:8192
  v_mfma_f32_16x16x32_bf16 v[168:171], a[232:235], v[84:87], v[168:171]
  buffer_load_dwordx4 v12, s[40:43], s27 offen offset:2048 lds
  v_exp_f32 v67, v67
  v_mfma_f32_16x16x32_bf16 v[172:175], a[236:239], v[84:87], v[172:175]
  ds_read_b64_tr_b16 a[254:255], v31 offset:9216
  ds_read_b128 a[200:203], v22 offset:8192
  v_mfma_f32_16x16x32_bf16 v[140:143], a[236:239], v[80:83], v[140:143]
  v_exp_f32 v68, v68
  s_waitcnt lgkmcnt(9)
  v_mfma_f32_16x16x32_bf16 v[144:147], a[240:243], v[80:83], v[144:147]
  ds_read_b128 a[196:199], v21 offset:8192
  v_cvt_pk_bf16_f32 v88, v64, v65
  v_mfma_f32_16x16x32_bf16 v[176:179], a[240:243], v[84:87], v[176:179]
  v_exp_f32 v69, v69
  v_mfma_f32_16x16x32_bf16 v[180:183], a[244:247], v[84:87], v[180:183]
  ds_read_b128 a[192:195], v20 offset:8192
  v_cvt_pk_bf16_f32 v89, v66, v67
  v_mfma_f32_16x16x32_bf16 v[148:151], a[244:247], v[80:83], v[148:151]
  buffer_load_dwordx4 v13, s[40:43], s27 offen offset:3072 lds
  v_exp_f32 v70, v70
  s_waitcnt lgkmcnt(7)
  v_mfma_f32_16x16x32_bf16 v[152:155], a[248:251], v[80:83], v[152:155]
  v_exp_f32 v71, v71
  v_mfma_f32_16x16x32_bf16 v[184:187], a[248:251], v[84:87], v[184:187]
  v_exp_f32 v76, v76
  s_waitcnt lgkmcnt(3)
  v_mfma_f32_16x16x32_bf16 v[188:191], a[252:255], v[84:87], v[188:191]
  v_exp_f32 v77, v77
  v_mfma_f32_16x16x32_bf16 v[156:159], a[252:255], v[80:83], v[156:159]
  v_exp_f32 v78, v78
  v_mfma_f32_16x16x32_bf16 v[112:115], v[44:47], v[80:83], v[112:115]
  v_exp_f32 v79, v79
  v_mfma_f32_16x16x32_bf16 v[116:119], v[44:47], v[84:87], v[116:119]
  s_add_u32 m0, s26, 4096
  v_cvt_pk_bf16_f32 v90, v68, v69
  s_waitcnt lgkmcnt(0)
  v_mfma_f32_16x16x32_bf16 v[48:51], a[192:195], a[128:131], v[96:99]
  v_exp_f32 v72, v72
  v_mfma_f32_16x16x32_bf16 v[48:51], a[196:199], a[132:135], v[48:51]
  s_add_u32 s27, s29, 73728
  buffer_load_dwordx4 v32, s[12:15], s27 offen offset:0 lds
  v_mfma_f32_16x16x32_bf16 v[48:51], a[200:203], a[136:139], v[48:51]
  v_exp_f32 v73, v73
  v_mfma_f32_16x16x32_bf16 v[48:51], a[204:207], a[140:143], v[48:51]
  v_exp_f32 v74, v74
  v_mfma_f32_16x16x32_bf16 v[52:55], a[220:223], a[140:143], v[96:99]
  v_exp_f32 v75, v75
  v_mfma_f32_16x16x32_bf16 v[52:55], a[216:219], a[136:139], v[52:55]
  buffer_load_dwordx4 v33, s[16:19], s27 offen offset:2048 lds
  v_mfma_f32_16x16x32_bf16 v[52:55], a[212:215], a[132:135], v[52:55]
  v_cvt_pk_bf16_f32 v91, v70, v71
  v_cvt_pk_bf16_f32 v94, v76, v77
  v_mfma_f32_16x16x32_bf16 v[52:55], a[208:211], a[128:131], v[52:55]
  v_cvt_pk_bf16_f32 v95, v78, v79
  v_cvt_pk_bf16_f32 v92, v72, v73
  v_mfma_f32_16x16x32_bf16 v[60:63], a[208:211], a[144:147], v[100:103]
  v_cvt_pk_bf16_f32 v93, v74, v75
  v_mfma_f32_16x16x32_bf16 v[60:63], a[212:215], a[148:151], v[60:63]
  s_add_u32 s27, s29, 76800
  buffer_load_dwordx4 v32, s[12:15], s27 offen offset:1024 lds
  v_mfma_f32_16x16x32_bf16 v[60:63], a[216:219], a[152:155], v[60:63]
  v_exp_f32 v48, v48
  v_mfma_f32_16x16x32_bf16 v[60:63], a[220:223], a[156:159], v[60:63]
  v_exp_f32 v49, v49
  v_mfma_f32_16x16x32_bf16 v[56:59], a[204:207], a[156:159], v[100:103]
  v_exp_f32 v50, v50
  v_mfma_f32_16x16x32_bf16 v[56:59], a[200:203], a[152:155], v[56:59]
  buffer_load_dwordx4 v33, s[16:19], s27 offen offset:3072 lds
  v_mfma_f32_16x16x32_bf16 v[56:59], a[196:199], a[148:151], v[56:59]
  v_exp_f32 v51, v51
  v_mfma_f32_16x16x32_bf16 v[56:59], a[192:195], a[144:147], v[56:59]
  s_waitcnt vmcnt(13)
  s_barrier
  v_mfma_f32_16x16x32_bf16 v[192:195], a[224:227], v[88:91], v[192:195]
  v_exp_f32 v52, v52
  v_mfma_f32_16x16x32_bf16 v[224:227], a[224:227], v[92:95], v[224:227]
  s_add_u32 m0, s26, 20480
  ds_read_b64_tr_b16 a[224:225], v24 offset:12288
  v_mfma_f32_16x16x32_bf16 v[228:231], a[228:231], v[92:95], v[228:231]
  v_exp_f32 v53, v53
  v_mfma_f32_16x16x32_bf16 v[196:199], a[228:231], v[88:91], v[196:199]
  s_add_u32 s27, s28, 98304
  buffer_load_dwordx4 v10, s[40:43], s27 offen offset:0 lds
  v_mfma_f32_16x16x32_bf16 v[200:203], a[232:235], v[88:91], v[200:203]
  v_exp_f32 v54, v54
  v_mfma_f32_16x16x32_bf16 v[232:235], a[232:235], v[92:95], v[232:235]
  ds_read_b64_tr_b16 a[226:227], v24 offset:13312
  v_lshlrev_b32 v18, 8, v1
  v_mfma_f32_16x16x32_bf16 v[236:239], a[236:239], v[92:95], v[236:239]
  v_exp_f32 v55, v55
  v_mfma_f32_16x16x32_bf16 v[204:207], a[236:239], v[88:91], v[204:207]
  ds_read_b64_tr_b16 a[228:229], v25 offset:12288
  v_mov_b32 v19, 0
  v_mfma_f32_16x16x32_bf16 v[208:211], a[240:243], v[88:91], v[208:211]
  v_exp_f32 v60, v60
  v_mfma_f32_16x16x32_bf16 v[240:243], a[240:243], v[92:95], v[240:243]
  buffer_load_dwordx4 v11, s[40:43], s27 offen offset:1024 lds
  s_lshl_b32 s34, s25, 13
  v_mfma_f32_16x16x32_bf16 v[244:247], a[244:247], v[92:95], v[244:247]
  ds_read_b64_tr_b16 a[230:231], v25 offset:13312
  s_add_u32 s34, s34, 41943072
  v_mfma_f32_16x16x32_bf16 v[212:215], a[244:247], v[88:91], v[212:215]
  v_exp_f32 v61, v61
  v_mfma_f32_16x16x32_bf16 v[216:219], a[248:251], v[88:91], v[216:219]
  ds_read_b64_tr_b16 a[232:233], v26 offset:12288
  v_cvt_pk_bf16_f32 v80, v48, v49
  v_mfma_f32_16x16x32_bf16 v[248:251], a[248:251], v[92:95], v[248:251]
  v_exp_f32 v62, v62
  v_mfma_f32_16x16x32_bf16 v[252:255], a[252:255], v[92:95], v[252:255]
  ds_read_b64_tr_b16 a[234:235], v26 offset:13312
  v_cvt_pk_bf16_f32 v81, v50, v51
  v_mfma_f32_16x16x32_bf16 v[220:223], a[252:255], v[88:91], v[220:223]
  buffer_load_dwordx4 v12, s[40:43], s27 offen offset:2048 lds
  s_or_b32 s33, s24, s3
  s_cselect_b64 exec, 0, 0xffffffff
  buffer_atomic_or v19, v18, s[20:23], s34 offen sc1
  s_mov_b64 exec, -1
  v_mfma_f32_16x16x32_bf16 v[120:123], v[44:47], v[88:91], v[120:123]
  v_exp_f32 v63, v63
  v_mfma_f32_16x16x32_bf16 v[124:127], v[44:47], v[92:95], v[124:127]
  ds_read_b64_tr_b16 a[236:237], v27 offset:12288
  v_cvt_pk_bf16_f32 v82, v52, v53
  v_mfma_f32_16x16x32_bf16 v[64:67], a[192:195], a[160:163], v[104:107]
  v_exp_f32 v56, v56
  v_mfma_f32_16x16x32_bf16 v[64:67], a[196:199], a[164:167], v[64:67]
  ds_read_b64_tr_b16 a[238:239], v27 offset:13312
  v_cvt_pk_bf16_f32 v83, v54, v55
  v_mfma_f32_16x16x32_bf16 v[64:67], a[200:203], a[168:171], v[64:67]
  v_exp_f32 v57, v57
  v_mfma_f32_16x16x32_bf16 v[64:67], a[204:207], a[172:175], v[64:67]
  buffer_load_dwordx4 v13, s[40:43], s27 offen offset:3072 lds
  v_mfma_f32_16x16x32_bf16 v[68:71], a[220:223], a[172:175], v[104:107]
  ds_read_b64_tr_b16 a[240:241], v28 offset:12288
  v_cvt_pk_bf16_f32 v86, v60, v61
  v_mfma_f32_16x16x32_bf16 v[68:71], a[216:219], a[168:171], v[68:71]
  v_exp_f32 v58, v58
  v_mfma_f32_16x16x32_bf16 v[68:71], a[212:215], a[164:167], v[68:71]
  ds_read_b64_tr_b16 a[242:243], v28 offset:13312
  v_cvt_pk_bf16_f32 v87, v62, v63
  v_mfma_f32_16x16x32_bf16 v[68:71], a[208:211], a[160:163], v[68:71]
  v_exp_f32 v59, v59
  v_mfma_f32_16x16x32_bf16 v[76:79], a[208:211], a[176:179], v[108:111]
  ds_read_b64_tr_b16 a[244:245], v29 offset:12288
  v_cvt_pk_bf16_f32 v84, v56, v57
  v_mfma_f32_16x16x32_bf16 v[76:79], a[212:215], a[180:183], v[76:79]
  ds_read_b128 a[208:211], v20 offset:13312
  v_cvt_pk_bf16_f32 v85, v58, v59
  v_mfma_f32_16x16x32_bf16 v[76:79], a[216:219], a[184:187], v[76:79]
  ds_read_b64_tr_b16 a[246:247], v29 offset:13312
  v_mfma_f32_16x16x32_bf16 v[76:79], a[220:223], a[188:191], v[76:79]
  ds_read_b128 a[212:215], v21 offset:13312
  s_waitcnt lgkmcnt(5)
  v_mfma_f32_16x16x32_bf16 v[72:75], a[204:207], a[188:191], v[108:111]
  v_exp_f32 v64, v64
  v_mfma_f32_16x16x32_bf16 v[72:75], a[200:203], a[184:187], v[72:75]
  ds_read_b64_tr_b16 a[248:249], v30 offset:12288
  s_mul_i32 s34, s39, 14336
  v_mfma_f32_16x16x32_bf16 v[72:75], a[196:199], a[180:183], v[72:75]
  ds_read_b128 a[216:219], v22 offset:13312
  s_and_b32 s35, s101, 1
  v_mfma_f32_16x16x32_bf16 v[72:75], a[192:195], a[176:179], v[72:75]
  v_exp_f32 v65, v65
  v_mfma_f32_16x16x32_bf16 v[128:131], a[224:227], v[80:83], v[128:131]
  ds_read_b64_tr_b16 a[250:251], v30 offset:13312
  v_cvt_pk_bf16_f32 v88, v64, v65
  v_mfma_f32_16x16x32_bf16 v[160:163], a[224:227], v[84:87], v[160:163]
  ds_read_b128 a[220:223], v23 offset:13312
  s_lshl_b32 s35, s35, 7
  v_mfma_f32_16x16x32_bf16 v[164:167], a[228:231], v[84:87], v[164:167]
  v_exp_f32 v66, v66
  v_mfma_f32_16x16x32_bf16 v[132:135], a[228:231], v[80:83], v[132:135]
  ds_read_b64_tr_b16 a[252:253], v31 offset:12288
  s_add_u32 s38, s34, s35
  v_mfma_f32_16x16x32_bf16 v[136:139], a[232:235], v[80:83], v[136:139]
  ds_read_b128 a[204:207], v23 offset:12288
  s_lshl_b32 s35, s35, 4
L_page6:
  s_cmp_eq_u32 s100, 1
  s_cbranch_scc1 L_page9
  v_mfma_f32_16x16x32_bf16 v[168:171], a[232:235], v[84:87], v[168:171]
  v_exp_f32 v67, v67
  v_mfma_f32_16x16x32_bf16 v[172:175], a[236:239], v[84:87], v[172:175]
  ds_read_b64_tr_b16 a[254:255], v31 offset:13312
  ds_read_b128 a[200:203], v22 offset:12288
  v_mfma_f32_16x16x32_bf16 v[140:143], a[236:239], v[80:83], v[140:143]
  v_exp_f32 v68, v68
  s_waitcnt lgkmcnt(7)
  v_mfma_f32_16x16x32_bf16 v[144:147], a[240:243], v[80:83], v[144:147]
  ds_read_b128 a[196:199], v21 offset:12288
  v_cvt_pk_bf16_f32 v89, v66, v67
  v_mfma_f32_16x16x32_bf16 v[176:179], a[240:243], v[84:87], v[176:179]
  v_exp_f32 v69, v69
  v_mfma_f32_16x16x32_bf16 v[180:183], a[244:247], v[84:87], v[180:183]
  ds_read_b128 a[192:195], v20 offset:12288
  v_cvt_pk_bf16_f32 v90, v68, v69
  v_mfma_f32_16x16x32_bf16 v[148:151], a[244:247], v[80:83], v[148:151]
  v_exp_f32 v70, v70
  s_waitcnt lgkmcnt(6)
  v_mfma_f32_16x16x32_bf16 v[152:155], a[248:251], v[80:83], v[152:155]
  v_exp_f32 v71, v71
  v_mfma_f32_16x16x32_bf16 v[184:187], a[248:251], v[84:87], v[184:187]
  v_exp_f32 v76, v76
  s_waitcnt vmcnt(0) lgkmcnt(3)
  v_mfma_f32_16x16x32_bf16 v[188:191], a[252:255], v[84:87], v[188:191]
  v_exp_f32 v77, v77
  v_mfma_f32_16x16x32_bf16 v[156:159], a[252:255], v[80:83], v[156:159]
  v_exp_f32 v78, v78
  v_mfma_f32_16x16x32_bf16 v[112:115], v[44:47], v[80:83], v[112:115]
  v_exp_f32 v79, v79
  v_mfma_f32_16x16x32_bf16 v[116:119], v[44:47], v[84:87], v[116:119]
  s_add_u32 m0, s26, 8192
  ds_read_b64_tr_b16 a[32:33], v2 offset:16384
  s_waitcnt lgkmcnt(1)
  v_mfma_f32_16x16x32_bf16 v[48:51], a[192:195], a[128:131], v[96:99]
  v_exp_f32 v72, v72
  v_mfma_f32_16x16x32_bf16 v[48:51], a[196:199], a[132:135], v[48:51]
  s_add_u32 s27, s29, 81920
  buffer_load_dwordx4 v32, s[12:15], s27 offen offset:0 lds
  v_mfma_f32_16x16x32_bf16 v[48:51], a[200:203], a[136:139], v[48:51]
  v_exp_f32 v73, v73
  v_mfma_f32_16x16x32_bf16 v[48:51], a[204:207], a[140:143], v[48:51]
  v_exp_f32 v74, v74
  v_mfma_f32_16x16x32_bf16 v[52:55], a[220:223], a[140:143], v[96:99]
  ds_read_b64_tr_b16 a[34:35], v2 offset:18432
  v_cvt_pk_bf16_f32 v91, v70, v71
  v_mfma_f32_16x16x32_bf16 v[52:55], a[216:219], a[136:139], v[52:55]
  buffer_load_dwordx4 v33, s[16:19], s27 offen offset:2048 lds
  s_add_u32 s34, s34, s35
  v_mfma_f32_16x16x32_bf16 v[52:55], a[212:215], a[132:135], v[52:55]
  v_exp_f32 v75, v75
  v_mfma_f32_16x16x32_bf16 v[52:55], a[208:211], a[128:131], v[52:55]
  v_cvt_pk_bf16_f32 v94, v76, v77
  v_cvt_pk_bf16_f32 v95, v78, v79
  v_mfma_f32_16x16x32_bf16 v[60:63], a[208:211], a[144:147], v[100:103]
  v_cvt_pk_bf16_f32 v92, v72, v73
  v_cvt_pk_bf16_f32 v93, v74, v75
  v_mfma_f32_16x16x32_bf16 v[60:63], a[212:215], a[148:151], v[60:63]
  s_add_u32 s27, s29, 84992
  buffer_load_dwordx4 v32, s[12:15], s27 offen offset:1024 lds
  v_mfma_f32_16x16x32_bf16 v[60:63], a[216:219], a[152:155], v[60:63]
  ds_read_b64_tr_b16 a[40:41], v3 offset:16384
  v_lshrrev_b32 v18, 2, v1
  v_mfma_f32_16x16x32_bf16 v[60:63], a[220:223], a[156:159], v[60:63]
  v_exp_f32 v48, v48
  v_mfma_f32_16x16x32_bf16 v[56:59], a[204:207], a[156:159], v[100:103]
  v_exp_f32 v49, v49
  v_mfma_f32_16x16x32_bf16 v[56:59], a[200:203], a[152:155], v[56:59]
  buffer_load_dwordx4 v33, s[16:19], s27 offen offset:3072 lds
  v_mfma_f32_16x16x32_bf16 v[56:59], a[196:199], a[148:151], v[56:59]
  v_exp_f32 v50, v50
  v_mfma_f32_16x16x32_bf16 v[56:59], a[192:195], a[144:147], v[56:59]
  s_barrier
  v_mfma_f32_16x16x32_bf16 v[192:195], a[224:227], v[88:91], v[192:195]
  ds_read_b64_tr_b16 a[42:43], v3 offset:18432
  v_cvt_pk_bf16_f32 v80, v48, v49
  v_mfma_f32_16x16x32_bf16 v[224:227], a[224:227], v[92:95], v[224:227]
  s_add_u32 m0, s11, 0
  ds_read_b64_tr_b16 a[48:49], v4 offset:16384
  v_mfma_f32_16x16x32_bf16 v[228:231], a[228:231], v[92:95], v[228:231]
  v_exp_f32 v51, v51
  v_mfma_f32_16x16x32_bf16 v[196:199], a[228:231], v[88:91], v[196:199]
  s_add_u32 s27, s28, 128
  buffer_load_dwordx4 v10, s[40:43], s27 offen offset:0 lds
  v_mfma_f32_16x16x32_bf16 v[200:203], a[232:235], v[88:91], v[200:203]
  v_exp_f32 v52, v52
  v_mfma_f32_16x16x32_bf16 v[232:235], a[232:235], v[92:95], v[232:235]
  v_exp_f32 v53, v53
  v_mfma_f32_16x16x32_bf16 v[236:239], a[236:239], v[92:95], v[236:239]
  ds_read_b64_tr_b16 a[224:225], v24 offset:0
  v_cvt_pk_bf16_f32 v81, v50, v51
  v_mfma_f32_16x16x32_bf16 v[204:207], a[236:239], v[88:91], v[204:207]
  v_exp_f32 v54, v54
  v_mfma_f32_16x16x32_bf16 v[208:211], a[240:243], v[88:91], v[208:211]
  ds_read_b64_tr_b16 a[226:227], v24 offset:1024
  v_cvt_pk_bf16_f32 v82, v52, v53
  v_mfma_f32_16x16x32_bf16 v[240:243], a[240:243], v[92:95], v[240:243]
  buffer_load_dwordx4 v11, s[40:43], s27 offen offset:1024 lds
  v_mfma_f32_16x16x32_bf16 v[244:247], a[244:247], v[92:95], v[244:247]
  v_exp_f32 v55, v55
  v_mfma_f32_16x16x32_bf16 v[212:215], a[244:247], v[88:91], v[212:215]
  ds_read_b64_tr_b16 a[50:51], v4 offset:18432
  v_cvt_pk_bf16_f32 v83, v54, v55
  v_mfma_f32_16x16x32_bf16 v[216:219], a[248:251], v[88:91], v[216:219]
  ds_read_b64_tr_b16 a[228:229], v25 offset:0
  v_lshlrev_b32 v18, 10, v18
  v_mfma_f32_16x16x32_bf16 v[248:251], a[248:251], v[92:95], v[248:251]
  v_exp_f32 v60, v60
  v_mfma_f32_16x16x32_bf16 v[252:255], a[252:255], v[92:95], v[252:255]
  ds_read_b64_tr_b16 a[230:231], v25 offset:1024
  v_and_b32 v19, 3, v1
  v_mfma_f32_16x16x32_bf16 v[220:223], a[252:255], v[88:91], v[220:223]
  buffer_load_dwordx4 v12, s[40:43], s27 offen offset:2048 lds
  v_mfma_f32_16x16x32_bf16 v[120:123], v[44:47], v[88:91], v[120:123]
  v_exp_f32 v61, v61
  v_mfma_f32_16x16x32_bf16 v[124:127], v[44:47], v[92:95], v[124:127]
  ds_read_b64_tr_b16 a[232:233], v26 offset:0
  v_cvt_pk_bf16_f32 v86, v60, v61
  v_mfma_f32_16x16x32_bf16 v[64:67], a[192:195], a[160:163], v[104:107]
  ds_read_b64_tr_b16 a[56:57], v5 offset:16384
  v_lshl_add_u32 v18, v19, 8, v18
  v_mfma_f32_16x16x32_bf16 v[64:67], a[196:199], a[164:167], v[64:67]
  v_exp_f32 v62, v62
  v_mfma_f32_16x16x32_bf16 v[64:67], a[200:203], a[168:171], v[64:67]
  ds_read_b64_tr_b16 a[234:235], v26 offset:1024
  v_lshrrev_b32 v17, 4, v1
  v_mfma_f32_16x16x32_bf16 v[64:67], a[204:207], a[172:175], v[64:67]
  buffer_load_dwordx4 v13, s[40:43], s27 offen offset:3072 lds
  v_exp_f32 v63, v63
  v_mfma_f32_16x16x32_bf16 v[68:71], a[220:223], a[172:175], v[104:107]
  ds_read_b64_tr_b16 a[236:237], v27 offset:0
  v_cvt_pk_bf16_f32 v87, v62, v63
  v_mfma_f32_16x16x32_bf16 v[68:71], a[216:219], a[168:171], v[68:71]
  ds_read_b64_tr_b16 a[58:59], v5 offset:18432
  v_exp_f32 v56, v56
  v_mfma_f32_16x16x32_bf16 v[68:71], a[212:215], a[164:167], v[68:71]
  ds_read_b64_tr_b16 a[238:239], v27 offset:1024
  v_mul_u32_u24 v17, 3584, v17
  v_mfma_f32_16x16x32_bf16 v[68:71], a[208:211], a[160:163], v[68:71]
  s_add_u32 m0, s11, 4096
  v_exp_f32 v57, v57
  v_mfma_f32_16x16x32_bf16 v[76:79], a[208:211], a[176:179], v[108:111]
  ds_read_b64_tr_b16 a[240:241], v28 offset:0
  v_cvt_pk_bf16_f32 v84, v56, v57
  v_mfma_f32_16x16x32_bf16 v[76:79], a[212:215], a[180:183], v[76:79]
  s_add_u32 s27, s28, 32896
  buffer_load_dwordx4 v10, s[40:43], s27 offen offset:0 lds
  v_exp_f32 v58, v58
  v_mfma_f32_16x16x32_bf16 v[76:79], a[216:219], a[184:187], v[76:79]
  ds_read_b64_tr_b16 a[242:243], v28 offset:1024
  ds_read_b64_tr_b16 a[36:37], v2 offset:20480
  v_mfma_f32_16x16x32_bf16 v[76:79], a[220:223], a[188:191], v[76:79]
  v_exp_f32 v59, v59
  v_mfma_f32_16x16x32_bf16 v[72:75], a[204:207], a[188:191], v[108:111]
  ds_read_b64_tr_b16 a[244:245], v29 offset:0
  ds_read_b128 a[208:211], v20 offset:1024
  v_mfma_f32_16x16x32_bf16 v[72:75], a[200:203], a[184:187], v[72:75]
  ds_read_b64_tr_b16 a[246:247], v29 offset:1024
  v_cvt_pk_bf16_f32 v85, v58, v59
  v_mfma_f32_16x16x32_bf16 v[72:75], a[196:199], a[180:183], v[72:75]
  ds_read_b128 a[212:215], v21 offset:1024
  v_and_b32 v19, 15, v1
  v_mfma_f32_16x16x32_bf16 v[72:75], a[192:195], a[176:179], v[72:75]
  buffer_load_dwordx4 v11, s[40:43], s27 offen offset:1024 lds
  ds_read_b64_tr_b16 a[38:39], v2 offset:22528
  v_exp_f32 v64, v64
  v_mfma_f32_16x16x32_bf16 v[128:131], a[224:227], v[80:83], v[128:131]
  ds_read_b64_tr_b16 a[248:249], v30 offset:0
  ds_read_b128 a[216:219], v22 offset:1024
  v_mfma_f32_16x16x32_bf16 v[160:163], a[224:227], v[84:87], v[160:163]
  v_exp_f32 v65, v65
  v_mfma_f32_16x16x32_bf16 v[164:167], a[228:231], v[84:87], v[164:167]
  ds_read_b64_tr_b16 a[250:251], v30 offset:1024
  ds_read_b128 a[220:223], v23 offset:1024
  v_mfma_f32_16x16x32_bf16 v[132:135], a[228:231], v[80:83], v[132:135]
  v_exp_f32 v66, v66
  v_mfma_f32_16x16x32_bf16 v[136:139], a[232:235], v[80:83], v[136:139]
  ds_read_b64_tr_b16 a[252:253], v31 offset:0
  ds_read_b128 a[204:207], v23 offset:0
  ds_read_b64_tr_b16 a[44:45], v3 offset:20480
  v_mfma_f32_16x16x32_bf16 v[168:171], a[232:235], v[84:87], v[168:171]
  buffer_load_dwordx4 v12, s[40:43], s27 offen offset:2048 lds
  v_exp_f32 v67, v67
  v_mfma_f32_16x16x32_bf16 v[172:175], a[236:239], v[84:87], v[172:175]
  ds_read_b64_tr_b16 a[254:255], v31 offset:1024
  ds_read_b128 a[200:203], v22 offset:0
  v_mfma_f32_16x16x32_bf16 v[140:143], a[236:239], v[80:83], v[140:143]
  v_exp_f32 v68, v68
  v_mfma_f32_16x16x32_bf16 v[144:147], a[240:243], v[80:83], v[144:147]
  ds_read_b128 a[196:199], v21 offset:0
  v_lshl_add_u32 v17, v19, 7, v17
  v_mfma_f32_16x16x32_bf16 v[176:179], a[240:243], v[84:87], v[176:179]
  ds_read_b64_tr_b16 a[46:47], v3 offset:22528
  v_exp_f32 v69, v69
  s_waitcnt lgkmcnt(10)
  v_mfma_f32_16x16x32_bf16 v[180:183], a[244:247], v[84:87], v[180:183]
  ds_read_b128 a[192:195], v20 offset:0
  v_cvt_pk_bf16_f32 v88, v64, v65
  v_mfma_f32_16x16x32_bf16 v[148:151], a[244:247], v[80:83], v[148:151]
  buffer_load_dwordx4 v13, s[40:43], s27 offen offset:3072 lds
  v_exp_f32 v70, v70
  s_waitcnt lgkmcnt(8)
  v_mfma_f32_16x16x32_bf16 v[152:155], a[248:251], v[80:83], v[152:155]
  v_exp_f32 v71, v71
  v_mfma_f32_16x16x32_bf16 v[184:187], a[248:251], v[84:87], v[184:187]
  ds_read_b64_tr_b16 a[52:53], v4 offset:20480
  v_cvt_pk_bf16_f32 v89, v66, v67
  s_waitcnt lgkmcnt(5)
  v_mfma_f32_16x16x32_bf16 v[188:191], a[252:255], v[84:87], v[188:191]
  v_exp_f32 v76, v76
  v_mfma_f32_16x16x32_bf16 v[156:159], a[252:255], v[80:83], v[156:159]
  v_exp_f32 v77, v77
  v_mfma_f32_16x16x32_bf16 v[112:115], v[44:47], v[80:83], v[112:115]
  v_exp_f32 v78, v78
  v_mfma_f32_16x16x32_bf16 v[116:119], v[44:47], v[84:87], v[116:119]
  s_add_u32 m0, s26, 12288
  ds_read_b64_tr_b16 a[54:55], v4 offset:22528
  s_waitcnt lgkmcnt(2)
  v_mfma_f32_16x16x32_bf16 v[48:51], a[192:195], a[128:131], v[96:99]
  v_exp_f32 v79, v79
  v_mfma_f32_16x16x32_bf16 v[48:51], a[196:199], a[132:135], v[48:51]
  s_add_u32 s27, s29, 90112
  buffer_load_dwordx4 v32, s[12:15], s27 offen offset:0 lds
  v_mfma_f32_16x16x32_bf16 v[48:51], a[200:203], a[136:139], v[48:51]
  v_exp_f32 v72, v72
  v_mfma_f32_16x16x32_bf16 v[48:51], a[204:207], a[140:143], v[48:51]
  ds_read_b64_tr_b16 a[60:61], v5 offset:20480
  v_cvt_pk_bf16_f32 v90, v68, v69
  v_mfma_f32_16x16x32_bf16 v[52:55], a[220:223], a[140:143], v[96:99]
  v_exp_f32 v73, v73
  v_mfma_f32_16x16x32_bf16 v[52:55], a[216:219], a[136:139], v[52:55]
  buffer_load_dwordx4 v33, s[16:19], s27 offen offset:2048 lds
  v_mfma_f32_16x16x32_bf16 v[52:55], a[212:215], a[132:135], v[52:55]
  v_exp_f32 v74, v74
  v_mfma_f32_16x16x32_bf16 v[52:55], a[208:211], a[128:131], v[52:55]
  v_exp_f32 v75, v75
  v_mfma_f32_16x16x32_bf16 v[60:63], a[208:211], a[144:147], v[100:103]
  ds_read_b64_tr_b16 a[62:63], v5 offset:22528
  v_cvt_pk_bf16_f32 v91, v70, v71
  v_mfma_f32_16x16x32_bf16 v[60:63], a[212:215], a[148:151], v[60:63]
  s_add_u32 s27, s29, 93184
  buffer_load_dwordx4 v32, s[12:15], s27 offen offset:1024 lds
  v_mfma_f32_16x16x32_bf16 v[60:63], a[216:219], a[152:155], v[60:63]
  v_cvt_pk_bf16_f32 v94, v76, v77
  v_cvt_pk_bf16_f32 v95, v78, v79
  v_mfma_f32_16x16x32_bf16 v[60:63], a[220:223], a[156:159], v[60:63]
  v_cvt_pk_bf16_f32 v92, v72, v73
  v_cvt_pk_bf16_f32 v93, v74, v75
  v_mfma_f32_16x16x32_bf16 v[56:59], a[204:207], a[156:159], v[100:103]
  v_exp_f32 v48, v48
  v_mfma_f32_16x16x32_bf16 v[56:59], a[200:203], a[152:155], v[56:59]
  buffer_load_dwordx4 v33, s[16:19], s27 offen offset:3072 lds
  v_mfma_f32_16x16x32_bf16 v[56:59], a[196:199], a[148:151], v[56:59]
  v_exp_f32 v49, v49
  v_mfma_f32_16x16x32_bf16 v[56:59], a[192:195], a[144:147], v[56:59]
  s_barrier
  v_mfma_f32_16x16x32_bf16 v[192:195], a[224:227], v[88:91], v[192:195]
  v_exp_f32 v50, v50
  v_mfma_f32_16x16x32_bf16 v[224:227], a[224:227], v[92:95], v[224:227]
  s_add_u32 m0, s26, 16384
  ds_read_b64_tr_b16 a[224:225], v24 offset:4096
  v_mfma_f32_16x16x32_bf16 v[228:231], a[228:231], v[92:95], v[228:231]
  v_exp_f32 v51, v51
  v_mfma_f32_16x16x32_bf16 v[196:199], a[228:231], v[88:91], v[196:199]
  s_waitcnt lgkmcnt(1)
  s_add_u32 s27, s28, 131072
  buffer_load_dwordx4 v10, s[40:43], s27 offen offset:0 lds
  v_mfma_f32_16x16x32_bf16 v[200:203], a[232:235], v[88:91], v[200:203]
  v_exp_f32 v52, v52
  v_mfma_f32_16x16x32_bf16 v[232:235], a[232:235], v[92:95], v[232:235]
  v_exp_f32 v53, v53
  v_mfma_f32_16x16x32_bf16 v[236:239], a[236:239], v[92:95], v[236:239]
  v_exp_f32 v54, v54
  v_mfma_f32_16x16x32_bf16 v[204:207], a[236:239], v[88:91], v[204:207]
  ds_read_b64_tr_b16 a[226:227], v24 offset:5120
  v_lshlrev_b32 v14, 16, v36
  v_mfma_f32_16x16x32_bf16 v[208:211], a[240:243], v[88:91], v[208:211]
  v_exp_f32 v55, v55
  v_mfma_f32_16x16x32_bf16 v[240:243], a[240:243], v[92:95], v[240:243]
  buffer_load_dwordx4 v11, s[40:43], s27 offen offset:1024 lds
  v_mfma_f32_16x16x32_bf16 v[244:247], a[244:247], v[92:95], v[244:247]
  ds_read_b64_tr_b16 a[228:229], v25 offset:4096
  v_lshlrev_b32 v15, 16, v40
  v_mfma_f32_16x16x32_bf16 v[212:215], a[244:247], v[88:91], v[212:215]
  v_exp_f32 v60, v60
  v_mfma_f32_16x16x32_bf16 v[216:219], a[248:251], v[88:91], v[216:219]
  ds_read_b64_tr_b16 a[230:231], v25 offset:5120
  v_and_b32 v36, s70, v36
  v_mfma_f32_16x16x32_bf16 v[248:251], a[248:251], v[92:95], v[248:251]
  v_exp_f32 v61, v61
  v_mfma_f32_16x16x32_bf16 v[252:255], a[252:255], v[92:95], v[252:255]
  ds_read_b64_tr_b16 a[232:233], v26 offset:4096
  v_cvt_pk_bf16_f32 v80, v48, v49
  v_mfma_f32_16x16x32_bf16 v[220:223], a[252:255], v[88:91], v[220:223]
  buffer_load_dwordx4 v12, s[40:43], s27 offen offset:2048 lds
  v_mfma_f32_16x16x32_bf16 v[120:123], v[44:47], v[88:91], v[120:123]
  v_exp_f32 v62, v62
  v_mfma_f32_16x16x32_bf16 v[124:127], v[44:47], v[92:95], v[124:127]
  ds_read_b64_tr_b16 a[234:235], v26 offset:5120
  v_cvt_pk_bf16_f32 v81, v50, v51
  v_mfma_f32_16x16x32_bf16 v[64:67], a[192:195], a[160:163], v[104:107]
  v_exp_f32 v63, v63
  v_mfma_f32_16x16x32_bf16 v[64:67], a[196:199], a[164:167], v[64:67]
  ds_read_b64_tr_b16 a[236:237], v27 offset:4096
  v_cvt_pk_bf16_f32 v82, v52, v53
  v_mfma_f32_16x16x32_bf16 v[64:67], a[200:203], a[168:171], v[64:67]
  v_exp_f32 v56, v56
  v_mfma_f32_16x16x32_bf16 v[64:67], a[204:207], a[172:175], v[64:67]
  buffer_load_dwordx4 v13, s[40:43], s27 offen offset:3072 lds
  v_mfma_f32_16x16x32_bf16 v[68:71], a[220:223], a[172:175], v[104:107]
  ds_read_b64_tr_b16 a[238:239], v27 offset:5120
  v_cvt_pk_bf16_f32 v83, v54, v55
  v_mfma_f32_16x16x32_bf16 v[68:71], a[216:219], a[168:171], v[68:71]
  v_exp_f32 v57, v57
  v_mfma_f32_16x16x32_bf16 v[68:71], a[212:215], a[164:167], v[68:71]
  ds_read_b64_tr_b16 a[240:241], v28 offset:4096
  v_cvt_pk_bf16_f32 v86, v60, v61
  v_mfma_f32_16x16x32_bf16 v[68:71], a[208:211], a[160:163], v[68:71]
  s_add_u32 m0, s26, 20480
  ds_read_b64_tr_b16 a[242:243], v28 offset:5120
  v_mfma_f32_16x16x32_bf16 v[76:79], a[208:211], a[176:179], v[108:111]
  v_exp_f32 v58, v58
  v_mfma_f32_16x16x32_bf16 v[76:79], a[212:215], a[180:183], v[76:79]
  s_add_u32 s27, s28, 163840
  buffer_load_dwordx4 v10, s[40:43], s27 offen offset:0 lds
  v_mfma_f32_16x16x32_bf16 v[76:79], a[216:219], a[184:187], v[76:79]
  v_exp_f32 v59, v59
  v_mfma_f32_16x16x32_bf16 v[76:79], a[220:223], a[188:191], v[76:79]
  ds_read_b64_tr_b16 a[244:245], v29 offset:4096
  v_cvt_pk_bf16_f32 v87, v62, v63
  v_mfma_f32_16x16x32_bf16 v[72:75], a[204:207], a[188:191], v[108:111]
  ds_read_b128 a[208:211], v20 offset:5120
  v_and_b32 v40, s70, v40
  v_mfma_f32_16x16x32_bf16 v[72:75], a[200:203], a[184:187], v[72:75]
  ds_read_b64_tr_b16 a[246:247], v29 offset:5120
  v_cvt_pk_bf16_f32 v84, v56, v57
  v_mfma_f32_16x16x32_bf16 v[72:75], a[196:199], a[180:183], v[72:75]
  ds_read_b128 a[212:215], v21 offset:5120
  v_cvt_pk_bf16_f32 v85, v58, v59
  v_mfma_f32_16x16x32_bf16 v[72:75], a[192:195], a[176:179], v[72:75]
  buffer_load_dwordx4 v11, s[40:43], s27 offen offset:1024 lds
  v_exp_f32 v64, v64
  s_waitcnt lgkmcnt(6)
  v_mfma_f32_16x16x32_bf16 v[128:131], a[224:227], v[80:83], v[128:131]
  ds_read_b64_tr_b16 a[248:249], v30 offset:4096
  ds_read_b128 a[216:219], v22 offset:5120
  v_mul_f32 v14, v34, v14
  v_mfma_f32_16x16x32_bf16 v[160:163], a[224:227], v[84:87], v[160:163]
  v_exp_f32 v65, v65
  v_mfma_f32_16x16x32_bf16 v[164:167], a[228:231], v[84:87], v[164:167]
  ds_read_b64_tr_b16 a[250:251], v30 offset:5120
  ds_read_b128 a[220:223], v23 offset:5120
  v_mfma_f32_16x16x32_bf16 v[132:135], a[228:231], v[80:83], v[132:135]
  v_exp_f32 v66, v66
  v_mul_f32 v36, v34, v36
  v_mfma_f32_16x16x32_bf16 v[136:139], a[232:235], v[80:83], v[136:139]
  ds_read_b64_tr_b16 a[252:253], v31 offset:4096
  ds_read_b128 a[204:207], v23 offset:4096
  v_mfma_f32_16x16x32_bf16 v[168:171], a[232:235], v[84:87], v[168:171]
  buffer_load_dwordx4 v12, s[40:43], s27 offen offset:2048 lds
  v_exp_f32 v67, v67
  v_mfma_f32_16x16x32_bf16 v[172:175], a[236:239], v[84:87], v[172:175]
  ds_read_b64_tr_b16 a[254:255], v31 offset:5120
  ds_read_b128 a[200:203], v22 offset:4096
  v_fma_f32 v40, v40, v35, v36
  v_mfma_f32_16x16x32_bf16 v[140:143], a[236:239], v[80:83], v[140:143]
  v_exp_f32 v68, v68
  s_waitcnt lgkmcnt(8)
  v_mfma_f32_16x16x32_bf16 v[144:147], a[240:243], v[80:83], v[144:147]
  ds_read_b128 a[196:199], v21 offset:4096
  v_fma_f32 v36, v15, v35, v14
  v_mfma_f32_16x16x32_bf16 v[176:179], a[240:243], v[84:87], v[176:179]
  v_exp_f32 v69, v69
  v_mfma_f32_16x16x32_bf16 v[180:183], a[244:247], v[84:87], v[180:183]
  ds_read_b128 a[192:195], v20 offset:4096
  v_lshlrev_b32 v14, 16, v37
  v_mfma_f32_16x16x32_bf16 v[148:151], a[244:247], v[80:83], v[148:151]
  buffer_load_dwordx4 v13, s[40:43], s27 offen offset:3072 lds
  v_exp_f32 v70, v70
  s_waitcnt lgkmcnt(6)
  v_mfma_f32_16x16x32_bf16 v[152:155], a[248:251], v[80:83], v[152:155]
  v_exp_f32 v71, v71
  v_mfma_f32_16x16x32_bf16 v[184:187], a[248:251], v[84:87], v[184:187]
  v_exp_f32 v76, v76
  s_waitcnt lgkmcnt(3)
  v_mfma_f32_16x16x32_bf16 v[188:191], a[252:255], v[84:87], v[188:191]
  v_lshlrev_b32 v15, 16, v41
  v_and_b32 v37, s70, v37
  v_mfma_f32_16x16x32_bf16 v[156:159], a[252:255], v[80:83], v[156:159]
  v_exp_f32 v77, v77
  v_mfma_f32_16x16x32_bf16 v[112:115], v[44:47], v[80:83], v[112:115]
  v_exp_f32 v78, v78
  v_mfma_f32_16x16x32_bf16 v[116:119], v[44:47], v[84:87], v[116:119]
  s_add_u32 m0, s26, 0
  v_and_b32 v41, s70, v41
  s_waitcnt lgkmcnt(0)
  v_mfma_f32_16x16x32_bf16 v[48:51], a[192:195], a[128:131], v[96:99]
  v_exp_f32 v79, v79
  v_mfma_f32_16x16x32_bf16 v[48:51], a[196:199], a[132:135], v[48:51]
  s_add_u32 s27, s29, 98304
  buffer_load_dwordx4 v32, s[12:15], s27 offen offset:0 lds
  v_mfma_f32_16x16x32_bf16 v[48:51], a[200:203], a[136:139], v[48:51]
  v_exp_f32 v72, v72
  v_mfma_f32_16x16x32_bf16 v[48:51], a[204:207], a[140:143], v[48:51]
  v_mul_f32 v14, v34, v14
  v_mul_f32 v37, v34, v37
  v_mfma_f32_16x16x32_bf16 v[52:55], a[220:223], a[140:143], v[96:99]
  v_exp_f32 v73, v73
  v_mfma_f32_16x16x32_bf16 v[52:55], a[216:219], a[136:139], v[52:55]
  buffer_load_dwordx4 v33, s[16:19], s27 offen offset:2048 lds
  v_mfma_f32_16x16x32_bf16 v[52:55], a[212:215], a[132:135], v[52:55]
  v_exp_f32 v74, v74
  v_mfma_f32_16x16x32_bf16 v[52:55], a[208:211], a[128:131], v[52:55]
  v_exp_f32 v75, v75
  v_mfma_f32_16x16x32_bf16 v[60:63], a[208:211], a[144:147], v[100:103]
  v_cvt_pk_bf16_f32 v88, v64, v65
  v_cvt_pk_bf16_f32 v89, v66, v67
  v_mfma_f32_16x16x32_bf16 v[60:63], a[212:215], a[148:151], v[60:63]
  s_add_u32 s27, s29, 101376
  buffer_load_dwordx4 v32, s[12:15], s27 offen offset:1024 lds
  v_mfma_f32_16x16x32_bf16 v[60:63], a[216:219], a[152:155], v[60:63]
  v_cvt_pk_bf16_f32 v90, v68, v69
  v_cvt_pk_bf16_f32 v91, v70, v71
  v_mfma_f32_16x16x32_bf16 v[60:63], a[220:223], a[156:159], v[60:63]
  v_fma_f32 v41, v41, v35, v37
  v_cvt_pk_bf16_f32 v94, v76, v77
  v_mfma_f32_16x16x32_bf16 v[56:59], a[204:207], a[156:159], v[100:103]
  v_cvt_pk_bf16_f32 v95, v78, v79
  v_cvt_pk_bf16_f32 v92, v72, v73
  v_mfma_f32_16x16x32_bf16 v[56:59], a[200:203], a[152:155], v[56:59]
  buffer_load_dwordx4 v33, s[16:19], s27 offen offset:3072 lds
  v_mfma_f32_16x16x32_bf16 v[56:59], a[196:199], a[148:151], v[56:59]
  v_cvt_pk_bf16_f32 v93, v74, v75
  v_fma_f32 v37, v15, v35, v14
  v_mfma_f32_16x16x32_bf16 v[56:59], a[192:195], a[144:147], v[56:59]
  s_waitcnt vmcnt(17)
  s_barrier
  v_exp_f32 v48, v48
  v_mfma_f32_16x16x32_bf16 v[192:195], a[224:227], v[88:91], v[192:195]
  v_exp_f32 v49, v49
  v_mfma_f32_16x16x32_bf16 v[224:227], a[224:227], v[92:95], v[224:227]
  v_lshlrev_b32 v14, 16, v38
  v_lshlrev_b32 v15, 16, v42
  v_mfma_f32_16x16x32_bf16 v[228:231], a[228:231], v[92:95], v[228:231]
  v_exp_f32 v50, v50
  v_mfma_f32_16x16x32_bf16 v[196:199], a[228:231], v[88:91], v[196:199]
  v_exp_f32 v51, v51
  s_waitcnt vmcnt(4)
  v_mfma_f32_16x16x32_bf16 v[200:203], a[232:235], v[88:91], v[200:203]
  v_exp_f32 v52, v52
  v_mfma_f32_16x16x32_bf16 v[232:235], a[232:235], v[92:95], v[232:235]
  ds_read_b64_tr_b16 a[224:225], v24 offset:8192
  v_and_b32 v38, s70, v38
  v_mfma_f32_16x16x32_bf16 v[236:239], a[236:239], v[92:95], v[236:239]
  v_exp_f32 v53, v53
  v_mfma_f32_16x16x32_bf16 v[204:207], a[236:239], v[88:91], v[204:207]
  v_exp_f32 v54, v54
  v_mfma_f32_16x16x32_bf16 v[208:211], a[240:243], v[88:91], v[208:211]
  ds_read_b64_tr_b16 a[226:227], v24 offset:9216
  v_and_b32 v42, s70, v42
  v_mfma_f32_16x16x32_bf16 v[240:243], a[240:243], v[92:95], v[240:243]
  ds_read_b64_tr_b16 a[64:65], v2 offset:16384
  v_mul_f32 v14, v34, v14
  v_mfma_f32_16x16x32_bf16 v[244:247], a[244:247], v[92:95], v[244:247]
  v_exp_f32 v55, v55
  v_mfma_f32_16x16x32_bf16 v[212:215], a[244:247], v[88:91], v[212:215]
  ds_read_b64_tr_b16 a[228:229], v25 offset:8192
  v_mul_f32 v38, v34, v38
  v_mfma_f32_16x16x32_bf16 v[216:219], a[248:251], v[88:91], v[216:219]
  v_exp_f32 v60, v60
  v_mfma_f32_16x16x32_bf16 v[248:251], a[248:251], v[92:95], v[248:251]
  ds_read_b64_tr_b16 a[230:231], v25 offset:9216
  v_fma_f32 v42, v42, v35, v38
  v_mfma_f32_16x16x32_bf16 v[252:255], a[252:255], v[92:95], v[252:255]
  v_exp_f32 v61, v61
  v_mfma_f32_16x16x32_bf16 v[220:223], a[252:255], v[88:91], v[220:223]
  ds_read_b64_tr_b16 a[66:67], v2 offset:18432
  v_fma_f32 v38, v15, v35, v14
  v_mfma_f32_16x16x32_bf16 v[120:123], v[44:47], v[88:91], v[120:123]
  ds_read_b64_tr_b16 a[232:233], v26 offset:8192
  v_lshlrev_b32 v14, 16, v39
  v_mfma_f32_16x16x32_bf16 v[124:127], v[44:47], v[92:95], v[124:127]
  v_exp_f32 v62, v62
  v_mfma_f32_16x16x32_bf16 v[64:67], a[192:195], a[160:163], v[104:107]
  ds_read_b64_tr_b16 a[234:235], v26 offset:9216
  v_cvt_pk_bf16_f32 v80, v48, v49
  v_mfma_f32_16x16x32_bf16 v[64:67], a[196:199], a[164:167], v[64:67]
  v_exp_f32 v63, v63
  v_mfma_f32_16x16x32_bf16 v[64:67], a[200:203], a[168:171], v[64:67]
  ds_read_b64_tr_b16 a[236:237], v27 offset:8192
  v_cvt_pk_bf16_f32 v81, v50, v51
  v_mfma_f32_16x16x32_bf16 v[64:67], a[204:207], a[172:175], v[64:67]
  ds_read_b64_tr_b16 a[72:73], v3 offset:16384
  v_lshlrev_b32 v15, 16, v43
  v_mfma_f32_16x16x32_bf16 v[68:71], a[220:223], a[172:175], v[104:107]
  v_exp_f32 v56, v56
  v_mfma_f32_16x16x32_bf16 v[68:71], a[216:219], a[168:171], v[68:71]
  ds_read_b64_tr_b16 a[238:239], v27 offset:9216
  v_cvt_pk_bf16_f32 v82, v52, v53
  v_mfma_f32_16x16x32_bf16 v[68:71], a[212:215], a[164:167], v[68:71]
  v_exp_f32 v57, v57
  v_mfma_f32_16x16x32_bf16 v[68:71], a[208:211], a[160:163], v[68:71]
  ds_read_b64_tr_b16 a[240:241], v28 offset:8192
  v_cvt_pk_bf16_f32 v83, v54, v55
  v_mfma_f32_16x16x32_bf16 v[76:79], a[208:211], a[176:179], v[108:111]
  v_exp_f32 v58, v58
  v_mfma_f32_16x16x32_bf16 v[76:79], a[212:215], a[180:183], v[76:79]
  ds_read_b64_tr_b16 a[74:75], v3 offset:18432
  v_cvt_pk_bf16_f32 v86, v60, v61
  v_mfma_f32_16x16x32_bf16 v[76:79], a[216:219], a[184:187], v[76:79]
  ds_read_b64_tr_b16 a[242:243], v28 offset:9216
  v_cvt_pk_bf16_f32 v87, v62, v63
  v_mfma_f32_16x16x32_bf16 v[76:79], a[220:223], a[188:191], v[76:79]
  v_exp_f32 v59, v59
  v_mfma_f32_16x16x32_bf16 v[72:75], a[204:207], a[188:191], v[108:111]
  ds_read_b64_tr_b16 a[244:245], v29 offset:8192
  ds_read_b128 a[208:211], v20 offset:9216
  v_mfma_f32_16x16x32_bf16 v[72:75], a[200:203], a[184:187], v[72:75]
  ds_read_b64_tr_b16 a[246:247], v29 offset:9216
  v_cvt_pk_bf16_f32 v84, v56, v57
  v_mfma_f32_16x16x32_bf16 v[72:75], a[196:199], a[180:183], v[72:75]
  ds_read_b128 a[212:215], v21 offset:9216
  ds_read_b64_tr_b16 a[80:81], v4 offset:16384
  v_cvt_pk_bf16_f32 v85, v58, v59
  v_and_b32 v39, s70, v39
  v_mfma_f32_16x16x32_bf16 v[72:75], a[192:195], a[176:179], v[72:75]
  v_exp_f32 v64, v64
  v_mfma_f32_16x16x32_bf16 v[128:131], a[224:227], v[80:83], v[128:131]
  ds_read_b64_tr_b16 a[248:249], v30 offset:8192
  ds_read_b128 a[216:219], v22 offset:9216
  v_mfma_f32_16x16x32_bf16 v[160:163], a[224:227], v[84:87], v[160:163]
  v_exp_f32 v65, v65
  v_and_b32 v43, s70, v43
  v_mfma_f32_16x16x32_bf16 v[164:167], a[228:231], v[84:87], v[164:167]
  ds_read_b64_tr_b16 a[250:251], v30 offset:9216
  ds_read_b128 a[220:223], v23 offset:9216
  v_mfma_f32_16x16x32_bf16 v[132:135], a[228:231], v[80:83], v[132:135]
  ds_read_b64_tr_b16 a[82:83], v4 offset:18432
  v_exp_f32 v66, v66
  v_mfma_f32_16x16x32_bf16 v[136:139], a[232:235], v[80:83], v[136:139]
  ds_read_b64_tr_b16 a[252:253], v31 offset:8192
  ds_read_b128 a[204:207], v23 offset:8192
  v_mul_f32 v14, v34, v14
  v_mfma_f32_16x16x32_bf16 v[168:171], a[232:235], v[84:87], v[168:171]
  v_exp_f32 v67, v67
  v_mfma_f32_16x16x32_bf16 v[172:175], a[236:239], v[84:87], v[172:175]
  ds_read_b64_tr_b16 a[254:255], v31 offset:9216
  ds_read_b128 a[200:203], v22 offset:8192
  v_mfma_f32_16x16x32_bf16 v[140:143], a[236:239], v[80:83], v[140:143]
  v_exp_f32 v68, v68
  v_mul_f32 v39, v34, v39
  s_waitcnt lgkmcnt(9)
  v_mfma_f32_16x16x32_bf16 v[144:147], a[240:243], v[80:83], v[144:147]
  ds_read_b128 a[196:199], v21 offset:8192
  ds_read_b64_tr_b16 a[88:89], v5 offset:16384
  v_mfma_f32_16x16x32_bf16 v[176:179], a[240:243], v[84:87], v[176:179]
  v_exp_f32 v69, v69
  v_mfma_f32_16x16x32_bf16 v[180:183], a[244:247], v[84:87], v[180:183]
  ds_read_b128 a[192:195], v20 offset:8192
  v_fma_f32 v43, v43, v35, v39
  v_mfma_f32_16x16x32_bf16 v[148:151], a[244:247], v[80:83], v[148:151]
  v_exp_f32 v70, v70
  s_waitcnt lgkmcnt(9)
  v_mfma_f32_16x16x32_bf16 v[152:155], a[248:251], v[80:83], v[152:155]
  v_exp_f32 v71, v71
  v_mfma_f32_16x16x32_bf16 v[184:187], a[248:251], v[84:87], v[184:187]
  ds_read_b64_tr_b16 a[90:91], v5 offset:18432
  v_fma_f32 v39, v15, v35, v14
  s_waitcnt lgkmcnt(5)
  v_mfma_f32_16x16x32_bf16 v[188:191], a[252:255], v[84:87], v[188:191]
  v_exp_f32 v76, v76
  v_mfma_f32_16x16x32_bf16 v[156:159], a[252:255], v[80:83], v[156:159]
  v_permlane32_swap_b32 v36, v37
  v_mfma_f32_16x16x32_bf16 v[112:115], v[44:47], v[80:83], v[112:115]
  v_exp_f32 v77, v77
  v_mfma_f32_16x16x32_bf16 v[116:119], v[44:47], v[84:87], v[116:119]
  s_add_u32 m0, s26, 4096
  ds_read_b64_tr_b16 a[68:69], v2 offset:20480
  s_waitcnt lgkmcnt(2)
  v_mfma_f32_16x16x32_bf16 v[48:51], a[192:195], a[128:131], v[96:99]
  v_exp_f32 v78, v78
  v_mfma_f32_16x16x32_bf16 v[48:51], a[196:199], a[132:135], v[48:51]
  s_add_u32 s27, s29, 106496
  buffer_load_dwordx4 v32, s[12:15], s27 offen offset:0 lds
  v_permlane32_swap_b32 v40, v41
  v_mfma_f32_16x16x32_bf16 v[48:51], a[200:203], a[136:139], v[48:51]
  v_exp_f32 v79, v79
  v_mfma_f32_16x16x32_bf16 v[48:51], a[204:207], a[140:143], v[48:51]
  v_permlane32_swap_b32 v38, v39
  v_mfma_f32_16x16x32_bf16 v[52:55], a[220:223], a[140:143], v[96:99]
  v_exp_f32 v72, v72
  v_mfma_f32_16x16x32_bf16 v[52:55], a[216:219], a[136:139], v[52:55]
  buffer_load_dwordx4 v33, s[16:19], s27 offen offset:2048 lds
  ds_read_b64_tr_b16 a[70:71], v2 offset:22528
L_page7:
  s_cmp_eq_u32 s100, 1
  s_cbranch_scc1 L_page10
  v_mfma_f32_16x16x32_bf16 v[52:55], a[212:215], a[132:135], v[52:55]
  v_exp_f32 v73, v73
  v_mfma_f32_16x16x32_bf16 v[52:55], a[208:211], a[128:131], v[52:55]
  v_permlane32_swap_b32 v42, v43
  v_mfma_f32_16x16x32_bf16 v[60:63], a[208:211], a[144:147], v[100:103]
  v_exp_f32 v74, v74
  v_mfma_f32_16x16x32_bf16 v[60:63], a[212:215], a[148:151], v[60:63]
  s_add_u32 s27, s29, 109568
  buffer_load_dwordx4 v32, s[12:15], s27 offen offset:1024 lds
  v_mfma_f32_16x16x32_bf16 v[60:63], a[216:219], a[152:155], v[60:63]
  ds_read_b64_tr_b16 a[76:77], v3 offset:20480
  v_add_f32 v36, v36, v37
  v_mfma_f32_16x16x32_bf16 v[60:63], a[220:223], a[156:159], v[60:63]
  v_exp_f32 v75, v75
  v_cvt_pk_bf16_f32 v88, v64, v65
  v_cvt_pk_bf16_f32 v89, v66, v67
  v_mfma_f32_16x16x32_bf16 v[56:59], a[204:207], a[156:159], v[100:103]
  v_cvt_pk_bf16_f32 v90, v68, v69
  v_cvt_pk_bf16_f32 v91, v70, v71
  v_mfma_f32_16x16x32_bf16 v[56:59], a[200:203], a[152:155], v[56:59]
  buffer_load_dwordx4 v33, s[16:19], s27 offen offset:3072 lds
  v_cvt_pk_bf16_f32 v94, v76, v77
  v_cvt_pk_bf16_f32 v95, v78, v79
  v_add_f32 v40, v40, v41
  v_mfma_f32_16x16x32_bf16 v[56:59], a[196:199], a[148:151], v[56:59]
  v_cvt_pk_bf16_f32 v92, v72, v73
  v_cvt_pk_bf16_f32 v93, v74, v75
  v_mfma_f32_16x16x32_bf16 v[56:59], a[192:195], a[144:147], v[56:59]
  s_barrier
  ds_read_b64_tr_b16 a[78:79], v3 offset:22528
  v_exp_f32 v48, v48
  v_mfma_f32_16x16x32_bf16 v[192:195], a[224:227], v[88:91], v[192:195]
  v_add_f32 v38, v38, v39
  v_add_f32 v42, v42, v43
  v_mfma_f32_16x16x32_bf16 v[224:227], a[224:227], v[92:95], v[224:227]
  v_exp_f32 v49, v49
  v_mfma_f32_16x16x32_bf16 v[228:231], a[228:231], v[92:95], v[228:231]
  v_exp_f32 v50, v50
  v_mfma_f32_16x16x32_bf16 v[196:199], a[228:231], v[88:91], v[196:199]
  ds_read_b64_tr_b16 a[84:85], v4 offset:20480
  v_cvt_pk_bf16_f32 v80, v48, v49
  v_mfma_f32_16x16x32_bf16 v[200:203], a[232:235], v[88:91], v[200:203]
  v_exp_f32 v51, v51
  v_mfma_f32_16x16x32_bf16 v[232:235], a[232:235], v[92:95], v[232:235]
  v_permlane16_swap_b32 v36, v40
  v_mfma_f32_16x16x32_bf16 v[236:239], a[236:239], v[92:95], v[236:239]
  v_exp_f32 v52, v52
  v_mfma_f32_16x16x32_bf16 v[204:207], a[236:239], v[88:91], v[204:207]
  v_exp_f32 v53, v53
  v_mfma_f32_16x16x32_bf16 v[208:211], a[240:243], v[88:91], v[208:211]
  v_permlane16_swap_b32 v38, v42
  v_mfma_f32_16x16x32_bf16 v[240:243], a[240:243], v[92:95], v[240:243]
  ds_read_b64_tr_b16 a[86:87], v4 offset:22528
  v_add_f32 v36, v36, v40
  v_mfma_f32_16x16x32_bf16 v[244:247], a[244:247], v[92:95], v[244:247]
  ds_read_b64_tr_b16 a[224:225], v24 offset:12288
  v_add_f32 v38, v38, v42
  v_mfma_f32_16x16x32_bf16 v[212:215], a[244:247], v[88:91], v[212:215]
  v_exp_f32 v54, v54
  v_mfma_f32_16x16x32_bf16 v[216:219], a[248:251], v[88:91], v[216:219]
  ds_read_b64_tr_b16 a[226:227], v24 offset:13312
  v_add_f32_dpp v36, v36, v36 row_ror:8 row_mask:0xf bank_mask:0xf
  v_mfma_f32_16x16x32_bf16 v[248:251], a[248:251], v[92:95], v[248:251]
  v_exp_f32 v55, v55
  v_mfma_f32_16x16x32_bf16 v[252:255], a[252:255], v[92:95], v[252:255]
  ds_read_b64_tr_b16 a[228:229], v25 offset:12288
  ds_read_b64_tr_b16 a[92:93], v5 offset:20480
  v_mfma_f32_16x16x32_bf16 v[220:223], a[252:255], v[88:91], v[220:223]
  v_exp_f32 v60, v60
  v_mfma_f32_16x16x32_bf16 v[120:123], v[44:47], v[88:91], v[120:123]
  ds_read_b64_tr_b16 a[230:231], v25 offset:13312
  v_add_f32_dpp v38, v38, v38 row_ror:8 row_mask:0xf bank_mask:0xf
  v_mfma_f32_16x16x32_bf16 v[124:127], v[44:47], v[92:95], v[124:127]
  v_exp_f32 v61, v61
  v_mfma_f32_16x16x32_bf16 v[64:67], a[192:195], a[160:163], v[104:107]
  ds_read_b64_tr_b16 a[232:233], v26 offset:12288
  v_add_f32_dpp v36, v36, v36 row_ror:4 row_mask:0xf bank_mask:0xf
  v_mfma_f32_16x16x32_bf16 v[64:67], a[196:199], a[164:167], v[64:67]
  ds_read_b64_tr_b16 a[94:95], v5 offset:22528
  v_exp_f32 v62, v62
  v_mfma_f32_16x16x32_bf16 v[64:67], a[200:203], a[168:171], v[64:67]
  ds_read_b64_tr_b16 a[234:235], v26 offset:13312
  v_add_f32_dpp v38, v38, v38 row_ror:4 row_mask:0xf bank_mask:0xf
  v_mfma_f32_16x16x32_bf16 v[64:67], a[204:207], a[172:175], v[64:67]
  v_exp_f32 v63, v63
  v_mfma_f32_16x16x32_bf16 v[68:71], a[220:223], a[172:175], v[104:107]
  ds_read_b64_tr_b16 a[236:237], v27 offset:12288
  v_cvt_pk_bf16_f32 v81, v50, v51
  v_mfma_f32_16x16x32_bf16 v[68:71], a[216:219], a[168:171], v[68:71]
  v_exp_f32 v56, v56
  v_mfma_f32_16x16x32_bf16 v[68:71], a[212:215], a[164:167], v[68:71]
  ds_read_b64_tr_b16 a[238:239], v27 offset:13312
  v_cvt_pk_bf16_f32 v82, v52, v53
  v_mfma_f32_16x16x32_bf16 v[68:71], a[208:211], a[160:163], v[68:71]
  s_add_u32 m0, s26, 16384
  v_exp_f32 v57, v57
  v_mfma_f32_16x16x32_bf16 v[76:79], a[208:211], a[176:179], v[108:111]
  ds_read_b64_tr_b16 a[240:241], v28 offset:12288
  v_cvt_pk_bf16_f32 v83, v54, v55
  v_mfma_f32_16x16x32_bf16 v[76:79], a[212:215], a[180:183], v[76:79]
  s_waitcnt lgkmcnt(4)
  s_add_u32 s27, s28, 196608
  buffer_load_dwordx4 v10, s[40:43], s27 offen offset:0 lds
  v_exp_f32 v58, v58
  v_mfma_f32_16x16x32_bf16 v[76:79], a[216:219], a[184:187], v[76:79]
  ds_read_b64_tr_b16 a[242:243], v28 offset:13312
  v_add_f32_dpp v36, v36, v36 row_ror:2 row_mask:0xf bank_mask:0xf
  v_mfma_f32_16x16x32_bf16 v[76:79], a[220:223], a[188:191], v[76:79]
  v_exp_f32 v59, v59
  v_mfma_f32_16x16x32_bf16 v[72:75], a[204:207], a[188:191], v[108:111]
  ds_read_b64_tr_b16 a[244:245], v29 offset:12288
  ds_read_b128 a[208:211], v20 offset:13312
  v_mfma_f32_16x16x32_bf16 v[72:75], a[200:203], a[184:187], v[72:75]
  v_cvt_pk_bf16_f32 v86, v60, v61
  v_cvt_pk_bf16_f32 v87, v62, v63
  v_mfma_f32_16x16x32_bf16 v[72:75], a[196:199], a[180:183], v[72:75]
  ds_read_b64_tr_b16 a[246:247], v29 offset:13312
  ds_read_b128 a[212:215], v21 offset:13312
  v_cvt_pk_bf16_f32 v84, v56, v57
  v_cvt_pk_bf16_f32 v85, v58, v59
  v_mfma_f32_16x16x32_bf16 v[72:75], a[192:195], a[176:179], v[72:75]
  buffer_load_dwordx4 v11, s[40:43], s27 offen offset:1024 lds
  v_exp_f32 v64, v64
  v_add_f32_dpp v38, v38, v38 row_ror:2 row_mask:0xf bank_mask:0xf
  v_mfma_f32_16x16x32_bf16 v[128:131], a[224:227], v[80:83], v[128:131]
  ds_read_b64_tr_b16 a[248:249], v30 offset:12288
  ds_read_b128 a[216:219], v22 offset:13312
  v_mfma_f32_16x16x32_bf16 v[160:163], a[224:227], v[84:87], v[160:163]
  v_exp_f32 v65, v65
  v_mfma_f32_16x16x32_bf16 v[164:167], a[228:231], v[84:87], v[164:167]
  ds_read_b64_tr_b16 a[250:251], v30 offset:13312
  ds_read_b128 a[220:223], v23 offset:13312
  v_add_f32_dpp v36, v36, v36 row_ror:1 row_mask:0xf bank_mask:0xf
  v_mfma_f32_16x16x32_bf16 v[132:135], a[228:231], v[80:83], v[132:135]
  v_exp_f32 v66, v66
  s_waitcnt lgkmcnt(8)
  v_mfma_f32_16x16x32_bf16 v[136:139], a[232:235], v[80:83], v[136:139]
  ds_read_b64_tr_b16 a[252:253], v31 offset:12288
  ds_read_b128 a[204:207], v23 offset:12288
  v_mfma_f32_16x16x32_bf16 v[168:171], a[232:235], v[84:87], v[168:171]
  buffer_load_dwordx4 v12, s[40:43], s27 offen offset:2048 lds
  v_exp_f32 v67, v67
  v_add_f32_dpp v38, v38, v38 row_ror:1 row_mask:0xf bank_mask:0xf
  v_mfma_f32_16x16x32_bf16 v[172:175], a[236:239], v[84:87], v[172:175]
  ds_read_b64_tr_b16 a[254:255], v31 offset:13312
  ds_read_b128 a[200:203], v22 offset:12288
  v_mfma_f32_16x16x32_bf16 v[140:143], a[236:239], v[80:83], v[140:143]
  v_exp_f32 v68, v68
  v_mfma_f32_16x16x32_bf16 v[144:147], a[240:243], v[80:83], v[144:147]
  ds_read_b128 a[196:199], v21 offset:12288
  v_lshrrev_b32 v14, 4, v0
  v_mfma_f32_16x16x32_bf16 v[176:179], a[240:243], v[84:87], v[176:179]
  v_exp_f32 v69, v69
  s_waitcnt lgkmcnt(8)
  v_mfma_f32_16x16x32_bf16 v[180:183], a[244:247], v[84:87], v[180:183]
  ds_read_b128 a[192:195], v20 offset:12288
  v_lshlrev_b32 v14, 2, v14
  v_mfma_f32_16x16x32_bf16 v[148:151], a[244:247], v[80:83], v[148:151]
  buffer_load_dwordx4 v13, s[40:43], s27 offen offset:3072 lds
  v_exp_f32 v70, v70
  s_waitcnt lgkmcnt(6)
  v_mfma_f32_16x16x32_bf16 v[152:155], a[248:251], v[80:83], v[152:155]
  v_exp_f32 v71, v71
  v_mfma_f32_16x16x32_bf16 v[184:187], a[248:251], v[84:87], v[184:187]
  ds_write_b32 v14, v36
  v_cvt_pk_bf16_f32 v88, v64, v65
  s_waitcnt lgkmcnt(4)
  v_mfma_f32_16x16x32_bf16 v[188:191], a[252:255], v[84:87], v[188:191]
  v_exp_f32 v76, v76
  v_mfma_f32_16x16x32_bf16 v[156:159], a[252:255], v[80:83], v[156:159]
  v_exp_f32 v77, v77
  v_mfma_f32_16x16x32_bf16 v[112:115], v[44:47], v[80:83], v[112:115]
  ds_write_b32 v14, v38 offset:64
  v_cvt_pk_bf16_f32 v89, v66, v67
  v_mfma_f32_16x16x32_bf16 v[116:119], v[44:47], v[84:87], v[116:119]
  s_add_u32 m0, s26, 8192
  v_cvt_pk_bf16_f32 v90, v68, v69
  s_waitcnt lgkmcnt(2)
  v_mfma_f32_16x16x32_bf16 v[48:51], a[192:195], a[128:131], v[96:99]
  v_exp_f32 v78, v78
  v_mfma_f32_16x16x32_bf16 v[48:51], a[196:199], a[132:135], v[48:51]
  s_add_u32 s27, s29, 114688
  buffer_load_dwordx4 v32, s[12:15], s27 offen offset:0 lds
  v_mfma_f32_16x16x32_bf16 v[48:51], a[200:203], a[136:139], v[48:51]
  v_exp_f32 v79, v79
  v_mfma_f32_16x16x32_bf16 v[48:51], a[204:207], a[140:143], v[48:51]
  v_exp_f32 v72, v72
  v_mfma_f32_16x16x32_bf16 v[52:55], a[220:223], a[140:143], v[96:99]
  v_exp_f32 v73, v73
  v_mfma_f32_16x16x32_bf16 v[52:55], a[216:219], a[136:139], v[52:55]
  buffer_load_dwordx4 v33, s[16:19], s27 offen offset:2048 lds
  v_mfma_f32_16x16x32_bf16 v[52:55], a[212:215], a[132:135], v[52:55]
  v_exp_f32 v74, v74
  v_mfma_f32_16x16x32_bf16 v[52:55], a[208:211], a[128:131], v[52:55]
  v_exp_f32 v75, v75
  v_mfma_f32_16x16x32_bf16 v[60:63], a[208:211], a[144:147], v[100:103]
  v_cvt_pk_bf16_f32 v91, v70, v71
  v_cvt_pk_bf16_f32 v94, v76, v77
  v_mfma_f32_16x16x32_bf16 v[60:63], a[212:215], a[148:151], v[60:63]
  s_add_u32 s27, s29, 117760
  buffer_load_dwordx4 v32, s[12:15], s27 offen offset:1024 lds
  v_mfma_f32_16x16x32_bf16 v[60:63], a[216:219], a[152:155], v[60:63]
  v_cvt_pk_bf16_f32 v95, v78, v79
  v_cvt_pk_bf16_f32 v92, v72, v73
  v_mfma_f32_16x16x32_bf16 v[60:63], a[220:223], a[156:159], v[60:63]
  v_cvt_pk_bf16_f32 v93, v74, v75
  v_mfma_f32_16x16x32_bf16 v[56:59], a[204:207], a[156:159], v[100:103]
  v_exp_f32 v48, v48
  v_mfma_f32_16x16x32_bf16 v[56:59], a[200:203], a[152:155], v[56:59]
  buffer_load_dwordx4 v33, s[16:19], s27 offen offset:3072 lds
  v_mfma_f32_16x16x32_bf16 v[56:59], a[196:199], a[148:151], v[56:59]
  v_exp_f32 v49, v49
  v_mfma_f32_16x16x32_bf16 v[56:59], a[192:195], a[144:147], v[56:59]
  s_waitcnt vmcnt(12) lgkmcnt(0)
  s_barrier
  v_mfma_f32_16x16x32_bf16 v[192:195], a[224:227], v[88:91], v[192:195]
  v_exp_f32 v50, v50
  v_mfma_f32_16x16x32_bf16 v[224:227], a[224:227], v[92:95], v[224:227]
  s_add_u32 m0, s26, 20480
  ds_read_b64_tr_b16 a[224:225], v24 offset:0
  v_mfma_f32_16x16x32_bf16 v[228:231], a[228:231], v[92:95], v[228:231]
  v_exp_f32 v51, v51
  v_mfma_f32_16x16x32_bf16 v[196:199], a[228:231], v[88:91], v[196:199]
  s_add_u32 s27, s28, 229376
  buffer_load_dwordx4 v10, s[40:43], s27 offen offset:0 lds
  v_mfma_f32_16x16x32_bf16 v[200:203], a[232:235], v[88:91], v[200:203]
  v_exp_f32 v52, v52
  v_mfma_f32_16x16x32_bf16 v[232:235], a[232:235], v[92:95], v[232:235]
  v_exp_f32 v53, v53
  v_mfma_f32_16x16x32_bf16 v[236:239], a[236:239], v[92:95], v[236:239]
  v_exp_f32 v54, v54
  v_mfma_f32_16x16x32_bf16 v[204:207], a[236:239], v[88:91], v[204:207]
  ds_read_b64_tr_b16 a[226:227], v24 offset:1024
  v_cvt_pk_bf16_f32 v80, v48, v49
  v_mfma_f32_16x16x32_bf16 v[208:211], a[240:243], v[88:91], v[208:211]
  v_exp_f32 v55, v55
  v_mfma_f32_16x16x32_bf16 v[240:243], a[240:243], v[92:95], v[240:243]
  buffer_load_dwordx4 v11, s[40:43], s27 offen offset:1024 lds
  v_mfma_f32_16x16x32_bf16 v[244:247], a[244:247], v[92:95], v[244:247]
  ds_read_b64_tr_b16 a[228:229], v25 offset:0
  v_cvt_pk_bf16_f32 v81, v50, v51
  v_mfma_f32_16x16x32_bf16 v[212:215], a[244:247], v[88:91], v[212:215]
  v_exp_f32 v60, v60
  v_mfma_f32_16x16x32_bf16 v[216:219], a[248:251], v[88:91], v[216:219]
  ds_read_b64_tr_b16 a[230:231], v25 offset:1024
  v_cvt_pk_bf16_f32 v82, v52, v53
  v_mfma_f32_16x16x32_bf16 v[248:251], a[248:251], v[92:95], v[248:251]
  v_exp_f32 v61, v61
  v_mfma_f32_16x16x32_bf16 v[252:255], a[252:255], v[92:95], v[252:255]
  ds_read_b64_tr_b16 a[232:233], v26 offset:0
  v_cvt_pk_bf16_f32 v83, v54, v55
  v_mfma_f32_16x16x32_bf16 v[220:223], a[252:255], v[88:91], v[220:223]
  buffer_load_dwordx4 v12, s[40:43], s27 offen offset:2048 lds
  v_mfma_f32_16x16x32_bf16 v[120:123], v[44:47], v[88:91], v[120:123]
  v_exp_f32 v62, v62
  v_mfma_f32_16x16x32_bf16 v[124:127], v[44:47], v[92:95], v[124:127]
  ds_read_b64_tr_b16 a[234:235], v26 offset:1024
  v_cvt_pk_bf16_f32 v86, v60, v61
  v_mfma_f32_16x16x32_bf16 v[64:67], a[192:195], a[160:163], v[104:107]
  v_exp_f32 v63, v63
  v_mfma_f32_16x16x32_bf16 v[64:67], a[196:199], a[164:167], v[64:67]
  ds_read_b64_tr_b16 a[236:237], v27 offset:0
  v_cvt_pk_bf16_f32 v87, v62, v63
  v_mfma_f32_16x16x32_bf16 v[64:67], a[200:203], a[168:171], v[64:67]
  v_exp_f32 v56, v56
  v_mfma_f32_16x16x32_bf16 v[64:67], a[204:207], a[172:175], v[64:67]
  buffer_load_dwordx4 v13, s[40:43], s27 offen offset:3072 lds
  v_mfma_f32_16x16x32_bf16 v[68:71], a[220:223], a[172:175], v[104:107]
  ds_read_b64_tr_b16 a[238:239], v27 offset:1024
  v_and_b32 v14, 1, v1
  v_mfma_f32_16x16x32_bf16 v[68:71], a[216:219], a[168:171], v[68:71]
  v_exp_f32 v57, v57
  v_mfma_f32_16x16x32_bf16 v[68:71], a[212:215], a[164:167], v[68:71]
  ds_read_b64_tr_b16 a[240:241], v28 offset:0
  v_cvt_pk_bf16_f32 v84, v56, v57
  v_mfma_f32_16x16x32_bf16 v[68:71], a[208:211], a[160:163], v[68:71]
  v_exp_f32 v58, v58
  v_mfma_f32_16x16x32_bf16 v[76:79], a[208:211], a[176:179], v[108:111]
  ds_read_b64_tr_b16 a[242:243], v28 offset:1024
  v_lshlrev_b32 v14, 3, v14
  v_mfma_f32_16x16x32_bf16 v[76:79], a[212:215], a[180:183], v[76:79]
  v_exp_f32 v59, v59
  v_mfma_f32_16x16x32_bf16 v[76:79], a[216:219], a[184:187], v[76:79]
  ds_read_b64_tr_b16 a[244:245], v29 offset:0
  v_cvt_pk_bf16_f32 v85, v58, v59
  v_mfma_f32_16x16x32_bf16 v[76:79], a[220:223], a[188:191], v[76:79]
  ds_read_b128 a[208:211], v20 offset:1024
  v_bfe_u32 v16, v1, 1, 1
  v_mfma_f32_16x16x32_bf16 v[72:75], a[204:207], a[188:191], v[108:111]
  ds_read_b64_tr_b16 a[246:247], v29 offset:1024
  v_lshl_add_u32 v15, v16, 10, v14
  v_mfma_f32_16x16x32_bf16 v[72:75], a[200:203], a[184:187], v[72:75]
  ds_read_b128 a[212:215], v21 offset:1024
  v_lshl_add_u32 v14, v16, 6, v14
  v_mfma_f32_16x16x32_bf16 v[72:75], a[196:199], a[180:183], v[72:75]
  v_exp_f32 v64, v64
  v_mfma_f32_16x16x32_bf16 v[72:75], a[192:195], a[176:179], v[72:75]
  ds_read_b64_tr_b16 a[248:249], v30 offset:0
  s_and_b32 s37, s36, 0xfc00
  s_waitcnt lgkmcnt(7)
  v_mfma_f32_16x16x32_bf16 v[128:131], a[224:227], v[80:83], v[128:131]
  ds_read_b128 a[216:219], v22 offset:1024
  s_add_u32 s36, s36, s37
  v_mfma_f32_16x16x32_bf16 v[160:163], a[224:227], v[84:87], v[160:163]
  v_exp_f32 v65, v65
  v_mfma_f32_16x16x32_bf16 v[164:167], a[228:231], v[84:87], v[164:167]
  ds_read_b64_tr_b16 a[250:251], v30 offset:1024
  ds_read_b128 a[220:223], v23 offset:1024
  v_mfma_f32_16x16x32_bf16 v[132:135], a[228:231], v[80:83], v[132:135]
  v_exp_f32 v66, v66
  v_mfma_f32_16x16x32_bf16 v[136:139], a[232:235], v[80:83], v[136:139]
  ds_read_b64_tr_b16 a[252:253], v31 offset:0
  ds_read_b128 a[204:207], v23 offset:0
  v_mfma_f32_16x16x32_bf16 v[168:171], a[232:235], v[84:87], v[168:171]
  v_exp_f32 v67, v67
  v_mfma_f32_16x16x32_bf16 v[172:175], a[236:239], v[84:87], v[172:175]
  ds_read_b64_tr_b16 a[254:255], v31 offset:1024
  ds_read_b128 a[200:203], v22 offset:0
  v_mfma_f32_16x16x32_bf16 v[140:143], a[236:239], v[80:83], v[140:143]
  v_exp_f32 v68, v68
  s_waitcnt lgkmcnt(8)
  v_mfma_f32_16x16x32_bf16 v[144:147], a[240:243], v[80:83], v[144:147]
  ds_read_b128 a[196:199], v21 offset:0
  s_lshr_b32 s37, s101, 1
  v_mfma_f32_16x16x32_bf16 v[176:179], a[240:243], v[84:87], v[176:179]
  v_exp_f32 v69, v69
  v_mfma_f32_16x16x32_bf16 v[180:183], a[244:247], v[84:87], v[180:183]
  ds_read_b128 a[192:195], v20 offset:0
  v_cvt_pk_bf16_f32 v88, v64, v65
  v_mfma_f32_16x16x32_bf16 v[148:151], a[244:247], v[80:83], v[148:151]
  v_exp_f32 v70, v70
  s_waitcnt lgkmcnt(7)
  v_mfma_f32_16x16x32_bf16 v[152:155], a[248:251], v[80:83], v[152:155]
  v_exp_f32 v71, v71
  v_mfma_f32_16x16x32_bf16 v[184:187], a[248:251], v[84:87], v[184:187]
  v_exp_f32 v76, v76
  s_waitcnt vmcnt(0) lgkmcnt(3)
  v_mfma_f32_16x16x32_bf16 v[188:191], a[252:255], v[84:87], v[188:191]
  v_exp_f32 v77, v77
  v_mfma_f32_16x16x32_bf16 v[156:159], a[252:255], v[80:83], v[156:159]
  v_exp_f32 v78, v78
  v_mfma_f32_16x16x32_bf16 v[112:115], v[44:47], v[80:83], v[112:115]
  v_exp_f32 v79, v79
  v_mfma_f32_16x16x32_bf16 v[116:119], v[44:47], v[84:87], v[116:119]
  s_add_u32 m0, s26, 12288
  v_cvt_pk_bf16_f32 v89, v66, v67
  s_waitcnt lgkmcnt(0)
  v_mfma_f32_16x16x32_bf16 v[48:51], a[192:195], a[128:131], v[96:99]
  v_exp_f32 v72, v72
  v_mfma_f32_16x16x32_bf16 v[48:51], a[196:199], a[132:135], v[48:51]
  s_add_u32 s27, s29, 122880
  buffer_load_dwordx4 v32, s[12:15], s27 offen offset:0 lds
  v_mfma_f32_16x16x32_bf16 v[48:51], a[200:203], a[136:139], v[48:51]
  v_exp_f32 v73, v73
  v_mfma_f32_16x16x32_bf16 v[48:51], a[204:207], a[140:143], v[48:51]
  v_exp_f32 v74, v74
  v_mfma_f32_16x16x32_bf16 v[52:55], a[220:223], a[140:143], v[96:99]
  v_exp_f32 v75, v75
  v_mfma_f32_16x16x32_bf16 v[52:55], a[216:219], a[136:139], v[52:55]
  buffer_load_dwordx4 v33, s[16:19], s27 offen offset:2048 lds
  s_cmp_eq_u32 s37, 2
  s_cselect_b32 s37, 1.0, 0
  v_mfma_f32_16x16x32_bf16 v[52:55], a[212:215], a[132:135], v[52:55]
  v_cvt_pk_bf16_f32 v90, v68, v69
  v_cvt_pk_bf16_f32 v91, v70, v71
  v_mfma_f32_16x16x32_bf16 v[52:55], a[208:211], a[128:131], v[52:55]
  v_cvt_pk_bf16_f32 v94, v76, v77
  v_cvt_pk_bf16_f32 v95, v78, v79
  v_mfma_f32_16x16x32_bf16 v[60:63], a[208:211], a[144:147], v[100:103]
  v_cvt_pk_bf16_f32 v92, v72, v73
  v_cvt_pk_bf16_f32 v93, v74, v75
  v_mfma_f32_16x16x32_bf16 v[60:63], a[212:215], a[148:151], v[60:63]
  s_add_u32 s27, s29, 125952
  buffer_load_dwordx4 v32, s[12:15], s27 offen offset:1024 lds
  v_mfma_f32_16x16x32_bf16 v[60:63], a[216:219], a[152:155], v[60:63]
  v_exp_f32 v48, v48
  v_mfma_f32_16x16x32_bf16 v[60:63], a[220:223], a[156:159], v[60:63]
  ds_read_b64 v[36:37], v14 offset:0
  v_mfma_f32_16x16x32_bf16 v[56:59], a[204:207], a[156:159], v[100:103]
  v_exp_f32 v49, v49
  v_mfma_f32_16x16x32_bf16 v[56:59], a[200:203], a[152:155], v[56:59]
  buffer_load_dwordx4 v33, s[16:19], s27 offen offset:3072 lds
  v_mfma_f32_16x16x32_bf16 v[56:59], a[196:199], a[148:151], v[56:59]
  v_exp_f32 v50, v50
  v_mfma_f32_16x16x32_bf16 v[56:59], a[192:195], a[144:147], v[56:59]
  s_barrier
  v_mfma_f32_16x16x32_bf16 v[192:195], a[224:227], v[88:91], v[192:195]
  ds_read_b64 v[38:39], v14 offset:16
  v_cvt_pk_bf16_f32 v80, v48, v49
  v_mfma_f32_16x16x32_bf16 v[224:227], a[224:227], v[92:95], v[224:227]
  v_exp_f32 v51, v51
  v_mfma_f32_16x16x32_bf16 v[228:231], a[228:231], v[92:95], v[228:231]
  ds_read_b64 v[40:41], v14 offset:32
  v_cvt_pk_bf16_f32 v81, v50, v51
  v_mfma_f32_16x16x32_bf16 v[196:199], a[228:231], v[88:91], v[196:199]
  s_mov_b64 exec, 0xffffffff
  buffer_load_dword v19, v17, s[44:47], s34 offen
  s_mov_b64 exec, -1
  v_mfma_f32_16x16x32_bf16 v[200:203], a[232:235], v[88:91], v[200:203]
  v_exp_f32 v52, v52
  v_mfma_f32_16x16x32_bf16 v[232:235], a[232:235], v[92:95], v[232:235]
  v_exp_f32 v53, v53
  v_mfma_f32_16x16x32_bf16 v[236:239], a[236:239], v[92:95], v[236:239]
  ds_read_b64 v[42:43], v14 offset:48
  s_waitcnt lgkmcnt(2)
  v_add_f32 v36, v36, v38
  v_mfma_f32_16x16x32_bf16 v[204:207], a[236:239], v[88:91], v[204:207]
  ds_read_b64_tr_b16 a[224:225], v24 offset:4096
  v_add_f32 v37, v37, v39
  v_mfma_f32_16x16x32_bf16 v[208:211], a[240:243], v[88:91], v[208:211]
  v_exp_f32 v54, v54
  v_mfma_f32_16x16x32_bf16 v[240:243], a[240:243], v[92:95], v[240:243]
  ds_read_b64_tr_b16 a[226:227], v24 offset:5120
  s_waitcnt lgkmcnt(2)
  v_add_f32 v40, v40, v42
  v_mfma_f32_16x16x32_bf16 v[244:247], a[244:247], v[92:95], v[244:247]
  ds_read_b64_tr_b16 a[96:97], v2 offset:16384
  v_add_f32 v41, v41, v43
  v_mfma_f32_16x16x32_bf16 v[212:215], a[244:247], v[88:91], v[212:215]
  v_exp_f32 v55, v55
  v_mfma_f32_16x16x32_bf16 v[216:219], a[248:251], v[88:91], v[216:219]
  ds_read_b64_tr_b16 a[228:229], v25 offset:4096
  v_add_f32 v36, v36, v40
  v_mfma_f32_16x16x32_bf16 v[248:251], a[248:251], v[92:95], v[248:251]
  v_exp_f32 v60, v60
  v_mfma_f32_16x16x32_bf16 v[252:255], a[252:255], v[92:95], v[252:255]
  ds_read_b64_tr_b16 a[230:231], v25 offset:5120
  v_add_f32 v37, v37, v41
  v_mfma_f32_16x16x32_bf16 v[220:223], a[252:255], v[88:91], v[220:223]
  v_exp_f32 v61, v61
  v_mfma_f32_16x16x32_bf16 v[120:123], v[44:47], v[88:91], v[120:123]
  ds_read_b64_tr_b16 a[98:99], v2 offset:18432
  v_cvt_pk_bf16_f32 v82, v52, v53
  v_mfma_f32_16x16x32_bf16 v[124:127], v[44:47], v[92:95], v[124:127]
  ds_read_b64_tr_b16 a[232:233], v26 offset:4096
  v_cvt_pk_bf16_f32 v83, v54, v55
  v_mfma_f32_16x16x32_bf16 v[64:67], a[192:195], a[160:163], v[104:107]
  v_exp_f32 v62, v62
  v_mfma_f32_16x16x32_bf16 v[64:67], a[196:199], a[164:167], v[64:67]
  ds_read_b64_tr_b16 a[234:235], v26 offset:5120
  v_cvt_pk_bf16_f32 v38, v36, v37
  v_mfma_f32_16x16x32_bf16 v[64:67], a[200:203], a[168:171], v[64:67]
  v_exp_f32 v63, v63
  v_mfma_f32_16x16x32_bf16 v[64:67], a[204:207], a[172:175], v[64:67]
  ds_read_b64_tr_b16 a[236:237], v27 offset:4096
  v_cvt_pk_bf16_f32 v86, v60, v61
  v_mfma_f32_16x16x32_bf16 v[68:71], a[220:223], a[172:175], v[104:107]
  ds_read_b64_tr_b16 a[104:105], v3 offset:16384
  v_cvt_pk_bf16_f32 v87, v62, v63
  v_mfma_f32_16x16x32_bf16 v[68:71], a[216:219], a[168:171], v[68:71]
  v_exp_f32 v56, v56
  v_mfma_f32_16x16x32_bf16 v[68:71], a[212:215], a[164:167], v[68:71]
  ds_read_b64_tr_b16 a[238:239], v27 offset:5120
  v_lshlrev_b32 v36, 16, v38
  v_mfma_f32_16x16x32_bf16 v[68:71], a[208:211], a[160:163], v[68:71]
  v_exp_f32 v57, v57
  v_mfma_f32_16x16x32_bf16 v[76:79], a[208:211], a[176:179], v[108:111]
  ds_read_b64_tr_b16 a[240:241], v28 offset:4096
  v_cvt_pk_bf16_f32 v84, v56, v57
  v_mfma_f32_16x16x32_bf16 v[76:79], a[212:215], a[180:183], v[76:79]
  ds_read_b64_tr_b16 a[106:107], v3 offset:18432
  v_exp_f32 v58, v58
  v_mfma_f32_16x16x32_bf16 v[76:79], a[216:219], a[184:187], v[76:79]
  ds_read_b64_tr_b16 a[242:243], v28 offset:5120
  v_and_b32 v37, s70, v38
  v_mfma_f32_16x16x32_bf16 v[76:79], a[220:223], a[188:191], v[76:79]
  v_exp_f32 v59, v59
  v_mfma_f32_16x16x32_bf16 v[72:75], a[204:207], a[188:191], v[108:111]
  ds_read_b64_tr_b16 a[244:245], v29 offset:4096
  ds_read_b128 a[208:211], v20 offset:5120
  v_mfma_f32_16x16x32_bf16 v[72:75], a[200:203], a[184:187], v[72:75]
  ds_read_b64_tr_b16 a[246:247], v29 offset:5120
  v_cvt_pk_bf16_f32 v85, v58, v59
  v_mfma_f32_16x16x32_bf16 v[72:75], a[196:199], a[180:183], v[72:75]
  ds_read_b128 a[212:215], v21 offset:5120
  ds_read_b64_tr_b16 a[112:113], v4 offset:16384
  v_mfma_f32_16x16x32_bf16 v[72:75], a[192:195], a[176:179], v[72:75]
  v_exp_f32 v64, v64
  v_mfma_f32_16x16x32_bf16 v[128:131], a[224:227], v[80:83], v[128:131]
  ds_read_b64_tr_b16 a[248:249], v30 offset:4096
  ds_read_b128 a[216:219], v22 offset:5120
  v_mfma_f32_16x16x32_bf16 v[160:163], a[224:227], v[84:87], v[160:163]
  v_exp_f32 v65, v65
  v_mfma_f32_16x16x32_bf16 v[164:167], a[228:231], v[84:87], v[164:167]
  ds_read_b64_tr_b16 a[250:251], v30 offset:5120
  ds_read_b128 a[220:223], v23 offset:5120
  v_mfma_f32_16x16x32_bf16 v[132:135], a[228:231], v[80:83], v[132:135]
  ds_read_b64_tr_b16 a[114:115], v4 offset:18432
  v_exp_f32 v66, v66
  v_mfma_f32_16x16x32_bf16 v[136:139], a[232:235], v[80:83], v[136:139]
  ds_read_b64_tr_b16 a[252:253], v31 offset:4096
  ds_read_b128 a[204:207], v23 offset:4096
  v_mfma_f32_16x16x32_bf16 v[168:171], a[232:235], v[84:87], v[168:171]
  v_exp_f32 v67, v67
  v_add_f32 v36, s37, v36
  v_mfma_f32_16x16x32_bf16 v[172:175], a[236:239], v[84:87], v[172:175]
  ds_read_b64_tr_b16 a[254:255], v31 offset:5120
  ds_read_b128 a[200:203], v22 offset:4096
  v_mfma_f32_16x16x32_bf16 v[140:143], a[236:239], v[80:83], v[140:143]
  v_exp_f32 v68, v68
  s_waitcnt lgkmcnt(11)
  v_mfma_f32_16x16x32_bf16 v[144:147], a[240:243], v[80:83], v[144:147]
  ds_read_b128 a[196:199], v21 offset:4096
  ds_read_b64_tr_b16 a[120:121], v5 offset:16384
  v_add_f32 v37, s37, v37
  v_mfma_f32_16x16x32_bf16 v[176:179], a[240:243], v[84:87], v[176:179]
  v_exp_f32 v69, v69
  v_mfma_f32_16x16x32_bf16 v[180:183], a[244:247], v[84:87], v[180:183]
  ds_read_b128 a[192:195], v20 offset:4096
  v_cvt_pk_bf16_f32 v36, v36, v37
  v_mfma_f32_16x16x32_bf16 v[148:151], a[244:247], v[80:83], v[148:151]
  v_exp_f32 v70, v70
  s_waitcnt lgkmcnt(9)
  v_mfma_f32_16x16x32_bf16 v[152:155], a[248:251], v[80:83], v[152:155]
  v_exp_f32 v71, v71
  v_mfma_f32_16x16x32_bf16 v[184:187], a[248:251], v[84:87], v[184:187]
  ds_read_b64_tr_b16 a[122:123], v5 offset:18432
  v_mov_b32 v37, s30
  s_waitcnt lgkmcnt(5)
  v_mfma_f32_16x16x32_bf16 v[188:191], a[252:255], v[84:87], v[188:191]
  v_exp_f32 v76, v76
  v_mfma_f32_16x16x32_bf16 v[156:159], a[252:255], v[80:83], v[156:159]
  v_exp_f32 v77, v77
  v_mfma_f32_16x16x32_bf16 v[112:115], v[44:47], v[80:83], v[112:115]
  s_mov_b64 exec, 15
  buffer_store_dwordx2 v[36:37], v15, s[20:23], s36 offen offset:0 sc1
  s_mov_b64 exec, -1
  v_mfma_f32_16x16x32_bf16 v[116:119], v[44:47], v[84:87], v[116:119]
  s_add_u32 m0, s26, 0
  ds_read_b64_tr_b16 a[100:101], v2 offset:20480
  s_waitcnt lgkmcnt(2)
  v_mfma_f32_16x16x32_bf16 v[48:51], a[192:195], a[128:131], v[96:99]
  v_exp_f32 v78, v78
  v_mfma_f32_16x16x32_bf16 v[48:51], a[196:199], a[132:135], v[48:51]
  s_add_u32 s27, s29, 131072
  buffer_load_dwordx4 v33, s[16:19], s27 offen offset:2048 lds
  v_mfma_f32_16x16x32_bf16 v[48:51], a[200:203], a[136:139], v[48:51]
  v_exp_f32 v79, v79
  v_mfma_f32_16x16x32_bf16 v[48:51], a[204:207], a[140:143], v[48:51]
  v_exp_f32 v72, v72
  v_mfma_f32_16x16x32_bf16 v[52:55], a[220:223], a[140:143], v[96:99]
  ds_read_b64_tr_b16 a[102:103], v2 offset:22528
  v_cvt_pk_bf16_f32 v88, v64, v65
  v_mfma_f32_16x16x32_bf16 v[52:55], a[216:219], a[136:139], v[52:55]
  s_add_u32 s27, s29, 134144
  buffer_load_dwordx4 v33, s[16:19], s27 offen offset:3072 lds
  v_mfma_f32_16x16x32_bf16 v[52:55], a[212:215], a[132:135], v[52:55]
  v_exp_f32 v73, v73
  v_mfma_f32_16x16x32_bf16 v[52:55], a[208:211], a[128:131], v[52:55]
  v_exp_f32 v74, v74
  v_mfma_f32_16x16x32_bf16 v[60:63], a[208:211], a[144:147], v[100:103]
  ds_read_b64_tr_b16 a[108:109], v3 offset:20480
  v_cvt_pk_bf16_f32 v89, v66, v67
  v_mfma_f32_16x16x32_bf16 v[60:63], a[212:215], a[148:151], v[60:63]
  v_exp_f32 v75, v75
  v_mfma_f32_16x16x32_bf16 v[60:63], a[216:219], a[152:155], v[60:63]
  v_cvt_pk_bf16_f32 v90, v68, v69
  v_cvt_pk_bf16_f32 v91, v70, v71
  v_mfma_f32_16x16x32_bf16 v[60:63], a[220:223], a[156:159], v[60:63]
  v_cvt_pk_bf16_f32 v94, v76, v77
  v_cvt_pk_bf16_f32 v95, v78, v79
  v_mfma_f32_16x16x32_bf16 v[56:59], a[204:207], a[156:159], v[100:103]
  v_cvt_pk_bf16_f32 v92, v72, v73
  v_cvt_pk_bf16_f32 v93, v74, v75
  v_mfma_f32_16x16x32_bf16 v[56:59], a[200:203], a[152:155], v[56:59]
  v_exp_f32 v48, v48
  v_mfma_f32_16x16x32_bf16 v[56:59], a[196:199], a[148:151], v[56:59]
  ds_read_b64_tr_b16 a[110:111], v3 offset:22528
  v_mfma_f32_16x16x32_bf16 v[56:59], a[192:195], a[144:147], v[56:59]
  s_barrier
  v_mfma_f32_16x16x32_bf16 v[192:195], a[224:227], v[88:91], v[192:195]
  v_exp_f32 v49, v49
  v_mfma_f32_16x16x32_bf16 v[224:227], a[224:227], v[92:95], v[224:227]
  v_exp_f32 v50, v50
  v_mfma_f32_16x16x32_bf16 v[228:231], a[228:231], v[92:95], v[228:231]
  ds_read_b64_tr_b16 a[116:117], v4 offset:20480
  v_cvt_pk_bf16_f32 v80, v48, v49
  v_mfma_f32_16x16x32_bf16 v[196:199], a[228:231], v[88:91], v[196:199]
  s_mov_b64 exec, 0xffffffff
  s_not_b64 exec, exec
  s_waitcnt vmcnt(3)
  buffer_load_dword v19, v17, s[44:47], s34 offen
  s_mov_b64 exec, -1
  v_mfma_f32_16x16x32_bf16 v[200:203], a[232:235], v[88:91], v[200:203]
  v_exp_f32 v51, v51
  v_mfma_f32_16x16x32_bf16 v[232:235], a[232:235], v[92:95], v[232:235]
  v_exp_f32 v52, v52
  v_mfma_f32_16x16x32_bf16 v[236:239], a[236:239], v[92:95], v[236:239]
  v_exp_f32 v53, v53
  v_mfma_f32_16x16x32_bf16 v[204:207], a[236:239], v[88:91], v[204:207]
  ds_read_b64_tr_b16 a[118:119], v4 offset:22528
  v_cvt_pk_bf16_f32 v81, v50, v51
L_page8:
  s_cmp_eq_u32 s100, 1
  s_cbranch_scc1 L_page11
  v_mfma_f32_16x16x32_bf16 v[208:211], a[240:243], v[88:91], v[208:211]
  ds_read_b64_tr_b16 a[224:225], v24 offset:8192
  v_cvt_pk_bf16_f32 v82, v52, v53
  v_mfma_f32_16x16x32_bf16 v[240:243], a[240:243], v[92:95], v[240:243]
  v_exp_f32 v54, v54
  v_mfma_f32_16x16x32_bf16 v[244:247], a[244:247], v[92:95], v[244:247]
  ds_read_b64_tr_b16 a[226:227], v24 offset:9216
  s_and_b32 s34, s3, 1
  v_mfma_f32_16x16x32_bf16 v[212:215], a[244:247], v[88:91], v[212:215]
  v_exp_f32 v55, v55
  v_mfma_f32_16x16x32_bf16 v[216:219], a[248:251], v[88:91], v[216:219]
  ds_read_b64_tr_b16 a[228:229], v25 offset:8192
  v_cvt_pk_bf16_f32 v83, v54, v55
  v_mfma_f32_16x16x32_bf16 v[248:251], a[248:251], v[92:95], v[248:251]
  ds_read_b64_tr_b16 a[124:125], v5 offset:20480
  s_lshl_b32 s34, s34, 2
  v_mfma_f32_16x16x32_bf16 v[252:255], a[252:255], v[92:95], v[252:255]
  v_exp_f32 v60, v60
  v_mfma_f32_16x16x32_bf16 v[220:223], a[252:255], v[88:91], v[220:223]
  ds_read_b64_tr_b16 a[230:231], v25 offset:9216
  s_xor_b32 s34, s34, s32
  v_mfma_f32_16x16x32_bf16 v[120:123], v[44:47], v[88:91], v[120:123]
  v_exp_f32 v61, v61
  v_mfma_f32_16x16x32_bf16 v[124:127], v[44:47], v[92:95], v[124:127]
  ds_read_b64_tr_b16 a[232:233], v26 offset:8192
  v_cvt_pk_bf16_f32 v86, v60, v61
  v_mfma_f32_16x16x32_bf16 v[64:67], a[192:195], a[160:163], v[104:107]
  v_exp_f32 v62, v62
  v_mfma_f32_16x16x32_bf16 v[64:67], a[196:199], a[164:167], v[64:67]
  ds_read_b64_tr_b16 a[126:127], v5 offset:22528
  s_lshl_b32 s62, s31, 6
  v_mfma_f32_16x16x32_bf16 v[64:67], a[200:203], a[168:171], v[64:67]
  ds_read_b64_tr_b16 a[234:235], v26 offset:9216
  s_lshl_b32 s34, s34, 1
  v_mfma_f32_16x16x32_bf16 v[64:67], a[204:207], a[172:175], v[64:67]
  v_exp_f32 v63, v63
  v_mfma_f32_16x16x32_bf16 v[68:71], a[220:223], a[172:175], v[104:107]
  ds_read_b64_tr_b16 a[236:237], v27 offset:8192
  v_cvt_pk_bf16_f32 v87, v62, v63
  v_mfma_f32_16x16x32_bf16 v[68:71], a[216:219], a[168:171], v[68:71]
  v_exp_f32 v56, v56
  v_mfma_f32_16x16x32_bf16 v[68:71], a[212:215], a[164:167], v[68:71]
  ds_read_b64_tr_b16 a[238:239], v27 offset:9216
  s_add_u32 s62, s62, s34
  v_mfma_f32_16x16x32_bf16 v[68:71], a[208:211], a[160:163], v[68:71]
  s_add_u32 m0, s26, 16384
  v_exp_f32 v57, v57
  v_mfma_f32_16x16x32_bf16 v[76:79], a[208:211], a[176:179], v[108:111]
  ds_read_b64_tr_b16 a[240:241], v28 offset:8192
  v_cvt_pk_bf16_f32 v84, v56, v57
  v_mfma_f32_16x16x32_bf16 v[76:79], a[212:215], a[180:183], v[76:79]
  s_waitcnt lgkmcnt(4)
  s_add_u32 s27, s28, 262144
  buffer_load_dwordx4 v10, s[40:43], s27 offen offset:0 lds
  v_exp_f32 v58, v58
  v_mfma_f32_16x16x32_bf16 v[76:79], a[216:219], a[184:187], v[76:79]
  ds_read_b64_tr_b16 a[242:243], v28 offset:9216
  s_and_b32 s71, s32, 3
  v_mfma_f32_16x16x32_bf16 v[76:79], a[220:223], a[188:191], v[76:79]
  v_exp_f32 v59, v59
  v_mfma_f32_16x16x32_bf16 v[72:75], a[204:207], a[188:191], v[108:111]
  ds_read_b64_tr_b16 a[244:245], v29 offset:8192
  ds_read_b128 a[208:211], v20 offset:9216
  v_mfma_f32_16x16x32_bf16 v[72:75], a[200:203], a[184:187], v[72:75]
  ds_read_b64_tr_b16 a[246:247], v29 offset:9216
  v_cvt_pk_bf16_f32 v85, v58, v59
  v_mfma_f32_16x16x32_bf16 v[72:75], a[196:199], a[180:183], v[72:75]
  ds_read_b128 a[212:215], v21 offset:9216
  s_lshl_b32 s71, s71, 1
  v_mfma_f32_16x16x32_bf16 v[72:75], a[192:195], a[176:179], v[72:75]
  buffer_load_dwordx4 v11, s[40:43], s27 offen offset:1024 lds
  v_exp_f32 v64, v64
  v_mfma_f32_16x16x32_bf16 v[128:131], a[224:227], v[80:83], v[128:131]
  ds_read_b64_tr_b16 a[248:249], v30 offset:8192
  ds_read_b128 a[216:219], v22 offset:9216
  v_mfma_f32_16x16x32_bf16 v[160:163], a[224:227], v[84:87], v[160:163]
  v_exp_f32 v65, v65
  v_mfma_f32_16x16x32_bf16 v[164:167], a[228:231], v[84:87], v[164:167]
  ds_read_b64_tr_b16 a[250:251], v30 offset:9216
  ds_read_b128 a[220:223], v23 offset:9216
  v_mfma_f32_16x16x32_bf16 v[132:135], a[228:231], v[80:83], v[132:135]
  v_exp_f32 v66, v66
  s_waitcnt lgkmcnt(9)
  v_mfma_f32_16x16x32_bf16 v[136:139], a[232:235], v[80:83], v[136:139]
  ds_read_b64_tr_b16 a[252:253], v31 offset:8192
  ds_read_b128 a[204:207], v23 offset:8192
  v_mfma_f32_16x16x32_bf16 v[168:171], a[232:235], v[84:87], v[168:171]
  buffer_load_dwordx4 v12, s[40:43], s27 offen offset:2048 lds
  v_exp_f32 v67, v67
  v_mfma_f32_16x16x32_bf16 v[172:175], a[236:239], v[84:87], v[172:175]
  ds_read_b64_tr_b16 a[254:255], v31 offset:9216
  ds_read_b128 a[200:203], v22 offset:8192
  v_mfma_f32_16x16x32_bf16 v[140:143], a[236:239], v[80:83], v[140:143]
  v_exp_f32 v68, v68
  s_waitcnt lgkmcnt(9)
  v_mfma_f32_16x16x32_bf16 v[144:147], a[240:243], v[80:83], v[144:147]
  ds_read_b128 a[196:199], v21 offset:8192
  v_cvt_pk_bf16_f32 v88, v64, v65
  v_mfma_f32_16x16x32_bf16 v[176:179], a[240:243], v[84:87], v[176:179]
  v_exp_f32 v69, v69
  v_mfma_f32_16x16x32_bf16 v[180:183], a[244:247], v[84:87], v[180:183]
  ds_read_b128 a[192:195], v20 offset:8192
  v_cvt_pk_bf16_f32 v89, v66, v67
  v_mfma_f32_16x16x32_bf16 v[148:151], a[244:247], v[80:83], v[148:151]
  buffer_load_dwordx4 v13, s[40:43], s27 offen offset:3072 lds
  v_exp_f32 v70, v70
  s_waitcnt lgkmcnt(7)
  v_mfma_f32_16x16x32_bf16 v[152:155], a[248:251], v[80:83], v[152:155]
  v_exp_f32 v71, v71
  v_mfma_f32_16x16x32_bf16 v[184:187], a[248:251], v[84:87], v[184:187]
  v_exp_f32 v76, v76
  s_waitcnt lgkmcnt(3)
  v_mfma_f32_16x16x32_bf16 v[188:191], a[252:255], v[84:87], v[188:191]
  v_exp_f32 v77, v77
  v_mfma_f32_16x16x32_bf16 v[156:159], a[252:255], v[80:83], v[156:159]
  v_exp_f32 v78, v78
  v_mfma_f32_16x16x32_bf16 v[112:115], v[44:47], v[80:83], v[112:115]
  v_exp_f32 v79, v79
  v_mfma_f32_16x16x32_bf16 v[116:119], v[44:47], v[84:87], v[116:119]
  v_exp_f32 v72, v72
  s_waitcnt lgkmcnt(0)
  v_mfma_f32_16x16x32_bf16 v[48:51], a[192:195], a[128:131], v[96:99]
  v_exp_f32 v73, v73
  v_mfma_f32_16x16x32_bf16 v[48:51], a[196:199], a[132:135], v[48:51]
  s_add_u32 m0, s26, 20480
  v_cvt_pk_bf16_f32 v90, v68, v69
  v_mfma_f32_16x16x32_bf16 v[48:51], a[200:203], a[136:139], v[48:51]
  v_exp_f32 v74, v74
  v_mfma_f32_16x16x32_bf16 v[48:51], a[204:207], a[140:143], v[48:51]
  s_add_u32 s27, s28, 294912
  buffer_load_dwordx4 v10, s[40:43], s27 offen offset:0 lds
  v_mfma_f32_16x16x32_bf16 v[52:55], a[220:223], a[140:143], v[96:99]
  v_exp_f32 v75, v75
  v_mfma_f32_16x16x32_bf16 v[52:55], a[216:219], a[136:139], v[52:55]
  v_cvt_pk_bf16_f32 v91, v70, v71
  v_cvt_pk_bf16_f32 v94, v76, v77
  v_mfma_f32_16x16x32_bf16 v[52:55], a[212:215], a[132:135], v[52:55]
  v_cvt_pk_bf16_f32 v95, v78, v79
  v_cvt_pk_bf16_f32 v92, v72, v73
  v_mfma_f32_16x16x32_bf16 v[52:55], a[208:211], a[128:131], v[52:55]
  v_cvt_pk_bf16_f32 v93, v74, v75
  s_lshr_b32 s34, s32, 2
  v_mfma_f32_16x16x32_bf16 v[60:63], a[208:211], a[144:147], v[100:103]
  v_exp_f32 v48, v48
  v_mfma_f32_16x16x32_bf16 v[60:63], a[212:215], a[148:151], v[60:63]
  buffer_load_dwordx4 v11, s[40:43], s27 offen offset:1024 lds
  s_or_b32 s71, s71, s34
  v_mfma_f32_16x16x32_bf16 v[60:63], a[216:219], a[152:155], v[60:63]
  v_exp_f32 v49, v49
  v_mfma_f32_16x16x32_bf16 v[60:63], a[220:223], a[156:159], v[60:63]
  s_lshl_b32 s34, s3, 4
  s_add_u32 s62, s62, s34
  v_mfma_f32_16x16x32_bf16 v[56:59], a[204:207], a[156:159], v[100:103]
  v_exp_f32 v50, v50
  v_mfma_f32_16x16x32_bf16 v[56:59], a[200:203], a[152:155], v[56:59]
  s_lshl_b32 s62, s62, 10
  s_mov_b32 s66, 4096
  v_mfma_f32_16x16x32_bf16 v[56:59], a[196:199], a[148:151], v[56:59]
  v_exp_f32 v51, v51
  v_mfma_f32_16x16x32_bf16 v[56:59], a[192:195], a[144:147], v[56:59]
  s_barrier
  buffer_load_dwordx4 v12, s[40:43], s27 offen offset:2048 lds
  v_mfma_f32_16x16x32_bf16 v[192:195], a[224:227], v[88:91], v[192:195]
  v_exp_f32 v52, v52
  v_mfma_f32_16x16x32_bf16 v[224:227], a[224:227], v[92:95], v[224:227]
  ds_read_b64_tr_b16 a[224:225], v24 offset:12288
  v_cvt_pk_bf16_f32 v80, v48, v49
  v_mfma_f32_16x16x32_bf16 v[228:231], a[228:231], v[92:95], v[228:231]
  v_exp_f32 v53, v53
  v_mfma_f32_16x16x32_bf16 v[196:199], a[228:231], v[88:91], v[196:199]
  ds_read_b64_tr_b16 a[226:227], v24 offset:13312
  v_cvt_pk_bf16_f32 v81, v50, v51
  v_mfma_f32_16x16x32_bf16 v[200:203], a[232:235], v[88:91], v[200:203]
  v_exp_f32 v54, v54
  v_mfma_f32_16x16x32_bf16 v[232:235], a[232:235], v[92:95], v[232:235]
  buffer_load_dwordx4 v13, s[40:43], s27 offen offset:3072 lds
  s_mov_b32 s67, 8192
  v_mfma_f32_16x16x32_bf16 v[236:239], a[236:239], v[92:95], v[236:239]
  v_exp_f32 v55, v55
  v_mfma_f32_16x16x32_bf16 v[204:207], a[236:239], v[88:91], v[204:207]
  ds_read_b64_tr_b16 a[228:229], v25 offset:12288
  v_cvt_pk_bf16_f32 v82, v52, v53
  v_mfma_f32_16x16x32_bf16 v[208:211], a[240:243], v[88:91], v[208:211]
  v_exp_f32 v60, v60
  v_mfma_f32_16x16x32_bf16 v[240:243], a[240:243], v[92:95], v[240:243]
  s_mov_b64 exec, 0xffffffff
  buffer_load_dword v34, v18, s[48:51], s38 offen
  s_mov_b64 exec, -1
  v_mfma_f32_16x16x32_bf16 v[244:247], a[244:247], v[92:95], v[244:247]
  ds_read_b64_tr_b16 a[230:231], v25 offset:13312
  v_cvt_pk_bf16_f32 v83, v54, v55
  v_mfma_f32_16x16x32_bf16 v[212:215], a[244:247], v[88:91], v[212:215]
  v_exp_f32 v61, v61
  v_mfma_f32_16x16x32_bf16 v[216:219], a[248:251], v[88:91], v[216:219]
  ds_read_b64_tr_b16 a[232:233], v26 offset:12288
  v_cvt_pk_bf16_f32 v86, v60, v61
  v_mfma_f32_16x16x32_bf16 v[248:251], a[248:251], v[92:95], v[248:251]
  v_exp_f32 v62, v62
  v_mfma_f32_16x16x32_bf16 v[252:255], a[252:255], v[92:95], v[252:255]
  ds_read_b64_tr_b16 a[234:235], v26 offset:13312
  v_lshlrev_b32 v42, 4, v1
  v_mfma_f32_16x16x32_bf16 v[220:223], a[252:255], v[88:91], v[220:223]
  v_exp_f32 v63, v63
  v_mfma_f32_16x16x32_bf16 v[120:123], v[44:47], v[88:91], v[120:123]
  ds_read_b64_tr_b16 a[236:237], v27 offset:12288
  v_cvt_pk_bf16_f32 v87, v62, v63
  v_mfma_f32_16x16x32_bf16 v[124:127], v[44:47], v[92:95], v[124:127]
  v_exp_f32 v56, v56
  v_mfma_f32_16x16x32_bf16 v[64:67], a[192:195], a[160:163], v[104:107]
  ds_read_b64_tr_b16 a[238:239], v27 offset:13312
  s_lshl_b32 s10, s3, 10
  v_mfma_f32_16x16x32_bf16 v[64:67], a[196:199], a[164:167], v[64:67]
  v_exp_f32 v57, v57
  v_mfma_f32_16x16x32_bf16 v[64:67], a[200:203], a[168:171], v[64:67]
  ds_read_b64_tr_b16 a[240:241], v28 offset:12288
  v_cvt_pk_bf16_f32 v84, v56, v57
  v_mfma_f32_16x16x32_bf16 v[64:67], a[204:207], a[172:175], v[64:67]
  v_exp_f32 v58, v58
  v_mfma_f32_16x16x32_bf16 v[68:71], a[220:223], a[172:175], v[104:107]
  ds_read_b64_tr_b16 a[242:243], v28 offset:13312
  s_lshl_b32 s9, s3, 11
  v_mfma_f32_16x16x32_bf16 v[68:71], a[216:219], a[168:171], v[68:71]
  v_exp_f32 v59, v59
  v_mfma_f32_16x16x32_bf16 v[68:71], a[212:215], a[164:167], v[68:71]
  ds_read_b64_tr_b16 a[244:245], v29 offset:12288
  v_cvt_pk_bf16_f32 v85, v58, v59
  v_mfma_f32_16x16x32_bf16 v[68:71], a[208:211], a[160:163], v[68:71]
  ds_read_b64_tr_b16 a[246:247], v29 offset:13312
  s_add_u32 s9, s9, 57344
  v_mfma_f32_16x16x32_bf16 v[76:79], a[208:211], a[176:179], v[108:111]
  ds_read_b128 a[208:211], v20 offset:13312
  v_lshrrev_b32 v40, 4, v1
  v_mfma_f32_16x16x32_bf16 v[76:79], a[212:215], a[180:183], v[76:79]
  ds_read_b128 a[212:215], v21 offset:13312
  v_and_b32 v41, 15, v1
  v_mfma_f32_16x16x32_bf16 v[76:79], a[216:219], a[184:187], v[76:79]
  v_exp_f32 v64, v64
  v_mfma_f32_16x16x32_bf16 v[76:79], a[220:223], a[188:191], v[76:79]
  ds_read_b64_tr_b16 a[248:249], v30 offset:12288
  v_xor_b32 v40, v40, v41
  v_mfma_f32_16x16x32_bf16 v[72:75], a[204:207], a[188:191], v[108:111]
  ds_read_b128 a[216:219], v22 offset:13312
  v_lshlrev_b32 v40, 4, v40
  v_mfma_f32_16x16x32_bf16 v[72:75], a[200:203], a[184:187], v[72:75]
  v_exp_f32 v65, v65
  v_mfma_f32_16x16x32_bf16 v[72:75], a[196:199], a[180:183], v[72:75]
  ds_read_b64_tr_b16 a[250:251], v30 offset:13312
  v_cvt_pk_bf16_f32 v88, v64, v65
  v_mfma_f32_16x16x32_bf16 v[72:75], a[192:195], a[176:179], v[72:75]
  ds_read_b128 a[220:223], v23 offset:13312
  v_lshl_add_u32 v40, v41, 10, v40
  v_mfma_f32_16x16x32_bf16 v[128:131], a[224:227], v[80:83], v[128:131]
  v_exp_f32 v66, v66
  v_mfma_f32_16x16x32_bf16 v[160:163], a[224:227], v[84:87], v[160:163]
  s_mov_b64 exec, 0xffffffff
  s_not_b64 exec, exec
  buffer_load_dword v35, v18, s[48:51], s38 offen
  s_mov_b64 exec, -1
  s_waitcnt lgkmcnt(6)
  v_mfma_f32_16x16x32_bf16 v[164:167], a[228:231], v[84:87], v[164:167]
  ds_read_b64_tr_b16 a[252:253], v31 offset:12288
  s_lshl_b32 s34, s3, 8
  v_mfma_f32_16x16x32_bf16 v[132:135], a[228:231], v[80:83], v[132:135]
  ds_read_b128 a[204:207], v23 offset:12288
  v_add_u32 v40, s34, v40
  v_mfma_f32_16x16x32_bf16 v[136:139], a[232:235], v[80:83], v[136:139]
  v_exp_f32 v67, v67
  v_mfma_f32_16x16x32_bf16 v[168:171], a[232:235], v[84:87], v[168:171]
  ds_read_b64_tr_b16 a[254:255], v31 offset:13312
  v_cvt_pk_bf16_f32 v89, v66, v67
  v_mfma_f32_16x16x32_bf16 v[172:175], a[236:239], v[84:87], v[172:175]
  ds_read_b128 a[200:203], v22 offset:12288
  v_mfma_f32_16x16x32_bf16 v[140:143], a[236:239], v[80:83], v[140:143]
  v_exp_f32 v68, v68
  v_mfma_f32_16x16x32_bf16 v[144:147], a[240:243], v[80:83], v[144:147]
  ds_read_b128 a[196:199], v21 offset:12288
  s_waitcnt lgkmcnt(5)
  v_mfma_f32_16x16x32_bf16 v[176:179], a[240:243], v[84:87], v[176:179]
  v_exp_f32 v69, v69
  v_mfma_f32_16x16x32_bf16 v[180:183], a[244:247], v[84:87], v[180:183]
  ds_read_b128 a[192:195], v20 offset:12288
  v_cvt_pk_bf16_f32 v90, v68, v69
  v_mfma_f32_16x16x32_bf16 v[148:151], a[244:247], v[80:83], v[148:151]
  v_exp_f32 v70, v70
  v_mfma_f32_16x16x32_bf16 v[152:155], a[248:251], v[80:83], v[152:155]
  v_exp_f32 v71, v71
  v_mfma_f32_16x16x32_bf16 v[184:187], a[248:251], v[84:87], v[184:187]
  v_exp_f32 v76, v76
  s_waitcnt lgkmcnt(3)
  v_mfma_f32_16x16x32_bf16 v[188:191], a[252:255], v[84:87], v[188:191]
  v_exp_f32 v77, v77
  v_mfma_f32_16x16x32_bf16 v[156:159], a[252:255], v[80:83], v[156:159]
  v_exp_f32 v78, v78
  v_mfma_f32_16x16x32_bf16 v[112:115], v[44:47], v[80:83], v[112:115]
  v_exp_f32 v79, v79
  v_mfma_f32_16x16x32_bf16 v[116:119], v[44:47], v[84:87], v[116:119]
  v_exp_f32 v72, v72
  s_waitcnt lgkmcnt(0)
  v_mfma_f32_16x16x32_bf16 v[48:51], a[192:195], a[128:131], v[96:99]
  s_add_u32 m0, s10, 49152
  v_cvt_pk_bf16_f32 v91, v70, v71
  v_mfma_f32_16x16x32_bf16 v[48:51], a[196:199], a[132:135], v[48:51]
  s_add_u32 s27, s10, 4096
  buffer_load_dwordx4 v42, s[20:23], s27 offen lds
  v_mfma_f32_16x16x32_bf16 v[48:51], a[200:203], a[136:139], v[48:51]
  v_exp_f32 v73, v73
  v_mfma_f32_16x16x32_bf16 v[48:51], a[204:207], a[140:143], v[48:51]
  v_exp_f32 v74, v74
  v_mfma_f32_16x16x32_bf16 v[52:55], a[220:223], a[140:143], v[96:99]
  s_add_u32 m0, s10, 53248
  v_cvt_pk_bf16_f32 v94, v76, v77
  v_mfma_f32_16x16x32_bf16 v[52:55], a[216:219], a[136:139], v[52:55]
  s_add_u32 s27, s10, 8192
  buffer_load_dwordx4 v42, s[20:23], s27 offen lds
  v_mfma_f32_16x16x32_bf16 v[52:55], a[212:215], a[132:135], v[52:55]
  v_exp_f32 v75, v75
  v_mfma_f32_16x16x32_bf16 v[52:55], a[208:211], a[128:131], v[52:55]
  v_cvt_pk_bf16_f32 v95, v78, v79
  v_cvt_pk_bf16_f32 v92, v72, v73
  v_mfma_f32_16x16x32_bf16 v[60:63], a[208:211], a[144:147], v[100:103]
  s_mov_b32 m0, s9
  v_cvt_pk_bf16_f32 v93, v74, v75
  v_mfma_f32_16x16x32_bf16 v[60:63], a[212:215], a[148:151], v[60:63]
  buffer_load_dwordx4 v42, s[4:7], s62 offen offset:0 lds
  v_mfma_f32_16x16x32_bf16 v[60:63], a[216:219], a[152:155], v[60:63]
  v_exp_f32 v48, v48
  v_mfma_f32_16x16x32_bf16 v[60:63], a[220:223], a[156:159], v[60:63]
  v_exp_f32 v49, v49
  v_mfma_f32_16x16x32_bf16 v[56:59], a[204:207], a[156:159], v[100:103]
  v_exp_f32 v50, v50
  v_mfma_f32_16x16x32_bf16 v[56:59], a[200:203], a[152:155], v[56:59]
  buffer_load_dwordx4 v42, s[4:7], s62 offen offset:1024 lds
  v_mfma_f32_16x16x32_bf16 v[56:59], a[196:199], a[148:151], v[56:59]
  v_exp_f32 v51, v51
  v_mfma_f32_16x16x32_bf16 v[56:59], a[192:195], a[144:147], v[56:59]
  s_waitcnt vmcnt(15)
  s_barrier
  v_mfma_f32_16x16x32_bf16 v[192:195], a[224:227], v[88:91], v[192:195]
  v_exp_f32 v52, v52
  v_mfma_f32_16x16x32_bf16 v[224:227], a[224:227], v[92:95], v[224:227]
  s_add_u32 m0, s26, 8192
  ds_read_b64_tr_b16 a[224:225], v24 offset:0
  v_mfma_f32_16x16x32_bf16 v[228:231], a[228:231], v[92:95], v[228:231]
  v_exp_f32 v53, v53
  v_mfma_f32_16x16x32_bf16 v[196:199], a[228:231], v[88:91], v[196:199]
  s_add_u32 s27, s28, 327680
  buffer_load_dwordx4 v10, s[40:43], s27 offen offset:0 lds
  v_mfma_f32_16x16x32_bf16 v[200:203], a[232:235], v[88:91], v[200:203]
  v_exp_f32 v54, v54
  v_mfma_f32_16x16x32_bf16 v[232:235], a[232:235], v[92:95], v[232:235]
  ds_read_b64_tr_b16 a[226:227], v24 offset:1024
  v_xor_b32 v20, 0, v40
  v_mfma_f32_16x16x32_bf16 v[236:239], a[236:239], v[92:95], v[236:239]
  v_exp_f32 v55, v55
  v_mfma_f32_16x16x32_bf16 v[204:207], a[236:239], v[88:91], v[204:207]
  buffer_load_dwordx4 v11, s[40:43], s27 offen offset:1024 lds
  v_mfma_f32_16x16x32_bf16 v[208:211], a[240:243], v[88:91], v[208:211]
  ds_read_b64_tr_b16 a[228:229], v25 offset:0
  v_xor_b32 v21, 64, v40
  v_mfma_f32_16x16x32_bf16 v[240:243], a[240:243], v[92:95], v[240:243]
  v_exp_f32 v60, v60
  v_mfma_f32_16x16x32_bf16 v[244:247], a[244:247], v[92:95], v[244:247]
  ds_read_b64_tr_b16 a[230:231], v25 offset:1024
  v_xor_b32 v22, 128, v40
  v_mfma_f32_16x16x32_bf16 v[212:215], a[244:247], v[88:91], v[212:215]
  buffer_load_dwordx4 v12, s[40:43], s27 offen offset:2048 lds
  v_mfma_f32_16x16x32_bf16 v[216:219], a[248:251], v[88:91], v[216:219]
  v_exp_f32 v61, v61
  v_mfma_f32_16x16x32_bf16 v[248:251], a[248:251], v[92:95], v[248:251]
  ds_read_b64_tr_b16 a[232:233], v26 offset:0
  v_xor_b32 v23, 192, v40
  v_mfma_f32_16x16x32_bf16 v[252:255], a[252:255], v[92:95], v[252:255]
  v_exp_f32 v62, v62
  v_mfma_f32_16x16x32_bf16 v[220:223], a[252:255], v[88:91], v[220:223]
  buffer_load_dwordx4 v13, s[40:43], s27 offen offset:3072 lds
  v_mfma_f32_16x16x32_bf16 v[120:123], v[44:47], v[88:91], v[120:123]
  ds_read_b64_tr_b16 a[234:235], v26 offset:1024
  v_cvt_pk_bf16_f32 v80, v48, v49
  v_mfma_f32_16x16x32_bf16 v[124:127], v[44:47], v[92:95], v[124:127]
  s_add_u32 m0, s26, 12288
  ds_read_b64_tr_b16 a[236:237], v27 offset:0
  v_mfma_f32_16x16x32_bf16 v[64:67], a[192:195], a[160:163], v[104:107]
  v_exp_f32 v63, v63
  v_mfma_f32_16x16x32_bf16 v[64:67], a[196:199], a[164:167], v[64:67]
  s_add_u32 s27, s28, 360448
  buffer_load_dwordx4 v10, s[40:43], s27 offen offset:0 lds
  v_mfma_f32_16x16x32_bf16 v[64:67], a[200:203], a[168:171], v[64:67]
  v_exp_f32 v56, v56
  v_mfma_f32_16x16x32_bf16 v[64:67], a[204:207], a[172:175], v[64:67]
  ds_read_b64_tr_b16 a[238:239], v27 offset:1024
  v_cvt_pk_bf16_f32 v81, v50, v51
  v_mfma_f32_16x16x32_bf16 v[68:71], a[220:223], a[172:175], v[104:107]
  v_exp_f32 v57, v57
  v_mfma_f32_16x16x32_bf16 v[68:71], a[216:219], a[168:171], v[68:71]
  buffer_load_dwordx4 v11, s[40:43], s27 offen offset:1024 lds
  v_mfma_f32_16x16x32_bf16 v[68:71], a[212:215], a[164:167], v[68:71]
  ds_read_b64_tr_b16 a[240:241], v28 offset:0
  v_cvt_pk_bf16_f32 v82, v52, v53
  v_mfma_f32_16x16x32_bf16 v[68:71], a[208:211], a[160:163], v[68:71]
  v_exp_f32 v58, v58
  v_mfma_f32_16x16x32_bf16 v[76:79], a[208:211], a[176:179], v[108:111]
  ds_read_b64_tr_b16 a[242:243], v28 offset:1024
  v_cvt_pk_bf16_f32 v83, v54, v55
  v_mfma_f32_16x16x32_bf16 v[76:79], a[212:215], a[180:183], v[76:79]
  buffer_load_dwordx4 v12, s[40:43], s27 offen offset:2048 lds
  v_mfma_f32_16x16x32_bf16 v[76:79], a[216:219], a[184:187], v[76:79]
  v_exp_f32 v59, v59
  v_mfma_f32_16x16x32_bf16 v[76:79], a[220:223], a[188:191], v[76:79]
  ds_read_b64_tr_b16 a[244:245], v29 offset:0
  v_lshrrev_b32 v14, 5, v1
  v_mfma_f32_16x16x32_bf16 v[72:75], a[204:207], a[188:191], v[108:111]
  ds_read_b64_tr_b16 a[246:247], v29 offset:1024
  v_bfe_u32 v15, v1, 3, 2
  v_mfma_f32_16x16x32_bf16 v[72:75], a[200:203], a[184:187], v[72:75]
  buffer_load_dwordx4 v13, s[40:43], s27 offen offset:3072 lds
  s_waitcnt lgkmcnt(3)
  v_mfma_f32_16x16x32_bf16 v[72:75], a[196:199], a[180:183], v[72:75]
  ds_read_b64_tr_b16 a[248:249], v30 offset:0
  v_lshlrev_b32 v15, 8, v15
  v_mfma_f32_16x16x32_bf16 v[72:75], a[192:195], a[176:179], v[72:75]
  ds_read_b64_tr_b16 a[250:251], v30 offset:1024
  v_cvt_pk_bf16_f32 v86, v60, v61
  v_mfma_f32_16x16x32_bf16 v[112:115], v[44:47], v[80:83], v[112:115]
  ds_read_b64_tr_b16 a[252:253], v31 offset:0
  ds_read_b64_tr_b16 a[254:255], v31 offset:1024
  v_mfma_f32_16x16x32_bf16 v[128:131], a[224:227], v[80:83], v[128:131]
  v_cvt_pk_bf16_f32 v87, v62, v63
  v_cvt_pk_bf16_f32 v84, v56, v57
  v_mfma_f32_16x16x32_bf16 v[132:135], a[228:231], v[80:83], v[132:135]
  v_exp_f32 v64, v64
  v_mfma_f32_16x16x32_bf16 v[136:139], a[232:235], v[80:83], v[136:139]
  v_cvt_pk_bf16_f32 v85, v58, v59
  v_and_b32 v16, 7, v1
  v_mfma_f32_16x16x32_bf16 v[140:143], a[236:239], v[80:83], v[140:143]
  v_exp_f32 v65, v65
  s_waitcnt lgkmcnt(6)
  v_mfma_f32_16x16x32_bf16 v[144:147], a[240:243], v[80:83], v[144:147]
  v_exp_f32 v66, v66
  s_waitcnt lgkmcnt(4)
  v_mfma_f32_16x16x32_bf16 v[148:151], a[244:247], v[80:83], v[148:151]
  v_exp_f32 v67, v67
  s_waitcnt lgkmcnt(2)
  v_mfma_f32_16x16x32_bf16 v[152:155], a[248:251], v[80:83], v[152:155]
  s_waitcnt vmcnt(8) lgkmcnt(0)
  s_barrier
  v_lshl_add_u32 v15, v16, 4, v15
  v_mfma_f32_16x16x32_bf16 v[156:159], a[252:255], v[80:83], v[156:159]
  v_exp_f32 v68, v68
  v_mfma_f32_16x16x32_bf16 v[116:119], v[44:47], v[84:87], v[116:119]
  s_add_u32 m0, s26, 0
  v_lshl_add_u32 v26, v14, 10, v15
  v_mfma_f32_16x16x32_bf16 v[160:163], a[224:227], v[84:87], v[160:163]
  v_exp_f32 v69, v69
  v_mfma_f32_16x16x32_bf16 v[164:167], a[228:231], v[84:87], v[164:167]
  s_add_u32 s27, s28, 393216
  buffer_load_dwordx4 v10, s[40:43], s27 offen offset:0 lds
  v_mfma_f32_16x16x32_bf16 v[168:171], a[232:235], v[84:87], v[168:171]
  v_exp_f32 v70, v70
  v_mfma_f32_16x16x32_bf16 v[172:175], a[236:239], v[84:87], v[172:175]
  v_exp_f32 v71, v71
  v_mfma_f32_16x16x32_bf16 v[176:179], a[240:243], v[84:87], v[176:179]
  buffer_load_dwordx4 v11, s[40:43], s27 offen offset:1024 lds
  v_mfma_f32_16x16x32_bf16 v[180:183], a[244:247], v[84:87], v[180:183]
  v_cvt_pk_bf16_f32 v88, v64, v65
  v_cvt_pk_bf16_f32 v89, v66, v67
  v_mfma_f32_16x16x32_bf16 v[184:187], a[248:251], v[84:87], v[184:187]
  v_exp_f32 v76, v76
  v_cvt_pk_bf16_f32 v90, v68, v69
  v_cvt_pk_bf16_f32 v91, v70, v71
  v_lshl_add_u32 v19, v14, 7, v15
  v_mfma_f32_16x16x32_bf16 v[188:191], a[252:255], v[84:87], v[188:191]
  buffer_load_dwordx4 v12, s[40:43], s27 offen offset:2048 lds
  v_exp_f32 v77, v77
  v_mfma_f32_16x16x32_bf16 v[120:123], v[44:47], v[88:91], v[120:123]
  v_exp_f32 v78, v78
  v_mfma_f32_16x16x32_bf16 v[192:195], a[224:227], v[88:91], v[192:195]
  v_exp_f32 v79, v79
  s_sub_u32 s34, s26, s11
  v_mfma_f32_16x16x32_bf16 v[196:199], a[228:231], v[88:91], v[196:199]
  buffer_load_dwordx4 v13, s[40:43], s27 offen offset:3072 lds
  v_exp_f32 v72, v72
  v_mfma_f32_16x16x32_bf16 v[200:203], a[232:235], v[88:91], v[200:203]
  s_add_u32 m0, s26, 4096
  v_exp_f32 v73, v73
  v_mfma_f32_16x16x32_bf16 v[204:207], a[236:239], v[88:91], v[204:207]
  v_exp_f32 v74, v74
  v_subrev_u32 v28, s34, v2
  v_mfma_f32_16x16x32_bf16 v[208:211], a[240:243], v[88:91], v[208:211]
  s_add_u32 s27, s28, 425984
  buffer_load_dwordx4 v10, s[40:43], s27 offen offset:0 lds
  v_exp_f32 v75, v75
  v_mfma_f32_16x16x32_bf16 v[212:215], a[244:247], v[88:91], v[212:215]
  v_cvt_pk_bf16_f32 v94, v76, v77
  v_cvt_pk_bf16_f32 v95, v78, v79
  v_mfma_f32_16x16x32_bf16 v[216:219], a[248:251], v[88:91], v[216:219]
  v_cvt_pk_bf16_f32 v92, v72, v73
  v_cvt_pk_bf16_f32 v93, v74, v75
  v_subrev_u32 v29, s34, v3
  v_mfma_f32_16x16x32_bf16 v[220:223], a[252:255], v[88:91], v[220:223]
  buffer_load_dwordx4 v11, s[40:43], s27 offen offset:1024 lds
  v_mfma_f32_16x16x32_bf16 v[124:127], v[44:47], v[92:95], v[124:127]
  v_subrev_u32 v30, s34, v4
  v_subrev_u32 v31, s34, v5
  v_mfma_f32_16x16x32_bf16 v[224:227], a[224:227], v[92:95], v[224:227]
  v_add_u32 v27, s9, v26
  v_mfma_f32_16x16x32_bf16 v[228:231], a[228:231], v[92:95], v[228:231]
  buffer_load_dwordx4 v12, s[40:43], s27 offen offset:2048 lds
  v_mfma_f32_16x16x32_bf16 v[232:235], a[232:235], v[92:95], v[232:235]
  v_rcp_f32 v114, v112
  v_mfma_f32_16x16x32_bf16 v[236:239], a[236:239], v[92:95], v[236:239]
  v_mul_f32 v128, v128, v114
  v_mul_f32 v129, v129, v114
  v_mfma_f32_16x16x32_bf16 v[240:243], a[240:243], v[92:95], v[240:243]
  buffer_load_dwordx4 v13, s[40:43], s27 offen offset:3072 lds
  v_mfma_f32_16x16x32_bf16 v[244:247], a[244:247], v[92:95], v[244:247]
  v_mul_f32 v130, v130, v114
  v_mul_f32 v131, v131, v114
  v_mfma_f32_16x16x32_bf16 v[248:251], a[248:251], v[92:95], v[248:251]
  v_mul_f32 v132, v132, v114
  v_mul_f32 v133, v133, v114
  v_mfma_f32_16x16x32_bf16 v[252:255], a[252:255], v[92:95], v[252:255]
  v_mul_f32 v134, v134, v114
  v_mul_f32 v135, v135, v114
  v_cvt_pk_bf16_f32 v128, v128, v129
  v_cvt_pk_bf16_f32 v129, v130, v131
  v_cvt_pk_bf16_f32 v130, v132, v133
  v_cvt_pk_bf16_f32 v131, v134, v135
  v_rcp_f32 v118, v116
  v_rcp_f32 v122, v120
  v_rcp_f32 v126, v124
  s_mov_b32 s34, 0x4e800000
  v_add_f32 v40, v112, v116
  v_add_f32 v41, v120, v124
  v_add_f32 v40, v40, v41
  v_cmp_ngt_f32 vcc, s34, v40
  s_nop 1
  s_cbranch_vccnz L_exact
L_exact_done:
  ds_read_b64_tr_b16 a[128:129], v2 offset:16384
  ds_read_b64_tr_b16 a[130:131], v2 offset:18432
  ds_read_b64_tr_b16 a[136:137], v3 offset:16384
  ds_read_b64_tr_b16 a[138:139], v3 offset:18432
  ds_read_b64_tr_b16 a[144:145], v4 offset:16384
  ds_read_b64_tr_b16 a[146:147], v4 offset:18432
  ds_read_b64_tr_b16 a[152:153], v5 offset:16384
  ds_read_b64_tr_b16 a[154:155], v5 offset:18432
  ds_read_b64_tr_b16 a[132:133], v2 offset:20480
  ds_read_b64_tr_b16 a[134:135], v2 offset:22528
  ds_read_b64_tr_b16 a[140:141], v3 offset:20480
  ds_read_b64_tr_b16 a[142:143], v3 offset:22528
  ds_read_b64_tr_b16 a[148:149], v4 offset:20480
  ds_read_b64_tr_b16 a[150:151], v4 offset:22528
  ds_read_b64_tr_b16 a[156:157], v5 offset:20480
  ds_read_b64_tr_b16 a[158:159], v5 offset:22528
  ds_read_b64_tr_b16 v[32:33], v28 offset:0
  ds_read_b64_tr_b16 v[34:35], v28 offset:2048
  ds_read_b64_tr_b16 v[40:41], v29 offset:0
  ds_read_b64_tr_b16 v[42:43], v29 offset:2048
  ds_read_b64_tr_b16 v[48:49], v30 offset:0
  ds_read_b64_tr_b16 v[50:51], v30 offset:2048
  ds_read_b64_tr_b16 v[56:57], v31 offset:0
  ds_read_b64_tr_b16 v[58:59], v31 offset:2048
  ds_read_b64_tr_b16 v[36:37], v28 offset:4096
  ds_read_b64_tr_b16 v[38:39], v28 offset:6144
  ds_read_b64_tr_b16 v[44:45], v29 offset:4096
  ds_read_b64_tr_b16 v[46:47], v29 offset:6144
  ds_read_b64_tr_b16 v[52:53], v30 offset:4096
  ds_read_b64_tr_b16 v[54:55], v30 offset:6144
  ds_read_b64_tr_b16 v[60:61], v31 offset:4096
  ds_read_b64_tr_b16 v[62:63], v31 offset:6144
  ds_read_b128 v[64:67], v19 offset:49152
  ds_read_b128 v[68:71], v19 offset:50176
  ds_read_b128 v[72:75], v19 offset:51200
  ds_read_b128 v[76:79], v19 offset:52224
  ds_read_b128 v[80:83], v19 offset:53248
  ds_read_b128 v[84:87], v19 offset:54272
  ds_read_b128 v[88:91], v27 offset:0
  ds_read_b128 v[92:95], v27 offset:128
  ds_write_b128 v20, v[128:131] offset:0
  s_add_u32 m0, s26, 16384
  s_add_u32 s27, s28, 458752
  buffer_load_dwordx4 v10, s[40:43], s27 offen offset:0 lds
  v_pk_mul_f32 v[136:137], v[136:137], v[114:115] op_sel_hi:[1,0]
  v_pk_mul_f32 v[138:139], v[138:139], v[114:115] op_sel_hi:[1,0]
  v_pk_mul_f32 v[140:141], v[140:141], v[114:115] op_sel_hi:[1,0]
  v_pk_mul_f32 v[142:143], v[142:143], v[114:115] op_sel_hi:[1,0]
  v_cvt_pk_bf16_f32 v136, v136, v137
  v_cvt_pk_bf16_f32 v137, v138, v139
  v_cvt_pk_bf16_f32 v138, v140, v141
  v_cvt_pk_bf16_f32 v139, v142, v143
  ds_write_b128 v21, v[136:139] offset:0
  buffer_load_dwordx4 v11, s[40:43], s27 offen offset:1024 lds
  v_pk_mul_f32 v[144:145], v[144:145], v[114:115] op_sel_hi:[1,0]
L_page9:
  s_cmp_eq_u32 s100, 1
  s_cbranch_scc1 L_pgretX
  v_pk_mul_f32 v[146:147], v[146:147], v[114:115] op_sel_hi:[1,0]
  v_pk_mul_f32 v[148:149], v[148:149], v[114:115] op_sel_hi:[1,0]
  v_pk_mul_f32 v[150:151], v[150:151], v[114:115] op_sel_hi:[1,0]
  v_cvt_pk_bf16_f32 v144, v144, v145
  v_cvt_pk_bf16_f32 v145, v146, v147
  v_cvt_pk_bf16_f32 v146, v148, v149
  v_cvt_pk_bf16_f32 v147, v150, v151
  ds_write_b128 v22, v[144:147] offset:0
  buffer_load_dwordx4 v12, s[40:43], s27 offen offset:2048 lds
  v_pk_mul_f32 v[152:153], v[152:153], v[114:115] op_sel_hi:[1,0]
  v_pk_mul_f32 v[154:155], v[154:155], v[114:115] op_sel_hi:[1,0]
  v_pk_mul_f32 v[156:157], v[156:157], v[114:115] op_sel_hi:[1,0]
  v_pk_mul_f32 v[158:159], v[158:159], v[114:115] op_sel_hi:[1,0]
  v_cvt_pk_bf16_f32 v152, v152, v153
  v_cvt_pk_bf16_f32 v153, v154, v155
  v_cvt_pk_bf16_f32 v154, v156, v157
  v_cvt_pk_bf16_f32 v155, v158, v159
  ds_write_b128 v23, v[152:155] offset:0
  buffer_load_dwordx4 v13, s[40:43], s27 offen offset:3072 lds
  v_pk_mul_f32 v[160:161], v[160:161], v[118:119] op_sel_hi:[1,0]
  v_pk_mul_f32 v[162:163], v[162:163], v[118:119] op_sel_hi:[1,0]
  v_pk_mul_f32 v[164:165], v[164:165], v[118:119] op_sel_hi:[1,0]
  v_pk_mul_f32 v[166:167], v[166:167], v[118:119] op_sel_hi:[1,0]
  v_cvt_pk_bf16_f32 v160, v160, v161
  v_cvt_pk_bf16_f32 v161, v162, v163
  v_cvt_pk_bf16_f32 v162, v164, v165
  v_cvt_pk_bf16_f32 v163, v166, v167
  s_waitcnt lgkmcnt(0)
  s_barrier
  s_waitcnt vmcnt(12)
  ds_read_b64_tr_b16 a[160:161], v2 offset:8192
  ds_read_b64_tr_b16 a[162:163], v2 offset:10240
  ds_read_b64_tr_b16 a[168:169], v3 offset:8192
  ds_read_b64_tr_b16 a[170:171], v3 offset:10240
  ds_read_b64_tr_b16 a[176:177], v4 offset:8192
  ds_read_b64_tr_b16 a[178:179], v4 offset:10240
  ds_read_b64_tr_b16 a[184:185], v5 offset:8192
  ds_read_b64_tr_b16 a[186:187], v5 offset:10240
  ds_read_b64_tr_b16 a[164:165], v2 offset:12288
  ds_read_b64_tr_b16 a[166:167], v2 offset:14336
  ds_read_b64_tr_b16 a[172:173], v3 offset:12288
  ds_read_b64_tr_b16 a[174:175], v3 offset:14336
  ds_read_b64_tr_b16 a[180:181], v4 offset:12288
  ds_read_b64_tr_b16 a[182:183], v4 offset:14336
  ds_read_b64_tr_b16 a[188:189], v5 offset:12288
  ds_read_b64_tr_b16 a[190:191], v5 offset:14336
  ds_write_b128 v20, v[160:163] offset:16384
  s_add_u32 m0, s26, 20480
  s_add_u32 s27, s28, 491520
  buffer_load_dwordx4 v10, s[40:43], s27 offen offset:0 lds
  v_pk_mul_f32 v[168:169], v[168:169], v[118:119] op_sel_hi:[1,0]
  v_pk_mul_f32 v[170:171], v[170:171], v[118:119] op_sel_hi:[1,0]
  v_pk_mul_f32 v[172:173], v[172:173], v[118:119] op_sel_hi:[1,0]
  v_pk_mul_f32 v[174:175], v[174:175], v[118:119] op_sel_hi:[1,0]
  v_cvt_pk_bf16_f32 v168, v168, v169
  v_cvt_pk_bf16_f32 v169, v170, v171
  v_cvt_pk_bf16_f32 v170, v172, v173
  v_cvt_pk_bf16_f32 v171, v174, v175
  ds_write_b128 v21, v[168:171] offset:16384
  buffer_load_dwordx4 v11, s[40:43], s27 offen offset:1024 lds
  v_pk_mul_f32 v[176:177], v[176:177], v[118:119] op_sel_hi:[1,0]
  v_pk_mul_f32 v[178:179], v[178:179], v[118:119] op_sel_hi:[1,0]
  v_pk_mul_f32 v[180:181], v[180:181], v[118:119] op_sel_hi:[1,0]
  v_pk_mul_f32 v[182:183], v[182:183], v[118:119] op_sel_hi:[1,0]
  v_cvt_pk_bf16_f32 v176, v176, v177
  v_cvt_pk_bf16_f32 v177, v178, v179
  v_cvt_pk_bf16_f32 v178, v180, v181
  v_cvt_pk_bf16_f32 v179, v182, v183
  ds_write_b128 v22, v[176:179] offset:16384
  buffer_load_dwordx4 v12, s[40:43], s27 offen offset:2048 lds
  v_pk_mul_f32 v[184:185], v[184:185], v[118:119] op_sel_hi:[1,0]
  v_pk_mul_f32 v[186:187], v[186:187], v[118:119] op_sel_hi:[1,0]
  v_pk_mul_f32 v[188:189], v[188:189], v[118:119] op_sel_hi:[1,0]
  v_pk_mul_f32 v[190:191], v[190:191], v[118:119] op_sel_hi:[1,0]
  v_cvt_pk_bf16_f32 v184, v184, v185
  v_cvt_pk_bf16_f32 v185, v186, v187
  v_cvt_pk_bf16_f32 v186, v188, v189
  v_cvt_pk_bf16_f32 v187, v190, v191
  ds_write_b128 v23, v[184:187] offset:16384
  buffer_load_dwordx4 v13, s[40:43], s27 offen offset:3072 lds
  v_pk_mul_f32 v[192:193], v[192:193], v[122:123] op_sel_hi:[1,0]
  v_pk_mul_f32 v[194:195], v[194:195], v[122:123] op_sel_hi:[1,0]
  v_pk_mul_f32 v[196:197], v[196:197], v[122:123] op_sel_hi:[1,0]
  v_pk_mul_f32 v[198:199], v[198:199], v[122:123] op_sel_hi:[1,0]
  v_cvt_pk_bf16_f32 v192, v192, v193
  v_cvt_pk_bf16_f32 v193, v194, v195
  v_cvt_pk_bf16_f32 v194, v196, v197
  v_cvt_pk_bf16_f32 v195, v198, v199
  ds_write_b128 v20, v[192:195] offset:32768
  s_waitcnt lgkmcnt(4)
  s_add_u32 m0, s26, 8192
  s_add_u32 s27, s28, 65664
  buffer_load_dwordx4 v10, s[40:43], s27 offen offset:0 lds
  v_pk_mul_f32 v[200:201], v[200:201], v[122:123] op_sel_hi:[1,0]
  v_pk_mul_f32 v[202:203], v[202:203], v[122:123] op_sel_hi:[1,0]
  v_pk_mul_f32 v[204:205], v[204:205], v[122:123] op_sel_hi:[1,0]
  v_pk_mul_f32 v[206:207], v[206:207], v[122:123] op_sel_hi:[1,0]
  v_cvt_pk_bf16_f32 v200, v200, v201
  v_cvt_pk_bf16_f32 v201, v202, v203
  v_cvt_pk_bf16_f32 v202, v204, v205
  v_cvt_pk_bf16_f32 v203, v206, v207
  ds_write_b128 v21, v[200:203] offset:32768
  buffer_load_dwordx4 v11, s[40:43], s27 offen offset:1024 lds
  v_pk_mul_f32 v[208:209], v[208:209], v[122:123] op_sel_hi:[1,0]
  v_pk_mul_f32 v[210:211], v[210:211], v[122:123] op_sel_hi:[1,0]
  v_pk_mul_f32 v[212:213], v[212:213], v[122:123] op_sel_hi:[1,0]
  v_pk_mul_f32 v[214:215], v[214:215], v[122:123] op_sel_hi:[1,0]
  v_cvt_pk_bf16_f32 v208, v208, v209
  v_cvt_pk_bf16_f32 v209, v210, v211
  v_cvt_pk_bf16_f32 v210, v212, v213
  v_cvt_pk_bf16_f32 v211, v214, v215
  ds_write_b128 v22, v[208:211] offset:32768
  buffer_load_dwordx4 v12, s[40:43], s27 offen offset:2048 lds
  v_pk_mul_f32 v[216:217], v[216:217], v[122:123] op_sel_hi:[1,0]
  v_pk_mul_f32 v[218:219], v[218:219], v[122:123] op_sel_hi:[1,0]
  v_pk_mul_f32 v[220:221], v[220:221], v[122:123] op_sel_hi:[1,0]
  v_pk_mul_f32 v[222:223], v[222:223], v[122:123] op_sel_hi:[1,0]
  v_cvt_pk_bf16_f32 v216, v216, v217
  v_cvt_pk_bf16_f32 v217, v218, v219
  v_cvt_pk_bf16_f32 v218, v220, v221
  v_cvt_pk_bf16_f32 v219, v222, v223
  ds_write_b128 v23, v[216:219] offset:32768
  buffer_load_dwordx4 v13, s[40:43], s27 offen offset:3072 lds
  v_pk_mul_f32 v[224:225], v[224:225], v[126:127] op_sel_hi:[1,0]
  v_pk_mul_f32 v[226:227], v[226:227], v[126:127] op_sel_hi:[1,0]
  v_pk_mul_f32 v[228:229], v[228:229], v[126:127] op_sel_hi:[1,0]
  v_pk_mul_f32 v[230:231], v[230:231], v[126:127] op_sel_hi:[1,0]
  v_cvt_pk_bf16_f32 v224, v224, v225
  v_cvt_pk_bf16_f32 v225, v226, v227
  v_cvt_pk_bf16_f32 v226, v228, v229
  v_cvt_pk_bf16_f32 v227, v230, v231
  ds_write_b128 v20, v[224:227] offset:49152
  s_add_u32 m0, s26, 12288
  s_add_u32 s27, s28, 98432
  buffer_load_dwordx4 v10, s[40:43], s27 offen offset:0 lds
  v_pk_mul_f32 v[232:233], v[232:233], v[126:127] op_sel_hi:[1,0]
  v_pk_mul_f32 v[234:235], v[234:235], v[126:127] op_sel_hi:[1,0]
  v_pk_mul_f32 v[236:237], v[236:237], v[126:127] op_sel_hi:[1,0]
  v_pk_mul_f32 v[238:239], v[238:239], v[126:127] op_sel_hi:[1,0]
  v_cvt_pk_bf16_f32 v232, v232, v233
  v_cvt_pk_bf16_f32 v233, v234, v235
  v_cvt_pk_bf16_f32 v234, v236, v237
  v_cvt_pk_bf16_f32 v235, v238, v239
  ds_write_b128 v21, v[232:235] offset:49152
  buffer_load_dwordx4 v11, s[40:43], s27 offen offset:1024 lds
  v_pk_mul_f32 v[240:241], v[240:241], v[126:127] op_sel_hi:[1,0]
  v_pk_mul_f32 v[242:243], v[242:243], v[126:127] op_sel_hi:[1,0]
  v_pk_mul_f32 v[244:245], v[244:245], v[126:127] op_sel_hi:[1,0]
  v_pk_mul_f32 v[246:247], v[246:247], v[126:127] op_sel_hi:[1,0]
  v_cvt_pk_bf16_f32 v240, v240, v241
  v_cvt_pk_bf16_f32 v241, v242, v243
  v_cvt_pk_bf16_f32 v242, v244, v245
  v_cvt_pk_bf16_f32 v243, v246, v247
  ds_write_b128 v22, v[240:243] offset:49152
  buffer_load_dwordx4 v12, s[40:43], s27 offen offset:2048 lds
  v_pk_mul_f32 v[248:249], v[248:249], v[126:127] op_sel_hi:[1,0]
  v_pk_mul_f32 v[250:251], v[250:251], v[126:127] op_sel_hi:[1,0]
  v_pk_mul_f32 v[252:253], v[252:253], v[126:127] op_sel_hi:[1,0]
  v_pk_mul_f32 v[254:255], v[254:255], v[126:127] op_sel_hi:[1,0]
  v_cvt_pk_bf16_f32 v248, v248, v249
  v_cvt_pk_bf16_f32 v249, v250, v251
  v_cvt_pk_bf16_f32 v250, v252, v253
  v_cvt_pk_bf16_f32 v251, v254, v255
  ds_write_b128 v23, v[248:251] offset:49152
  buffer_load_dwordx4 v13, s[40:43], s27 offen offset:3072 lds
  s_waitcnt lgkmcnt(0)
  s_barrier
  ds_read_b128 a[192:195], v6 offset:0
  ds_read_b128 a[196:199], v7 offset:0
  ds_read_b128 a[200:203], v8 offset:0
  ds_read_b128 a[204:207], v9 offset:0
  ds_read_b128 a[208:211], v6 offset:256
  ds_read_b128 a[212:215], v7 offset:256
  ds_read_b128 a[216:219], v8 offset:256
  ds_read_b128 a[220:223], v9 offset:256
  s_waitcnt lgkmcnt(7)
  v_mfma_f32_16x16x32_bf16 v[128:131], a[0:3], a[192:195], 0
  s_waitcnt vmcnt(16)
  ds_read_b64_tr_b16 v[192:193], v2 offset:0
  s_waitcnt lgkmcnt(7)
  v_mfma_f32_16x16x32_bf16 v[128:131], a[4:7], a[196:199], v[128:131]
  ds_read_b64_tr_b16 v[194:195], v2 offset:2048
  v_mfma_f32_16x16x32_bf16 v[132:135], a[12:15], a[196:199], 0
  ds_read_b64_tr_b16 v[200:201], v3 offset:0
  v_mfma_f32_16x16x32_bf16 v[132:135], a[8:11], a[192:195], v[132:135]
  ds_read_b64_tr_b16 v[202:203], v3 offset:2048
  v_mfma_f32_16x16x32_bf16 v[136:139], a[16:19], a[192:195], 0
  ds_read_b64_tr_b16 v[208:209], v4 offset:0
  v_mfma_f32_16x16x32_bf16 v[136:139], a[20:23], a[196:199], v[136:139]
  ds_read_b64_tr_b16 v[210:211], v4 offset:2048
  v_mfma_f32_16x16x32_bf16 v[140:143], a[28:31], a[196:199], 0
  ds_read_b64_tr_b16 v[216:217], v5 offset:0
  v_mfma_f32_16x16x32_bf16 v[140:143], a[24:27], a[192:195], v[140:143]
  ds_read_b64_tr_b16 v[218:219], v5 offset:2048
  s_waitcnt lgkmcnt(7)
  v_mfma_f32_16x16x32_bf16 v[140:143], a[56:59], a[200:203], v[140:143]
  ds_read_b64_tr_b16 v[196:197], v2 offset:4096
  v_and_b32 v14, 15, v1
  v_mfma_f32_16x16x32_bf16 v[140:143], a[60:63], a[204:207], v[140:143]
  ds_read_b64_tr_b16 v[198:199], v2 offset:6144
  v_lshlrev_b32 v14, 6, v14
  v_mfma_f32_16x16x32_bf16 v[136:139], a[52:55], a[204:207], v[136:139]
  ds_read_b64_tr_b16 v[204:205], v3 offset:4096
  v_bfe_u32 v15, v1, 4, 1
  v_mfma_f32_16x16x32_bf16 v[136:139], a[48:51], a[200:203], v[136:139]
  ds_read_b64_tr_b16 v[206:207], v3 offset:6144
  v_lshl_add_u32 v14, v15, 5, v14
  v_mfma_f32_16x16x32_bf16 v[132:135], a[40:43], a[200:203], v[132:135]
  ds_read_b128 a[224:227], v6 offset:512
  v_lshrrev_b32 v15, 5, v1
  v_mfma_f32_16x16x32_bf16 v[132:135], a[44:47], a[204:207], v[132:135]
  ds_read_b128 a[228:231], v7 offset:512
  v_lshl_add_u32 v20, v15, 4, v14
  v_mfma_f32_16x16x32_bf16 v[128:131], a[36:39], a[204:207], v[128:131]
  ds_read_b64_tr_b16 v[212:213], v4 offset:4096
  s_lshl_b32 s56, s25, 3
  v_mfma_f32_16x16x32_bf16 v[128:131], a[32:35], a[200:203], v[128:131]
  ds_read_b64_tr_b16 v[214:215], v4 offset:6144
  s_add_u32 s56, s56, s24
  v_mfma_f32_16x16x32_bf16 v[128:131], a[64:67], a[208:211], v[128:131]
  ds_read_b64_tr_b16 v[220:221], v5 offset:4096
  s_lshl_b32 s56, s56, 16
  v_mfma_f32_16x16x32_bf16 v[128:131], a[68:71], a[212:215], v[128:131]
  ds_read_b64_tr_b16 v[222:223], v5 offset:6144
  s_lshl_b32 s34, s3, 11
  v_mfma_f32_16x16x32_bf16 v[132:135], a[76:79], a[212:215], v[132:135]
  ds_read_b128 a[232:235], v8 offset:512
  s_add_u32 s56, s56, s34
  v_mfma_f32_16x16x32_bf16 v[132:135], a[72:75], a[208:211], v[132:135]
  ds_read_b128 a[236:239], v9 offset:512
  s_add_u32 s56, s56, 1048576
  v_mfma_f32_16x16x32_bf16 v[136:139], a[80:83], a[208:211], v[136:139]
  ds_read_b128 a[240:243], v6 offset:16384
  v_mov_b32 v29, s30
  v_mfma_f32_16x16x32_bf16 v[136:139], a[84:87], a[212:215], v[136:139]
  ds_read_b128 a[244:247], v7 offset:16384
  s_lshl_b32 s65, s25, 13
  v_mfma_f32_16x16x32_bf16 v[140:143], a[92:95], a[212:215], v[140:143]
  s_lshl_b32 s34, s24, 2
  s_add_u32 s65, s65, s34
  v_mfma_f32_16x16x32_bf16 v[140:143], a[88:91], a[208:211], v[140:143]
  s_add_u32 s65, s65, 41943040
  s_lshl_b32 s34, s3, 8
  v_mfma_f32_16x16x32_bf16 v[140:143], a[120:123], a[216:219], v[140:143]
  ds_read_b128 a[248:251], v8 offset:16384
  s_add_u32 s65, s65, s34
  v_mfma_f32_16x16x32_bf16 v[140:143], a[124:127], a[220:223], v[140:143]
  ds_read_b128 a[252:255], v9 offset:16384
  s_add_u32 s34, s65, 1024
  v_mfma_f32_16x16x32_bf16 v[136:139], a[116:119], a[220:223], v[136:139]
  s_waitcnt vmcnt(8)
  ds_read_b64_tr_b16 v[224:225], v2 offset:16384
  s_add_u32 s35, s65, 7168
  v_mfma_f32_16x16x32_bf16 v[136:139], a[112:115], a[216:219], v[136:139]
  ds_read_b64_tr_b16 v[226:227], v2 offset:18432
  s_cmp_lt_u32 s3, 2
  s_cselect_b32 s12, s34, s35
  s_cselect_b32 s13, s35, s34
  v_mfma_f32_16x16x32_bf16 v[132:135], a[104:107], a[216:219], v[132:135]
  ds_read_b64_tr_b16 v[232:233], v3 offset:16384
  s_mov_b32 s19, s35
  v_mfma_f32_16x16x32_bf16 v[132:135], a[108:111], a[220:223], v[132:135]
  ds_read_b64_tr_b16 v[234:235], v3 offset:18432
  v_lshrrev_b32 v14, 3, v1
  v_mfma_f32_16x16x32_bf16 v[128:131], a[100:103], a[220:223], v[128:131]
  ds_read_b64_tr_b16 v[240:241], v4 offset:16384
  v_mul_u32_u24 v14, 3584, v14
  v_mfma_f32_16x16x32_bf16 v[128:131], a[96:99], a[216:219], v[128:131]
  ds_read_b64_tr_b16 v[242:243], v4 offset:18432
  v_and_b32 v15, 1, v1
  v_mfma_f32_16x16x32_bf16 v[128:131], a[128:131], a[224:227], v[128:131]
  s_add_u32 m0, s26, 0
  ds_read_b64_tr_b16 v[248:249], v5 offset:16384
  v_mfma_f32_16x16x32_bf16 v[128:131], a[132:135], a[228:231], v[128:131]
  s_add_u32 s27, s28, 131200
  ds_read_b64_tr_b16 v[250:251], v5 offset:18432
  v_mfma_f32_16x16x32_bf16 v[132:135], a[140:143], a[228:231], v[132:135]
  s_waitcnt lgkmcnt(9)
  buffer_load_dwordx4 v10, s[40:43], s27 offen offset:0 lds
  v_mfma_f32_16x16x32_bf16 v[132:135], a[136:139], a[224:227], v[132:135]
  ds_read_b64_tr_b16 v[228:229], v2 offset:20480
  v_lshl_add_u32 v14, v15, 4, v14
  v_mfma_f32_16x16x32_bf16 v[136:139], a[144:147], a[224:227], v[136:139]
  ds_read_b64_tr_b16 v[230:231], v2 offset:22528
  v_bfe_u32 v15, v1, 1, 2
  v_mfma_f32_16x16x32_bf16 v[136:139], a[148:151], a[228:231], v[136:139]
  ds_read_b64_tr_b16 v[236:237], v3 offset:20480
  v_bfe_u32 v16, v1, 4, 1
  v_mfma_f32_16x16x32_bf16 v[140:143], a[156:159], a[228:231], v[140:143]
  buffer_load_dwordx4 v11, s[40:43], s27 offen offset:1024 lds
  v_mfma_f32_16x16x32_bf16 v[140:143], a[152:155], a[224:227], v[140:143]
  ds_read_b64_tr_b16 v[238:239], v3 offset:22528
  v_xor_b32 v15, v15, v16
  v_mfma_f32_16x16x32_bf16 v[140:143], a[184:187], a[232:235], v[140:143]
  ds_read_b64_tr_b16 v[244:245], v4 offset:20480
  v_xor_b32 v16, 0, v15
  v_mfma_f32_16x16x32_bf16 v[140:143], a[188:191], a[236:239], v[140:143]
  ds_read_b64_tr_b16 v[246:247], v4 offset:22528
  v_lshl_add_u32 v16, v16, 5, v14
  v_mfma_f32_16x16x32_bf16 v[136:139], a[180:183], a[236:239], v[136:139]
  buffer_load_dwordx4 v12, s[40:43], s27 offen offset:2048 lds
  v_mfma_f32_16x16x32_bf16 v[136:139], a[176:179], a[232:235], v[136:139]
  ds_read_b64_tr_b16 v[252:253], v5 offset:20480
  v_add_u32 v21, 0, v16
  v_mfma_f32_16x16x32_bf16 v[132:135], a[168:171], a[232:235], v[132:135]
  ds_read_b64_tr_b16 v[254:255], v5 offset:22528
  v_xor_b32 v16, 2, v15
  v_mfma_f32_16x16x32_bf16 v[132:135], a[172:175], a[236:239], v[132:135]
  ds_read_b128 a[192:195], v6 offset:16640
  v_lshl_add_u32 v16, v16, 5, v14
  v_mfma_f32_16x16x32_bf16 v[128:131], a[164:167], a[236:239], v[128:131]
  buffer_load_dwordx4 v13, s[40:43], s27 offen offset:3072 lds
  s_waitcnt vmcnt(4)
  v_mfma_f32_16x16x32_bf16 v[128:131], a[160:163], a[232:235], v[128:131]
  ds_read_b64_tr_b16 v[96:97], v2 offset:8192
  v_add_u32 v22, 27648, v16
  v_mfma_f32_16x16x32_bf16 v[144:147], a[0:3], a[240:243], 0
  s_add_u32 m0, s26, 4096
  ds_read_b64_tr_b16 v[98:99], v2 offset:10240
  v_mfma_f32_16x16x32_bf16 v[144:147], a[4:7], a[244:247], v[144:147]
  s_add_u32 s27, s28, 163968
  ds_read_b64_tr_b16 v[104:105], v3 offset:8192
  v_mfma_f32_16x16x32_bf16 v[148:151], a[12:15], a[244:247], 0
  buffer_load_dwordx4 v10, s[40:43], s27 offen offset:0 lds
  v_mfma_f32_16x16x32_bf16 v[148:151], a[8:11], a[240:243], v[148:151]
  ds_read_b64_tr_b16 v[106:107], v3 offset:10240
  v_xor_b32 v16, 0, v15
  v_mfma_f32_16x16x32_bf16 v[152:155], a[16:19], a[240:243], 0
  ds_read_b64_tr_b16 v[112:113], v4 offset:8192
  v_lshl_add_u32 v16, v16, 5, v14
  v_mfma_f32_16x16x32_bf16 v[152:155], a[20:23], a[244:247], v[152:155]
  ds_read_b128 a[196:199], v7 offset:16640
  v_add_u32 v23, 55296, v16
  v_mfma_f32_16x16x32_bf16 v[156:159], a[28:31], a[244:247], 0
  ds_read_b64_tr_b16 v[114:115], v4 offset:10240
  v_xor_b32 v16, 2, v15
  v_mfma_f32_16x16x32_bf16 v[156:159], a[24:27], a[240:243], v[156:159]
  buffer_load_dwordx4 v11, s[40:43], s27 offen offset:1024 lds
  v_mfma_f32_16x16x32_bf16 v[156:159], a[56:59], a[248:251], v[156:159]
  ds_read_b64_tr_b16 v[120:121], v5 offset:8192
  v_lshl_add_u32 v16, v16, 5, v14
  v_mfma_f32_16x16x32_bf16 v[156:159], a[60:63], a[252:255], v[156:159]
  ds_read_b64_tr_b16 v[122:123], v5 offset:10240
  v_add_u32 v24, 82944, v16
  v_mfma_f32_16x16x32_bf16 v[152:155], a[52:55], a[252:255], v[152:155]
  ds_read_b64_tr_b16 v[100:101], v2 offset:12288
  s_lshl_b32 s60, s32, 9
  v_mfma_f32_16x16x32_bf16 v[152:155], a[48:51], a[248:251], v[152:155]
  buffer_load_dwordx4 v12, s[40:43], s27 offen offset:2048 lds
  s_lshl_b32 s34, s3, 7
  v_mfma_f32_16x16x32_bf16 v[148:151], a[40:43], a[248:251], v[148:151]
  ds_read_b64_tr_b16 v[102:103], v2 offset:14336
  s_add_u32 s60, s60, s34
  v_mfma_f32_16x16x32_bf16 v[148:151], a[44:47], a[252:255], v[148:151]
  ds_read_b64_tr_b16 v[108:109], v3 offset:12288
  s_lshl_b32 s61, s71, 7
  v_mfma_f32_16x16x32_bf16 v[144:147], a[36:39], a[252:255], v[144:147]
  ds_read_b64_tr_b16 v[110:111], v3 offset:14336
  s_lshl_b32 s34, s3, 16
  v_mfma_f32_16x16x32_bf16 v[144:147], a[32:35], a[248:251], v[144:147]
  buffer_load_dwordx4 v13, s[40:43], s27 offen offset:3072 lds
  ds_read_b128 a[200:203], v8 offset:16640
  ds_read_b128 a[204:207], v9 offset:16640
  v_mfma_f32_16x16x32_bf16 v[144:147], a[64:67], a[192:195], v[144:147]
  ds_read_b64_tr_b16 v[116:117], v4 offset:12288
  s_add_u32 s61, s61, s34
  s_waitcnt lgkmcnt(9)
  v_mfma_f32_16x16x32_bf16 v[144:147], a[68:71], a[196:199], v[144:147]
  s_add_u32 m0, s26, 16384
  ds_read_b64_tr_b16 v[118:119], v4 offset:14336
  v_mfma_f32_16x16x32_bf16 v[148:151], a[76:79], a[196:199], v[148:151]
  s_add_u32 s27, s28, 196736
  ds_read_b64_tr_b16 v[124:125], v5 offset:12288
  v_mfma_f32_16x16x32_bf16 v[148:151], a[72:75], a[192:195], v[148:151]
  buffer_load_dwordx4 v10, s[40:43], s27 offen offset:0 lds
  s_lshl_b32 s63, s31, 19
  v_mfma_f32_16x16x32_bf16 v[152:155], a[80:83], a[192:195], v[152:155]
  ds_read_b64_tr_b16 v[126:127], v5 offset:14336
  s_bfe_u32 s34, s62, 0x2000e
  v_mfma_f32_16x16x32_bf16 v[152:155], a[84:87], a[196:199], v[152:155]
  ds_read_b128 a[208:211], v6 offset:16896
  s_lshl_b32 s34, s34, 13
  v_mfma_f32_16x16x32_bf16 v[156:159], a[92:95], a[196:199], v[156:159]
  ds_read_b128 a[212:215], v7 offset:16896
  s_add_u32 s63, s63, s34
  v_mfma_f32_16x16x32_bf16 v[156:159], a[88:91], a[192:195], v[156:159]
  buffer_load_dwordx4 v11, s[40:43], s27 offen offset:1024 lds
  s_bfe_u32 s34, s62, 0x4000a
  s_waitcnt lgkmcnt(7)
  v_mfma_f32_16x16x32_bf16 v[156:159], a[120:123], a[200:203], v[156:159]
  ds_read_b128 a[216:219], v8 offset:16896
  s_lshl_b32 s34, s34, 6
  s_waitcnt lgkmcnt(7)
  v_mfma_f32_16x16x32_bf16 v[156:159], a[124:127], a[204:207], v[156:159]
  ds_read_b128 a[220:223], v9 offset:16896
  s_add_u32 s63, s63, s34
  v_mfma_f32_16x16x32_bf16 v[152:155], a[116:119], a[204:207], v[152:155]
  ds_read_b128 a[224:227], v6 offset:768
  s_add_u32 s63, s63, 1048576
  v_mfma_f32_16x16x32_bf16 v[152:155], a[112:115], a[200:203], v[152:155]
  ds_read_b128 a[228:231], v7 offset:768
  v_lshrrev_b32 v14, 5, v1
  v_mfma_f32_16x16x32_bf16 v[148:151], a[104:107], a[200:203], v[148:151]
  buffer_load_dwordx4 v12, s[40:43], s27 offen offset:2048 lds
  s_waitcnt lgkmcnt(5)
  v_mfma_f32_16x16x32_bf16 v[148:151], a[108:111], a[204:207], v[148:151]
  ds_read_b128 a[232:235], v8 offset:768
  v_bfe_u32 v15, v1, 2, 3
  v_mfma_f32_16x16x32_bf16 v[144:147], a[100:103], a[204:207], v[144:147]
  ds_read_b128 a[236:239], v9 offset:768
  v_lshlrev_b32 v15, 10, v15
  v_mfma_f32_16x16x32_bf16 v[144:147], a[96:99], a[200:203], v[144:147]
  v_lshl_add_u32 v15, v14, 6, v15
  v_and_b32 v16, 3, v1
  v_mfma_f32_16x16x32_bf16 v[144:147], a[128:131], a[208:211], v[144:147]
  buffer_load_dwordx4 v13, s[40:43], s27 offen offset:3072 lds
  s_waitcnt lgkmcnt(4)
  v_mfma_f32_16x16x32_bf16 v[144:147], a[132:135], a[212:215], v[144:147]
  ds_read_b128 a[240:243], v6 offset:17152
  v_lshl_add_u32 v25, v16, 4, v15
  v_mfma_f32_16x16x32_bf16 v[148:151], a[140:143], a[212:215], v[148:151]
  s_add_u32 m0, s26, 20480
  ds_read_b128 a[244:247], v7 offset:17152
  v_mfma_f32_16x16x32_bf16 v[148:151], a[136:139], a[208:211], v[148:151]
  s_add_u32 s27, s28, 229504
  s_lshl_b32 s69, s31, 13
  v_mfma_f32_16x16x32_bf16 v[152:155], a[144:147], a[208:211], v[152:155]
  buffer_load_dwordx4 v10, s[40:43], s27 offen offset:0 lds
  s_lshl_b32 s34, s3, 8
  v_mfma_f32_16x16x32_bf16 v[152:155], a[148:151], a[212:215], v[152:155]
  s_add_u32 s69, s69, s34
  s_add_u32 s69, s69, 41943040
  v_mfma_f32_16x16x32_bf16 v[156:159], a[156:159], a[212:215], v[156:159]
  s_add_u32 s14, s20, s69
  s_addc_u32 s15, s21, 0
  v_mfma_f32_16x16x32_bf16 v[156:159], a[152:155], a[208:211], v[156:159]
  s_mov_b32 s16, s30
  s_mov_b32 s17, s30
  v_mfma_f32_16x16x32_bf16 v[156:159], a[184:187], a[216:219], v[156:159]
  buffer_load_dwordx4 v11, s[40:43], s27 offen offset:1024 lds
  s_cmp_eq_u32 s32, 7
  s_cselect_b32 s46, 0, s46
  v_mfma_f32_16x16x32_bf16 v[156:159], a[188:191], a[220:223], v[156:159]
  ds_read_b128 a[248:251], v8 offset:17152
  v_xor_b32 v30, s30, v65
  v_mfma_f32_16x16x32_bf16 v[152:155], a[180:183], a[220:223], v[152:155]
  ds_read_b128 a[252:255], v9 offset:17152
  v_bitop3_b32 v30, v30, v67, s30 bitop3:0xf6
  v_mfma_f32_16x16x32_bf16 v[152:155], a[176:179], a[216:219], v[152:155]
  v_bitop3_b32 v30, v30, v69, s30 bitop3:0xf6
  v_bitop3_b32 v30, v30, v71, s30 bitop3:0xf6
  v_mfma_f32_16x16x32_bf16 v[148:151], a[168:171], a[216:219], v[148:151]
  buffer_load_dwordx4 v12, s[40:43], s27 offen offset:2048 lds
  s_waitcnt lgkmcnt(2)
  v_mfma_f32_16x16x32_bf16 v[148:151], a[172:175], a[220:223], v[148:151]
  v_bitop3_b32 v30, v30, v73, s30 bitop3:0xf6
  v_bitop3_b32 v30, v30, v75, s30 bitop3:0xf6
  v_mfma_f32_16x16x32_bf16 v[144:147], a[164:167], a[220:223], v[144:147]
  v_bitop3_b32 v30, v30, v77, s30 bitop3:0xf6
  v_bitop3_b32 v30, v30, v79, s30 bitop3:0xf6
  v_mfma_f32_16x16x32_bf16 v[144:147], a[160:163], a[216:219], v[144:147]
  v_bitop3_b32 v30, v30, v81, s30 bitop3:0xf6
  v_bitop3_b32 v30, v30, v83, s30 bitop3:0xf6
  v_mfma_f32_16x16x32_bf16 v[128:131], v[192:195], a[224:227], v[128:131]
  ds_read_b128 a[192:195], v6 offset:32768
  v_bitop3_b32 v30, v30, v85, s30 bitop3:0xf6
  v_mfma_f32_16x16x32_bf16 v[128:131], v[196:199], a[228:231], v[128:131]
  buffer_load_dwordx4 v13, s[40:43], s27 offen offset:3072 lds
  v_mfma_f32_16x16x32_bf16 v[132:135], v[204:207], a[228:231], v[132:135]
  ds_read_b128 a[196:199], v7 offset:32768
  v_bitop3_b32 v30, v30, v87, s30 bitop3:0xf6
  v_mfma_f32_16x16x32_bf16 v[132:135], v[200:203], a[224:227], v[132:135]
  s_add_u32 m0, s26, 8192
  v_xor_b32 v30, s30, v30
  v_mfma_f32_16x16x32_bf16 v[136:139], v[208:211], a[224:227], v[136:139]
  s_add_u32 s27, s28, 262272
  v_mfma_f32_16x16x32_bf16 v[136:139], v[212:215], a[228:231], v[136:139]
  buffer_load_dwordx4 v10, s[40:43], s27 offen offset:0 lds
  v_mfma_f32_16x16x32_bf16 v[140:143], v[220:223], a[228:231], v[140:143]
  v_mfma_f32_16x16x32_bf16 v[140:143], v[216:219], a[224:227], v[140:143]
  v_mfma_f32_16x16x32_bf16 v[140:143], v[248:251], a[232:235], v[140:143]
  ds_read_b128 a[200:203], v8 offset:32768
  v_mfma_f32_16x16x32_bf16 v[140:143], v[252:255], a[236:239], v[140:143]
  buffer_load_dwordx4 v11, s[40:43], s27 offen offset:1024 lds
  v_mfma_f32_16x16x32_bf16 v[136:139], v[244:247], a[236:239], v[136:139]
  ds_read_b128 a[204:207], v9 offset:32768
  v_mfma_f32_16x16x32_bf16 v[136:139], v[240:243], a[232:235], v[136:139]
  v_mfma_f32_16x16x32_bf16 v[132:135], v[232:235], a[232:235], v[132:135]
  v_mfma_f32_16x16x32_bf16 v[132:135], v[236:239], a[236:239], v[132:135]
  buffer_load_dwordx4 v12, s[40:43], s27 offen offset:2048 lds
  v_mfma_f32_16x16x32_bf16 v[128:131], v[228:231], a[236:239], v[128:131]
  v_mfma_f32_16x16x32_bf16 v[128:131], v[224:227], a[232:235], v[128:131]
  v_mfma_f32_16x16x32_bf16 v[144:147], v[192:195], a[240:243], v[144:147]
  ds_read_b128 a[208:211], v6 offset:33024
  v_mfma_f32_16x16x32_bf16 v[144:147], v[196:199], a[244:247], v[144:147]
  buffer_load_dwordx4 v13, s[40:43], s27 offen offset:3072 lds
  v_mfma_f32_16x16x32_bf16 v[148:151], v[204:207], a[244:247], v[148:151]
  ds_read_b128 a[212:215], v7 offset:33024
  s_waitcnt lgkmcnt(2)
  v_mfma_f32_16x16x32_bf16 v[148:151], v[200:203], a[240:243], v[148:151]
  v_cvt_pk_bf16_f32 v128, v128, v129
  v_cvt_pk_bf16_f32 v129, v130, v131
  v_mfma_f32_16x16x32_bf16 v[152:155], v[208:211], a[240:243], v[152:155]
  s_add_u32 m0, s26, 12288
  v_cvt_pk_bf16_f32 v130, v132, v133
  v_mfma_f32_16x16x32_bf16 v[152:155], v[212:215], a[244:247], v[152:155]
  s_add_u32 s27, s28, 295040
  v_cvt_pk_bf16_f32 v131, v134, v135
  v_mfma_f32_16x16x32_bf16 v[156:159], v[220:223], a[244:247], v[156:159]
  buffer_load_dwordx4 v10, s[40:43], s27 offen offset:0 lds
  s_add_u32 s57, s56, 0
  v_mfma_f32_16x16x32_bf16 v[156:159], v[216:219], a[240:243], v[156:159]
  v_permlane16_swap_b32 v128, v130
  v_mfma_f32_16x16x32_bf16 v[156:159], v[248:251], a[248:251], v[156:159]
  v_permlane16_swap_b32 v129, v131
  v_mfma_f32_16x16x32_bf16 v[156:159], v[252:255], a[252:255], v[156:159]
  ds_read_b128 a[216:219], v8 offset:33024
  v_mfma_f32_16x16x32_bf16 v[152:155], v[244:247], a[252:255], v[152:155]
  buffer_load_dwordx4 v11, s[40:43], s27 offen offset:1024 lds
  v_mfma_f32_16x16x32_bf16 v[152:155], v[240:243], a[248:251], v[152:155]
  ds_read_b128 a[220:223], v9 offset:33024
  v_mfma_f32_16x16x32_bf16 v[148:151], v[232:235], a[248:251], v[148:151]
  v_mfma_f32_16x16x32_bf16 v[148:151], v[236:239], a[252:255], v[148:151]
  v_mfma_f32_16x16x32_bf16 v[144:147], v[228:231], a[252:255], v[144:147]
  buffer_load_dwordx4 v12, s[40:43], s27 offen offset:2048 lds
  v_mfma_f32_16x16x32_bf16 v[144:147], v[224:227], a[248:251], v[144:147]
  v_mfma_f32_16x16x32_bf16 v[160:163], a[0:3], a[192:195], 0
  ds_read_b128 a[224:227], v6 offset:33280
  v_mfma_f32_16x16x32_bf16 v[160:163], a[4:7], a[196:199], v[160:163]
  ds_read_b128 a[228:231], v7 offset:33280
  v_mfma_f32_16x16x32_bf16 v[164:167], a[12:15], a[196:199], 0
  buffer_load_dwordx4 v13, s[40:43], s27 offen offset:3072 lds
  v_mfma_f32_16x16x32_bf16 v[164:167], a[8:11], a[192:195], v[164:167]
  v_mfma_f32_16x16x32_bf16 v[168:171], a[16:19], a[192:195], 0
  v_mfma_f32_16x16x32_bf16 v[168:171], a[20:23], a[196:199], v[168:171]
  v_mfma_f32_16x16x32_bf16 v[172:175], a[28:31], a[196:199], 0
  buffer_store_dwordx4 v[128:131], v20, s[20:23], s57 offen offset:0 sc1
  v_mfma_f32_16x16x32_bf16 v[172:175], a[24:27], a[192:195], v[172:175]
  v_cvt_pk_bf16_f32 v136, v136, v137
  v_cvt_pk_bf16_f32 v137, v138, v139
  v_mfma_f32_16x16x32_bf16 v[172:175], a[56:59], a[200:203], v[172:175]
  v_cvt_pk_bf16_f32 v138, v140, v141
  v_cvt_pk_bf16_f32 v139, v142, v143
  v_mfma_f32_16x16x32_bf16 v[172:175], a[60:63], a[204:207], v[172:175]
  s_add_u32 s57, s56, 0
  ds_read_b128 a[232:235], v8 offset:33280
  v_mfma_f32_16x16x32_bf16 v[168:171], a[52:55], a[204:207], v[168:171]
  v_permlane16_swap_b32 v136, v138
  v_mfma_f32_16x16x32_bf16 v[168:171], a[48:51], a[200:203], v[168:171]
  v_permlane16_swap_b32 v137, v139
L_page10:
  s_cmp_eq_u32 s100, 1
  s_cbranch_scc1 L_pgretX
  v_mfma_f32_16x16x32_bf16 v[164:167], a[40:43], a[200:203], v[164:167]
  ds_read_b128 a[236:239], v9 offset:33280
  v_mfma_f32_16x16x32_bf16 v[164:167], a[44:47], a[204:207], v[164:167]
  v_mfma_f32_16x16x32_bf16 v[160:163], a[36:39], a[204:207], v[160:163]
  v_mfma_f32_16x16x32_bf16 v[160:163], a[32:35], a[200:203], v[160:163]
  s_waitcnt lgkmcnt(2)
  v_mfma_f32_16x16x32_bf16 v[160:163], a[64:67], a[208:211], v[160:163]
  ds_read_b128 a[240:243], v6 offset:33536
  v_mfma_f32_16x16x32_bf16 v[160:163], a[68:71], a[212:215], v[160:163]
  ds_read_b128 a[244:247], v7 offset:33536
  v_mfma_f32_16x16x32_bf16 v[164:167], a[76:79], a[212:215], v[164:167]
  v_mfma_f32_16x16x32_bf16 v[164:167], a[72:75], a[208:211], v[164:167]
  v_mfma_f32_16x16x32_bf16 v[168:171], a[80:83], a[208:211], v[168:171]
  buffer_store_dwordx4 v[136:139], v20, s[20:23], s57 offen offset:1024 sc1
  v_mfma_f32_16x16x32_bf16 v[168:171], a[84:87], a[212:215], v[168:171]
  v_cvt_pk_bf16_f32 v144, v144, v145
  v_cvt_pk_bf16_f32 v145, v146, v147
  v_mfma_f32_16x16x32_bf16 v[172:175], a[92:95], a[212:215], v[172:175]
  v_cvt_pk_bf16_f32 v146, v148, v149
  v_cvt_pk_bf16_f32 v147, v150, v151
  v_mfma_f32_16x16x32_bf16 v[172:175], a[88:91], a[208:211], v[172:175]
  s_add_u32 s57, s56, 8192
  v_mfma_f32_16x16x32_bf16 v[172:175], a[120:123], a[216:219], v[172:175]
  v_permlane16_swap_b32 v144, v146
  v_mfma_f32_16x16x32_bf16 v[172:175], a[124:127], a[220:223], v[172:175]
  v_permlane16_swap_b32 v145, v147
  v_mfma_f32_16x16x32_bf16 v[168:171], a[116:119], a[220:223], v[168:171]
  ds_read_b128 a[248:251], v8 offset:33536
  v_mfma_f32_16x16x32_bf16 v[168:171], a[112:115], a[216:219], v[168:171]
  ds_read_b128 a[252:255], v9 offset:33536
  v_mfma_f32_16x16x32_bf16 v[164:167], a[104:107], a[216:219], v[164:167]
  v_mfma_f32_16x16x32_bf16 v[164:167], a[108:111], a[220:223], v[164:167]
  v_mfma_f32_16x16x32_bf16 v[160:163], a[100:103], a[220:223], v[160:163]
  v_mfma_f32_16x16x32_bf16 v[160:163], a[96:99], a[216:219], v[160:163]
  v_mfma_f32_16x16x32_bf16 v[160:163], a[128:131], a[224:227], v[160:163]
  ds_read_b128 a[192:195], v6 offset:49152
  v_mfma_f32_16x16x32_bf16 v[160:163], a[132:135], a[228:231], v[160:163]
  ds_read_b128 a[196:199], v7 offset:49152
  v_mfma_f32_16x16x32_bf16 v[164:167], a[140:143], a[228:231], v[164:167]
  buffer_store_dwordx4 v[144:147], v20, s[20:23], s57 offen offset:0 sc1
  v_mfma_f32_16x16x32_bf16 v[164:167], a[136:139], a[224:227], v[164:167]
  v_cvt_pk_bf16_f32 v152, v152, v153
  v_cvt_pk_bf16_f32 v153, v154, v155
  v_mfma_f32_16x16x32_bf16 v[168:171], a[144:147], a[224:227], v[168:171]
  v_cvt_pk_bf16_f32 v154, v156, v157
  v_cvt_pk_bf16_f32 v155, v158, v159
  v_mfma_f32_16x16x32_bf16 v[168:171], a[148:151], a[228:231], v[168:171]
  s_add_u32 s57, s56, 8192
  s_waitcnt lgkmcnt(2)
  v_mfma_f32_16x16x32_bf16 v[172:175], a[156:159], a[228:231], v[172:175]
  v_permlane16_swap_b32 v152, v154
  v_mfma_f32_16x16x32_bf16 v[172:175], a[152:155], a[224:227], v[172:175]
  v_permlane16_swap_b32 v153, v155
  v_mfma_f32_16x16x32_bf16 v[172:175], a[184:187], a[232:235], v[172:175]
  ds_read_b128 a[200:203], v8 offset:49152
  v_mfma_f32_16x16x32_bf16 v[172:175], a[188:191], a[236:239], v[172:175]
  ds_read_b128 a[204:207], v9 offset:49152
  v_mfma_f32_16x16x32_bf16 v[168:171], a[180:183], a[236:239], v[168:171]
  v_mfma_f32_16x16x32_bf16 v[168:171], a[176:179], a[232:235], v[168:171]
  v_mfma_f32_16x16x32_bf16 v[164:167], a[168:171], a[232:235], v[164:167]
  v_mfma_f32_16x16x32_bf16 v[164:167], a[172:175], a[236:239], v[164:167]
  v_mfma_f32_16x16x32_bf16 v[160:163], a[164:167], a[236:239], v[160:163]
  v_mfma_f32_16x16x32_bf16 v[160:163], a[160:163], a[232:235], v[160:163]
  v_mfma_f32_16x16x32_bf16 v[160:163], v[192:195], a[240:243], v[160:163]
  buffer_store_dwordx4 v[152:155], v20, s[20:23], s57 offen offset:1024 sc1
  v_mfma_f32_16x16x32_bf16 v[160:163], v[196:199], a[244:247], v[160:163]
  ds_read_b128 a[208:211], v6 offset:49408
  v_mfma_f32_16x16x32_bf16 v[164:167], v[204:207], a[244:247], v[164:167]
  ds_read_b128 a[212:215], v7 offset:49408
  v_mfma_f32_16x16x32_bf16 v[164:167], v[200:203], a[240:243], v[164:167]
  v_mfma_f32_16x16x32_bf16 v[168:171], v[208:211], a[240:243], v[168:171]
  v_mfma_f32_16x16x32_bf16 v[168:171], v[212:215], a[244:247], v[168:171]
  v_mfma_f32_16x16x32_bf16 v[172:175], v[220:223], a[244:247], v[172:175]
  v_mfma_f32_16x16x32_bf16 v[172:175], v[216:219], a[240:243], v[172:175]
  v_mfma_f32_16x16x32_bf16 v[172:175], v[248:251], a[248:251], v[172:175]
  ds_read_b128 a[216:219], v8 offset:49408
  v_mfma_f32_16x16x32_bf16 v[172:175], v[252:255], a[252:255], v[172:175]
  ds_read_b128 a[220:223], v9 offset:49408
  v_mfma_f32_16x16x32_bf16 v[168:171], v[244:247], a[252:255], v[168:171]
  v_mfma_f32_16x16x32_bf16 v[168:171], v[240:243], a[248:251], v[168:171]
  v_mfma_f32_16x16x32_bf16 v[164:167], v[232:235], a[248:251], v[164:167]
  v_mfma_f32_16x16x32_bf16 v[164:167], v[236:239], a[252:255], v[164:167]
  v_mfma_f32_16x16x32_bf16 v[160:163], v[228:231], a[252:255], v[160:163]
  v_mfma_f32_16x16x32_bf16 v[160:163], v[224:227], a[248:251], v[160:163]
  s_waitcnt lgkmcnt(2)
  v_mfma_f32_16x16x32_bf16 v[176:179], a[0:3], a[192:195], 0
  ds_read_b128 a[224:227], v6 offset:49664
  v_mfma_f32_16x16x32_bf16 v[176:179], a[4:7], a[196:199], v[176:179]
  ds_read_b128 a[228:231], v7 offset:49664
  v_mfma_f32_16x16x32_bf16 v[180:183], a[12:15], a[196:199], 0
  v_mfma_f32_16x16x32_bf16 v[180:183], a[8:11], a[192:195], v[180:183]
  s_nop 0
  v_cvt_pk_bf16_f32 v160, v160, v161
  v_cvt_pk_bf16_f32 v161, v162, v163
  v_mfma_f32_16x16x32_bf16 v[184:187], a[16:19], a[192:195], 0
  v_cvt_pk_bf16_f32 v162, v164, v165
  v_cvt_pk_bf16_f32 v163, v166, v167
  v_mfma_f32_16x16x32_bf16 v[184:187], a[20:23], a[196:199], v[184:187]
  s_add_u32 s57, s56, 16384
  v_mfma_f32_16x16x32_bf16 v[188:191], a[28:31], a[196:199], 0
  v_permlane16_swap_b32 v160, v162
  v_mfma_f32_16x16x32_bf16 v[188:191], a[24:27], a[192:195], v[188:191]
  s_waitcnt vmcnt(10)
  ds_read_b64_tr_b16 a[0:1], v2 offset:0
  v_mfma_f32_16x16x32_bf16 v[188:191], a[56:59], a[200:203], v[188:191]
  v_permlane16_swap_b32 v161, v163
  v_mfma_f32_16x16x32_bf16 v[188:191], a[60:63], a[204:207], v[188:191]
  ds_read_b64_tr_b16 a[2:3], v2 offset:2048
  v_mfma_f32_16x16x32_bf16 v[184:187], a[52:55], a[204:207], v[184:187]
  ds_read_b64_tr_b16 a[8:9], v3 offset:0
  v_mfma_f32_16x16x32_bf16 v[184:187], a[48:51], a[200:203], v[184:187]
  buffer_store_dwordx4 v[160:163], v20, s[20:23], s57 offen offset:0 sc1
  v_mfma_f32_16x16x32_bf16 v[180:183], a[40:43], a[200:203], v[180:183]
  ds_read_b64_tr_b16 a[10:11], v3 offset:2048
  v_cvt_pk_bf16_f32 v168, v168, v169
  v_mfma_f32_16x16x32_bf16 v[180:183], a[44:47], a[204:207], v[180:183]
  ds_read_b64_tr_b16 a[16:17], v4 offset:0
  v_cvt_pk_bf16_f32 v169, v170, v171
  v_mfma_f32_16x16x32_bf16 v[176:179], a[36:39], a[204:207], v[176:179]
  ds_read_b64_tr_b16 a[18:19], v4 offset:2048
  v_cvt_pk_bf16_f32 v170, v172, v173
  v_mfma_f32_16x16x32_bf16 v[176:179], a[32:35], a[200:203], v[176:179]
  ds_read_b64_tr_b16 a[24:25], v5 offset:0
  v_cvt_pk_bf16_f32 v171, v174, v175
  v_mfma_f32_16x16x32_bf16 v[176:179], a[64:67], a[208:211], v[176:179]
  ds_read_b64_tr_b16 a[26:27], v5 offset:2048
  s_add_u32 s57, s56, 16384
  v_mfma_f32_16x16x32_bf16 v[176:179], a[68:71], a[212:215], v[176:179]
  ds_read_b64_tr_b16 a[4:5], v2 offset:4096
  v_mfma_f32_16x16x32_bf16 v[180:183], a[76:79], a[212:215], v[180:183]
  v_permlane16_swap_b32 v168, v170
  v_mfma_f32_16x16x32_bf16 v[180:183], a[72:75], a[208:211], v[180:183]
  v_permlane16_swap_b32 v169, v171
  v_mfma_f32_16x16x32_bf16 v[184:187], a[80:83], a[208:211], v[184:187]
  ds_read_b64_tr_b16 a[6:7], v2 offset:6144
  v_mfma_f32_16x16x32_bf16 v[184:187], a[84:87], a[212:215], v[184:187]
  ds_read_b64_tr_b16 a[12:13], v3 offset:4096
  v_mfma_f32_16x16x32_bf16 v[188:191], a[92:95], a[212:215], v[188:191]
  ds_read_b64_tr_b16 a[14:15], v3 offset:6144
  v_mfma_f32_16x16x32_bf16 v[188:191], a[88:91], a[208:211], v[188:191]
  ds_read_b64_tr_b16 a[20:21], v4 offset:4096
  v_mfma_f32_16x16x32_bf16 v[188:191], a[120:123], a[216:219], v[188:191]
  ds_read_b128 a[232:235], v8 offset:49664
  v_mfma_f32_16x16x32_bf16 v[188:191], a[124:127], a[220:223], v[188:191]
  buffer_store_dwordx4 v[168:171], v20, s[20:23], s57 offen offset:1024 sc1
  v_mfma_f32_16x16x32_bf16 v[184:187], a[116:119], a[220:223], v[184:187]
  ds_read_b128 a[236:239], v9 offset:49664
  v_mfma_f32_16x16x32_bf16 v[184:187], a[112:115], a[216:219], v[184:187]
  ds_read_b64_tr_b16 a[22:23], v4 offset:6144
  v_mfma_f32_16x16x32_bf16 v[180:183], a[104:107], a[216:219], v[180:183]
  ds_read_b64_tr_b16 a[28:29], v5 offset:4096
  v_mfma_f32_16x16x32_bf16 v[180:183], a[108:111], a[220:223], v[180:183]
  ds_read_b64_tr_b16 a[30:31], v5 offset:6144
  v_mfma_f32_16x16x32_bf16 v[176:179], a[100:103], a[220:223], v[176:179]
  ds_read_b128 a[240:243], v6 offset:49920
  v_mfma_f32_16x16x32_bf16 v[176:179], a[96:99], a[216:219], v[176:179]
  ds_read_b128 a[244:247], v7 offset:49920
  v_mfma_f32_16x16x32_bf16 v[176:179], a[128:131], a[224:227], v[176:179]
  s_bitcmp1_b32 3, s3
  s_cselect_b32 s18, s65, s19
  v_mfma_f32_16x16x32_bf16 v[176:179], a[132:135], a[228:231], v[176:179]
  ds_read_b64_tr_b16 a[32:33], v2 offset:16384
  v_mfma_f32_16x16x32_bf16 v[180:183], a[140:143], a[228:231], v[180:183]
  s_waitcnt vmcnt(2)
  s_barrier
  s_atomic_swap s30, s[20:21], s18
  v_mfma_f32_16x16x32_bf16 v[180:183], a[136:139], a[224:227], v[180:183]
  ds_read_b64_tr_b16 a[34:35], v2 offset:18432
  v_mfma_f32_16x16x32_bf16 v[184:187], a[144:147], a[224:227], v[184:187]
  ds_read_b64_tr_b16 a[40:41], v3 offset:16384
  v_mfma_f32_16x16x32_bf16 v[184:187], a[148:151], a[228:231], v[184:187]
  ds_read_b64_tr_b16 a[42:43], v3 offset:18432
  v_mfma_f32_16x16x32_bf16 v[188:191], a[156:159], a[228:231], v[188:191]
  ds_read_b64_tr_b16 a[48:49], v4 offset:16384
  s_waitcnt lgkmcnt(5)
  v_mfma_f32_16x16x32_bf16 v[188:191], a[152:155], a[224:227], v[188:191]
  s_add_u32 m0, s26, 0
  ds_read_b64_tr_b16 a[50:51], v4 offset:18432
  v_mfma_f32_16x16x32_bf16 v[188:191], a[184:187], a[232:235], v[188:191]
  s_add_u32 s27, s28, 327808
  ds_read_b64_tr_b16 a[56:57], v5 offset:16384
  v_mfma_f32_16x16x32_bf16 v[188:191], a[188:191], a[236:239], v[188:191]
  buffer_load_dwordx4 v10, s[40:43], s27 offen offset:0 lds
  v_mfma_f32_16x16x32_bf16 v[184:187], a[180:183], a[236:239], v[184:187]
  ds_read_b64_tr_b16 a[58:59], v5 offset:18432
  v_mfma_f32_16x16x32_bf16 v[184:187], a[176:179], a[232:235], v[184:187]
  ds_read_b64_tr_b16 a[36:37], v2 offset:20480
  v_mfma_f32_16x16x32_bf16 v[180:183], a[168:171], a[232:235], v[180:183]
  ds_read_b128 a[248:251], v8 offset:49920
  v_mfma_f32_16x16x32_bf16 v[180:183], a[172:175], a[236:239], v[180:183]
  buffer_load_dwordx4 v11, s[40:43], s27 offen offset:1024 lds
  v_mfma_f32_16x16x32_bf16 v[176:179], a[164:167], a[236:239], v[176:179]
  ds_read_b128 a[252:255], v9 offset:49920
  v_mfma_f32_16x16x32_bf16 v[176:179], a[160:163], a[232:235], v[176:179]
  ds_read_b64_tr_b16 a[38:39], v2 offset:22528
  v_mfma_f32_16x16x32_bf16 v[176:179], v[192:195], a[240:243], v[176:179]
  ds_read_b64_tr_b16 a[44:45], v3 offset:20480
  v_mfma_f32_16x16x32_bf16 v[176:179], v[196:199], a[244:247], v[176:179]
  buffer_load_dwordx4 v12, s[40:43], s27 offen offset:2048 lds
  v_mfma_f32_16x16x32_bf16 v[180:183], v[204:207], a[244:247], v[180:183]
  ds_read_b64_tr_b16 a[46:47], v3 offset:22528
  v_mfma_f32_16x16x32_bf16 v[180:183], v[200:203], a[240:243], v[180:183]
  ds_read_b64_tr_b16 a[52:53], v4 offset:20480
  v_mfma_f32_16x16x32_bf16 v[184:187], v[208:211], a[240:243], v[184:187]
  ds_read_b64_tr_b16 a[54:55], v4 offset:22528
  v_mfma_f32_16x16x32_bf16 v[184:187], v[212:215], a[244:247], v[184:187]
  buffer_load_dwordx4 v13, s[40:43], s27 offen offset:3072 lds
  v_mfma_f32_16x16x32_bf16 v[188:191], v[220:223], a[244:247], v[188:191]
  ds_read_b64_tr_b16 a[60:61], v5 offset:20480
  s_waitcnt lgkmcnt(5)
  v_mfma_f32_16x16x32_bf16 v[188:191], v[216:219], a[240:243], v[188:191]
  s_add_u32 m0, s26, 4096
  ds_read_b64_tr_b16 a[62:63], v5 offset:22528
  ds_read_b128 a[192:195], v6 offset:0
  ds_read_b128 a[196:199], v7 offset:0
  v_mfma_f32_16x16x32_bf16 v[188:191], v[248:251], a[248:251], v[188:191]
  s_add_u32 s27, s28, 360576
  ds_read_b64_tr_b16 a[64:65], v2 offset:8192
  v_mfma_f32_16x16x32_bf16 v[188:191], v[252:255], a[252:255], v[188:191]
  buffer_load_dwordx4 v10, s[40:43], s27 offen offset:0 lds
  ds_read_b64_tr_b16 a[66:67], v2 offset:10240
  v_mfma_f32_16x16x32_bf16 v[184:187], v[244:247], a[252:255], v[184:187]
  ds_read_b64_tr_b16 a[72:73], v3 offset:8192
  v_mfma_f32_16x16x32_bf16 v[184:187], v[240:243], a[248:251], v[184:187]
  ds_read_b64_tr_b16 a[74:75], v3 offset:10240
  v_mfma_f32_16x16x32_bf16 v[180:183], v[232:235], a[248:251], v[180:183]
  ds_read_b64_tr_b16 a[80:81], v4 offset:8192
  v_mfma_f32_16x16x32_bf16 v[180:183], v[236:239], a[252:255], v[180:183]
  buffer_load_dwordx4 v11, s[40:43], s27 offen offset:1024 lds
  v_mfma_f32_16x16x32_bf16 v[176:179], v[228:231], a[252:255], v[176:179]
  ds_read_b64_tr_b16 a[82:83], v4 offset:10240
  s_waitcnt lgkmcnt(6)
  v_mfma_f32_16x16x32_bf16 v[176:179], v[224:227], a[248:251], v[176:179]
  ds_read_b128 a[200:203], v6 offset:16384
  ds_read_b128 a[204:207], v7 offset:16384
  v_mfma_f32_16x16x32_bf16 v[192:195], v[32:35], a[192:195], 0
  ds_read_b64_tr_b16 a[88:89], v5 offset:8192
  v_mfma_f32_16x16x32_bf16 v[192:195], v[36:39], a[196:199], v[192:195]
  ds_read_b64_tr_b16 a[90:91], v5 offset:10240
  v_mfma_f32_16x16x32_bf16 v[196:199], v[44:47], a[196:199], 0
  buffer_load_dwordx4 v12, s[40:43], s27 offen offset:2048 lds
  ds_read_b64_tr_b16 a[68:69], v2 offset:12288
  v_mfma_f32_16x16x32_bf16 v[196:199], v[40:43], a[192:195], v[196:199]
  ds_read_b64_tr_b16 a[70:71], v2 offset:14336
  v_cvt_pk_bf16_f32 v176, v176, v177
  v_mfma_f32_16x16x32_bf16 v[200:203], v[48:51], a[192:195], 0
  ds_read_b64_tr_b16 a[76:77], v3 offset:12288
  v_cvt_pk_bf16_f32 v177, v178, v179
  v_mfma_f32_16x16x32_bf16 v[200:203], v[52:55], a[196:199], v[200:203]
  ds_read_b64_tr_b16 a[78:79], v3 offset:14336
  v_cvt_pk_bf16_f32 v178, v180, v181
  v_mfma_f32_16x16x32_bf16 v[204:207], v[60:63], a[196:199], 0
  buffer_load_dwordx4 v13, s[40:43], s27 offen offset:3072 lds
  s_waitcnt lgkmcnt(6)
  v_mfma_f32_16x16x32_bf16 v[204:207], v[56:59], a[192:195], v[204:207]
  ds_read_b128 a[208:211], v6 offset:32768
  ds_read_b128 a[212:215], v7 offset:32768
  v_mfma_f32_16x16x32_bf16 v[208:211], v[32:35], a[200:203], 0
  ds_read_b64_tr_b16 a[84:85], v4 offset:12288
  v_cvt_pk_bf16_f32 v179, v182, v183
  v_mfma_f32_16x16x32_bf16 v[208:211], v[36:39], a[204:207], v[208:211]
  s_bitcmp1_b32 4, s3
  s_cselect_b32 s18, s65, s19
  ds_read_b64_tr_b16 a[86:87], v4 offset:14336
  v_mfma_f32_16x16x32_bf16 v[212:215], v[44:47], a[204:207], 0
  ds_read_b64_tr_b16 a[92:93], v5 offset:12288
  s_add_u32 s57, s56, 24576
  v_mfma_f32_16x16x32_bf16 v[212:215], v[40:43], a[200:203], v[212:215]
  s_waitcnt vmcnt(8)
  s_barrier
  s_atomic_swap s30, s[20:21], s18
  v_permlane16_swap_b32 v176, v178
  v_permlane16_swap_b32 v177, v179
  v_mfma_f32_16x16x32_bf16 v[216:219], v[48:51], a[200:203], 0
  ds_read_b64_tr_b16 a[94:95], v5 offset:14336
  buffer_store_dwordx4 v[176:179], v20, s[20:23], s57 offen offset:0 sc1
  v_mfma_f32_16x16x32_bf16 v[216:219], v[52:55], a[204:207], v[216:219]
  ds_read_b128 a[216:219], v6 offset:49152
  v_cvt_pk_bf16_f32 v184, v184, v185
  v_mfma_f32_16x16x32_bf16 v[220:223], v[60:63], a[204:207], 0
  ds_read_b128 a[220:223], v7 offset:49152
  v_cvt_pk_bf16_f32 v185, v186, v187
  v_mfma_f32_16x16x32_bf16 v[220:223], v[56:59], a[200:203], v[220:223]
  ds_read_b128 a[224:227], v8 offset:0
  v_cvt_pk_bf16_f32 v186, v188, v189
  s_waitcnt lgkmcnt(8)
  v_mfma_f32_16x16x32_bf16 v[224:227], v[32:35], a[208:211], 0
  ds_read_b128 a[228:231], v9 offset:0
  v_cvt_pk_bf16_f32 v187, v190, v191
  s_waitcnt lgkmcnt(8)
  v_mfma_f32_16x16x32_bf16 v[224:227], v[36:39], a[212:215], v[224:227]
  s_add_u32 s57, s56, 24576
  ds_read_b128 a[232:235], v8 offset:16384
  v_mfma_f32_16x16x32_bf16 v[228:231], v[44:47], a[212:215], 0
  v_permlane16_swap_b32 v184, v186
  v_mfma_f32_16x16x32_bf16 v[228:231], v[40:43], a[208:211], v[228:231]
  v_permlane16_swap_b32 v185, v187
  v_mfma_f32_16x16x32_bf16 v[232:235], v[48:51], a[208:211], 0
  ds_read_b128 a[236:239], v9 offset:16384
  v_mfma_f32_16x16x32_bf16 v[232:235], v[52:55], a[212:215], v[232:235]
  ds_read_b128 a[240:243], v8 offset:32768
  v_mfma_f32_16x16x32_bf16 v[236:239], v[60:63], a[212:215], 0
  ds_read_b128 a[244:247], v9 offset:32768
  v_mfma_f32_16x16x32_bf16 v[236:239], v[56:59], a[208:211], v[236:239]
  s_waitcnt lgkmcnt(7)
  v_mfma_f32_16x16x32_bf16 v[240:243], v[32:35], a[216:219], 0
  ds_read_b128 a[248:251], v8 offset:49152
  s_waitcnt lgkmcnt(7)
  v_mfma_f32_16x16x32_bf16 v[240:243], v[36:39], a[220:223], v[240:243]
  buffer_store_dwordx4 v[184:187], v20, s[20:23], s57 offen offset:1024 sc1
  v_mfma_f32_16x16x32_bf16 v[244:247], v[44:47], a[220:223], 0
  ds_read_b128 a[252:255], v9 offset:49152
  v_mfma_f32_16x16x32_bf16 v[244:247], v[40:43], a[216:219], v[244:247]
  v_mfma_f32_16x16x32_bf16 v[248:251], v[48:51], a[216:219], 0
  v_mfma_f32_16x16x32_bf16 v[248:251], v[52:55], a[220:223], v[248:251]
  v_mfma_f32_16x16x32_bf16 v[252:255], v[60:63], a[220:223], 0
  v_mfma_f32_16x16x32_bf16 v[252:255], v[56:59], a[216:219], v[252:255]
  s_waitcnt lgkmcnt(4)
  v_mfma_f32_16x16x32_bf16 v[192:195], v[96:99], a[224:227], v[192:195]
  ds_read_b128 a[192:195], v6 offset:256
  v_mfma_f32_16x16x32_bf16 v[192:195], v[100:103], a[228:231], v[192:195]
  ds_read_b128 a[196:199], v7 offset:256
  v_mfma_f32_16x16x32_bf16 v[196:199], v[108:111], a[228:231], v[196:199]
  v_mfma_f32_16x16x32_bf16 v[196:199], v[104:107], a[224:227], v[196:199]
  v_mfma_f32_16x16x32_bf16 v[200:203], v[112:115], a[224:227], v[200:203]
  v_mfma_f32_16x16x32_bf16 v[200:203], v[116:119], a[228:231], v[200:203]
  s_add_u32 m0, s26, 16384
  v_mfma_f32_16x16x32_bf16 v[204:207], v[124:127], a[228:231], v[204:207]
  s_add_u32 s27, s28, 393344
  v_mfma_f32_16x16x32_bf16 v[204:207], v[120:123], a[224:227], v[204:207]
  buffer_load_dwordx4 v10, s[40:43], s27 offen offset:0 lds
  v_mfma_f32_16x16x32_bf16 v[208:211], v[96:99], a[232:235], v[208:211]
  s_waitcnt vmcnt(3)
  ds_read_b64_tr_b16 a[96:97], v2 offset:0
  v_mfma_f32_16x16x32_bf16 v[208:211], v[100:103], a[236:239], v[208:211]
  ds_read_b64_tr_b16 a[98:99], v2 offset:2048
  v_mfma_f32_16x16x32_bf16 v[212:215], v[108:111], a[236:239], v[212:215]
  ds_read_b64_tr_b16 a[104:105], v3 offset:0
  v_mfma_f32_16x16x32_bf16 v[212:215], v[104:107], a[232:235], v[212:215]
  buffer_load_dwordx4 v11, s[40:43], s27 offen offset:1024 lds
  v_mfma_f32_16x16x32_bf16 v[216:219], v[112:115], a[232:235], v[216:219]
  ds_read_b64_tr_b16 a[106:107], v3 offset:2048
  v_mfma_f32_16x16x32_bf16 v[216:219], v[116:119], a[236:239], v[216:219]
  ds_read_b64_tr_b16 a[112:113], v4 offset:0
  v_mfma_f32_16x16x32_bf16 v[220:223], v[124:127], a[236:239], v[220:223]
  ds_read_b64_tr_b16 a[114:115], v4 offset:2048
  v_mfma_f32_16x16x32_bf16 v[220:223], v[120:123], a[232:235], v[220:223]
  buffer_load_dwordx4 v12, s[40:43], s27 offen offset:2048 lds
  s_waitcnt lgkmcnt(6)
  v_mfma_f32_16x16x32_bf16 v[224:227], v[96:99], a[240:243], v[224:227]
  ds_read_b64_tr_b16 a[120:121], v5 offset:0
  v_mfma_f32_16x16x32_bf16 v[224:227], v[100:103], a[244:247], v[224:227]
  ds_read_b64_tr_b16 a[122:123], v5 offset:2048
  v_mfma_f32_16x16x32_bf16 v[228:231], v[108:111], a[244:247], v[228:231]
  ds_read_b64_tr_b16 a[100:101], v2 offset:4096
  v_mfma_f32_16x16x32_bf16 v[228:231], v[104:107], a[240:243], v[228:231]
  buffer_load_dwordx4 v13, s[40:43], s27 offen offset:3072 lds
  v_mfma_f32_16x16x32_bf16 v[232:235], v[112:115], a[240:243], v[232:235]
  ds_read_b64_tr_b16 a[102:103], v2 offset:6144
  v_mfma_f32_16x16x32_bf16 v[232:235], v[116:119], a[244:247], v[232:235]
  s_add_u32 m0, s26, 20480
  ds_read_b64_tr_b16 a[108:109], v3 offset:4096
  v_mfma_f32_16x16x32_bf16 v[236:239], v[124:127], a[244:247], v[236:239]
  s_add_u32 s27, s28, 426112
  ds_read_b64_tr_b16 a[110:111], v3 offset:6144
  v_mfma_f32_16x16x32_bf16 v[236:239], v[120:123], a[240:243], v[236:239]
  buffer_load_dwordx4 v10, s[40:43], s27 offen offset:0 lds
  v_mfma_f32_16x16x32_bf16 v[240:243], v[96:99], a[248:251], v[240:243]
  ds_read_b128 a[200:203], v6 offset:16640
  v_mfma_f32_16x16x32_bf16 v[240:243], v[100:103], a[252:255], v[240:243]
  ds_read_b128 a[204:207], v7 offset:16640
  v_mfma_f32_16x16x32_bf16 v[244:247], v[108:111], a[252:255], v[244:247]
  ds_read_b64_tr_b16 a[116:117], v4 offset:4096
  v_mfma_f32_16x16x32_bf16 v[244:247], v[104:107], a[248:251], v[244:247]
  buffer_load_dwordx4 v11, s[40:43], s27 offen offset:1024 lds
  v_mfma_f32_16x16x32_bf16 v[248:251], v[112:115], a[248:251], v[248:251]
  ds_read_b64_tr_b16 a[118:119], v4 offset:6144
  v_mfma_f32_16x16x32_bf16 v[248:251], v[116:119], a[252:255], v[248:251]
  ds_read_b64_tr_b16 a[124:125], v5 offset:4096
  v_mfma_f32_16x16x32_bf16 v[252:255], v[124:127], a[252:255], v[252:255]
  ds_read_b64_tr_b16 a[126:127], v5 offset:6144
  v_mfma_f32_16x16x32_bf16 v[252:255], v[120:123], a[248:251], v[252:255]
  ds_read_b128 a[208:211], v6 offset:33024
  v_mfma_f32_16x16x32_bf16 v[192:195], a[0:3], a[192:195], v[192:195]
  buffer_load_dwordx4 v12, s[40:43], s27 offen offset:2048 lds
  v_mfma_f32_16x16x32_bf16 v[192:195], a[4:7], a[196:199], v[192:195]
  ds_read_b128 a[212:215], v7 offset:33024
  v_mfma_f32_16x16x32_bf16 v[196:199], a[12:15], a[196:199], v[196:199]
  ds_read_b128 a[216:219], v6 offset:49408
  v_mfma_f32_16x16x32_bf16 v[196:199], a[8:11], a[192:195], v[196:199]
  ds_read_b128 a[220:223], v7 offset:49408
  v_mfma_f32_16x16x32_bf16 v[200:203], a[16:19], a[192:195], v[200:203]
  buffer_load_dwordx4 v13, s[40:43], s27 offen offset:3072 lds
  v_mfma_f32_16x16x32_bf16 v[200:203], a[20:23], a[196:199], v[200:203]
  ds_read_b128 a[224:227], v8 offset:256
  v_mfma_f32_16x16x32_bf16 v[204:207], a[28:31], a[196:199], v[204:207]
  s_add_u32 m0, s26, 8192
  ds_read_b128 a[228:231], v9 offset:256
  v_mfma_f32_16x16x32_bf16 v[204:207], a[24:27], a[192:195], v[204:207]
  s_add_u32 s27, s28, 458880
  s_waitcnt lgkmcnt(7)
  v_mfma_f32_16x16x32_bf16 v[208:211], a[0:3], a[200:203], v[208:211]
  buffer_load_dwordx4 v10, s[40:43], s27 offen offset:0 lds
  v_mfma_f32_16x16x32_bf16 v[208:211], a[4:7], a[204:207], v[208:211]
  s_bitcmp1_b32 8, s3
  s_cselect_b32 s18, s65, s19
  v_mfma_f32_16x16x32_bf16 v[212:215], a[12:15], a[204:207], v[212:215]
  ds_read_b128 a[232:235], v8 offset:16640
  v_mfma_f32_16x16x32_bf16 v[212:215], a[8:11], a[200:203], v[212:215]
  s_waitcnt vmcnt(9)
  s_barrier
  s_atomic_swap s30, s[20:21], s18
  v_mfma_f32_16x16x32_bf16 v[216:219], a[16:19], a[200:203], v[216:219]
  buffer_load_dwordx4 v11, s[40:43], s27 offen offset:1024 lds
  v_mfma_f32_16x16x32_bf16 v[216:219], a[20:23], a[204:207], v[216:219]
  ds_read_b128 a[236:239], v9 offset:16640
  v_mfma_f32_16x16x32_bf16 v[220:223], a[28:31], a[204:207], v[220:223]
  v_mfma_f32_16x16x32_bf16 v[220:223], a[24:27], a[200:203], v[220:223]
  v_cmp_ne_u32 vcc, s30, v30
  s_nop 1
  s_cbranch_vccnz L_gretry
L_gok:
  s_waitcnt lgkmcnt(3)
  v_mfma_f32_16x16x32_bf16 v[224:227], a[0:3], a[208:211], v[224:227]
  buffer_load_dwordx4 v12, s[40:43], s27 offen offset:2048 lds
  v_mfma_f32_16x16x32_bf16 v[224:227], a[4:7], a[212:215], v[224:227]
  ds_read_b128 a[240:243], v6 offset:512
  v_mov_b32 v65, v64
  v_mfma_f32_16x16x32_bf16 v[228:231], a[12:15], a[212:215], v[228:231]
  ds_read_b128 a[244:247], v7 offset:512
  v_mov_b32 v67, v66
  v_mfma_f32_16x16x32_bf16 v[228:231], a[8:11], a[208:211], v[228:231]
  v_mov_b32 v69, v68
  v_mov_b32 v71, v70
  v_mfma_f32_16x16x32_bf16 v[232:235], a[16:19], a[208:211], v[232:235]
  v_permlane32_swap_b32 v64, v65
  v_mfma_f32_16x16x32_bf16 v[232:235], a[20:23], a[212:215], v[232:235]
  buffer_load_dwordx4 v13, s[40:43], s27 offen offset:3072 lds
  v_mfma_f32_16x16x32_bf16 v[236:239], a[28:31], a[212:215], v[236:239]
  v_permlane32_swap_b32 v66, v67
  v_mfma_f32_16x16x32_bf16 v[236:239], a[24:27], a[208:211], v[236:239]
  s_add_u32 m0, s26, 12288
  v_mfma_f32_16x16x32_bf16 v[240:243], a[0:3], a[216:219], v[240:243]
  s_add_u32 s27, s28, 491648
  ds_read_b128 a[248:251], v6 offset:16896
  v_mfma_f32_16x16x32_bf16 v[240:243], a[4:7], a[220:223], v[240:243]
  buffer_load_dwordx4 v10, s[40:43], s27 offen offset:0 lds
  v_mfma_f32_16x16x32_bf16 v[244:247], a[12:15], a[220:223], v[244:247]
  ds_read_b128 a[252:255], v7 offset:16896
  v_mfma_f32_16x16x32_bf16 v[244:247], a[8:11], a[216:219], v[244:247]
  v_permlane32_swap_b32 v68, v69
  v_mfma_f32_16x16x32_bf16 v[248:251], a[16:19], a[216:219], v[248:251]
  v_permlane32_swap_b32 v70, v71
  v_mfma_f32_16x16x32_bf16 v[248:251], a[20:23], a[220:223], v[248:251]
  buffer_load_dwordx4 v11, s[40:43], s27 offen offset:1024 lds
  s_waitcnt lgkmcnt(3)
  v_mfma_f32_16x16x32_bf16 v[252:255], a[28:31], a[220:223], v[252:255]
  v_lshlrev_b32 v32, 16, v64
  v_and_b32 v33, s70, v64
  v_mfma_f32_16x16x32_bf16 v[252:255], a[24:27], a[216:219], v[252:255]
  v_lshlrev_b32 v34, 16, v66
  v_and_b32 v35, s70, v66
  v_mfma_f32_16x16x32_bf16 v[192:195], a[32:35], a[224:227], v[192:195]
  ds_read_b128 a[192:195], v8 offset:512
  v_lshlrev_b32 v36, 16, v68
  v_mfma_f32_16x16x32_bf16 v[192:195], a[36:39], a[228:231], v[192:195]
  buffer_load_dwordx4 v12, s[40:43], s27 offen offset:2048 lds
  v_mfma_f32_16x16x32_bf16 v[196:199], a[44:47], a[228:231], v[196:199]
  ds_read_b128 a[196:199], v9 offset:512
  v_and_b32 v37, s70, v68
  v_mfma_f32_16x16x32_bf16 v[196:199], a[40:43], a[224:227], v[196:199]
  v_lshlrev_b32 v38, 16, v70
  v_and_b32 v39, s70, v70
  v_mfma_f32_16x16x32_bf16 v[200:203], a[48:51], a[224:227], v[200:203]
  v_lshlrev_b32 v40, 16, v65
  v_and_b32 v41, s70, v65
  v_mfma_f32_16x16x32_bf16 v[200:203], a[52:55], a[228:231], v[200:203]
  buffer_load_dwordx4 v13, s[40:43], s27 offen offset:3072 lds
  v_mfma_f32_16x16x32_bf16 v[204:207], a[60:63], a[228:231], v[204:207]
  s_waitcnt vmcnt(8)
  ds_read_b64_tr_b16 a[128:129], v2 offset:16384
  v_lshlrev_b32 v42, 16, v67
  v_mfma_f32_16x16x32_bf16 v[204:207], a[56:59], a[224:227], v[204:207]
  ds_read_b64_tr_b16 a[130:131], v2 offset:18432
  v_and_b32 v43, s70, v67
  v_mfma_f32_16x16x32_bf16 v[208:211], a[32:35], a[232:235], v[208:211]
  s_add_u32 m0, s26, 0
  ds_read_b64_tr_b16 a[136:137], v3 offset:16384
  v_mfma_f32_16x16x32_bf16 v[208:211], a[36:39], a[236:239], v[208:211]
  s_add_u32 s27, s60, 0
  ds_read_b64_tr_b16 a[138:139], v3 offset:18432
  v_mfma_f32_16x16x32_bf16 v[212:215], a[44:47], a[236:239], v[212:215]
  buffer_load_dwordx4 v21, s[44:47], s27 offen offset:0 lds
  v_mfma_f32_16x16x32_bf16 v[212:215], a[40:43], a[232:235], v[212:215]
  ds_read_b64_tr_b16 a[144:145], v4 offset:16384
  v_lshlrev_b32 v44, 16, v69
  v_mfma_f32_16x16x32_bf16 v[216:219], a[48:51], a[232:235], v[216:219]
  ds_read_b64_tr_b16 a[146:147], v4 offset:18432
  v_and_b32 v45, s70, v69
  v_mfma_f32_16x16x32_bf16 v[216:219], a[52:55], a[236:239], v[216:219]
  ds_read_b64_tr_b16 a[152:153], v5 offset:16384
  v_lshlrev_b32 v46, 16, v71
  v_mfma_f32_16x16x32_bf16 v[220:223], a[60:63], a[236:239], v[220:223]
  buffer_load_dwordx4 v22, s[44:47], s27 offen offset:1024 lds
  s_waitcnt lgkmcnt(5)
  v_mfma_f32_16x16x32_bf16 v[220:223], a[56:59], a[232:235], v[220:223]
  ds_read_b64_tr_b16 a[154:155], v5 offset:18432
  v_and_b32 v47, s70, v71
  v_mfma_f32_16x16x32_bf16 v[192:195], a[64:67], a[240:243], v[192:195]
  s_load_dwordx8 s[4:11], s[14:15], 0 glc
  ds_read_b64_tr_b16 a[132:133], v2 offset:20480
  v_mfma_f32_16x16x32_bf16 v[192:195], a[68:71], a[244:247], v[192:195]
  ds_read_b64_tr_b16 a[134:135], v2 offset:22528
  v_mov_b32 v73, v72
  v_mfma_f32_16x16x32_bf16 v[196:199], a[76:79], a[244:247], v[196:199]
  buffer_load_dwordx4 v23, s[44:47], s27 offen offset:2048 lds
  v_mfma_f32_16x16x32_bf16 v[196:199], a[72:75], a[240:243], v[196:199]
  ds_read_b64_tr_b16 a[140:141], v3 offset:20480
  v_mov_b32 v75, v74
  v_mfma_f32_16x16x32_bf16 v[200:203], a[80:83], a[240:243], v[200:203]
  ds_read_b64_tr_b16 a[142:143], v3 offset:22528
  v_mov_b32 v77, v76
  v_mfma_f32_16x16x32_bf16 v[200:203], a[84:87], a[244:247], v[200:203]
  ds_read_b64_tr_b16 a[148:149], v4 offset:20480
  v_mov_b32 v79, v78
  v_mfma_f32_16x16x32_bf16 v[204:207], a[92:95], a[244:247], v[204:207]
  buffer_load_dwordx4 v24, s[44:47], s27 offen offset:3072 lds
  v_mfma_f32_16x16x32_bf16 v[204:207], a[88:91], a[240:243], v[204:207]
  ds_read_b64_tr_b16 a[150:151], v4 offset:22528
  v_mfma_f32_16x16x32_bf16 v[208:211], a[64:67], a[248:251], v[208:211]
  s_add_u32 m0, s26, 4096
  ds_read_b128 a[200:203], v8 offset:16896
  v_mfma_f32_16x16x32_bf16 v[208:211], a[68:71], a[252:255], v[208:211]
  s_add_u32 s27, s60, 114688
  ds_read_b128 a[204:207], v9 offset:16896
  v_mfma_f32_16x16x32_bf16 v[212:215], a[76:79], a[252:255], v[212:215]
  buffer_load_dwordx4 v21, s[44:47], s27 offen offset:0 lds
  v_mfma_f32_16x16x32_bf16 v[212:215], a[72:75], a[248:251], v[212:215]
  ds_read_b64_tr_b16 a[156:157], v5 offset:20480
  v_mfma_f32_16x16x32_bf16 v[216:219], a[80:83], a[248:251], v[216:219]
  ds_read_b64_tr_b16 a[158:159], v5 offset:22528
  v_mfma_f32_16x16x32_bf16 v[216:219], a[84:87], a[252:255], v[216:219]
  ds_read_b128 a[208:211], v6 offset:768
  v_mfma_f32_16x16x32_bf16 v[220:223], a[92:95], a[252:255], v[220:223]
  ds_read_b128 a[212:215], v7 offset:768
  v_mfma_f32_16x16x32_bf16 v[220:223], a[88:91], a[248:251], v[220:223]
  buffer_load_dwordx4 v22, s[44:47], s27 offen offset:1024 lds
  v_mfma_f32_16x16x32_bf16 v[192:195], a[96:99], a[192:195], v[192:195]
  ds_read_b128 a[216:219], v6 offset:17152
  v_mfma_f32_16x16x32_bf16 v[192:195], a[100:103], a[196:199], v[192:195]
  ds_read_b128 a[220:223], v7 offset:17152
L_page11:
  s_cmp_eq_u32 s100, 1
  s_cbranch_scc1 L_pgretX
  v_mfma_f32_16x16x32_bf16 v[196:199], a[108:111], a[196:199], v[196:199]
  ds_read_b128 a[224:227], v8 offset:768
  v_mfma_f32_16x16x32_bf16 v[196:199], a[104:107], a[192:195], v[196:199]
  buffer_load_dwordx4 v23, s[44:47], s27 offen offset:2048 lds
  v_mfma_f32_16x16x32_bf16 v[200:203], a[112:115], a[192:195], v[200:203]
  ds_read_b128 a[228:231], v9 offset:768
  v_mfma_f32_16x16x32_bf16 v[200:203], a[116:119], a[196:199], v[200:203]
  v_permlane32_swap_b32 v72, v73
  v_mfma_f32_16x16x32_bf16 v[204:207], a[124:127], a[196:199], v[204:207]
  v_permlane32_swap_b32 v74, v75
  v_mfma_f32_16x16x32_bf16 v[204:207], a[120:123], a[192:195], v[204:207]
  buffer_load_dwordx4 v24, s[44:47], s27 offen offset:3072 lds
  s_waitcnt lgkmcnt(5)
  v_mfma_f32_16x16x32_bf16 v[208:211], a[96:99], a[200:203], v[208:211]
  s_waitcnt vmcnt(8)
  ds_read_b64_tr_b16 a[160:161], v2 offset:8192
  v_mfma_f32_16x16x32_bf16 v[208:211], a[100:103], a[204:207], v[208:211]
  ds_read_b64_tr_b16 a[162:163], v2 offset:10240
  v_mfma_f32_16x16x32_bf16 v[212:215], a[108:111], a[204:207], v[212:215]
  ds_read_b64_tr_b16 a[168:169], v3 offset:8192
  v_mfma_f32_16x16x32_bf16 v[212:215], a[104:107], a[200:203], v[212:215]
  ds_read_b64_tr_b16 a[170:171], v3 offset:10240
  v_mfma_f32_16x16x32_bf16 v[216:219], a[112:115], a[200:203], v[216:219]
  ds_read_b64_tr_b16 a[176:177], v4 offset:8192
  v_mfma_f32_16x16x32_bf16 v[216:219], a[116:119], a[204:207], v[216:219]
  ds_read_b64_tr_b16 a[178:179], v4 offset:10240
  s_waitcnt lgkmcnt(0)
  s_xor_b64 s[4:5], s[4:5], s[16:17]
  s_xor_b64 s[6:7], s[6:7], s[16:17]
  s_xor_b64 s[8:9], s[8:9], s[16:17]
  s_xor_b64 s[10:11], s[10:11], s[16:17]
  s_or_b64 s[4:5], s[4:5], s[6:7]
  s_or_b64 s[8:9], s[8:9], s[10:11]
  s_or_b64 s[4:5], s[4:5], s[8:9]
  s_cselect_b32 s38, 1, 0
  s_cselect_b32 s39, 0xe0000000, s63
  v_mfma_f32_16x16x32_bf16 v[220:223], a[124:127], a[204:207], v[220:223]
  ds_read_b64_tr_b16 a[184:185], v5 offset:8192
  v_mfma_f32_16x16x32_bf16 v[220:223], a[120:123], a[200:203], v[220:223]
  ds_read_b64_tr_b16 a[186:187], v5 offset:10240
  v_mfma_f32_16x16x32_bf16 v[192:195], a[128:131], a[208:211], v[192:195]
  s_add_u32 s64, s39, 0
  buffer_load_dwordx4 v[128:131], v25, s[20:23], s64 offen sc1 nt
  v_mfma_f32_16x16x32_bf16 v[192:195], a[132:135], a[212:215], v[192:195]
  ds_read_b64_tr_b16 a[164:165], v2 offset:12288
  v_mfma_f32_16x16x32_bf16 v[196:199], a[140:143], a[212:215], v[196:199]
  ds_read_b64_tr_b16 a[166:167], v2 offset:14336
  v_mfma_f32_16x16x32_bf16 v[196:199], a[136:139], a[208:211], v[196:199]
  ds_read_b64_tr_b16 a[172:173], v3 offset:12288
  v_mfma_f32_16x16x32_bf16 v[200:203], a[144:147], a[208:211], v[200:203]
  s_add_u32 s64, s39, 65536
  buffer_load_dwordx4 v[132:135], v25, s[20:23], s64 offen sc1 nt
  v_mfma_f32_16x16x32_bf16 v[200:203], a[148:151], a[212:215], v[200:203]
  ds_read_b64_tr_b16 a[174:175], v3 offset:14336
  v_mfma_f32_16x16x32_bf16 v[204:207], a[156:159], a[212:215], v[204:207]
  ds_read_b64_tr_b16 a[180:181], v4 offset:12288
  v_mfma_f32_16x16x32_bf16 v[204:207], a[152:155], a[208:211], v[204:207]
  ds_read_b64_tr_b16 a[182:183], v4 offset:14336
  v_mfma_f32_16x16x32_bf16 v[208:211], a[128:131], a[216:219], v[208:211]
  s_add_u32 s64, s39, 131072
  buffer_load_dwordx4 v[136:139], v25, s[20:23], s64 offen sc1 nt
  ds_read_b64_tr_b16 a[188:189], v5 offset:12288
  v_mfma_f32_16x16x32_bf16 v[208:211], a[132:135], a[220:223], v[208:211]
  ds_read_b64_tr_b16 a[190:191], v5 offset:14336
  v_mfma_f32_16x16x32_bf16 v[212:215], a[140:143], a[220:223], v[212:215]
  ds_read_b128 a[232:235], v8 offset:17152
  v_mfma_f32_16x16x32_bf16 v[212:215], a[136:139], a[216:219], v[212:215]
  ds_read_b128 a[236:239], v9 offset:17152
  v_mfma_f32_16x16x32_bf16 v[216:219], a[144:147], a[216:219], v[216:219]
  s_add_u32 s64, s39, 196608
  buffer_load_dwordx4 v[140:143], v25, s[20:23], s64 offen sc1 nt
  v_mfma_f32_16x16x32_bf16 v[216:219], a[148:151], a[220:223], v[216:219]
  ds_read_b128 a[240:243], v8 offset:33024
  v_mfma_f32_16x16x32_bf16 v[220:223], a[156:159], a[220:223], v[220:223]
  ds_read_b128 a[244:247], v9 offset:33024
  v_mfma_f32_16x16x32_bf16 v[220:223], a[152:155], a[216:219], v[220:223]
  ds_read_b128 a[248:251], v6 offset:33280
  s_waitcnt lgkmcnt(6)
  v_mfma_f32_16x16x32_bf16 v[192:195], a[160:163], a[224:227], v[192:195]
  s_add_u32 s64, s39, 262144
  buffer_load_dwordx4 v[144:147], v25, s[20:23], s64 offen sc1 nt
  v_mfma_f32_16x16x32_bf16 v[192:195], a[164:167], a[228:231], v[192:195]
  ds_read_b128 a[252:255], v7 offset:33280
  v_mfma_f32_16x16x32_bf16 v[196:199], a[172:175], a[228:231], v[196:199]
  ds_read_b128 a[192:195], v8 offset:33280
  v_mfma_f32_16x16x32_bf16 v[196:199], a[168:171], a[224:227], v[196:199]
  ds_read_b128 a[196:199], v9 offset:33280
  s_waitcnt lgkmcnt(6)
  v_mfma_f32_16x16x32_bf16 v[200:203], a[176:179], a[224:227], v[200:203]
  s_add_u32 s64, s39, 327680
  buffer_load_dwordx4 v[148:151], v25, s[20:23], s64 offen sc1 nt
  v_mfma_f32_16x16x32_bf16 v[200:203], a[180:183], a[228:231], v[200:203]
  v_permlane32_swap_b32 v76, v77
  v_mfma_f32_16x16x32_bf16 v[204:207], a[188:191], a[228:231], v[204:207]
  v_permlane32_swap_b32 v78, v79
  v_mfma_f32_16x16x32_bf16 v[204:207], a[184:187], a[224:227], v[204:207]
  v_lshlrev_b32 v48, 16, v72
  v_and_b32 v49, s70, v72
  v_mfma_f32_16x16x32_bf16 v[208:211], a[160:163], a[232:235], v[208:211]
  ds_read_b128 a[200:203], v6 offset:33536
  v_lshlrev_b32 v50, 16, v74
  v_mfma_f32_16x16x32_bf16 v[208:211], a[164:167], a[236:239], v[208:211]
  s_add_u32 s64, s39, 393216
  buffer_load_dwordx4 v[152:155], v25, s[20:23], s64 offen sc1 nt
  v_mfma_f32_16x16x32_bf16 v[212:215], a[172:175], a[236:239], v[212:215]
  ds_read_b128 a[204:207], v7 offset:33536
  v_and_b32 v51, s70, v74
  v_mfma_f32_16x16x32_bf16 v[212:215], a[168:171], a[232:235], v[212:215]
  v_cvt_pk_bf16_f32 v192, v192, v193
  v_cvt_pk_bf16_f32 v193, v194, v195
  v_mfma_f32_16x16x32_bf16 v[216:219], a[176:179], a[232:235], v[216:219]
  v_cvt_pk_bf16_f32 v194, v196, v197
  v_cvt_pk_bf16_f32 v195, v198, v199
  v_mfma_f32_16x16x32_bf16 v[216:219], a[180:183], a[236:239], v[216:219]
  s_add_u32 s64, s39, 458752
  buffer_load_dwordx4 v[156:159], v25, s[20:23], s64 offen sc1 nt
  v_mfma_f32_16x16x32_bf16 v[220:223], a[188:191], a[236:239], v[220:223]
  s_add_u32 s57, s56, 32768
  v_lshlrev_b32 v52, 16, v76
  v_mfma_f32_16x16x32_bf16 v[220:223], a[184:187], a[232:235], v[220:223]
  v_permlane16_swap_b32 v192, v194
  s_waitcnt lgkmcnt(2)
  v_mfma_f32_16x16x32_bf16 v[224:227], a[32:35], a[240:243], v[224:227]
  v_permlane16_swap_b32 v193, v195
  v_mfma_f32_16x16x32_bf16 v[224:227], a[36:39], a[244:247], v[224:227]
  ds_read_b128 a[208:211], v8 offset:33536
  v_and_b32 v53, s70, v76
  v_mfma_f32_16x16x32_bf16 v[228:231], a[44:47], a[244:247], v[228:231]
  ds_read_b128 a[212:215], v9 offset:33536
  v_lshlrev_b32 v54, 16, v78
  v_mfma_f32_16x16x32_bf16 v[228:231], a[40:43], a[240:243], v[228:231]
  buffer_store_dwordx4 v[192:195], v20, s[20:23], s57 offen offset:0 sc1
  v_mfma_f32_16x16x32_bf16 v[232:235], a[48:51], a[240:243], v[232:235]
  v_cvt_pk_bf16_f32 v200, v200, v201
  v_cvt_pk_bf16_f32 v201, v202, v203
  v_mfma_f32_16x16x32_bf16 v[232:235], a[52:55], a[244:247], v[232:235]
  v_cvt_pk_bf16_f32 v202, v204, v205
  v_cvt_pk_bf16_f32 v203, v206, v207
  v_mfma_f32_16x16x32_bf16 v[236:239], a[60:63], a[244:247], v[236:239]
  s_add_u32 s57, s56, 32768
  v_and_b32 v55, s70, v78
  v_mfma_f32_16x16x32_bf16 v[236:239], a[56:59], a[240:243], v[236:239]
  v_permlane16_swap_b32 v200, v202
  v_mfma_f32_16x16x32_bf16 v[236:239], a[88:91], a[248:251], v[236:239]
  v_permlane16_swap_b32 v201, v203
  v_mfma_f32_16x16x32_bf16 v[236:239], a[92:95], a[252:255], v[236:239]
  ds_read_b128 a[216:219], v8 offset:49408
  v_lshlrev_b32 v56, 16, v73
  v_mfma_f32_16x16x32_bf16 v[232:235], a[84:87], a[252:255], v[232:235]
  ds_read_b128 a[220:223], v9 offset:49408
  v_and_b32 v57, s70, v73
  v_mfma_f32_16x16x32_bf16 v[232:235], a[80:83], a[248:251], v[232:235]
  v_lshlrev_b32 v58, 16, v75
  v_and_b32 v59, s70, v75
  v_mfma_f32_16x16x32_bf16 v[228:231], a[72:75], a[248:251], v[228:231]
  v_lshlrev_b32 v60, 16, v77
  v_and_b32 v61, s70, v77
  v_mfma_f32_16x16x32_bf16 v[228:231], a[76:79], a[252:255], v[228:231]
  v_lshlrev_b32 v62, 16, v79
  v_and_b32 v63, s70, v79
  v_mfma_f32_16x16x32_bf16 v[224:227], a[68:71], a[252:255], v[224:227]
  v_mov_b32 v81, v80
  v_mov_b32 v83, v82
  v_mfma_f32_16x16x32_bf16 v[224:227], a[64:67], a[248:251], v[224:227]
  v_mov_b32 v85, v84
  v_mov_b32 v87, v86
  v_mfma_f32_16x16x32_bf16 v[224:227], a[96:99], a[192:195], v[224:227]
  ds_read_b128 a[224:227], v6 offset:49664
  v_mfma_f32_16x16x32_bf16 v[224:227], a[100:103], a[196:199], v[224:227]
  buffer_store_dwordx4 v[200:203], v20, s[20:23], s57 offen offset:1024 sc1
  s_waitcnt lgkmcnt(1)
  v_mfma_f32_16x16x32_bf16 v[228:231], a[108:111], a[196:199], v[228:231]
  v_cvt_pk_bf16_f32 v208, v208, v209
  v_cvt_pk_bf16_f32 v209, v210, v211
  v_mfma_f32_16x16x32_bf16 v[228:231], a[104:107], a[192:195], v[228:231]
  v_cvt_pk_bf16_f32 v210, v212, v213
  v_cvt_pk_bf16_f32 v211, v214, v215
  v_mfma_f32_16x16x32_bf16 v[232:235], a[112:115], a[192:195], v[232:235]
  s_add_u32 s57, s56, 40960
  ds_read_b128 a[228:231], v7 offset:49664
  v_mfma_f32_16x16x32_bf16 v[232:235], a[116:119], a[196:199], v[232:235]
  v_permlane16_swap_b32 v208, v210
  v_mfma_f32_16x16x32_bf16 v[236:239], a[124:127], a[196:199], v[236:239]
  v_permlane16_swap_b32 v209, v211
  v_mfma_f32_16x16x32_bf16 v[236:239], a[120:123], a[192:195], v[236:239]
  v_permlane32_swap_b32 v80, v81
  v_mfma_f32_16x16x32_bf16 v[236:239], a[152:155], a[200:203], v[236:239]
  ds_read_b128 a[232:235], v8 offset:49664
  v_mfma_f32_16x16x32_bf16 v[236:239], a[156:159], a[204:207], v[236:239]
  ds_read_b128 a[236:239], v9 offset:49664
  v_mfma_f32_16x16x32_bf16 v[232:235], a[148:151], a[204:207], v[232:235]
  v_permlane32_swap_b32 v82, v83
  v_mfma_f32_16x16x32_bf16 v[232:235], a[144:147], a[200:203], v[232:235]
  v_permlane32_swap_b32 v84, v85
  v_mfma_f32_16x16x32_bf16 v[228:231], a[136:139], a[200:203], v[228:231]
  v_permlane32_swap_b32 v86, v87
  v_mfma_f32_16x16x32_bf16 v[228:231], a[140:143], a[204:207], v[228:231]
  v_lshlrev_b32 v96, 16, v80
  v_and_b32 v97, s70, v80
  v_mfma_f32_16x16x32_bf16 v[224:227], a[132:135], a[204:207], v[224:227]
  v_lshlrev_b32 v98, 16, v82
  v_and_b32 v99, s70, v82
  v_mfma_f32_16x16x32_bf16 v[224:227], a[128:131], a[200:203], v[224:227]
  buffer_store_dwordx4 v[208:211], v20, s[20:23], s57 offen offset:0 sc1
  v_mfma_f32_16x16x32_bf16 v[224:227], a[160:163], a[208:211], v[224:227]
  v_cvt_pk_bf16_f32 v216, v216, v217
  v_cvt_pk_bf16_f32 v217, v218, v219
  v_mfma_f32_16x16x32_bf16 v[224:227], a[164:167], a[212:215], v[224:227]
  v_cvt_pk_bf16_f32 v218, v220, v221
  v_cvt_pk_bf16_f32 v219, v222, v223
  v_mfma_f32_16x16x32_bf16 v[228:231], a[172:175], a[212:215], v[228:231]
  s_add_u32 s57, s56, 40960
  ds_read_b128 a[240:243], v6 offset:49920
  v_mfma_f32_16x16x32_bf16 v[228:231], a[168:171], a[208:211], v[228:231]
  v_permlane16_swap_b32 v216, v218
  v_mfma_f32_16x16x32_bf16 v[232:235], a[176:179], a[208:211], v[232:235]
  v_permlane16_swap_b32 v217, v219
  v_mfma_f32_16x16x32_bf16 v[232:235], a[180:183], a[212:215], v[232:235]
  ds_read_b128 a[244:247], v7 offset:49920
  v_lshlrev_b32 v100, 16, v84
  v_mfma_f32_16x16x32_bf16 v[236:239], a[188:191], a[212:215], v[236:239]
  v_and_b32 v101, s70, v84
  v_lshlrev_b32 v102, 16, v86
  v_mfma_f32_16x16x32_bf16 v[236:239], a[184:187], a[208:211], v[236:239]
  v_and_b32 v103, s70, v86
  v_lshlrev_b32 v104, 16, v81
  v_mfma_f32_16x16x32_bf16 v[240:243], a[32:35], a[216:219], v[240:243]
  ds_read_b128 a[248:251], v8 offset:49920
  v_and_b32 v105, s70, v81
  v_mfma_f32_16x16x32_bf16 v[240:243], a[36:39], a[220:223], v[240:243]
  ds_read_b128 a[252:255], v9 offset:49920
  v_lshlrev_b32 v106, 16, v83
  v_mfma_f32_16x16x32_bf16 v[244:247], a[44:47], a[220:223], v[244:247]
  v_and_b32 v107, s70, v83
  v_lshlrev_b32 v108, 16, v85
  v_mfma_f32_16x16x32_bf16 v[244:247], a[40:43], a[216:219], v[244:247]
  v_and_b32 v109, s70, v85
  v_lshlrev_b32 v110, 16, v87
  v_mfma_f32_16x16x32_bf16 v[248:251], a[48:51], a[216:219], v[248:251]
  v_and_b32 v111, s70, v87
  v_mul_f32 v48, 0x3fb8aa3b, v48
  v_mfma_f32_16x16x32_bf16 v[248:251], a[52:55], a[220:223], v[248:251]
  buffer_store_dwordx4 v[216:219], v20, s[20:23], s57 offen offset:1024 sc1
  s_waitcnt lgkmcnt(2)
  v_mfma_f32_16x16x32_bf16 v[252:255], a[60:63], a[220:223], v[252:255]
  v_cvt_pk_bf16_f32 v224, v224, v225
  v_cvt_pk_bf16_f32 v225, v226, v227
  v_mfma_f32_16x16x32_bf16 v[252:255], a[56:59], a[216:219], v[252:255]
  v_cvt_pk_bf16_f32 v226, v228, v229
  v_cvt_pk_bf16_f32 v227, v230, v231
  v_mfma_f32_16x16x32_bf16 v[252:255], a[88:91], a[224:227], v[252:255]
  s_add_u32 s57, s56, 49152
  v_mul_f32 v49, 0x3fb8aa3b, v49
  v_mfma_f32_16x16x32_bf16 v[252:255], a[92:95], a[228:231], v[252:255]
  v_permlane16_swap_b32 v224, v226
  v_mfma_f32_16x16x32_bf16 v[248:251], a[84:87], a[228:231], v[248:251]
  v_permlane16_swap_b32 v225, v227
  v_mfma_f32_16x16x32_bf16 v[248:251], a[80:83], a[224:227], v[248:251]
  v_mul_f32 v50, 0x3fb8aa3b, v50
  v_mul_f32 v51, 0x3fb8aa3b, v51
  v_mfma_f32_16x16x32_bf16 v[244:247], a[72:75], a[224:227], v[244:247]
  v_mul_f32 v52, 0x3fb8aa3b, v52
  v_mul_f32 v53, 0x3fb8aa3b, v53
  v_mfma_f32_16x16x32_bf16 v[244:247], a[76:79], a[228:231], v[244:247]
  v_mul_f32 v54, 0x3fb8aa3b, v54
  v_mul_f32 v55, 0x3fb8aa3b, v55
  v_mfma_f32_16x16x32_bf16 v[240:243], a[68:71], a[228:231], v[240:243]
  v_mul_f32 v56, 0x3fb8aa3b, v56
  v_mul_f32 v57, 0x3fb8aa3b, v57
  v_mfma_f32_16x16x32_bf16 v[240:243], a[64:67], a[224:227], v[240:243]
  v_mul_f32 v58, 0x3fb8aa3b, v58
  v_mul_f32 v59, 0x3fb8aa3b, v59
  v_mfma_f32_16x16x32_bf16 v[240:243], a[96:99], a[232:235], v[240:243]
  v_mul_f32 v60, 0x3fb8aa3b, v60
  v_mul_f32 v61, 0x3fb8aa3b, v61
  v_mfma_f32_16x16x32_bf16 v[240:243], a[100:103], a[236:239], v[240:243]
  v_mul_f32 v62, 0x3fb8aa3b, v62
  v_mul_f32 v63, 0x3fb8aa3b, v63
  v_mfma_f32_16x16x32_bf16 v[244:247], a[108:111], a[236:239], v[244:247]
  v_lshlrev_b32 v112, 16, v88
  v_and_b32 v113, s70, v88
  v_mfma_f32_16x16x32_bf16 v[244:247], a[104:107], a[232:235], v[244:247]
  buffer_store_dwordx4 v[224:227], v20, s[20:23], s57 offen offset:0 sc1
  v_mfma_f32_16x16x32_bf16 v[248:251], a[112:115], a[232:235], v[248:251]
  v_lshlrev_b32 v114, 16, v89
  v_and_b32 v115, s70, v89
  v_mfma_f32_16x16x32_bf16 v[248:251], a[116:119], a[236:239], v[248:251]
  v_lshlrev_b32 v116, 16, v90
  v_and_b32 v117, s70, v90
  v_mfma_f32_16x16x32_bf16 v[252:255], a[124:127], a[236:239], v[252:255]
  v_lshlrev_b32 v118, 16, v91
  v_and_b32 v119, s70, v91
  v_mfma_f32_16x16x32_bf16 v[252:255], a[120:123], a[232:235], v[252:255]
  v_lshlrev_b32 v120, 16, v92
  v_and_b32 v121, s70, v92
  v_mfma_f32_16x16x32_bf16 v[252:255], a[152:155], a[240:243], v[252:255]
  v_lshlrev_b32 v122, 16, v93
  v_and_b32 v123, s70, v93
  v_mfma_f32_16x16x32_bf16 v[252:255], a[156:159], a[244:247], v[252:255]
  v_lshlrev_b32 v124, 16, v94
  v_and_b32 v125, s70, v94
  v_mfma_f32_16x16x32_bf16 v[248:251], a[148:151], a[244:247], v[248:251]
  v_lshlrev_b32 v126, 16, v95
  v_and_b32 v127, s70, v95
  v_mfma_f32_16x16x32_bf16 v[248:251], a[144:147], a[240:243], v[248:251]
  v_cvt_pk_bf16_f32 v232, v232, v233
  v_cvt_pk_bf16_f32 v233, v234, v235
  v_mfma_f32_16x16x32_bf16 v[244:247], a[136:139], a[240:243], v[244:247]
  v_cvt_pk_bf16_f32 v234, v236, v237
  v_cvt_pk_bf16_f32 v235, v238, v239
  v_mfma_f32_16x16x32_bf16 v[244:247], a[140:143], a[244:247], v[244:247]
  s_add_u32 s57, s56, 49152
  v_lshrrev_b32 v14, 4, v1
  v_mfma_f32_16x16x32_bf16 v[240:243], a[132:135], a[244:247], v[240:243]
  v_permlane16_swap_b32 v232, v234
  v_mfma_f32_16x16x32_bf16 v[240:243], a[128:131], a[240:243], v[240:243]
  v_permlane16_swap_b32 v233, v235
  s_waitcnt lgkmcnt(0)
  v_mfma_f32_16x16x32_bf16 v[240:243], a[160:163], a[248:251], v[240:243]
  v_lshlrev_b32 v14, 9, v14
  v_add_u32 v2, v2, v14
  v_mfma_f32_16x16x32_bf16 v[240:243], a[164:167], a[252:255], v[240:243]
  buffer_store_dwordx4 v[232:235], v20, s[20:23], s57 offen offset:1024 sc1
  v_mfma_f32_16x16x32_bf16 v[244:247], a[172:175], a[252:255], v[244:247]
  v_add_u32 v3, v3, v14
  v_add_u32 v4, v4, v14
  v_mfma_f32_16x16x32_bf16 v[244:247], a[168:171], a[248:251], v[244:247]
  v_add_u32 v5, v5, v14
  v_mfma_f32_16x16x32_bf16 v[248:251], a[176:179], a[248:251], v[248:251]
  v_mfma_f32_16x16x32_bf16 v[248:251], a[180:183], a[252:255], v[248:251]
  v_mfma_f32_16x16x32_bf16 v[252:255], a[188:191], a[252:255], v[252:255]
  v_mfma_f32_16x16x32_bf16 v[252:255], a[184:187], a[248:251], v[252:255]
  v_cvt_pk_bf16_f32 v240, v240, v241
  v_cvt_pk_bf16_f32 v241, v242, v243
  s_nop 0
  v_cvt_pk_bf16_f32 v242, v244, v245
  v_cvt_pk_bf16_f32 v243, v246, v247
  s_nop 0
  v_cvt_pk_bf16_f32 v248, v248, v249
  v_cvt_pk_bf16_f32 v249, v250, v251
  v_cvt_pk_bf16_f32 v250, v252, v253
  v_cvt_pk_bf16_f32 v251, v254, v255
  s_add_u32 s57, s56, 57344
  v_permlane16_swap_b32 v240, v242
  v_permlane16_swap_b32 v241, v243
  buffer_store_dwordx4 v[240:243], v20, s[20:23], s57 offen offset:0 sc1
  v_permlane16_swap_b32 v248, v250
  v_permlane16_swap_b32 v249, v251
  buffer_store_dwordx4 v[248:251], v20, s[20:23], s57 offen offset:1024 sc1
  s_mov_b32 s100, 1
  s_cmp_eq_u32 s3, 0
  s_cbranch_scc1 L_page12
  s_cmp_eq_u32 s3, 1
  s_cbranch_scc1 L_page13
  s_cmp_eq_u32 s3, 2
  s_cbranch_scc1 L_page14
  s_branch L_page15
L_pgretY:
  s_mov_b32 s100, 0
  s_waitcnt vmcnt(4)
  s_barrier
  s_atomic_swap s30, s[20:21], s12
  s_load_dwordx8 s[4:11], s[14:15], 0 glc
  s_add_u32 m0, s26, 16384
  s_add_u32 s27, s60, 229376
  buffer_load_dwordx4 v21, s[44:47], s27 offen offset:0 lds
  buffer_load_dwordx4 v22, s[44:47], s27 offen offset:1024 lds
  buffer_load_dwordx4 v23, s[44:47], s27 offen offset:2048 lds
  buffer_load_dwordx4 v24, s[44:47], s27 offen offset:3072 lds
  s_add_u32 m0, s26, 20480
  s_add_u32 s27, s60, 344064
  buffer_load_dwordx4 v21, s[44:47], s27 offen offset:0 lds
  buffer_load_dwordx4 v22, s[44:47], s27 offen offset:1024 lds
  buffer_load_dwordx4 v23, s[44:47], s27 offen offset:2048 lds
  buffer_load_dwordx4 v24, s[44:47], s27 offen offset:3072 lds
  s_waitcnt lgkmcnt(0)
  s_xor_b64 s[4:5], s[4:5], s[16:17]
  s_xor_b64 s[6:7], s[6:7], s[16:17]
  s_xor_b64 s[8:9], s[8:9], s[16:17]
  s_xor_b64 s[10:11], s[10:11], s[16:17]
  s_or_b64 s[4:5], s[4:5], s[6:7]
  s_or_b64 s[8:9], s[8:9], s[10:11]
  s_or_b64 s[4:5], s[4:5], s[8:9]
  s_cselect_b32 s39, 0, s38
  s_sub_u32 s38, s38, s39
  s_waitcnt vmcnt(8)
  s_barrier
  s_atomic_swap s30, s[20:21], s13
  s_cmp_lg_u32 s39, 0
  s_cbranch_scc0 L_p0skip
  s_add_u32 s64, s63, 0
  buffer_load_dwordx4 v[128:131], v25, s[20:23], s64 offen sc1 nt
  s_add_u32 s64, s63, 65536
  buffer_load_dwordx4 v[132:135], v25, s[20:23], s64 offen sc1 nt
  s_add_u32 s64, s63, 131072
  buffer_load_dwordx4 v[136:139], v25, s[20:23], s64 offen sc1 nt
  s_add_u32 s64, s63, 196608
  buffer_load_dwordx4 v[140:143], v25, s[20:23], s64 offen sc1 nt
  s_add_u32 s64, s63, 262144
  buffer_load_dwordx4 v[144:147], v25, s[20:23], s64 offen sc1 nt
  s_add_u32 s64, s63, 327680
  buffer_load_dwordx4 v[148:151], v25, s[20:23], s64 offen sc1 nt
  s_add_u32 s64, s63, 393216
  buffer_load_dwordx4 v[152:155], v25, s[20:23], s64 offen sc1 nt
  s_add_u32 s64, s63, 458752
  buffer_load_dwordx4 v[156:159], v25, s[20:23], s64 offen sc1 nt
L_p0skip:
  s_cmp_lg_u32 s38, 0
  s_cbranch_scc1 L_p0late
L_p0join:
  s_cmp_ge_u32 s3, 2
  s_cbranch_scc1 L_stageX
L_xret1:
  s_load_dwordx8 s[4:11], s[14:15], 1024 glc
  s_add_u32 s34, s62, 25165824
  s_add_u32 s35, s62, 20971520
  s_waitcnt lgkmcnt(0)
  s_xor_b64 s[4:5], s[4:5], s[16:17]
  s_xor_b64 s[6:7], s[6:7], s[16:17]
  s_xor_b64 s[8:9], s[8:9], s[16:17]
  s_xor_b64 s[10:11], s[10:11], s[16:17]
  s_or_b64 s[4:5], s[4:5], s[6:7]
  s_or_b64 s[8:9], s[8:9], s[10:11]
  s_or_b64 s[4:5], s[4:5], s[8:9]
  s_cbranch_scc1 Lsf5_retry
Lsf5:
  s_add_u32 s64, s63, 32768
  buffer_load_dwordx4 v[192:195], v25, s[20:23], s64 offen sc1 nt
  s_add_u32 s64, s63, 98304
  buffer_load_dwordx4 v[196:199], v25, s[20:23], s64 offen sc1 nt
  s_add_u32 s64, s63, 163840
  buffer_load_dwordx4 v[200:203], v25, s[20:23], s64 offen sc1 nt
  s_add_u32 s64, s63, 229376
  buffer_load_dwordx4 v[204:207], v25, s[20:23], s64 offen sc1 nt
  s_add_u32 s64, s63, 294912
  buffer_load_dwordx4 v[208:211], v25, s[20:23], s64 offen sc1 nt
  s_add_u32 s64, s63, 360448
  buffer_load_dwordx4 v[212:215], v25, s[20:23], s64 offen sc1 nt
  s_add_u32 s64, s63, 425984
  buffer_load_dwordx4 v[216:219], v25, s[20:23], s64 offen sc1 nt
  s_add_u32 s64, s63, 491520
  buffer_load_dwordx4 v[220:223], v25, s[20:23], s64 offen sc1 nt
  s_waitcnt vmcnt(8)
  v_lshlrev_b32 v160, 16, v128
  v_and_b32 v161, s70, v128
  v_lshlrev_b32 v162, 16, v129
  v_and_b32 v163, s70, v129
  v_lshlrev_b32 v164, 16, v130
  v_and_b32 v165, s70, v130
  v_lshlrev_b32 v166, 16, v131
  v_and_b32 v167, s70, v131
  v_lshlrev_b32 v80, 16, v132
  v_and_b32 v81, s70, v132
  v_lshlrev_b32 v82, 16, v133
  v_and_b32 v83, s70, v133
  v_lshlrev_b32 v84, 16, v134
  v_and_b32 v85, s70, v134
  v_lshlrev_b32 v86, 16, v135
  v_and_b32 v87, s70, v135
  v_pk_add_f32 v[160:161], v[160:161], v[80:81]
  v_pk_add_f32 v[162:163], v[162:163], v[82:83]
  v_pk_add_f32 v[164:165], v[164:165], v[84:85]
  v_pk_add_f32 v[166:167], v[166:167], v[86:87]
  v_lshlrev_b32 v80, 16, v136
  v_and_b32 v81, s70, v136
  v_lshlrev_b32 v82, 16, v137
  v_and_b32 v83, s70, v137
  v_lshlrev_b32 v84, 16, v138
  v_and_b32 v85, s70, v138
  v_lshlrev_b32 v86, 16, v139
  v_and_b32 v87, s70, v139
  v_pk_add_f32 v[160:161], v[160:161], v[80:81]
  v_pk_add_f32 v[162:163], v[162:163], v[82:83]
  v_pk_add_f32 v[164:165], v[164:165], v[84:85]
  v_pk_add_f32 v[166:167], v[166:167], v[86:87]
  v_lshlrev_b32 v80, 16, v140
  v_and_b32 v81, s70, v140
  v_lshlrev_b32 v82, 16, v141
  v_and_b32 v83, s70, v141
  v_lshlrev_b32 v84, 16, v142
  v_and_b32 v85, s70, v142
  v_lshlrev_b32 v86, 16, v143
  v_and_b32 v87, s70, v143
  v_pk_add_f32 v[160:161], v[160:161], v[80:81]
  v_pk_add_f32 v[162:163], v[162:163], v[82:83]
  v_pk_add_f32 v[164:165], v[164:165], v[84:85]
  v_pk_add_f32 v[166:167], v[166:167], v[86:87]
  v_lshlrev_b32 v80, 16, v144
  v_and_b32 v81, s70, v144
  v_lshlrev_b32 v82, 16, v145
  v_and_b32 v83, s70, v145
  v_lshlrev_b32 v84, 16, v146
  v_and_b32 v85, s70, v146
  v_lshlrev_b32 v86, 16, v147
  v_and_b32 v87, s70, v147
  v_pk_add_f32 v[160:161], v[160:161], v[80:81]
  v_pk_add_f32 v[162:163], v[162:163], v[82:83]
  v_pk_add_f32 v[164:165], v[164:165], v[84:85]
  v_pk_add_f32 v[166:167], v[166:167], v[86:87]
  v_lshlrev_b32 v80, 16, v148
  v_and_b32 v81, s70, v148
  v_lshlrev_b32 v82, 16, v149
  v_and_b32 v83, s70, v149
  v_lshlrev_b32 v84, 16, v150
  v_and_b32 v85, s70, v150
  v_lshlrev_b32 v86, 16, v151
  v_and_b32 v87, s70, v151
  v_pk_add_f32 v[160:161], v[160:161], v[80:81]
  v_pk_add_f32 v[162:163], v[162:163], v[82:83]
  v_pk_add_f32 v[164:165], v[164:165], v[84:85]
  v_pk_add_f32 v[166:167], v[166:167], v[86:87]
  v_lshlrev_b32 v80, 16, v152
  v_and_b32 v81, s70, v152
  v_lshlrev_b32 v82, 16, v153
  v_and_b32 v83, s70, v153
  v_lshlrev_b32 v84, 16, v154
  v_and_b32 v85, s70, v154
  v_lshlrev_b32 v86, 16, v155
  v_and_b32 v87, s70, v155
  v_pk_add_f32 v[160:161], v[160:161], v[80:81]
  v_pk_add_f32 v[162:163], v[162:163], v[82:83]
  v_pk_add_f32 v[164:165], v[164:165], v[84:85]
  v_pk_add_f32 v[166:167], v[166:167], v[86:87]
  v_lshlrev_b32 v80, 16, v156
  v_and_b32 v81, s70, v156
  v_lshlrev_b32 v82, 16, v157
  v_and_b32 v83, s70, v157
  v_lshlrev_b32 v84, 16, v158
  v_and_b32 v85, s70, v158
  v_lshlrev_b32 v86, 16, v159
  v_and_b32 v87, s70, v159
  v_pk_add_f32 v[160:161], v[160:161], v[80:81]
  v_pk_add_f32 v[162:163], v[162:163], v[82:83]
  v_pk_add_f32 v[164:165], v[164:165], v[84:85]
  v_pk_add_f32 v[166:167], v[166:167], v[86:87]
  v_pk_fma_f32 v[160:161], v[160:161], v[32:33], v[112:113]
  v_pk_fma_f32 v[162:163], v[162:163], v[34:35], v[114:115]
  v_pk_fma_f32 v[164:165], v[164:165], v[36:37], v[116:117]
  v_pk_fma_f32 v[166:167], v[166:167], v[38:39], v[118:119]
  v_cvt_pk_bf16_f32 v180, v160, v161
  v_cvt_pk_bf16_f32 v181, v162, v163
  v_cvt_pk_bf16_f32 v182, v164, v165
  v_cvt_pk_bf16_f32 v183, v166, v167
  buffer_store_dwordx4 v[180:183], v26, s[20:23], s34 offen offset:0 sc1
  v_lshlrev_b32 v160, 16, v180
  v_and_b32 v161, s70, v180
  v_lshlrev_b32 v162, 16, v181
  v_and_b32 v163, s70, v181
  v_lshlrev_b32 v164, 16, v182
  v_and_b32 v165, s70, v182
  v_lshlrev_b32 v166, 16, v183
  v_and_b32 v167, s70, v183
  v_pk_add_f32 v[80:81], v[160:161], v[162:163]
  v_pk_mul_f32 v[84:85], v[160:161], v[160:161]
  v_pk_add_f32 v[82:83], v[164:165], v[166:167]
  v_pk_fma_f32 v[84:85], v[162:163], v[162:163], v[84:85]
  v_pk_add_f32 v[80:81], v[80:81], v[82:83]
  v_pk_fma_f32 v[84:85], v[164:165], v[164:165], v[84:85]
  v_add_f32 v176, v80, v81
  v_pk_fma_f32 v[84:85], v[166:167], v[166:167], v[84:85]
  v_add_f32 v178, v84, v85
  s_waitcnt vmcnt(8)
  v_lshlrev_b32 v168, 16, v192
  v_and_b32 v169, s70, v192
  v_lshlrev_b32 v170, 16, v193
  v_and_b32 v171, s70, v193
  v_lshlrev_b32 v172, 16, v194
  v_and_b32 v173, s70, v194
  v_lshlrev_b32 v174, 16, v195
  v_and_b32 v175, s70, v195
  s_waitcnt vmcnt(7)
  v_lshlrev_b32 v80, 16, v196
  v_and_b32 v81, s70, v196
  v_lshlrev_b32 v82, 16, v197
  v_and_b32 v83, s70, v197
  v_lshlrev_b32 v84, 16, v198
  v_and_b32 v85, s70, v198
  v_lshlrev_b32 v86, 16, v199
  v_and_b32 v87, s70, v199
  v_pk_add_f32 v[168:169], v[168:169], v[80:81]
  v_pk_add_f32 v[170:171], v[170:171], v[82:83]
  v_pk_add_f32 v[172:173], v[172:173], v[84:85]
  v_pk_add_f32 v[174:175], v[174:175], v[86:87]
  s_waitcnt vmcnt(6)
  v_lshlrev_b32 v80, 16, v200
  v_and_b32 v81, s70, v200
  v_lshlrev_b32 v82, 16, v201
  v_and_b32 v83, s70, v201
  v_lshlrev_b32 v84, 16, v202
  v_and_b32 v85, s70, v202
  v_lshlrev_b32 v86, 16, v203
  v_and_b32 v87, s70, v203
  v_pk_add_f32 v[168:169], v[168:169], v[80:81]
  v_pk_add_f32 v[170:171], v[170:171], v[82:83]
  v_pk_add_f32 v[172:173], v[172:173], v[84:85]
  v_pk_add_f32 v[174:175], v[174:175], v[86:87]
  s_waitcnt vmcnt(5)
  v_lshlrev_b32 v80, 16, v204
  v_and_b32 v81, s70, v204
  v_lshlrev_b32 v82, 16, v205
  v_and_b32 v83, s70, v205
  v_lshlrev_b32 v84, 16, v206
  v_and_b32 v85, s70, v206
  v_lshlrev_b32 v86, 16, v207
  v_and_b32 v87, s70, v207
  v_pk_add_f32 v[168:169], v[168:169], v[80:81]
  v_pk_add_f32 v[170:171], v[170:171], v[82:83]
  v_pk_add_f32 v[172:173], v[172:173], v[84:85]
  v_pk_add_f32 v[174:175], v[174:175], v[86:87]
  s_waitcnt vmcnt(4)
  v_lshlrev_b32 v80, 16, v208
  v_and_b32 v81, s70, v208
  v_lshlrev_b32 v82, 16, v209
  v_and_b32 v83, s70, v209
  v_lshlrev_b32 v84, 16, v210
  v_and_b32 v85, s70, v210
  v_lshlrev_b32 v86, 16, v211
  v_and_b32 v87, s70, v211
  v_pk_add_f32 v[168:169], v[168:169], v[80:81]
  v_pk_add_f32 v[170:171], v[170:171], v[82:83]
  v_pk_add_f32 v[172:173], v[172:173], v[84:85]
  v_pk_add_f32 v[174:175], v[174:175], v[86:87]
  s_waitcnt vmcnt(3)
  v_lshlrev_b32 v80, 16, v212
  v_and_b32 v81, s70, v212
  v_lshlrev_b32 v82, 16, v213
  v_and_b32 v83, s70, v213
  v_lshlrev_b32 v84, 16, v214
  v_and_b32 v85, s70, v214
  v_lshlrev_b32 v86, 16, v215
  v_and_b32 v87, s70, v215
  v_pk_add_f32 v[168:169], v[168:169], v[80:81]
  v_pk_add_f32 v[170:171], v[170:171], v[82:83]
  v_pk_add_f32 v[172:173], v[172:173], v[84:85]
  v_pk_add_f32 v[174:175], v[174:175], v[86:87]
  s_waitcnt vmcnt(2)
  v_lshlrev_b32 v80, 16, v216
  v_and_b32 v81, s70, v216
  v_lshlrev_b32 v82, 16, v217
  v_and_b32 v83, s70, v217
  v_lshlrev_b32 v84, 16, v218
  v_and_b32 v85, s70, v218
  v_lshlrev_b32 v86, 16, v219
  v_and_b32 v87, s70, v219
  v_pk_add_f32 v[168:169], v[168:169], v[80:81]
  v_pk_add_f32 v[170:171], v[170:171], v[82:83]
  v_pk_add_f32 v[172:173], v[172:173], v[84:85]
  v_pk_add_f32 v[174:175], v[174:175], v[86:87]
  s_waitcnt vmcnt(1)
  v_lshlrev_b32 v80, 16, v220
  v_and_b32 v81, s70, v220
  v_lshlrev_b32 v82, 16, v221
  v_and_b32 v83, s70, v221
  v_lshlrev_b32 v84, 16, v222
  v_and_b32 v85, s70, v222
  v_lshlrev_b32 v86, 16, v223
  v_and_b32 v87, s70, v223
  v_pk_add_f32 v[168:169], v[168:169], v[80:81]
  v_pk_add_f32 v[170:171], v[170:171], v[82:83]
  v_pk_add_f32 v[172:173], v[172:173], v[84:85]
L_page12:
  s_cmp_eq_u32 s100, 1
  s_cbranch_scc1 L_pgretY
  v_pk_add_f32 v[174:175], v[174:175], v[86:87]
  v_pk_fma_f32 v[168:169], v[168:169], v[40:41], v[120:121]
  v_pk_fma_f32 v[170:171], v[170:171], v[42:43], v[122:123]
  v_pk_fma_f32 v[172:173], v[172:173], v[44:45], v[124:125]
  v_pk_fma_f32 v[174:175], v[174:175], v[46:47], v[126:127]
  v_cvt_pk_bf16_f32 v184, v168, v169
  v_cvt_pk_bf16_f32 v185, v170, v171
  v_cvt_pk_bf16_f32 v186, v172, v173
  v_cvt_pk_bf16_f32 v187, v174, v175
  buffer_store_dwordx4 v[184:187], v26, s[20:23], s34 offen offset:128 sc1
  v_lshlrev_b32 v168, 16, v184
  v_and_b32 v169, s70, v184
  v_lshlrev_b32 v170, 16, v185
  v_and_b32 v171, s70, v185
  v_lshlrev_b32 v172, 16, v186
  v_and_b32 v173, s70, v186
  v_lshlrev_b32 v174, 16, v187
  v_and_b32 v175, s70, v187
  v_pk_add_f32 v[80:81], v[168:169], v[170:171]
  v_pk_mul_f32 v[84:85], v[168:169], v[168:169]
  v_pk_add_f32 v[82:83], v[172:173], v[174:175]
  v_pk_fma_f32 v[84:85], v[170:171], v[170:171], v[84:85]
  v_pk_add_f32 v[80:81], v[80:81], v[82:83]
  v_pk_fma_f32 v[84:85], v[172:173], v[172:173], v[84:85]
  v_add_f32 v177, v80, v81
  v_pk_fma_f32 v[84:85], v[174:175], v[174:175], v[84:85]
  v_add_f32 v179, v84, v85
  v_add_f32 v176, v176, v177
  v_add_f32 v178, v178, v179
  v_mov_b32 v177, v176
  v_mov_b32 v179, v178
  s_nop 0
  v_permlane16_swap_b32 v176, v177
  v_permlane16_swap_b32 v178, v179
  v_add_f32 v177, v176, v177
  v_add_f32 v176, v178, v179
  s_nop 1
  v_add_f32_dpp v176, v176, v176 row_ror:8 row_mask:0xf bank_mask:0xf
  v_add_f32_dpp v177, v177, v177 row_ror:8 row_mask:0xf bank_mask:0xf
  s_nop 0
  v_add_f32_dpp v176, v176, v176 row_ror:4 row_mask:0xf bank_mask:0xf
  v_add_f32_dpp v177, v177, v177 row_ror:4 row_mask:0xf bank_mask:0xf
  s_nop 0
  v_add_f32_dpp v176, v176, v176 row_ror:2 row_mask:0xf bank_mask:0xf
  v_add_f32_dpp v177, v177, v177 row_ror:2 row_mask:0xf bank_mask:0xf
  s_nop 0
  v_add_f32_dpp v176, v176, v176 row_ror:1 row_mask:0xf bank_mask:0xf
  v_add_f32_dpp v177, v177, v177 row_ror:1 row_mask:0xf bank_mask:0xf
  v_mul_f32 v177, 0x3b000000, v177
  v_mul_f32 v176, 0x3b000000, v176
  v_fma_f32 v176, -v177, v177, v176
  v_max_f32 v176, 0, v176
  v_add_f32 v176, 0x3727c5ac, v176
  v_rsq_f32 v176, v176
  s_nop 0
  v_mul_f32 v176, 0x3fb8aa3b, v176
  v_mul_f32_e64 v177, -v177, v176
  v_pk_fma_f32 v[160:161], v[160:161], v[176:177], v[176:177] op_sel:[0,0,1] op_sel_hi:[1,0,1]
  v_pk_fma_f32 v[162:163], v[162:163], v[176:177], v[176:177] op_sel:[0,0,1] op_sel_hi:[1,0,1]
  v_pk_fma_f32 v[164:165], v[164:165], v[176:177], v[176:177] op_sel:[0,0,1] op_sel_hi:[1,0,1]
  v_pk_fma_f32 v[166:167], v[166:167], v[176:177], v[176:177] op_sel:[0,0,1] op_sel_hi:[1,0,1]
  v_pk_fma_f32 v[160:161], v[160:161], v[96:97], v[48:49]
  v_pk_fma_f32 v[162:163], v[162:163], v[98:99], v[50:51]
  v_pk_fma_f32 v[164:165], v[164:165], v[100:101], v[52:53]
  v_pk_fma_f32 v[166:167], v[166:167], v[102:103], v[54:55]
  v_cvt_pk_bf16_f32 v64, v160, v161
  v_cvt_pk_bf16_f32 v65, v162, v163
  v_cvt_pk_bf16_f32 v66, v164, v165
  v_cvt_pk_bf16_f32 v67, v166, v167
  buffer_store_dwordx4 v[64:67], v26, s[20:23], s35 offen offset:0 sc1
  v_pk_fma_f32 v[168:169], v[168:169], v[176:177], v[176:177] op_sel:[0,0,1] op_sel_hi:[1,0,1]
  v_pk_fma_f32 v[170:171], v[170:171], v[176:177], v[176:177] op_sel:[0,0,1] op_sel_hi:[1,0,1]
  v_pk_fma_f32 v[172:173], v[172:173], v[176:177], v[176:177] op_sel:[0,0,1] op_sel_hi:[1,0,1]
  v_pk_fma_f32 v[174:175], v[174:175], v[176:177], v[176:177] op_sel:[0,0,1] op_sel_hi:[1,0,1]
  v_pk_fma_f32 v[168:169], v[168:169], v[104:105], v[56:57]
  v_pk_fma_f32 v[170:171], v[170:171], v[106:107], v[58:59]
  v_pk_fma_f32 v[172:173], v[172:173], v[108:109], v[60:61]
  v_pk_fma_f32 v[174:175], v[174:175], v[110:111], v[62:63]
  v_cvt_pk_bf16_f32 v68, v168, v169
  v_cvt_pk_bf16_f32 v69, v170, v171
  v_cvt_pk_bf16_f32 v70, v172, v173
  v_cvt_pk_bf16_f32 v71, v174, v175
  buffer_store_dwordx4 v[68:71], v26, s[20:23], s35 offen offset:128 sc1
  s_lshl_b32 s65, s32, 2
  s_add_u32 s65, s65, s69
  s_add_u32 s65, s65, 2048
  s_lshl_b32 s34, s31, 16
  s_lshl_b32 s35, s3, 14
  s_add_u32 s34, s34, s35
  s_add_u32 s34, s34, 20971520
  v_lshlrev_b32 v20, 4, v1
  v_xor_b32 v112, 0, v20
  v_xor_b32 v113, 16, v20
  v_xor_b32 v114, 32, v20
  v_xor_b32 v115, 48, v20
  v_xor_b32 v116, 64, v20
  v_xor_b32 v117, 80, v20
  v_xor_b32 v118, 96, v20
  v_xor_b32 v119, 112, v20
  v_xor_b32 v120, 128, v20
  v_xor_b32 v121, 144, v20
  v_xor_b32 v122, 160, v20
  v_xor_b32 v123, 176, v20
  v_xor_b32 v124, 192, v20
  v_xor_b32 v125, 208, v20
  v_xor_b32 v126, 224, v20
  v_xor_b32 v127, 240, v20
  v_lshrrev_b32 v14, 4, v1
  v_lshlrev_b32 v14, 9, v14
  v_sub_u32 v108, v2, v14
  v_sub_u32 v109, v3, v14
  v_sub_u32 v110, v4, v14
  v_sub_u32 v111, v5, v14
  s_mul_i32 s63, s31, 28
  s_add_u32 s63, s63, s3
  s_lshl_b32 s63, s63, 13
  s_add_u32 s63, s63, 33554432
  s_lshl_b32 s56, s32, 15
  s_add_u32 s56, s56, s63
  v_lshrrev_b32 v14, 4, v1
  v_and_b32 v15, 15, v1
  v_lshlrev_b32 v19, 10, v14
  v_lshl_add_u32 v19, v15, 3, v19
  v_bfe_u32 v28, v1, 1, 3
  v_lshlrev_b32 v28, 4, v28
  v_and_b32 v16, 1, v1
  v_lshl_add_u32 v28, v16, 10, v28
  s_lshl_b32 s67, s31, 16
  s_lshl_b32 s37, s71, 7
  s_add_u32 s67, s67, s37
  s_lshl_b32 s37, s3, 12
  s_add_u32 s67, s67, s37
  v_lshlrev_b32 v16, 6, v14
  v_xor_b32 v16, v16, v20
  v_add_u32 v25, s26, v16
  v_and_b32 v16, 3, v1
  v_xor_b32 v16, s3, v16
  v_lshl_add_u32 v16, v16, 2, v14
  v_lshlrev_b32 v16, 4, v16
  v_lshl_add_u32 v16, v15, 8, v16
  v_add_u32 v26, 65536, v16
  v_add_u32 v27, 49152, v26
  s_and_b32 s36, s3, 1
  s_lshl_b32 s36, s36, 7
  v_xor_b32 v96, s36, v112
  v_xor_b32 v97, s36, v113
  v_xor_b32 v98, s36, v114
  v_xor_b32 v99, s36, v115
  v_xor_b32 v100, s36, v116
  v_xor_b32 v101, s36, v117
  v_xor_b32 v102, s36, v118
  v_xor_b32 v103, s36, v119
  s_lshr_b32 s12, s3, 1
  s_sub_u32 s12, s12, s3
  s_add_u32 s12, s12, 10
  s_lshl_b32 s12, s12, 8
  s_lshl_b32 s18, s3, 13
  s_add_u32 s18, s18, 32768
  s_sub_u32 s13, s34, s35
  s_add_u32 s13, s13, s18
  s_waitcnt vmcnt(0)
  s_atomic_swap s30, s[20:21], s65 offset:0
  s_cmp_lt_u32 s3, 2
  s_cbranch_scc1 L_early
L_both:
  s_add_u32 s65, s65, 1024
  ds_read_b64_tr_b16 a[192:193], v2 offset:0
  ds_read_b64_tr_b16 a[194:195], v2 offset:512
  ds_read_b64_tr_b16 a[200:201], v3 offset:0
  ds_read_b64_tr_b16 a[202:203], v3 offset:512
  ds_read_b64_tr_b16 a[208:209], v4 offset:0
  ds_read_b64_tr_b16 a[210:211], v4 offset:512
  ds_read_b64_tr_b16 a[216:217], v5 offset:0
  ds_read_b64_tr_b16 a[218:219], v5 offset:512
  ds_read_b64_tr_b16 a[196:197], v2 offset:4096
  ds_read_b64_tr_b16 a[198:199], v2 offset:4608
  ds_read_b64_tr_b16 a[204:205], v3 offset:4096
  ds_read_b64_tr_b16 a[206:207], v3 offset:4608
  ds_read_b64_tr_b16 a[212:213], v4 offset:4096
  ds_read_b64_tr_b16 a[214:215], v4 offset:4608
  ds_read_b64_tr_b16 a[220:221], v5 offset:4096
  ds_read_b64_tr_b16 a[222:223], v5 offset:4608
  ds_read_b64_tr_b16 a[224:225], v2 offset:16384
  ds_read_b64_tr_b16 a[226:227], v2 offset:16896
  ds_read_b64_tr_b16 a[232:233], v3 offset:16384
  ds_read_b64_tr_b16 a[234:235], v3 offset:16896
  ds_read_b64_tr_b16 a[240:241], v4 offset:16384
  ds_read_b64_tr_b16 a[242:243], v4 offset:16896
  ds_read_b64_tr_b16 a[248:249], v5 offset:16384
  ds_read_b64_tr_b16 a[250:251], v5 offset:16896
  ds_read_b64_tr_b16 a[228:229], v2 offset:20480
  ds_read_b64_tr_b16 a[230:231], v2 offset:20992
  ds_read_b64_tr_b16 a[236:237], v3 offset:20480
  ds_read_b64_tr_b16 a[238:239], v3 offset:20992
  ds_read_b64_tr_b16 a[244:245], v4 offset:20480
  ds_read_b64_tr_b16 a[246:247], v4 offset:20992
  ds_read_b64_tr_b16 a[252:253], v5 offset:20480
  ds_read_b64_tr_b16 a[254:255], v5 offset:20992
  s_waitcnt vmcnt(0)
  s_barrier
  s_cmp_eq_u32 s32, 7
  s_cbranch_scc1 L_nof1
  ds_read_b128 v[64:67], v6 offset:0
  ds_read_b128 v[68:71], v7 offset:0
  ds_read_b128 v[72:75], v8 offset:0
  ds_read_b128 v[76:79], v9 offset:0
  s_waitcnt lgkmcnt(3)
  v_mfma_f32_16x16x32_bf16 v[44:47], a[24:27], v[64:67], 0
  s_add_u32 m0, s26, 0
  ds_read_b128 v[80:83], v6 offset:256
  s_waitcnt lgkmcnt(3)
  v_mfma_f32_16x16x32_bf16 v[44:47], a[28:31], v[68:71], v[44:47]
  s_add_u32 s27, s61, 262144
  ds_read_b128 v[84:87], v7 offset:256
  s_waitcnt lgkmcnt(3)
  v_mfma_f32_16x16x32_bf16 v[44:47], a[56:59], v[72:75], v[44:47]
  buffer_load_dwordx4 v10, s[48:51], s27 offen offset:0 lds
  s_waitcnt lgkmcnt(2)
  v_mfma_f32_16x16x32_bf16 v[44:47], a[60:63], v[76:79], v[44:47]
  ds_read_b128 v[88:91], v8 offset:256
  v_mfma_f32_16x16x32_bf16 v[40:43], a[52:55], v[76:79], 0
  ds_read_b128 v[92:95], v9 offset:256
  v_mfma_f32_16x16x32_bf16 v[40:43], a[48:51], v[72:75], v[40:43]
  ds_read_b64_tr_b16 v[192:193], v108 offset:8192
  v_mfma_f32_16x16x32_bf16 v[40:43], a[20:23], v[68:71], v[40:43]
  buffer_load_dwordx4 v11, s[48:51], s27 offen offset:1024 lds
  v_mfma_f32_16x16x32_bf16 v[40:43], a[16:19], v[64:67], v[40:43]
  ds_read_b64_tr_b16 v[194:195], v108 offset:10240
  v_mfma_f32_16x16x32_bf16 v[36:39], a[8:11], v[64:67], 0
  ds_read_b64_tr_b16 v[200:201], v109 offset:8192
  v_mfma_f32_16x16x32_bf16 v[36:39], a[12:15], v[68:71], v[36:39]
  ds_read_b64_tr_b16 v[202:203], v109 offset:10240
  v_mfma_f32_16x16x32_bf16 v[36:39], a[40:43], v[72:75], v[36:39]
  buffer_load_dwordx4 v12, s[48:51], s27 offen offset:2048 lds
  v_mfma_f32_16x16x32_bf16 v[36:39], a[44:47], v[76:79], v[36:39]
  ds_read_b64_tr_b16 v[208:209], v110 offset:8192
  v_mfma_f32_16x16x32_bf16 v[32:35], a[36:39], v[76:79], 0
  ds_read_b64_tr_b16 v[210:211], v110 offset:10240
  v_mfma_f32_16x16x32_bf16 v[32:35], a[32:35], v[72:75], v[32:35]
  ds_read_b64_tr_b16 v[216:217], v111 offset:8192
  v_mfma_f32_16x16x32_bf16 v[32:35], a[4:7], v[68:71], v[32:35]
  buffer_load_dwordx4 v13, s[48:51], s27 offen offset:3072 lds
  v_mfma_f32_16x16x32_bf16 v[32:35], a[0:3], v[64:67], v[32:35]
  ds_read_b64_tr_b16 v[218:219], v111 offset:10240
  s_waitcnt lgkmcnt(5)
  v_mfma_f32_16x16x32_bf16 v[32:35], a[64:67], v[80:83], v[32:35]
  s_add_u32 m0, s26, 4096
  ds_read_b128 v[64:67], v6 offset:512
  v_mfma_f32_16x16x32_bf16 v[32:35], a[68:71], v[84:87], v[32:35]
  s_add_u32 s27, s61, 294912
  ds_read_b128 v[68:71], v7 offset:512
  v_mfma_f32_16x16x32_bf16 v[32:35], a[96:99], v[88:91], v[32:35]
  s_load_dwordx8 s[4:11], s[14:15], s12 glc
  buffer_load_dwordx4 v10, s[48:51], s27 offen offset:0 lds
  v_mfma_f32_16x16x32_bf16 v[32:35], a[100:103], v[92:95], v[32:35]
  ds_read_b128 v[72:75], v8 offset:512
  v_mfma_f32_16x16x32_bf16 v[36:39], a[108:111], v[92:95], v[36:39]
  ds_read_b128 v[76:79], v9 offset:512
  v_mfma_f32_16x16x32_bf16 v[36:39], a[104:107], v[88:91], v[36:39]
  ds_read_b64_tr_b16 v[196:197], v108 offset:12288
  v_mfma_f32_16x16x32_bf16 v[36:39], a[76:79], v[84:87], v[36:39]
  buffer_load_dwordx4 v11, s[48:51], s27 offen offset:1024 lds
  v_mfma_f32_16x16x32_bf16 v[36:39], a[72:75], v[80:83], v[36:39]
  ds_read_b64_tr_b16 v[198:199], v108 offset:14336
  v_mfma_f32_16x16x32_bf16 v[40:43], a[80:83], v[80:83], v[40:43]
  ds_read_b64_tr_b16 v[204:205], v109 offset:12288
  v_mfma_f32_16x16x32_bf16 v[40:43], a[84:87], v[84:87], v[40:43]
  ds_read_b64_tr_b16 v[206:207], v109 offset:14336
  v_mfma_f32_16x16x32_bf16 v[40:43], a[112:115], v[88:91], v[40:43]
  buffer_load_dwordx4 v12, s[48:51], s27 offen offset:2048 lds
  v_mfma_f32_16x16x32_bf16 v[40:43], a[116:119], v[92:95], v[40:43]
  ds_read_b64_tr_b16 v[212:213], v110 offset:12288
  v_mfma_f32_16x16x32_bf16 v[44:47], a[124:127], v[92:95], v[44:47]
  ds_read_b64_tr_b16 v[214:215], v110 offset:14336
  v_mfma_f32_16x16x32_bf16 v[44:47], a[120:123], v[88:91], v[44:47]
  ds_read_b64_tr_b16 v[220:221], v111 offset:12288
  v_mfma_f32_16x16x32_bf16 v[44:47], a[92:95], v[84:87], v[44:47]
  buffer_load_dwordx4 v13, s[48:51], s27 offen offset:3072 lds
  v_mfma_f32_16x16x32_bf16 v[44:47], a[88:91], v[80:83], v[44:47]
  ds_read_b64_tr_b16 v[222:223], v111 offset:14336
  s_waitcnt lgkmcnt(5)
  v_mfma_f32_16x16x32_bf16 v[44:47], a[152:155], v[64:67], v[44:47]
  s_add_u32 m0, s26, 16384
  ds_read_b128 v[80:83], v6 offset:768
  v_mfma_f32_16x16x32_bf16 v[44:47], a[156:159], v[68:71], v[44:47]
  s_add_u32 s27, s61, 524288
  ds_read_b128 v[84:87], v7 offset:768
  v_mfma_f32_16x16x32_bf16 v[44:47], a[184:187], v[72:75], v[44:47]
  buffer_load_dwordx4 v10, s[48:51], s27 offen offset:0 lds
  v_mfma_f32_16x16x32_bf16 v[44:47], a[188:191], v[76:79], v[44:47]
  ds_read_b128 v[88:91], v8 offset:768
  v_mfma_f32_16x16x32_bf16 v[40:43], a[180:183], v[76:79], v[40:43]
  ds_read_b128 v[92:95], v9 offset:768
  v_mfma_f32_16x16x32_bf16 v[40:43], a[176:179], v[72:75], v[40:43]
  v_mfma_f32_16x16x32_bf16 v[40:43], a[148:151], v[68:71], v[40:43]
  buffer_load_dwordx4 v11, s[48:51], s27 offen offset:1024 lds
  v_mfma_f32_16x16x32_bf16 v[40:43], a[144:147], v[64:67], v[40:43]
  v_mfma_f32_16x16x32_bf16 v[36:39], a[136:139], v[64:67], v[36:39]
  v_mfma_f32_16x16x32_bf16 v[36:39], a[140:143], v[68:71], v[36:39]
  v_mfma_f32_16x16x32_bf16 v[36:39], a[168:171], v[72:75], v[36:39]
  buffer_load_dwordx4 v12, s[48:51], s27 offen offset:2048 lds
  v_mfma_f32_16x16x32_bf16 v[36:39], a[172:175], v[76:79], v[36:39]
  v_mfma_f32_16x16x32_bf16 v[32:35], a[164:167], v[76:79], v[32:35]
  s_lshl_b32 s35, s71, 7
  v_mfma_f32_16x16x32_bf16 v[32:35], a[160:163], v[72:75], v[32:35]
  v_mfma_f32_16x16x32_bf16 v[32:35], a[132:135], v[68:71], v[32:35]
  buffer_load_dwordx4 v13, s[48:51], s27 offen offset:3072 lds
  s_add_u32 s35, s35, 10240
  v_mfma_f32_16x16x32_bf16 v[32:35], a[128:131], v[64:67], v[32:35]
  s_waitcnt lgkmcnt(0)
  s_xor_b64 s[4:5], s[4:5], s[16:17]
  s_xor_b64 s[6:7], s[6:7], s[16:17]
  s_xor_b64 s[8:9], s[8:9], s[16:17]
  s_xor_b64 s[10:11], s[10:11], s[16:17]
  s_or_b64 s[4:5], s[4:5], s[6:7]
  s_or_b64 s[8:9], s[8:9], s[10:11]
  s_or_b64 s[4:5], s[4:5], s[8:9]
  s_cbranch_scc1 Lsf10_retry
Lsf10:
  v_mfma_f32_16x16x32_bf16 v[32:35], a[192:195], v[80:83], v[32:35]
  s_add_u32 m0, s18, 0
  ds_read_b128 v[64:67], v6 offset:16384
  v_mfma_f32_16x16x32_bf16 v[32:35], a[196:199], v[84:87], v[32:35]
  s_add_u32 s27, s13, 0
  buffer_load_dwordx4 v[104:107], v28, s[20:23], s35 offen
  v_mfma_f32_16x16x32_bf16 v[32:35], a[224:227], v[88:91], v[32:35]
  buffer_load_dwordx4 v96, s[20:23], s27 offen offset:0 sc1 lds
  v_mfma_f32_16x16x32_bf16 v[32:35], a[228:231], v[92:95], v[32:35]
  ds_read_b128 v[68:71], v7 offset:16384
  v_lshrrev_b32 v14, 3, v1
  v_mfma_f32_16x16x32_bf16 v[36:39], a[236:239], v[92:95], v[36:39]
  ds_read_b128 v[72:75], v8 offset:16384
  v_lshlrev_b32 v14, 10, v14
  v_mfma_f32_16x16x32_bf16 v[36:39], a[232:235], v[88:91], v[36:39]
  ds_read_b128 v[76:79], v9 offset:16384
  v_mfma_f32_16x16x32_bf16 v[36:39], a[204:207], v[84:87], v[36:39]
  buffer_load_dwordx4 v97, s[20:23], s27 offen offset:1024 sc1 lds
  v_mfma_f32_16x16x32_bf16 v[36:39], a[200:203], v[80:83], v[36:39]
  v_and_b32 v15, 7, v1
  v_mfma_f32_16x16x32_bf16 v[40:43], a[208:211], v[80:83], v[40:43]
  v_lshl_add_u32 v18, v15, 4, v14
  v_mfma_f32_16x16x32_bf16 v[40:43], a[212:215], v[84:87], v[40:43]
  v_mfma_f32_16x16x32_bf16 v[40:43], a[240:243], v[88:91], v[40:43]
  buffer_load_dwordx4 v98, s[20:23], s27 offen offset:2048 sc1 lds
  s_mul_i32 s34, s3, 12288
  v_mfma_f32_16x16x32_bf16 v[40:43], a[244:247], v[92:95], v[40:43]
  v_mfma_f32_16x16x32_bf16 v[44:47], a[252:255], v[92:95], v[44:47]
  s_add_u32 s34, s34, s67
  s_waitcnt vmcnt(8)
  ds_read_b64_tr_b16 v[224:225], v108 offset:0
  v_mfma_f32_16x16x32_bf16 v[44:47], a[248:251], v[88:91], v[44:47]
  ds_read_b64_tr_b16 v[226:227], v108 offset:2048
  v_mfma_f32_16x16x32_bf16 v[44:47], a[220:223], v[84:87], v[44:47]
  buffer_load_dwordx4 v99, s[20:23], s27 offen offset:3072 sc1 lds
  s_add_u32 s34, s34, 25165824
  v_mfma_f32_16x16x32_bf16 v[44:47], a[216:219], v[80:83], v[44:47]
  ds_read_b64_tr_b16 v[232:233], v109 offset:0
  s_waitcnt lgkmcnt(3)
  v_mfma_f32_16x16x32_bf16 v[60:63], a[24:27], v[64:67], 0
  s_add_u32 m0, s18, 4096
  ds_read_b128 v[80:83], v6 offset:16640
  v_mfma_f32_16x16x32_bf16 v[60:63], a[28:31], v[68:71], v[60:63]
  s_add_u32 s27, s13, 4096
  s_add_u32 s37, s34, 7168
  v_mfma_f32_16x16x32_bf16 v[60:63], a[56:59], v[72:75], v[60:63]
  buffer_load_dwordx4 v100, s[20:23], s27 offen offset:0 sc1 lds
  v_mfma_f32_16x16x32_bf16 v[60:63], a[60:63], v[76:79], v[60:63]
  ds_read_b128 v[84:87], v7 offset:16640
  v_mfma_f32_16x16x32_bf16 v[56:59], a[52:55], v[76:79], 0
  s_add_u32 s57, s56, 0
  ds_read_b128 v[88:91], v8 offset:16640
  v_mfma_f32_16x16x32_bf16 v[56:59], a[48:51], v[72:75], v[56:59]
  v_exp_f32_e64 v112, -v32
  v_mfma_f32_16x16x32_bf16 v[56:59], a[20:23], v[68:71], v[56:59]
  buffer_load_dwordx4 v101, s[20:23], s27 offen offset:1024 sc1 lds
  v_mfma_f32_16x16x32_bf16 v[56:59], a[16:19], v[64:67], v[56:59]
  v_exp_f32_e64 v113, -v33
  v_mfma_f32_16x16x32_bf16 v[52:55], a[8:11], v[64:67], 0
  v_exp_f32_e64 v114, -v34
  v_add_f32 v112, 1.0, v112
  v_mfma_f32_16x16x32_bf16 v[52:55], a[12:15], v[68:71], v[52:55]
  v_exp_f32_e64 v115, -v35
  v_mfma_f32_16x16x32_bf16 v[52:55], a[40:43], v[72:75], v[52:55]
  buffer_load_dwordx4 v102, s[20:23], s27 offen offset:2048 sc1 lds
  ds_read_b128 v[92:95], v9 offset:16640
  v_add_f32 v113, 1.0, v113
  v_mfma_f32_16x16x32_bf16 v[52:55], a[44:47], v[76:79], v[52:55]
  v_exp_f32_e64 v116, -v36
  v_add_f32 v114, 1.0, v114
  v_mfma_f32_16x16x32_bf16 v[48:51], a[36:39], v[76:79], 0
  v_rcp_f32 v112, v112
  v_mfma_f32_16x16x32_bf16 v[48:51], a[32:35], v[72:75], v[48:51]
  v_exp_f32_e64 v117, -v37
  v_mfma_f32_16x16x32_bf16 v[48:51], a[4:7], v[68:71], v[48:51]
  buffer_load_dwordx4 v103, s[20:23], s27 offen offset:3072 sc1 lds
  v_add_f32 v115, 1.0, v115
  v_mfma_f32_16x16x32_bf16 v[48:51], a[0:3], v[64:67], v[48:51]
  v_rcp_f32 v113, v113
  v_exp_f32_e64 v118, -v38
  s_waitcnt lgkmcnt(1)
  v_mfma_f32_16x16x32_bf16 v[48:51], a[64:67], v[80:83], v[48:51]
  s_add_u32 m0, s26, 20480
  v_add_f32 v116, 1.0, v116
  v_mfma_f32_16x16x32_bf16 v[48:51], a[68:71], v[84:87], v[48:51]
  s_add_u32 s27, s61, 557056
  v_rcp_f32 v114, v114
  v_mfma_f32_16x16x32_bf16 v[48:51], a[96:99], v[88:91], v[48:51]
  buffer_load_dwordx4 v10, s[48:51], s27 offen offset:0 lds
  v_mul_f32 v112, v112, v32
  v_exp_f32_e64 v119, -v39
  s_waitcnt lgkmcnt(0)
  v_mfma_f32_16x16x32_bf16 v[48:51], a[100:103], v[92:95], v[48:51]
  ds_read_b128 v[64:67], v6 offset:16896
  v_add_f32 v117, 1.0, v117
  v_mfma_f32_16x16x32_bf16 v[52:55], a[108:111], v[92:95], v[52:55]
  v_rcp_f32 v115, v115
  v_mfma_f32_16x16x32_bf16 v[52:55], a[104:107], v[88:91], v[52:55]
  v_mul_f32 v113, v113, v33
  v_add_f32 v118, 1.0, v118
  v_mfma_f32_16x16x32_bf16 v[52:55], a[76:79], v[84:87], v[52:55]
  buffer_load_dwordx4 v11, s[48:51], s27 offen offset:1024 lds
  v_rcp_f32 v116, v116
  v_mfma_f32_16x16x32_bf16 v[52:55], a[72:75], v[80:83], v[52:55]
  ds_read_b128 v[68:71], v7 offset:16896
  v_mul_f32 v114, v114, v34
  v_mfma_f32_16x16x32_bf16 v[56:59], a[80:83], v[80:83], v[56:59]
  ds_read_b128 v[72:75], v8 offset:16896
  v_add_f32 v119, 1.0, v119
  v_mfma_f32_16x16x32_bf16 v[56:59], a[84:87], v[84:87], v[56:59]
  v_rcp_f32 v117, v117
  v_mul_f32 v115, v115, v35
  v_mfma_f32_16x16x32_bf16 v[56:59], a[112:115], v[88:91], v[56:59]
  ds_read_b128 v[76:79], v9 offset:16896
  v_rcp_f32 v118, v118
  v_mfma_f32_16x16x32_bf16 v[56:59], a[116:119], v[92:95], v[56:59]
  ds_read_b64_tr_b16 v[234:235], v109 offset:2048
  v_mul_f32 v116, v116, v36
  v_mfma_f32_16x16x32_bf16 v[60:63], a[124:127], v[92:95], v[60:63]
  buffer_load_dwordx4 v12, s[48:51], s27 offen offset:2048 lds
  v_rcp_f32 v119, v119
  v_mul_f32 v117, v117, v37
  v_mfma_f32_16x16x32_bf16 v[60:63], a[120:123], v[88:91], v[60:63]
  v_mul_f32 v118, v118, v38
  v_mul_f32 v119, v119, v39
  v_mfma_f32_16x16x32_bf16 v[60:63], a[92:95], v[84:87], v[60:63]
  v_cvt_pk_bf16_f32 v120, v112, v113
  v_cvt_pk_bf16_f32 v121, v114, v115
  v_mfma_f32_16x16x32_bf16 v[60:63], a[88:91], v[80:83], v[60:63]
  v_cvt_pk_bf16_f32 v122, v116, v117
  s_waitcnt lgkmcnt(2)
  v_mfma_f32_16x16x32_bf16 v[60:63], a[152:155], v[64:67], v[60:63]
  ds_read_b128 v[80:83], v6 offset:17152
  v_cvt_pk_bf16_f32 v123, v118, v119
  v_mfma_f32_16x16x32_bf16 v[60:63], a[156:159], v[68:71], v[60:63]
  buffer_store_dwordx4 v[120:123], v20, s[20:23], s57 offen offset:0 sc1
  v_mfma_f32_16x16x32_bf16 v[60:63], a[184:187], v[72:75], v[60:63]
  buffer_load_dwordx4 v13, s[48:51], s27 offen offset:3072 lds
  s_waitcnt lgkmcnt(1)
  v_mfma_f32_16x16x32_bf16 v[60:63], a[188:191], v[76:79], v[60:63]
  v_exp_f32_e64 v112, -v40
  v_exp_f32_e64 v113, -v41
  v_mfma_f32_16x16x32_bf16 v[56:59], a[180:183], v[76:79], v[56:59]
  v_exp_f32_e64 v114, -v42
  v_mfma_f32_16x16x32_bf16 v[56:59], a[176:179], v[72:75], v[56:59]
  ds_read_b128 v[84:87], v7 offset:17152
  v_add_f32 v112, 1.0, v112
  v_mfma_f32_16x16x32_bf16 v[56:59], a[148:151], v[68:71], v[56:59]
  s_add_u32 m0, s26, 8192
  v_exp_f32_e64 v115, -v43
  v_mfma_f32_16x16x32_bf16 v[56:59], a[144:147], v[64:67], v[56:59]
  s_add_u32 s27, s61, 786432
  v_add_f32 v113, 1.0, v113
  v_exp_f32_e64 v116, -v44
  v_mfma_f32_16x16x32_bf16 v[52:55], a[136:139], v[64:67], v[52:55]
  buffer_load_dwordx4 v10, s[48:51], s27 offen offset:0 lds
  v_add_f32 v114, 1.0, v114
  v_mfma_f32_16x16x32_bf16 v[52:55], a[140:143], v[68:71], v[52:55]
  ds_read_b128 v[88:91], v8 offset:17152
  v_rcp_f32 v112, v112
  v_mfma_f32_16x16x32_bf16 v[52:55], a[168:171], v[72:75], v[52:55]
  ds_read_b128 v[92:95], v9 offset:17152
  v_exp_f32_e64 v117, -v45
  v_add_f32 v115, 1.0, v115
  v_mfma_f32_16x16x32_bf16 v[52:55], a[172:175], v[76:79], v[52:55]
  v_rcp_f32 v113, v113
  v_mfma_f32_16x16x32_bf16 v[48:51], a[164:167], v[76:79], v[48:51]
  v_exp_f32_e64 v118, -v46
  v_mfma_f32_16x16x32_bf16 v[48:51], a[160:163], v[72:75], v[48:51]
  v_add_f32 v116, 1.0, v116
  v_rcp_f32 v114, v114
  v_mfma_f32_16x16x32_bf16 v[48:51], a[132:135], v[68:71], v[48:51]
  buffer_load_dwordx4 v11, s[48:51], s27 offen offset:1024 lds
  v_mul_f32 v112, v112, v40
  v_mfma_f32_16x16x32_bf16 v[48:51], a[128:131], v[64:67], v[48:51]
  s_waitcnt vmcnt(7)
  s_barrier
  v_exp_f32_e64 v119, -v47
  s_waitcnt lgkmcnt(2)
  v_mfma_f32_16x16x32_bf16 v[48:51], a[192:195], v[80:83], v[48:51]
  ds_read_b128 v[64:67], v6 offset:32768
  v_add_f32 v117, 1.0, v117
  v_mfma_f32_16x16x32_bf16 v[48:51], a[196:199], v[84:87], v[48:51]
  v_rcp_f32 v115, v115
  v_mul_f32 v113, v113, v41
  s_waitcnt lgkmcnt(2)
  v_mfma_f32_16x16x32_bf16 v[48:51], a[224:227], v[88:91], v[48:51]
  ds_read_b128 v[68:71], v7 offset:32768
  v_add_f32 v118, 1.0, v118
  s_waitcnt lgkmcnt(2)
  v_mfma_f32_16x16x32_bf16 v[48:51], a[228:231], v[92:95], v[48:51]
  v_rcp_f32 v116, v116
  v_mfma_f32_16x16x32_bf16 v[52:55], a[236:239], v[92:95], v[52:55]
  buffer_load_dwordx4 v12, s[48:51], s27 offen offset:2048 lds
  v_mul_f32 v114, v114, v42
  v_add_f32 v119, 1.0, v119
  v_mfma_f32_16x16x32_bf16 v[52:55], a[232:235], v[88:91], v[52:55]
  v_rcp_f32 v117, v117
  v_mfma_f32_16x16x32_bf16 v[52:55], a[204:207], v[84:87], v[52:55]
  ds_read_b128 v[72:75], v8 offset:32768
  v_mul_f32 v115, v115, v43
  v_mfma_f32_16x16x32_bf16 v[52:55], a[200:203], v[80:83], v[52:55]
  v_rcp_f32 v118, v118
  v_mfma_f32_16x16x32_bf16 v[56:59], a[208:211], v[80:83], v[56:59]
  v_mul_f32 v116, v116, v44
  v_rcp_f32 v119, v119
  v_mfma_f32_16x16x32_bf16 v[56:59], a[212:215], v[84:87], v[56:59]
  ds_read_b128 v[76:79], v9 offset:32768
  v_mul_f32 v117, v117, v45
  v_mfma_f32_16x16x32_bf16 v[56:59], a[240:243], v[88:91], v[56:59]
  buffer_load_dwordx4 v13, s[48:51], s27 offen offset:3072 lds
  v_mul_f32 v118, v118, v46
  v_mfma_f32_16x16x32_bf16 v[56:59], a[244:247], v[92:95], v[56:59]
  v_mul_f32 v119, v119, v47
  v_cvt_pk_bf16_f32 v124, v112, v113
  v_mfma_f32_16x16x32_bf16 v[60:63], a[252:255], v[92:95], v[60:63]
  v_cvt_pk_bf16_f32 v125, v114, v115
  v_cvt_pk_bf16_f32 v126, v116, v117
  v_mfma_f32_16x16x32_bf16 v[60:63], a[248:251], v[88:91], v[60:63]
  ds_read_b64_tr_b16 v[240:241], v110 offset:0
  v_cvt_pk_bf16_f32 v127, v118, v119
  v_mfma_f32_16x16x32_bf16 v[60:63], a[220:223], v[84:87], v[60:63]
  buffer_store_dwordx4 v[124:127], v20, s[20:23], s57 offen offset:1024 sc1
  v_mfma_f32_16x16x32_bf16 v[60:63], a[216:219], v[80:83], v[60:63]
  s_add_u32 m0, s26, 12288
  s_waitcnt lgkmcnt(2)
  v_mfma_f32_16x16x32_bf16 v[44:47], a[24:27], v[64:67], 0
  s_add_u32 s27, s61, 819200
  ds_read_b64_tr_b16 v[242:243], v110 offset:2048
  v_mfma_f32_16x16x32_bf16 v[44:47], a[28:31], v[68:71], v[44:47]
  buffer_load_dwordx4 v10, s[48:51], s27 offen offset:0 lds
  v_mfma_f32_16x16x32_bf16 v[44:47], a[56:59], v[72:75], v[44:47]
  ds_read_b64_tr_b16 v[248:249], v111 offset:0
  s_waitcnt lgkmcnt(3)
  v_mfma_f32_16x16x32_bf16 v[44:47], a[60:63], v[76:79], v[44:47]
  ds_read_b64_tr_b16 v[250:251], v111 offset:2048
  v_mfma_f32_16x16x32_bf16 v[40:43], a[52:55], v[76:79], 0
  s_add_u32 s57, s56, 2048
  ds_read_b128 v[80:83], v6 offset:33024
  v_mfma_f32_16x16x32_bf16 v[40:43], a[48:51], v[72:75], v[40:43]
  v_exp_f32_e64 v112, -v48
  v_mfma_f32_16x16x32_bf16 v[40:43], a[20:23], v[68:71], v[40:43]
  ds_read_b64_tr_b16 v[228:229], v108 offset:4096
  v_mfma_f32_16x16x32_bf16 v[40:43], a[16:19], v[64:67], v[40:43]
  buffer_load_dwordx4 v11, s[48:51], s27 offen offset:1024 lds
  v_exp_f32_e64 v113, -v49
  v_mfma_f32_16x16x32_bf16 v[36:39], a[8:11], v[64:67], 0
  ds_read_b128 v[84:87], v7 offset:33024
  v_exp_f32_e64 v114, -v50
  v_mfma_f32_16x16x32_bf16 v[36:39], a[12:15], v[68:71], v[36:39]
  ds_read_b128 v[88:91], v8 offset:33024
  ds_read_b64_tr_b16 v[230:231], v108 offset:6144
  v_add_f32 v112, 1.0, v112
  v_exp_f32_e64 v115, -v51
  v_mfma_f32_16x16x32_bf16 v[36:39], a[40:43], v[72:75], v[36:39]
  ds_read_b128 v[92:95], v9 offset:33024
  v_add_f32 v113, 1.0, v113
  v_mfma_f32_16x16x32_bf16 v[36:39], a[44:47], v[76:79], v[36:39]
  ds_read_b64_tr_b16 v[236:237], v109 offset:4096
  v_exp_f32_e64 v116, -v52
  v_mfma_f32_16x16x32_bf16 v[32:35], a[36:39], v[76:79], 0
  ds_read_b64_tr_b16 v[238:239], v109 offset:6144
  v_add_f32 v114, 1.0, v114
  v_mfma_f32_16x16x32_bf16 v[32:35], a[32:35], v[72:75], v[32:35]
  buffer_load_dwordx4 v12, s[48:51], s27 offen offset:2048 lds
  v_rcp_f32 v112, v112
  v_mfma_f32_16x16x32_bf16 v[32:35], a[4:7], v[68:71], v[32:35]
  v_exp_f32_e64 v117, -v53
  v_add_f32 v115, 1.0, v115
  v_mfma_f32_16x16x32_bf16 v[32:35], a[0:3], v[64:67], v[32:35]
  ds_read_b64_tr_b16 v[244:245], v110 offset:4096
  v_rcp_f32 v113, v113
  s_waitcnt lgkmcnt(7)
  v_mfma_f32_16x16x32_bf16 v[32:35], a[64:67], v[80:83], v[32:35]
  v_exp_f32_e64 v118, -v54
  s_waitcnt lgkmcnt(6)
  v_mfma_f32_16x16x32_bf16 v[32:35], a[68:71], v[84:87], v[32:35]
  ds_read_b64_tr_b16 v[246:247], v110 offset:6144
  v_add_f32 v116, 1.0, v116
  s_waitcnt lgkmcnt(6)
  v_mfma_f32_16x16x32_bf16 v[32:35], a[96:99], v[88:91], v[32:35]
  v_rcp_f32 v114, v114
  s_waitcnt lgkmcnt(4)
  v_mfma_f32_16x16x32_bf16 v[32:35], a[100:103], v[92:95], v[32:35]
  buffer_load_dwordx4 v13, s[48:51], s27 offen offset:3072 lds
  ds_read_b64_tr_b16 v[252:253], v111 offset:4096
  v_mul_f32 v112, v112, v48
  v_exp_f32_e64 v119, -v55
L_page13:
  s_cmp_eq_u32 s100, 1
  s_cbranch_scc1 L_pgretY
  v_mfma_f32_16x16x32_bf16 v[36:39], a[108:111], v[92:95], v[36:39]
  ds_read_b64_tr_b16 v[254:255], v111 offset:6144
  v_add_f32 v117, 1.0, v117
  s_waitcnt vmcnt(9)
  v_mfma_f32_16x16x32_bf16 v[36:39], a[104:107], v[88:91], v[36:39]
  v_rcp_f32 v115, v115
  v_mfma_f32_16x16x32_bf16 v[36:39], a[76:79], v[84:87], v[36:39]
  s_waitcnt lgkmcnt(0)
  ds_read_b128 v[64:67], v6 offset:33280
  v_mul_f32 v113, v113, v49
  v_mfma_f32_16x16x32_bf16 v[36:39], a[72:75], v[80:83], v[36:39]
  s_add_u32 m0, s26, 0
  v_add_f32 v118, 1.0, v118
  v_mfma_f32_16x16x32_bf16 v[40:43], a[80:83], v[80:83], v[40:43]
  s_add_u32 s27, s61, 1048576
  ds_read_b128 v[68:71], v7 offset:33280
  v_rcp_f32 v116, v116
  v_mul_f32 v114, v114, v50
  v_mfma_f32_16x16x32_bf16 v[40:43], a[84:87], v[84:87], v[40:43]
  buffer_load_dwordx4 v10, s[48:51], s27 offen offset:0 lds
  ds_read_b128 v[72:75], v8 offset:33280
  v_add_f32 v119, 1.0, v119
  v_mfma_f32_16x16x32_bf16 v[40:43], a[112:115], v[88:91], v[40:43]
  ds_read_b128 v[76:79], v9 offset:33280
  v_rcp_f32 v117, v117
  v_mfma_f32_16x16x32_bf16 v[40:43], a[116:119], v[92:95], v[40:43]
  ds_read_b64_tr_b16 v[128:129], v108 offset:16384
  v_mul_f32 v115, v115, v51
  v_mfma_f32_16x16x32_bf16 v[44:47], a[124:127], v[92:95], v[44:47]
  v_rcp_f32 v118, v118
  v_mul_f32 v116, v116, v52
  v_mfma_f32_16x16x32_bf16 v[44:47], a[120:123], v[88:91], v[44:47]
  v_rcp_f32 v119, v119
  v_mfma_f32_16x16x32_bf16 v[44:47], a[92:95], v[84:87], v[44:47]
  v_mul_f32 v117, v117, v53
  v_mul_f32 v118, v118, v54
  v_mfma_f32_16x16x32_bf16 v[44:47], a[88:91], v[80:83], v[44:47]
  buffer_load_dwordx4 v11, s[48:51], s27 offen offset:1024 lds
  s_waitcnt lgkmcnt(3)
  v_mfma_f32_16x16x32_bf16 v[44:47], a[152:155], v[64:67], v[44:47]
  v_mul_f32 v119, v119, v55
  v_cvt_pk_bf16_f32 v120, v112, v113
  v_mfma_f32_16x16x32_bf16 v[44:47], a[156:159], v[68:71], v[44:47]
  v_cvt_pk_bf16_f32 v121, v114, v115
  v_cvt_pk_bf16_f32 v122, v116, v117
  s_waitcnt lgkmcnt(2)
  v_mfma_f32_16x16x32_bf16 v[44:47], a[184:187], v[72:75], v[44:47]
  ds_read_b128 v[80:83], v6 offset:33536
  v_cvt_pk_bf16_f32 v123, v118, v119
  s_waitcnt lgkmcnt(2)
  v_mfma_f32_16x16x32_bf16 v[44:47], a[188:191], v[76:79], v[44:47]
  buffer_store_dwordx4 v[120:123], v20, s[20:23], s57 offen offset:0 sc1
  v_mfma_f32_16x16x32_bf16 v[40:43], a[180:183], v[76:79], v[40:43]
  v_exp_f32_e64 v112, -v56
  v_mfma_f32_16x16x32_bf16 v[40:43], a[176:179], v[72:75], v[40:43]
  buffer_load_dwordx4 v12, s[48:51], s27 offen offset:2048 lds
  v_mfma_f32_16x16x32_bf16 v[40:43], a[148:151], v[68:71], v[40:43]
  v_exp_f32_e64 v113, -v57
  v_exp_f32_e64 v114, -v58
  v_mfma_f32_16x16x32_bf16 v[40:43], a[144:147], v[64:67], v[40:43]
  ds_read_b128 v[84:87], v7 offset:33536
  v_add_f32 v112, 1.0, v112
  v_mfma_f32_16x16x32_bf16 v[36:39], a[136:139], v[64:67], v[36:39]
  s_waitcnt vmcnt(8)
  s_atomic_swap s30, s[20:21], s65 offset:0
  v_exp_f32_e64 v115, -v59
  v_mfma_f32_16x16x32_bf16 v[36:39], a[140:143], v[68:71], v[36:39]
  ds_read_b128 v[88:91], v8 offset:33536
  v_add_f32 v113, 1.0, v113
  v_mfma_f32_16x16x32_bf16 v[36:39], a[168:171], v[72:75], v[36:39]
  ds_read_b128 v[92:95], v9 offset:33536
  ds_read_b64_tr_b16 v[130:131], v108 offset:18432
  v_exp_f32_e64 v116, -v60
  v_mfma_f32_16x16x32_bf16 v[36:39], a[172:175], v[76:79], v[36:39]
  v_add_f32 v114, 1.0, v114
  v_rcp_f32 v112, v112
  v_mfma_f32_16x16x32_bf16 v[32:35], a[164:167], v[76:79], v[32:35]
  buffer_load_dwordx4 v13, s[48:51], s27 offen offset:3072 lds
  ds_read_b64_tr_b16 v[136:137], v109 offset:16384
  v_exp_f32_e64 v117, -v61
  v_mfma_f32_16x16x32_bf16 v[32:35], a[160:163], v[72:75], v[32:35]
  ds_read_b64_tr_b16 v[138:139], v109 offset:18432
  v_add_f32 v115, 1.0, v115
  v_mfma_f32_16x16x32_bf16 v[32:35], a[132:135], v[68:71], v[32:35]
  v_rcp_f32 v113, v113
  v_mfma_f32_16x16x32_bf16 v[32:35], a[128:131], v[64:67], v[32:35]
  v_exp_f32_e64 v118, -v62
  v_add_f32 v116, 1.0, v116
  s_waitcnt lgkmcnt(5)
  v_mfma_f32_16x16x32_bf16 v[32:35], a[192:195], v[80:83], v[32:35]
  s_add_u32 m0, s26, 4096
  ds_read_b64_tr_b16 v[144:145], v110 offset:16384
  v_rcp_f32 v114, v114
  v_mfma_f32_16x16x32_bf16 v[32:35], a[196:199], v[84:87], v[32:35]
  s_add_u32 s27, s61, 1081344
  v_mul_f32 v112, v112, v56
  s_waitcnt lgkmcnt(5)
  v_mfma_f32_16x16x32_bf16 v[32:35], a[224:227], v[88:91], v[32:35]
  buffer_load_dwordx4 v10, s[48:51], s27 offen offset:0 lds
  ds_read_b64_tr_b16 v[146:147], v110 offset:18432
  v_exp_f32_e64 v119, -v63
  s_waitcnt lgkmcnt(4)
  v_mfma_f32_16x16x32_bf16 v[32:35], a[228:231], v[92:95], v[32:35]
  ds_read_b64_tr_b16 v[152:153], v111 offset:16384
  v_add_f32 v117, 1.0, v117
  v_mfma_f32_16x16x32_bf16 v[36:39], a[236:239], v[92:95], v[36:39]
  v_rcp_f32 v115, v115
  v_mul_f32 v113, v113, v57
  v_mfma_f32_16x16x32_bf16 v[36:39], a[232:235], v[88:91], v[36:39]
  ds_read_b64_tr_b16 v[154:155], v111 offset:18432
  v_add_f32 v118, 1.0, v118
  v_mfma_f32_16x16x32_bf16 v[36:39], a[204:207], v[84:87], v[36:39]
  v_rcp_f32 v116, v116
  v_mfma_f32_16x16x32_bf16 v[36:39], a[200:203], v[80:83], v[36:39]
  ds_read_b128 v[64:67], v6 offset:49152
  v_mul_f32 v114, v114, v58
  v_mfma_f32_16x16x32_bf16 v[40:43], a[208:211], v[80:83], v[40:43]
  buffer_load_dwordx4 v11, s[48:51], s27 offen offset:1024 lds
  ds_read_b128 v[68:71], v7 offset:49152
  ds_read_b64_tr_b16 v[132:133], v108 offset:20480
  v_add_f32 v119, 1.0, v119
  v_mfma_f32_16x16x32_bf16 v[40:43], a[212:215], v[84:87], v[40:43]
  ds_read_b128 v[72:75], v8 offset:49152
  v_rcp_f32 v117, v117
  v_mul_f32 v115, v115, v59
  v_mfma_f32_16x16x32_bf16 v[40:43], a[240:243], v[88:91], v[40:43]
  ds_read_b128 v[76:79], v9 offset:49152
  ds_read_b64_tr_b16 v[134:135], v108 offset:22528
  v_rcp_f32 v118, v118
  v_mfma_f32_16x16x32_bf16 v[40:43], a[244:247], v[92:95], v[40:43]
  ds_read_b64_tr_b16 v[140:141], v109 offset:20480
  v_mul_f32 v116, v116, v60
  v_mfma_f32_16x16x32_bf16 v[44:47], a[252:255], v[92:95], v[44:47]
  v_rcp_f32 v119, v119
  v_mfma_f32_16x16x32_bf16 v[44:47], a[248:251], v[88:91], v[44:47]
  ds_read_b64_tr_b16 v[142:143], v109 offset:22528
  v_mul_f32 v117, v117, v61
  v_mfma_f32_16x16x32_bf16 v[44:47], a[220:223], v[84:87], v[44:47]
  buffer_load_dwordx4 v12, s[48:51], s27 offen offset:2048 lds
  v_mul_f32 v118, v118, v62
  v_mul_f32 v119, v119, v63
  v_mfma_f32_16x16x32_bf16 v[44:47], a[216:219], v[80:83], v[44:47]
  v_cvt_pk_bf16_f32 v124, v112, v113
  s_waitcnt lgkmcnt(4)
  v_mfma_f32_16x16x32_bf16 v[60:63], a[24:27], v[64:67], 0
  ds_read_b64_tr_b16 v[148:149], v110 offset:20480
  v_cvt_pk_bf16_f32 v125, v114, v115
  v_mfma_f32_16x16x32_bf16 v[60:63], a[28:31], v[68:71], v[60:63]
  ds_read_b64_tr_b16 v[150:151], v110 offset:22528
  v_cvt_pk_bf16_f32 v126, v116, v117
  v_mfma_f32_16x16x32_bf16 v[60:63], a[56:59], v[72:75], v[60:63]
  ds_read_b64_tr_b16 v[156:157], v111 offset:20480
  v_cvt_pk_bf16_f32 v127, v118, v119
  s_waitcnt lgkmcnt(6)
  v_mfma_f32_16x16x32_bf16 v[60:63], a[60:63], v[76:79], v[60:63]
  buffer_store_dwordx4 v[124:127], v20, s[20:23], s57 offen offset:1024 sc1
  v_mfma_f32_16x16x32_bf16 v[56:59], a[52:55], v[76:79], 0
  buffer_load_dwordx4 v13, s[48:51], s27 offen offset:3072 lds
  s_add_u32 s57, s56, 4096
  v_mfma_f32_16x16x32_bf16 v[56:59], a[48:51], v[72:75], v[56:59]
  ds_read_b64_tr_b16 v[158:159], v111 offset:22528
  s_waitcnt vmcnt(10)
  v_mfma_f32_16x16x32_bf16 v[56:59], a[20:23], v[68:71], v[56:59]
  v_exp_f32_e64 v112, -v32
  v_mfma_f32_16x16x32_bf16 v[56:59], a[16:19], v[64:67], v[56:59]
  s_waitcnt lgkmcnt(0)
  ds_read_b128 v[80:83], v6 offset:49408
  v_exp_f32_e64 v113, -v33
  v_mfma_f32_16x16x32_bf16 v[52:55], a[8:11], v[64:67], 0
  s_add_u32 m0, s26, 16384
  ds_read_b128 v[84:87], v7 offset:49408
  v_exp_f32_e64 v114, -v34
  v_add_f32 v112, 1.0, v112
  v_mfma_f32_16x16x32_bf16 v[52:55], a[12:15], v[68:71], v[52:55]
  s_add_u32 s27, s61, 1310720
  ds_read_b128 v[88:91], v8 offset:49408
  v_exp_f32_e64 v115, -v35
  v_mfma_f32_16x16x32_bf16 v[52:55], a[40:43], v[72:75], v[52:55]
  buffer_load_dwordx4 v10, s[48:51], s27 offen offset:0 lds
  ds_read_b128 v[92:95], v9 offset:49408
  v_add_f32 v113, 1.0, v113
  v_mfma_f32_16x16x32_bf16 v[52:55], a[44:47], v[76:79], v[52:55]
  v_exp_f32_e64 v116, -v36
  v_add_f32 v114, 1.0, v114
  v_mfma_f32_16x16x32_bf16 v[48:51], a[36:39], v[76:79], 0
  v_rcp_f32 v112, v112
  v_mfma_f32_16x16x32_bf16 v[48:51], a[32:35], v[72:75], v[48:51]
  v_exp_f32_e64 v117, -v37
  v_mfma_f32_16x16x32_bf16 v[48:51], a[4:7], v[68:71], v[48:51]
  v_add_f32 v115, 1.0, v115
  v_rcp_f32 v113, v113
  v_mfma_f32_16x16x32_bf16 v[48:51], a[0:3], v[64:67], v[48:51]
  v_exp_f32_e64 v118, -v38
  s_waitcnt lgkmcnt(3)
  v_mfma_f32_16x16x32_bf16 v[48:51], a[64:67], v[80:83], v[48:51]
  buffer_load_dwordx4 v11, s[48:51], s27 offen offset:1024 lds
  v_add_f32 v116, 1.0, v116
  s_waitcnt lgkmcnt(2)
  v_mfma_f32_16x16x32_bf16 v[48:51], a[68:71], v[84:87], v[48:51]
  v_rcp_f32 v114, v114
  v_mul_f32 v112, v112, v32
  s_waitcnt lgkmcnt(1)
  v_mfma_f32_16x16x32_bf16 v[48:51], a[96:99], v[88:91], v[48:51]
  v_exp_f32_e64 v119, -v39
  s_waitcnt lgkmcnt(0)
  v_mfma_f32_16x16x32_bf16 v[48:51], a[100:103], v[92:95], v[48:51]
  ds_read_b128 v[64:67], v6 offset:49664
  v_add_f32 v117, 1.0, v117
  v_mfma_f32_16x16x32_bf16 v[52:55], a[108:111], v[92:95], v[52:55]
  v_rcp_f32 v115, v115
  v_mul_f32 v113, v113, v33
  v_mfma_f32_16x16x32_bf16 v[52:55], a[104:107], v[88:91], v[52:55]
  ds_read_b128 v[68:71], v7 offset:49664
  v_add_f32 v118, 1.0, v118
  v_mfma_f32_16x16x32_bf16 v[52:55], a[76:79], v[84:87], v[52:55]
  v_rcp_f32 v116, v116
  v_mfma_f32_16x16x32_bf16 v[52:55], a[72:75], v[80:83], v[52:55]
  buffer_load_dwordx4 v12, s[48:51], s27 offen offset:2048 lds
  v_mul_f32 v114, v114, v34
  v_mfma_f32_16x16x32_bf16 v[56:59], a[80:83], v[80:83], v[56:59]
  v_add_f32 v119, 1.0, v119
  v_rcp_f32 v117, v117
  v_mfma_f32_16x16x32_bf16 v[56:59], a[84:87], v[84:87], v[56:59]
  ds_read_b128 v[72:75], v8 offset:49664
  v_mul_f32 v115, v115, v35
  v_mfma_f32_16x16x32_bf16 v[56:59], a[112:115], v[88:91], v[56:59]
  ds_read_b128 v[76:79], v9 offset:49664
  v_rcp_f32 v118, v118
  v_mfma_f32_16x16x32_bf16 v[56:59], a[116:119], v[92:95], v[56:59]
  v_mul_f32 v116, v116, v36
  v_rcp_f32 v119, v119
  v_mfma_f32_16x16x32_bf16 v[60:63], a[124:127], v[92:95], v[60:63]
  v_mul_f32 v117, v117, v37
  v_mul_f32 v118, v118, v38
  v_mfma_f32_16x16x32_bf16 v[60:63], a[120:123], v[88:91], v[60:63]
  buffer_load_dwordx4 v13, s[48:51], s27 offen offset:3072 lds
  s_waitcnt lgkmcnt(2)
  v_mfma_f32_16x16x32_bf16 v[60:63], a[92:95], v[84:87], v[60:63]
  v_mul_f32 v119, v119, v39
  v_cvt_pk_bf16_f32 v120, v112, v113
  v_mfma_f32_16x16x32_bf16 v[60:63], a[88:91], v[80:83], v[60:63]
  ds_read_b64_tr_b16 v[160:161], v108 offset:8192
  v_cvt_pk_bf16_f32 v121, v114, v115
  v_mfma_f32_16x16x32_bf16 v[60:63], a[152:155], v[64:67], v[60:63]
  ds_read_b64_tr_b16 v[162:163], v108 offset:10240
  v_cvt_pk_bf16_f32 v122, v116, v117
  v_mfma_f32_16x16x32_bf16 v[60:63], a[156:159], v[68:71], v[60:63]
  s_add_u32 m0, s26, 20480
  v_cvt_pk_bf16_f32 v123, v118, v119
  s_waitcnt lgkmcnt(3)
  v_mfma_f32_16x16x32_bf16 v[60:63], a[184:187], v[72:75], v[60:63]
  buffer_store_dwordx4 v[120:123], v20, s[20:23], s57 offen offset:0 sc1
  s_add_u32 s27, s61, 1343488
  v_exp_f32_e64 v112, -v40
  s_waitcnt lgkmcnt(2)
  v_mfma_f32_16x16x32_bf16 v[60:63], a[188:191], v[76:79], v[60:63]
  buffer_load_dwordx4 v10, s[48:51], s27 offen offset:0 lds
  ds_read_b64_tr_b16 v[168:169], v109 offset:8192
  v_exp_f32_e64 v113, -v41
  v_mfma_f32_16x16x32_bf16 v[56:59], a[180:183], v[76:79], v[56:59]
  v_exp_f32_e64 v114, -v42
  v_add_f32 v112, 1.0, v112
  v_mfma_f32_16x16x32_bf16 v[56:59], a[176:179], v[72:75], v[56:59]
  ds_read_b64_tr_b16 v[170:171], v109 offset:10240
  v_exp_f32_e64 v115, -v43
  v_mfma_f32_16x16x32_bf16 v[56:59], a[148:151], v[68:71], v[56:59]
  ds_read_b128 v[80:83], v6 offset:49920
  v_add_f32 v113, 1.0, v113
  v_mfma_f32_16x16x32_bf16 v[56:59], a[144:147], v[64:67], v[56:59]
  ds_read_b64_tr_b16 v[176:177], v110 offset:8192
  v_exp_f32_e64 v116, -v44
  v_add_f32 v114, 1.0, v114
  v_mfma_f32_16x16x32_bf16 v[52:55], a[136:139], v[64:67], v[52:55]
  ds_read_b128 v[84:87], v7 offset:49920
  v_rcp_f32 v112, v112
  v_mfma_f32_16x16x32_bf16 v[52:55], a[140:143], v[68:71], v[52:55]
  buffer_load_dwordx4 v11, s[48:51], s27 offen offset:1024 lds
  ds_read_b128 v[88:91], v8 offset:49920
  ds_read_b64_tr_b16 v[178:179], v110 offset:10240
  v_exp_f32_e64 v117, -v45
  v_mfma_f32_16x16x32_bf16 v[52:55], a[168:171], v[72:75], v[52:55]
  s_load_dwordx8 s[4:11], s[14:15], 3072 glc
  ds_read_b128 v[92:95], v9 offset:49920
  v_add_f32 v115, 1.0, v115
  v_mfma_f32_16x16x32_bf16 v[52:55], a[172:175], v[76:79], v[52:55]
  ds_read_b64_tr_b16 v[184:185], v111 offset:8192
  v_rcp_f32 v113, v113
  v_exp_f32_e64 v118, -v46
  v_mfma_f32_16x16x32_bf16 v[48:51], a[164:167], v[76:79], v[48:51]
  s_waitcnt vmcnt(8)
  s_atomic_swap s30, s[20:21], s65 offset:1024
  v_add_f32 v116, 1.0, v116
  v_mfma_f32_16x16x32_bf16 v[48:51], a[160:163], v[72:75], v[48:51]
  ds_read_b64_tr_b16 v[186:187], v111 offset:10240
  v_rcp_f32 v114, v114
  v_mfma_f32_16x16x32_bf16 v[48:51], a[132:135], v[68:71], v[48:51]
  v_mul_f32 v112, v112, v40
  v_exp_f32_e64 v119, -v47
  v_mfma_f32_16x16x32_bf16 v[48:51], a[128:131], v[64:67], v[48:51]
  buffer_load_dwordx4 v12, s[48:51], s27 offen offset:2048 lds
  ds_read_b64_tr_b16 v[164:165], v108 offset:12288
  v_add_f32 v117, 1.0, v117
  s_waitcnt lgkmcnt(6)
  v_mfma_f32_16x16x32_bf16 v[48:51], a[192:195], v[80:83], v[48:51]
  v_rcp_f32 v115, v115
  v_mfma_f32_16x16x32_bf16 v[48:51], a[196:199], v[84:87], v[48:51]
  ds_read_b64_tr_b16 v[166:167], v108 offset:14336
  v_mul_f32 v113, v113, v41
  v_add_f32 v118, 1.0, v118
  s_waitcnt lgkmcnt(5)
  v_mfma_f32_16x16x32_bf16 v[48:51], a[224:227], v[88:91], v[48:51]
  v_rcp_f32 v116, v116
  s_waitcnt lgkmcnt(4)
  v_mfma_f32_16x16x32_bf16 v[48:51], a[228:231], v[92:95], v[48:51]
  ds_read_b64_tr_b16 v[172:173], v109 offset:12288
  v_mul_f32 v114, v114, v42
  v_mfma_f32_16x16x32_bf16 v[52:55], a[236:239], v[92:95], v[52:55]
  v_add_f32 v119, 1.0, v119
  v_rcp_f32 v117, v117
  v_mfma_f32_16x16x32_bf16 v[52:55], a[232:235], v[88:91], v[52:55]
  buffer_load_dwordx4 v13, s[48:51], s27 offen offset:3072 lds
  ds_read_b64_tr_b16 v[174:175], v109 offset:14336
  v_mul_f32 v115, v115, v43
  v_mfma_f32_16x16x32_bf16 v[52:55], a[204:207], v[84:87], v[52:55]
  v_rcp_f32 v118, v118
  v_mfma_f32_16x16x32_bf16 v[52:55], a[200:203], v[80:83], v[52:55]
  ds_read_b64_tr_b16 v[180:181], v110 offset:12288
  v_mul_f32 v116, v116, v44
  v_rcp_f32 v119, v119
  v_mfma_f32_16x16x32_bf16 v[56:59], a[208:211], v[80:83], v[56:59]
  ds_read_b64_tr_b16 v[182:183], v110 offset:14336
  v_mul_f32 v117, v117, v45
  v_mfma_f32_16x16x32_bf16 v[56:59], a[212:215], v[84:87], v[56:59]
  v_mul_f32 v118, v118, v46
  v_mul_f32 v119, v119, v47
  v_mfma_f32_16x16x32_bf16 v[56:59], a[240:243], v[88:91], v[56:59]
  ds_read_b64_tr_b16 v[188:189], v111 offset:12288
  v_cvt_pk_bf16_f32 v124, v112, v113
  v_mfma_f32_16x16x32_bf16 v[56:59], a[244:247], v[92:95], v[56:59]
  v_cvt_pk_bf16_f32 v125, v114, v115
  v_cvt_pk_bf16_f32 v126, v116, v117
  v_mfma_f32_16x16x32_bf16 v[60:63], a[252:255], v[92:95], v[60:63]
  ds_read_b64_tr_b16 v[190:191], v111 offset:14336
  v_cvt_pk_bf16_f32 v127, v118, v119
  v_mfma_f32_16x16x32_bf16 v[60:63], a[248:251], v[88:91], v[60:63]
  buffer_store_dwordx4 v[124:127], v20, s[20:23], s57 offen offset:1024 sc1
  v_mfma_f32_16x16x32_bf16 v[60:63], a[220:223], v[84:87], v[60:63]
  v_mfma_f32_16x16x32_bf16 v[60:63], a[216:219], v[80:83], v[60:63]
  s_waitcnt lgkmcnt(0)
  s_xor_b64 s[4:5], s[4:5], s[16:17]
  s_xor_b64 s[6:7], s[6:7], s[16:17]
  s_xor_b64 s[8:9], s[8:9], s[16:17]
  s_xor_b64 s[10:11], s[10:11], s[16:17]
  s_or_b64 s[4:5], s[4:5], s[6:7]
  s_or_b64 s[8:9], s[8:9], s[10:11]
  s_or_b64 s[4:5], s[4:5], s[8:9]
  s_cbranch_scc1 Lsf12_retry
Lsf12:
  s_add_u32 s64, s63, 0
  buffer_load_dwordx4 a[0:3], v20, s[20:23], s64 offen sc1
  s_add_u32 s57, s56, 6144
  v_exp_f32_e64 v112, -v48
  v_exp_f32_e64 v113, -v49
  v_exp_f32_e64 v114, -v50
  v_add_f32 v112, 1.0, v112
  v_exp_f32_e64 v115, -v51
  buffer_load_dwordx4 a[4:7], v20, s[20:23], s64 offen offset:1024 sc1
  v_add_f32 v113, 1.0, v113
  v_exp_f32_e64 v116, -v52
  v_add_f32 v114, 1.0, v114
  v_rcp_f32 v112, v112
  v_exp_f32_e64 v117, -v53
  v_add_f32 v115, 1.0, v115
  s_add_u32 s64, s63, 32768
  buffer_load_dwordx4 a[8:11], v20, s[20:23], s64 offen sc1
  v_rcp_f32 v113, v113
  v_exp_f32_e64 v118, -v54
  v_add_f32 v116, 1.0, v116
  v_rcp_f32 v114, v114
  v_mul_f32 v112, v112, v48
  v_exp_f32_e64 v119, -v55
  buffer_load_dwordx4 a[12:15], v20, s[20:23], s64 offen offset:1024 sc1
  v_add_f32 v117, 1.0, v117
  v_rcp_f32 v115, v115
  v_mul_f32 v113, v113, v49
  v_add_f32 v118, 1.0, v118
  v_rcp_f32 v116, v116
  v_mul_f32 v114, v114, v50
  s_add_u32 s64, s63, 65536
  buffer_load_dwordx4 a[16:19], v20, s[20:23], s64 offen sc1
  v_add_f32 v119, 1.0, v119
  v_rcp_f32 v117, v117
  v_mul_f32 v115, v115, v51
  v_rcp_f32 v118, v118
  v_mul_f32 v116, v116, v52
  v_rcp_f32 v119, v119
  buffer_load_dwordx4 a[20:23], v20, s[20:23], s64 offen offset:1024 sc1
  v_mul_f32 v117, v117, v53
  v_mul_f32 v118, v118, v54
  v_mul_f32 v119, v119, v55
  v_cvt_pk_bf16_f32 v120, v112, v113
  v_cvt_pk_bf16_f32 v121, v114, v115
  v_cvt_pk_bf16_f32 v122, v116, v117
  s_add_u32 s64, s63, 98304
  buffer_load_dwordx4 a[24:27], v20, s[20:23], s64 offen sc1
  v_cvt_pk_bf16_f32 v123, v118, v119
  v_exp_f32_e64 v112, -v56
  v_exp_f32_e64 v113, -v57
  v_exp_f32_e64 v114, -v58
  v_add_f32 v112, 1.0, v112
  v_exp_f32_e64 v115, -v59
  buffer_load_dwordx4 a[28:31], v20, s[20:23], s64 offen offset:1024 sc1
  v_add_f32 v113, 1.0, v113
  v_exp_f32_e64 v116, -v60
  v_add_f32 v114, 1.0, v114
  v_rcp_f32 v112, v112
  v_exp_f32_e64 v117, -v61
  v_add_f32 v115, 1.0, v115
  s_add_u32 s64, s63, 131072
  buffer_load_dwordx4 a[32:35], v20, s[20:23], s64 offen sc1
  v_rcp_f32 v113, v113
  v_exp_f32_e64 v118, -v62
  v_add_f32 v116, 1.0, v116
  v_rcp_f32 v114, v114
  v_mul_f32 v112, v112, v56
  v_exp_f32_e64 v119, -v63
  buffer_load_dwordx4 a[36:39], v20, s[20:23], s64 offen offset:1024 sc1
  v_add_f32 v117, 1.0, v117
  v_rcp_f32 v115, v115
  v_mul_f32 v113, v113, v57
  v_add_f32 v118, 1.0, v118
  v_rcp_f32 v116, v116
  v_mul_f32 v114, v114, v58
  s_add_u32 s64, s63, 163840
  buffer_load_dwordx4 a[40:43], v20, s[20:23], s64 offen sc1
  v_add_f32 v119, 1.0, v119
  v_rcp_f32 v117, v117
  v_mul_f32 v115, v115, v59
  v_rcp_f32 v118, v118
  v_mul_f32 v116, v116, v60
  v_rcp_f32 v119, v119
  buffer_load_dwordx4 a[44:47], v20, s[20:23], s64 offen offset:1024 sc1
  v_mul_f32 v117, v117, v61
  v_mul_f32 v118, v118, v62
  v_mul_f32 v119, v119, v63
  v_cvt_pk_bf16_f32 v124, v112, v113
  v_cvt_pk_bf16_f32 v125, v114, v115
  v_cvt_pk_bf16_f32 v126, v116, v117
  v_cvt_pk_bf16_f32 v127, v118, v119
  buffer_store_dwordx4 v[120:123], v20, s[20:23], s57 offen offset:0 sc1
  buffer_store_dwordx4 v[124:127], v20, s[20:23], s57 offen offset:1024 sc1
L_f1done:
  s_nop 1
  v_xor_b32 v124, s30, v105
  v_bitop3_b32 v124, v124, v107, s30 bitop3:0xf6
  v_cmp_ne_u32 vcc, 0, v124
  s_nop 1
  s_cbranch_vccnz Lchk14_retry
Lchk14:
  s_waitcnt vmcnt(13)
  v_mfma_f32_16x16x32_bf16 v[64:67], v[192:195], a[0:3], 0
  ds_read_b64_tr_b16 a[160:161], v108 offset:0
  v_lshlrev_b32 v14, 3, v1
  s_waitcnt vmcnt(12)
  v_mfma_f32_16x16x32_bf16 v[64:67], v[196:199], a[4:7], v[64:67]
  ds_read_b64_tr_b16 a[162:163], v108 offset:2048
  s_lshl_b32 s36, s3, 9
  v_mfma_f32_16x16x32_bf16 v[68:71], v[204:207], a[4:7], 0
  s_mov_b64 exec, 1
  buffer_atomic_swap v29, off, s[20:23], s65 offset:2048 sc1
  s_mov_b64 exec, -1
  s_add_u32 m0, s26, 8192
  s_add_u32 s27, s61, 1572864
  v_mfma_f32_16x16x32_bf16 v[68:71], v[200:203], a[0:3], v[68:71]
  buffer_load_dwordx4 v10, s[48:51], s27 offen offset:0 lds
  ds_read_b64_tr_b16 a[168:169], v109 offset:0
  v_mfma_f32_16x16x32_bf16 v[72:75], v[208:211], a[0:3], 0
  ds_read_b64_tr_b16 a[170:171], v109 offset:2048
  s_add_u32 s36, s36, 81920
  v_mfma_f32_16x16x32_bf16 v[72:75], v[212:215], a[4:7], v[72:75]
  ds_read_b64_tr_b16 a[176:177], v110 offset:0
  v_add_u32 v21, s36, v14
  v_mfma_f32_16x16x32_bf16 v[76:79], v[220:223], a[4:7], 0
  buffer_load_dwordx4 v11, s[48:51], s27 offen offset:1024 lds
  ds_read_b64_tr_b16 a[178:179], v110 offset:2048
  v_mfma_f32_16x16x32_bf16 v[76:79], v[216:219], a[0:3], v[76:79]
  ds_read_b64_tr_b16 a[184:185], v111 offset:0
  s_waitcnt vmcnt(14)
  v_mfma_f32_16x16x32_bf16 v[76:79], v[248:251], a[8:11], v[76:79]
  ds_read_b64_tr_b16 a[186:187], v111 offset:2048
  v_add_u32 v22, 49152, v21
  s_waitcnt vmcnt(13)
  v_mfma_f32_16x16x32_bf16 v[76:79], v[252:255], a[12:15], v[76:79]
  buffer_load_dwordx4 v12, s[48:51], s27 offen offset:2048 lds
  ds_read_b64_tr_b16 a[164:165], v108 offset:4096
  v_mfma_f32_16x16x32_bf16 v[72:75], v[244:247], a[12:15], v[72:75]
  ds_read_b64_tr_b16 a[166:167], v108 offset:6144
  v_and_b32 v105, s70, v104
  v_mfma_f32_16x16x32_bf16 v[72:75], v[240:243], a[8:11], v[72:75]
  s_load_dwordx8 s[4:11], s[14:15], 4096 glc
  ds_read_b64_tr_b16 a[172:173], v109 offset:4096
  v_mfma_f32_16x16x32_bf16 v[68:71], v[232:235], a[8:11], v[68:71]
  buffer_load_dwordx4 v13, s[48:51], s27 offen offset:3072 lds
  ds_read_b64_tr_b16 a[174:175], v109 offset:6144
  v_mfma_f32_16x16x32_bf16 v[68:71], v[236:239], a[12:15], v[68:71]
  ds_read_b64_tr_b16 a[180:181], v110 offset:4096
  v_lshlrev_b32 v104, 16, v104
  v_mfma_f32_16x16x32_bf16 v[64:67], v[228:231], a[12:15], v[64:67]
  s_add_u32 m0, s26, 12288
  s_add_u32 s27, s61, 1605632
  ds_read_b64_tr_b16 a[182:183], v110 offset:6144
  v_mfma_f32_16x16x32_bf16 v[64:67], v[224:227], a[8:11], v[64:67]
  buffer_load_dwordx4 v10, s[48:51], s27 offen offset:0 lds
  ds_read_b64_tr_b16 a[188:189], v111 offset:4096
  s_waitcnt vmcnt(15)
  v_mfma_f32_16x16x32_bf16 v[64:67], v[128:131], a[16:19], v[64:67]
  ds_read_b64_tr_b16 a[190:191], v111 offset:6144
  v_and_b32 v107, s70, v106
  s_waitcnt vmcnt(14)
  v_mfma_f32_16x16x32_bf16 v[64:67], v[132:135], a[20:23], v[64:67]
  ds_read_b64_tr_b16 a[192:193], v108 offset:16384
  v_lshlrev_b32 v106, 16, v106
  v_mfma_f32_16x16x32_bf16 v[68:71], v[140:143], a[20:23], v[68:71]
  buffer_load_dwordx4 v11, s[48:51], s27 offen offset:1024 lds
  v_mfma_f32_16x16x32_bf16 v[68:71], v[136:139], a[16:19], v[68:71]
  ds_read_b64_tr_b16 a[194:195], v108 offset:18432
  v_mul_f32 v104, 0x3f317218, v104
  v_mfma_f32_16x16x32_bf16 v[72:75], v[144:147], a[16:19], v[72:75]
  ds_read_b64_tr_b16 a[200:201], v109 offset:16384
  v_mul_f32 v105, 0x3f317218, v105
  v_mfma_f32_16x16x32_bf16 v[72:75], v[148:151], a[20:23], v[72:75]
  buffer_load_dwordx4 v12, s[48:51], s27 offen offset:2048 lds
  ds_read_b64_tr_b16 a[202:203], v109 offset:18432
  v_mfma_f32_16x16x32_bf16 v[76:79], v[156:159], a[20:23], v[76:79]
  ds_read_b64_tr_b16 a[208:209], v110 offset:16384
  v_mul_f32 v106, 0x3f317218, v106
  v_mfma_f32_16x16x32_bf16 v[76:79], v[152:155], a[16:19], v[76:79]
  ds_read_b64_tr_b16 a[210:211], v110 offset:18432
  s_waitcnt vmcnt(15)
  v_mfma_f32_16x16x32_bf16 v[76:79], v[184:187], a[24:27], v[76:79]
  buffer_load_dwordx4 v13, s[48:51], s27 offen offset:3072 lds
  ds_read_b64_tr_b16 a[216:217], v111 offset:16384
  s_waitcnt vmcnt(15)
  v_mfma_f32_16x16x32_bf16 v[76:79], v[188:191], a[28:31], v[76:79]
  ds_read_b64_tr_b16 a[218:219], v111 offset:18432
  v_mul_f32 v107, 0x3f317218, v107
  v_mfma_f32_16x16x32_bf16 v[72:75], v[180:183], a[28:31], v[72:75]
  s_waitcnt vmcnt(9)
  s_mov_b64 exec, 1
  buffer_atomic_swap v29, off, s[20:23], s65 offset:3072 sc1
  s_mov_b64 exec, -1
  ds_read_b64_tr_b16 a[196:197], v108 offset:20480
  v_mfma_f32_16x16x32_bf16 v[72:75], v[176:179], a[24:27], v[72:75]
  ds_read_b64_tr_b16 a[198:199], v108 offset:22528
  v_mfma_f32_16x16x32_bf16 v[68:71], v[168:171], a[24:27], v[68:71]
  ds_read_b64_tr_b16 a[204:205], v109 offset:20480
  v_mfma_f32_16x16x32_bf16 v[68:71], v[172:175], a[28:31], v[68:71]
  ds_read_b64_tr_b16 a[206:207], v109 offset:22528
  v_mfma_f32_16x16x32_bf16 v[64:67], v[164:167], a[28:31], v[64:67]
  ds_read_b64_tr_b16 a[212:213], v110 offset:20480
  v_mfma_f32_16x16x32_bf16 v[64:67], v[160:163], a[24:27], v[64:67]
  ds_read_b64_tr_b16 a[214:215], v110 offset:22528
  s_waitcnt lgkmcnt(0)
  s_xor_b64 s[4:5], s[4:5], s[16:17]
  s_xor_b64 s[6:7], s[6:7], s[16:17]
  s_xor_b64 s[8:9], s[8:9], s[16:17]
  s_xor_b64 s[10:11], s[10:11], s[16:17]
  s_or_b64 s[4:5], s[4:5], s[6:7]
  s_or_b64 s[8:9], s[8:9], s[10:11]
  s_or_b64 s[4:5], s[4:5], s[8:9]
  s_cbranch_scc1 Lsf16_retry
Lsf16:
  v_mfma_f32_16x16x32_bf16 v[64:67], a[160:163], a[32:35], v[64:67]
  s_add_u32 s64, s63, 2048
  ds_read_b64_tr_b16 a[220:221], v111 offset:20480
  v_mfma_f32_16x16x32_bf16 v[64:67], a[164:167], a[36:39], v[64:67]
  buffer_load_dwordx4 a[48:51], v20, s[20:23], s64 offen sc1
  ds_read_b64_tr_b16 a[222:223], v111 offset:22528
  v_mfma_f32_16x16x32_bf16 v[68:71], a[172:175], a[36:39], v[68:71]
  v_mfma_f32_16x16x32_bf16 v[68:71], a[168:171], a[32:35], v[68:71]
  v_mfma_f32_16x16x32_bf16 v[72:75], a[176:179], a[32:35], v[72:75]
  buffer_load_dwordx4 a[52:55], v20, s[20:23], s64 offen offset:1024 sc1
  v_mfma_f32_16x16x32_bf16 v[72:75], a[180:183], a[36:39], v[72:75]
  v_mfma_f32_16x16x32_bf16 v[76:79], a[188:191], a[36:39], v[76:79]
  s_add_u32 s64, s63, 34816
  v_mfma_f32_16x16x32_bf16 v[76:79], a[184:187], a[32:35], v[76:79]
  buffer_load_dwordx4 a[56:59], v20, s[20:23], s64 offen sc1
  v_mfma_f32_16x16x32_bf16 v[76:79], a[216:219], a[40:43], v[76:79]
  s_waitcnt lgkmcnt(0)
  v_mfma_f32_16x16x32_bf16 v[76:79], a[220:223], a[44:47], v[76:79]
  v_mfma_f32_16x16x32_bf16 v[72:75], a[212:215], a[44:47], v[72:75]
  buffer_load_dwordx4 a[60:63], v20, s[20:23], s64 offen offset:1024 sc1
  s_add_u32 m0, s26, 16384
  s_nop 0
  buffer_load_dwordx4 v18, s[20:23], s34 offen sc1 lds
  v_mfma_f32_16x16x32_bf16 v[72:75], a[208:211], a[40:43], v[72:75]
  v_mfma_f32_16x16x32_bf16 v[68:71], a[200:203], a[40:43], v[68:71]
  s_add_u32 s64, s63, 67584
  v_mfma_f32_16x16x32_bf16 v[68:71], a[204:207], a[44:47], v[68:71]
  buffer_load_dwordx4 a[64:67], v20, s[20:23], s64 offen sc1
  v_mfma_f32_16x16x32_bf16 v[64:67], a[196:199], a[44:47], v[64:67]
  buffer_load_dwordx4 v18, s[20:23], s37 offen offset:1024 sc1 lds
  v_mfma_f32_16x16x32_bf16 v[64:67], a[192:195], a[40:43], v[64:67]
  s_waitcnt vmcnt(6)
  v_mfma_f32_16x16x32_bf16 v[80:83], v[192:195], a[48:51], 0
  buffer_load_dwordx4 a[68:71], v20, s[20:23], s64 offen offset:1024 sc1
  s_waitcnt vmcnt(6)
  v_mfma_f32_16x16x32_bf16 v[80:83], v[196:199], a[52:55], v[80:83]
  v_mfma_f32_16x16x32_bf16 v[84:87], v[204:207], a[52:55], 0
  s_add_u32 s64, s63, 100352
  v_mfma_f32_16x16x32_bf16 v[84:87], v[200:203], a[48:51], v[84:87]
  buffer_load_dwordx4 a[72:75], v20, s[20:23], s64 offen sc1
  v_mfma_f32_16x16x32_bf16 v[88:91], v[208:211], a[48:51], 0
  v_mfma_f32_16x16x32_bf16 v[88:91], v[212:215], a[52:55], v[88:91]
  v_mfma_f32_16x16x32_bf16 v[92:95], v[220:223], a[52:55], 0
  buffer_load_dwordx4 a[76:79], v20, s[20:23], s64 offen offset:1024 sc1
  v_mfma_f32_16x16x32_bf16 v[92:95], v[216:219], a[48:51], v[92:95]
  ds_read_b64_tr_b16 a[224:225], v108 offset:8192
  s_waitcnt vmcnt(7)
L_page14:
  s_cmp_eq_u32 s100, 1
  s_cbranch_scc1 L_pgretY
  v_mfma_f32_16x16x32_bf16 v[92:95], v[248:251], a[56:59], v[92:95]
  s_add_u32 s64, s63, 133120
  ds_read_b64_tr_b16 a[226:227], v108 offset:10240
  s_waitcnt vmcnt(6)
  v_mfma_f32_16x16x32_bf16 v[92:95], v[252:255], a[60:63], v[92:95]
  buffer_load_dwordx4 a[80:83], v20, s[20:23], s64 offen sc1
  v_mfma_f32_16x16x32_bf16 v[88:91], v[244:247], a[60:63], v[88:91]
  ds_read_b64_tr_b16 a[232:233], v109 offset:8192
  v_mfma_f32_16x16x32_bf16 v[88:91], v[240:243], a[56:59], v[88:91]
  s_load_dwordx8 s[4:11], s[14:15], 5120 glc
  ds_read_b64_tr_b16 a[234:235], v109 offset:10240
  v_mfma_f32_16x16x32_bf16 v[84:87], v[232:235], a[56:59], v[84:87]
  buffer_load_dwordx4 a[84:87], v20, s[20:23], s64 offen offset:1024 sc1
  v_mfma_f32_16x16x32_bf16 v[84:87], v[236:239], a[60:63], v[84:87]
  ds_read_b64_tr_b16 a[240:241], v110 offset:8192
  v_mfma_f32_16x16x32_bf16 v[80:83], v[228:231], a[60:63], v[80:83]
  s_add_u32 s64, s63, 165888
  ds_read_b64_tr_b16 a[242:243], v110 offset:10240
  v_mfma_f32_16x16x32_bf16 v[80:83], v[224:227], a[56:59], v[80:83]
  buffer_load_dwordx4 a[88:91], v20, s[20:23], s64 offen sc1
  s_waitcnt vmcnt(7)
  v_mfma_f32_16x16x32_bf16 v[80:83], v[128:131], a[64:67], v[80:83]
  ds_read_b64_tr_b16 a[248:249], v111 offset:8192
  s_waitcnt vmcnt(5)
  v_mfma_f32_16x16x32_bf16 v[80:83], v[132:135], a[68:71], v[80:83]
  ds_read_b64_tr_b16 a[250:251], v111 offset:10240
  v_mfma_f32_16x16x32_bf16 v[84:87], v[140:143], a[68:71], v[84:87]
  buffer_load_dwordx4 a[92:95], v20, s[20:23], s64 offen offset:1024 sc1
  v_mfma_f32_16x16x32_bf16 v[84:87], v[136:139], a[64:67], v[84:87]
  ds_read_b64_tr_b16 a[228:229], v108 offset:12288
  v_mfma_f32_16x16x32_bf16 v[88:91], v[144:147], a[64:67], v[88:91]
  s_add_u32 s64, s63, 196608
  ds_read_b64_tr_b16 a[230:231], v108 offset:14336
  v_mfma_f32_16x16x32_bf16 v[88:91], v[148:151], a[68:71], v[88:91]
  buffer_load_dwordx4 a[96:99], v20, s[20:23], s64 offen sc1
  v_mfma_f32_16x16x32_bf16 v[92:95], v[156:159], a[68:71], v[92:95]
  ds_read_b64_tr_b16 a[236:237], v109 offset:12288
  v_mfma_f32_16x16x32_bf16 v[92:95], v[152:155], a[64:67], v[92:95]
  ds_read_b64_tr_b16 a[238:239], v109 offset:14336
  s_waitcnt vmcnt(6)
  v_mfma_f32_16x16x32_bf16 v[92:95], v[184:187], a[72:75], v[92:95]
  buffer_load_dwordx4 a[100:103], v20, s[20:23], s64 offen offset:1024 sc1
  s_waitcnt vmcnt(6)
  v_mfma_f32_16x16x32_bf16 v[92:95], v[188:191], a[76:79], v[92:95]
  ds_read_b64_tr_b16 a[244:245], v110 offset:12288
  v_mfma_f32_16x16x32_bf16 v[88:91], v[180:183], a[76:79], v[88:91]
  s_add_u32 s64, s63, 198656
  ds_read_b64_tr_b16 a[246:247], v110 offset:14336
  v_mfma_f32_16x16x32_bf16 v[88:91], v[176:179], a[72:75], v[88:91]
  buffer_load_dwordx4 a[104:107], v20, s[20:23], s64 offen sc1
  v_mfma_f32_16x16x32_bf16 v[84:87], v[168:171], a[72:75], v[84:87]
  ds_read_b64_tr_b16 a[252:253], v111 offset:12288
  v_mfma_f32_16x16x32_bf16 v[84:87], v[172:175], a[76:79], v[84:87]
  ds_read_b64_tr_b16 a[254:255], v111 offset:14336
  v_mfma_f32_16x16x32_bf16 v[80:83], v[164:167], a[76:79], v[80:83]
  buffer_load_dwordx4 a[108:111], v20, s[20:23], s64 offen offset:1024 sc1
  v_mfma_f32_16x16x32_bf16 v[80:83], v[160:163], a[72:75], v[80:83]
  s_waitcnt lgkmcnt(0)
  s_xor_b64 s[4:5], s[4:5], s[16:17]
  s_xor_b64 s[6:7], s[6:7], s[16:17]
  s_xor_b64 s[8:9], s[8:9], s[16:17]
  s_xor_b64 s[10:11], s[10:11], s[16:17]
  s_or_b64 s[4:5], s[4:5], s[6:7]
  s_or_b64 s[8:9], s[8:9], s[10:11]
  s_or_b64 s[4:5], s[4:5], s[8:9]
  s_cbranch_scc1 Lsf18_retry
Lsf18:
  s_waitcnt vmcnt(7)
  v_mfma_f32_16x16x32_bf16 v[80:83], a[160:163], a[80:83], v[80:83]
  s_add_u32 s64, s63, 4096
  s_waitcnt vmcnt(6)
  v_mfma_f32_16x16x32_bf16 v[80:83], a[164:167], a[84:87], v[80:83]
  buffer_load_dwordx4 a[112:115], v20, s[20:23], s64 offen sc1
  v_mfma_f32_16x16x32_bf16 v[84:87], a[172:175], a[84:87], v[84:87]
  v_mfma_f32_16x16x32_bf16 v[84:87], a[168:171], a[80:83], v[84:87]
  v_mfma_f32_16x16x32_bf16 v[88:91], a[176:179], a[80:83], v[88:91]
  buffer_load_dwordx4 a[116:119], v20, s[20:23], s64 offen offset:1024 sc1
  v_mfma_f32_16x16x32_bf16 v[88:91], a[180:183], a[84:87], v[88:91]
  v_mfma_f32_16x16x32_bf16 v[92:95], a[188:191], a[84:87], v[92:95]
  s_add_u32 s64, s63, 36864
  v_mfma_f32_16x16x32_bf16 v[92:95], a[184:187], a[80:83], v[92:95]
  buffer_load_dwordx4 a[120:123], v20, s[20:23], s64 offen sc1
  s_waitcnt vmcnt(8)
  v_mfma_f32_16x16x32_bf16 v[92:95], a[216:219], a[88:91], v[92:95]
  s_waitcnt vmcnt(7)
  v_mfma_f32_16x16x32_bf16 v[92:95], a[220:223], a[92:95], v[92:95]
  v_mfma_f32_16x16x32_bf16 v[88:91], a[212:215], a[92:95], v[88:91]
  buffer_load_dwordx4 a[124:127], v20, s[20:23], s64 offen offset:1024 sc1
  v_mfma_f32_16x16x32_bf16 v[88:91], a[208:211], a[88:91], v[88:91]
  v_mfma_f32_16x16x32_bf16 v[84:87], a[200:203], a[88:91], v[84:87]
  s_add_u32 s64, s63, 69632
  v_mfma_f32_16x16x32_bf16 v[84:87], a[204:207], a[92:95], v[84:87]
  buffer_load_dwordx4 a[128:131], v20, s[20:23], s64 offen sc1
  v_mfma_f32_16x16x32_bf16 v[80:83], a[196:199], a[92:95], v[80:83]
  v_mfma_f32_16x16x32_bf16 v[80:83], a[192:195], a[88:91], v[80:83]
  s_waitcnt vmcnt(8)
  v_mfma_f32_16x16x32_bf16 v[64:67], a[224:227], a[96:99], v[64:67]
  buffer_load_dwordx4 a[132:135], v20, s[20:23], s64 offen offset:1024 sc1
  s_waitcnt vmcnt(8)
  v_mfma_f32_16x16x32_bf16 v[64:67], a[228:231], a[100:103], v[64:67]
  v_mfma_f32_16x16x32_bf16 v[68:71], a[236:239], a[100:103], v[68:71]
  s_add_u32 s64, s63, 102400
  v_mfma_f32_16x16x32_bf16 v[68:71], a[232:235], a[96:99], v[68:71]
  buffer_load_dwordx4 a[136:139], v20, s[20:23], s64 offen sc1
  v_mfma_f32_16x16x32_bf16 v[72:75], a[240:243], a[96:99], v[72:75]
  v_mfma_f32_16x16x32_bf16 v[72:75], a[244:247], a[100:103], v[72:75]
  v_mfma_f32_16x16x32_bf16 v[76:79], a[252:255], a[100:103], v[76:79]
  buffer_load_dwordx4 a[140:143], v20, s[20:23], s64 offen offset:1024 sc1
  v_mfma_f32_16x16x32_bf16 v[76:79], a[248:251], a[96:99], v[76:79]
  s_waitcnt vmcnt(9)
  v_mfma_f32_16x16x32_bf16 v[80:83], a[224:227], a[104:107], v[80:83]
  s_add_u32 s64, s63, 135168
  s_waitcnt vmcnt(8)
  v_mfma_f32_16x16x32_bf16 v[80:83], a[228:231], a[108:111], v[80:83]
  buffer_load_dwordx4 a[144:147], v20, s[20:23], s64 offen sc1
  v_mfma_f32_16x16x32_bf16 v[84:87], a[236:239], a[108:111], v[84:87]
  v_mfma_f32_16x16x32_bf16 v[84:87], a[232:235], a[104:107], v[84:87]
  s_load_dwordx8 s[4:11], s[14:15], 6144 glc
  v_mfma_f32_16x16x32_bf16 v[88:91], a[240:243], a[104:107], v[88:91]
  buffer_load_dwordx4 a[148:151], v20, s[20:23], s64 offen offset:1024 sc1
  v_mfma_f32_16x16x32_bf16 v[88:91], a[244:247], a[108:111], v[88:91]
  v_mfma_f32_16x16x32_bf16 v[92:95], a[252:255], a[108:111], v[92:95]
  v_mfma_f32_16x16x32_bf16 v[92:95], a[248:251], a[104:107], v[92:95]
  s_waitcnt vmcnt(9)
  v_mfma_f32_16x16x32_bf16 v[32:35], v[192:195], a[112:115], 0
  s_add_u32 s64, s63, 167936
  s_waitcnt vmcnt(8)
  v_mfma_f32_16x16x32_bf16 v[32:35], v[196:199], a[116:119], v[32:35]
  buffer_load_dwordx4 a[152:155], v20, s[20:23], s64 offen sc1
  v_mfma_f32_16x16x32_bf16 v[36:39], v[204:207], a[116:119], 0
  v_mfma_f32_16x16x32_bf16 v[36:39], v[200:203], a[112:115], v[36:39]
  v_mfma_f32_16x16x32_bf16 v[40:43], v[208:211], a[112:115], 0
  buffer_load_dwordx4 a[156:159], v20, s[20:23], s64 offen offset:1024 sc1
  v_mfma_f32_16x16x32_bf16 v[40:43], v[212:215], a[116:119], v[40:43]
  v_mfma_f32_16x16x32_bf16 v[44:47], v[220:223], a[116:119], 0
  ds_write_b128 v25, v[64:67] offset:0
  v_mfma_f32_16x16x32_bf16 v[44:47], v[216:219], a[112:115], v[44:47]
  s_waitcnt vmcnt(9)
  v_mfma_f32_16x16x32_bf16 v[44:47], v[248:251], a[120:123], v[44:47]
  s_add_u32 s64, s63, 200704
  s_waitcnt vmcnt(8)
  v_mfma_f32_16x16x32_bf16 v[44:47], v[252:255], a[124:127], v[44:47]
  buffer_load_dwordx4 a[0:3], v20, s[20:23], s64 offen sc1
  v_mfma_f32_16x16x32_bf16 v[40:43], v[244:247], a[124:127], v[40:43]
  ds_write_b128 v25, v[68:71] offset:1024
  v_mfma_f32_16x16x32_bf16 v[40:43], v[240:243], a[120:123], v[40:43]
  v_mfma_f32_16x16x32_bf16 v[36:39], v[232:235], a[120:123], v[36:39]
  buffer_load_dwordx4 a[4:7], v20, s[20:23], s64 offen offset:1024 sc1
  v_mfma_f32_16x16x32_bf16 v[36:39], v[236:239], a[124:127], v[36:39]
  v_mfma_f32_16x16x32_bf16 v[32:35], v[228:231], a[124:127], v[32:35]
  ds_write_b128 v25, v[72:75] offset:2048
  v_mfma_f32_16x16x32_bf16 v[32:35], v[224:227], a[120:123], v[32:35]
  s_waitcnt lgkmcnt(0)
  s_xor_b64 s[4:5], s[4:5], s[16:17]
  s_xor_b64 s[6:7], s[6:7], s[16:17]
  s_xor_b64 s[8:9], s[8:9], s[16:17]
  s_xor_b64 s[10:11], s[10:11], s[16:17]
  s_or_b64 s[4:5], s[4:5], s[6:7]
  s_or_b64 s[8:9], s[8:9], s[10:11]
  s_or_b64 s[4:5], s[4:5], s[8:9]
  s_cbranch_scc1 Lsf20_retry
Lsf20:
  s_waitcnt vmcnt(9)
  v_mfma_f32_16x16x32_bf16 v[32:35], v[128:131], a[128:131], v[32:35]
  s_add_u32 s64, s63, 6144
  s_waitcnt vmcnt(8)
  v_mfma_f32_16x16x32_bf16 v[32:35], v[132:135], a[132:135], v[32:35]
  buffer_load_dwordx4 a[8:11], v20, s[20:23], s64 offen sc1
  v_mfma_f32_16x16x32_bf16 v[36:39], v[140:143], a[132:135], v[36:39]
  ds_write_b128 v25, v[76:79] offset:3072
  v_mfma_f32_16x16x32_bf16 v[36:39], v[136:139], a[128:131], v[36:39]
  v_mfma_f32_16x16x32_bf16 v[40:43], v[144:147], a[128:131], v[40:43]
  buffer_load_dwordx4 a[12:15], v20, s[20:23], s64 offen offset:1024 sc1
  v_mfma_f32_16x16x32_bf16 v[40:43], v[148:151], a[132:135], v[40:43]
  v_mfma_f32_16x16x32_bf16 v[44:47], v[156:159], a[132:135], v[44:47]
  ds_write_b128 v25, v[80:83] offset:4096
  v_mfma_f32_16x16x32_bf16 v[44:47], v[152:155], a[128:131], v[44:47]
  s_waitcnt vmcnt(9)
  v_mfma_f32_16x16x32_bf16 v[44:47], v[184:187], a[136:139], v[44:47]
  s_add_u32 s64, s63, 38912
  s_waitcnt vmcnt(8)
  v_mfma_f32_16x16x32_bf16 v[44:47], v[188:191], a[140:143], v[44:47]
  buffer_load_dwordx4 a[16:19], v20, s[20:23], s64 offen sc1
  v_mfma_f32_16x16x32_bf16 v[40:43], v[180:183], a[140:143], v[40:43]
  ds_write_b128 v25, v[84:87] offset:5120
  v_mfma_f32_16x16x32_bf16 v[40:43], v[176:179], a[136:139], v[40:43]
  v_mfma_f32_16x16x32_bf16 v[36:39], v[168:171], a[136:139], v[36:39]
  buffer_load_dwordx4 a[20:23], v20, s[20:23], s64 offen offset:1024 sc1
  v_mfma_f32_16x16x32_bf16 v[36:39], v[172:175], a[140:143], v[36:39]
  v_mfma_f32_16x16x32_bf16 v[32:35], v[164:167], a[140:143], v[32:35]
  ds_write_b128 v25, v[88:91] offset:6144
  v_mfma_f32_16x16x32_bf16 v[32:35], v[160:163], a[136:139], v[32:35]
  s_waitcnt vmcnt(9)
  v_mfma_f32_16x16x32_bf16 v[32:35], a[160:163], a[144:147], v[32:35]
  s_add_u32 s64, s63, 71680
  s_waitcnt vmcnt(8)
  v_mfma_f32_16x16x32_bf16 v[32:35], a[164:167], a[148:151], v[32:35]
  buffer_load_dwordx4 a[24:27], v20, s[20:23], s64 offen sc1
  v_mfma_f32_16x16x32_bf16 v[36:39], a[172:175], a[148:151], v[36:39]
  ds_write_b128 v25, v[92:95] offset:7168
  v_mfma_f32_16x16x32_bf16 v[36:39], a[168:171], a[144:147], v[36:39]
  v_mfma_f32_16x16x32_bf16 v[40:43], a[176:179], a[144:147], v[40:43]
  buffer_load_dwordx4 a[28:31], v20, s[20:23], s64 offen offset:1024 sc1
  v_mfma_f32_16x16x32_bf16 v[40:43], a[180:183], a[148:151], v[40:43]
  v_mfma_f32_16x16x32_bf16 v[44:47], a[188:191], a[148:151], v[44:47]
  v_mfma_f32_16x16x32_bf16 v[44:47], a[184:187], a[144:147], v[44:47]
  s_waitcnt vmcnt(9)
  v_mfma_f32_16x16x32_bf16 v[44:47], a[216:219], a[152:155], v[44:47]
  s_add_u32 s64, s63, 104448
  s_waitcnt lgkmcnt(0)
  s_barrier
  s_waitcnt vmcnt(8)
  v_mfma_f32_16x16x32_bf16 v[44:47], a[220:223], a[156:159], v[44:47]
  buffer_load_dwordx4 a[32:35], v20, s[20:23], s64 offen sc1
  v_mfma_f32_16x16x32_bf16 v[40:43], a[212:215], a[156:159], v[40:43]
  ds_read_b128 v[108:111], v26 offset:0
  v_mfma_f32_16x16x32_bf16 v[40:43], a[208:211], a[152:155], v[40:43]
  ds_read_b128 v[112:115], v26 offset:24576
  v_mfma_f32_16x16x32_bf16 v[36:39], a[200:203], a[152:155], v[36:39]
  buffer_load_dwordx4 a[36:39], v20, s[20:23], s64 offen offset:1024 sc1
  v_mfma_f32_16x16x32_bf16 v[36:39], a[204:207], a[156:159], v[36:39]
  ds_read_b128 v[116:119], v27 offset:0
  v_mfma_f32_16x16x32_bf16 v[32:35], a[196:199], a[156:159], v[32:35]
  ds_read_b128 v[120:123], v27 offset:24576
  v_mfma_f32_16x16x32_bf16 v[32:35], a[192:195], a[152:155], v[32:35]
  ds_read_b64 v[96:97], v21 offset:0
  s_waitcnt vmcnt(9)
  v_mfma_f32_16x16x32_bf16 v[32:35], a[224:227], a[0:3], v[32:35]
  s_add_u32 s64, s63, 137216
  s_add_u32 s36, s67, 0
  s_waitcnt vmcnt(8)
  v_mfma_f32_16x16x32_bf16 v[32:35], a[228:231], a[4:7], v[32:35]
  buffer_load_dwordx4 a[40:43], v20, s[20:23], s64 offen sc1
  v_mfma_f32_16x16x32_bf16 v[36:39], a[236:239], a[4:7], v[36:39]
  s_waitcnt lgkmcnt(3)
  v_add_f32 v108, v108, v112
  v_add_f32 v109, v109, v113
  v_mfma_f32_16x16x32_bf16 v[36:39], a[232:235], a[0:3], v[36:39]
  v_add_f32 v110, v110, v114
  v_add_f32 v111, v111, v115
  v_mfma_f32_16x16x32_bf16 v[40:43], a[240:243], a[0:3], v[40:43]
  buffer_load_dwordx4 a[44:47], v20, s[20:23], s64 offen offset:1024 sc1
  v_mfma_f32_16x16x32_bf16 v[40:43], a[244:247], a[4:7], v[40:43]
  s_waitcnt lgkmcnt(1)
  v_add_f32 v116, v116, v120
  v_add_f32 v117, v117, v121
  v_mfma_f32_16x16x32_bf16 v[44:47], a[252:255], a[4:7], v[44:47]
  v_add_f32 v118, v118, v122
  v_add_f32 v119, v119, v123
  v_mfma_f32_16x16x32_bf16 v[44:47], a[248:251], a[0:3], v[44:47]
  s_waitcnt lgkmcnt(0)
  v_lshlrev_b32 v112, 16, v96
  s_waitcnt vmcnt(9)
  v_mfma_f32_16x16x32_bf16 v[48:51], v[192:195], a[8:11], 0
  s_add_u32 s64, s63, 169984
  v_and_b32 v113, s70, v96
  s_waitcnt vmcnt(8)
  v_mfma_f32_16x16x32_bf16 v[48:51], v[196:199], a[12:15], v[48:51]
  buffer_load_dwordx4 a[48:51], v20, s[20:23], s64 offen sc1
  v_mfma_f32_16x16x32_bf16 v[52:55], v[204:207], a[12:15], 0
  v_lshlrev_b32 v114, 16, v97
  v_and_b32 v115, s70, v97
  v_mfma_f32_16x16x32_bf16 v[52:55], v[200:203], a[8:11], v[52:55]
  v_add_f32 v108, v108, v116
  v_add_f32 v109, v109, v117
  v_mfma_f32_16x16x32_bf16 v[56:59], v[208:211], a[8:11], 0
  buffer_load_dwordx4 a[52:55], v20, s[20:23], s64 offen offset:1024 sc1
  v_mfma_f32_16x16x32_bf16 v[56:59], v[212:215], a[12:15], v[56:59]
  v_add_f32 v110, v110, v118
  v_add_f32 v111, v111, v119
  v_mfma_f32_16x16x32_bf16 v[60:63], v[220:223], a[12:15], 0
  ds_write_b128 v25, v[32:35] offset:8192
  v_mfma_f32_16x16x32_bf16 v[60:63], v[216:219], a[8:11], v[60:63]
  v_fmac_f32 v112, v108, v104
  s_waitcnt vmcnt(9)
  v_mfma_f32_16x16x32_bf16 v[60:63], v[248:251], a[16:19], v[60:63]
  s_add_u32 s64, s63, 202752
  ds_write_b128 v25, v[36:39] offset:9216
  s_waitcnt vmcnt(8)
  v_mfma_f32_16x16x32_bf16 v[60:63], v[252:255], a[20:23], v[60:63]
  buffer_load_dwordx4 a[56:59], v20, s[20:23], s64 offen sc1
  v_mfma_f32_16x16x32_bf16 v[56:59], v[244:247], a[20:23], v[56:59]
  ds_write_b128 v25, v[40:43] offset:10240
  v_mfma_f32_16x16x32_bf16 v[56:59], v[240:243], a[16:19], v[56:59]
  v_fmac_f32 v113, v109, v105
  v_fmac_f32 v114, v110, v106
  v_mfma_f32_16x16x32_bf16 v[52:55], v[232:235], a[16:19], v[52:55]
  buffer_load_dwordx4 a[60:63], v20, s[20:23], s64 offen offset:1024 sc1
  ds_write_b128 v25, v[44:47] offset:11264
  v_mfma_f32_16x16x32_bf16 v[52:55], v[236:239], a[20:23], v[52:55]
  v_fmac_f32 v115, v111, v107
  v_cvt_pk_bf16_f32 v96, v112, v113
  v_mfma_f32_16x16x32_bf16 v[48:51], v[228:231], a[20:23], v[48:51]
  v_cvt_pk_bf16_f32 v97, v114, v115
  v_mfma_f32_16x16x32_bf16 v[48:51], v[224:227], a[16:19], v[48:51]
  buffer_store_dwordx2 v[96:97], v19, s[52:55], s36 offen sc1
  s_waitcnt vmcnt(10)
  v_mfma_f32_16x16x32_bf16 v[48:51], v[128:131], a[24:27], v[48:51]
  ds_read_b128 v[108:111], v26 offset:4096
  s_waitcnt vmcnt(9)
  v_mfma_f32_16x16x32_bf16 v[48:51], v[132:135], a[28:31], v[48:51]
  ds_read_b128 v[112:115], v26 offset:28672
  v_mfma_f32_16x16x32_bf16 v[52:55], v[140:143], a[28:31], v[52:55]
  s_waitcnt lgkmcnt(2)
  s_barrier
  ds_read_b128 v[116:119], v27 offset:4096
  v_mfma_f32_16x16x32_bf16 v[52:55], v[136:139], a[24:27], v[52:55]
  ds_read_b128 v[120:123], v27 offset:28672
  v_mfma_f32_16x16x32_bf16 v[56:59], v[144:147], a[24:27], v[56:59]
  ds_read_b64 v[98:99], v21 offset:24576
  s_add_u32 s36, s67, 16384
  v_mfma_f32_16x16x32_bf16 v[56:59], v[148:151], a[28:31], v[56:59]
  s_waitcnt lgkmcnt(3)
  v_add_f32 v108, v108, v112
  v_add_f32 v109, v109, v113
  v_mfma_f32_16x16x32_bf16 v[60:63], v[156:159], a[28:31], v[60:63]
  v_add_f32 v110, v110, v114
  v_add_f32 v111, v111, v115
  v_mfma_f32_16x16x32_bf16 v[60:63], v[152:155], a[24:27], v[60:63]
  s_waitcnt lgkmcnt(1)
  v_add_f32 v116, v116, v120
  s_waitcnt vmcnt(8)
  v_mfma_f32_16x16x32_bf16 v[60:63], v[184:187], a[32:35], v[60:63]
  v_add_f32 v117, v117, v121
  v_add_f32 v118, v118, v122
  s_waitcnt vmcnt(7)
  v_mfma_f32_16x16x32_bf16 v[60:63], v[188:191], a[36:39], v[60:63]
  v_add_f32 v119, v119, v123
  s_waitcnt lgkmcnt(0)
  v_lshlrev_b32 v112, 16, v98
  v_mfma_f32_16x16x32_bf16 v[56:59], v[180:183], a[36:39], v[56:59]
  v_and_b32 v113, s70, v98
  v_lshlrev_b32 v114, 16, v99
  v_mfma_f32_16x16x32_bf16 v[56:59], v[176:179], a[32:35], v[56:59]
  v_and_b32 v115, s70, v99
  v_add_f32 v108, v108, v116
  v_mfma_f32_16x16x32_bf16 v[52:55], v[168:171], a[32:35], v[52:55]
  v_add_f32 v109, v109, v117
  v_add_f32 v110, v110, v118
  v_mfma_f32_16x16x32_bf16 v[52:55], v[172:175], a[36:39], v[52:55]
  v_add_f32 v111, v111, v119
  v_fmac_f32 v112, v108, v104
  v_mfma_f32_16x16x32_bf16 v[48:51], v[164:167], a[36:39], v[48:51]
  v_fmac_f32 v113, v109, v105
  v_fmac_f32 v114, v110, v106
  v_mfma_f32_16x16x32_bf16 v[48:51], v[160:163], a[32:35], v[48:51]
  v_fmac_f32 v115, v111, v107
  s_waitcnt vmcnt(6)
  v_mfma_f32_16x16x32_bf16 v[48:51], a[160:163], a[40:43], v[48:51]
  v_cvt_pk_bf16_f32 v98, v112, v113
  v_cvt_pk_bf16_f32 v99, v114, v115
  s_waitcnt vmcnt(5)
  v_mfma_f32_16x16x32_bf16 v[48:51], a[164:167], a[44:47], v[48:51]
  buffer_store_dwordx2 v[98:99], v19, s[52:55], s36 offen sc1
  v_mfma_f32_16x16x32_bf16 v[52:55], a[172:175], a[44:47], v[52:55]
  ds_read_b128 v[108:111], v26 offset:8192
  v_mfma_f32_16x16x32_bf16 v[52:55], a[168:171], a[40:43], v[52:55]
  ds_read_b128 v[112:115], v26 offset:32768
  v_mfma_f32_16x16x32_bf16 v[56:59], a[176:179], a[40:43], v[56:59]
  ds_read_b128 v[116:119], v27 offset:8192
  v_mfma_f32_16x16x32_bf16 v[56:59], a[180:183], a[44:47], v[56:59]
  ds_read_b128 v[120:123], v27 offset:32768
  v_mfma_f32_16x16x32_bf16 v[60:63], a[188:191], a[44:47], v[60:63]
  ds_read_b64 v[100:101], v22 offset:0
  s_add_u32 s36, s67, 32768
  v_mfma_f32_16x16x32_bf16 v[60:63], a[184:187], a[40:43], v[60:63]
  s_waitcnt lgkmcnt(3)
  v_add_f32 v108, v108, v112
  s_waitcnt vmcnt(5)
  v_mfma_f32_16x16x32_bf16 v[60:63], a[216:219], a[48:51], v[60:63]
  v_add_f32 v109, v109, v113
  v_add_f32 v110, v110, v114
  s_waitcnt vmcnt(4)
  v_mfma_f32_16x16x32_bf16 v[60:63], a[220:223], a[52:55], v[60:63]
  v_add_f32 v111, v111, v115
  s_waitcnt lgkmcnt(1)
  v_add_f32 v116, v116, v120
  v_mfma_f32_16x16x32_bf16 v[56:59], a[212:215], a[52:55], v[56:59]
  v_add_f32 v117, v117, v121
  v_add_f32 v118, v118, v122
  v_mfma_f32_16x16x32_bf16 v[56:59], a[208:211], a[48:51], v[56:59]
  v_add_f32 v119, v119, v123
  s_waitcnt lgkmcnt(0)
  v_lshlrev_b32 v112, 16, v100
  v_mfma_f32_16x16x32_bf16 v[52:55], a[200:203], a[48:51], v[52:55]
  v_and_b32 v113, s70, v100
  v_lshlrev_b32 v114, 16, v101
  v_mfma_f32_16x16x32_bf16 v[52:55], a[204:207], a[52:55], v[52:55]
  v_and_b32 v115, s70, v101
  v_add_f32 v108, v108, v116
  v_mfma_f32_16x16x32_bf16 v[48:51], a[196:199], a[52:55], v[48:51]
  v_add_f32 v109, v109, v117
  v_add_f32 v110, v110, v118
  v_mfma_f32_16x16x32_bf16 v[48:51], a[192:195], a[48:51], v[48:51]
  v_add_f32 v111, v111, v119
  s_waitcnt vmcnt(3)
  v_mfma_f32_16x16x32_bf16 v[48:51], a[224:227], a[56:59], v[48:51]
  v_fmac_f32 v112, v108, v104
  v_fmac_f32 v113, v109, v105
  s_waitcnt vmcnt(2)
  v_mfma_f32_16x16x32_bf16 v[48:51], a[228:231], a[60:63], v[48:51]
  v_fmac_f32 v114, v110, v106
  v_fmac_f32 v115, v111, v107
  v_mfma_f32_16x16x32_bf16 v[52:55], a[236:239], a[60:63], v[52:55]
  v_cvt_pk_bf16_f32 v100, v112, v113
  v_cvt_pk_bf16_f32 v101, v114, v115
  v_mfma_f32_16x16x32_bf16 v[52:55], a[232:235], a[56:59], v[52:55]
  buffer_store_dwordx2 v[100:101], v19, s[52:55], s36 offen sc1
  v_mfma_f32_16x16x32_bf16 v[56:59], a[240:243], a[56:59], v[56:59]
  v_mfma_f32_16x16x32_bf16 v[56:59], a[244:247], a[60:63], v[56:59]
  v_mfma_f32_16x16x32_bf16 v[60:63], a[252:255], a[60:63], v[60:63]
  v_mfma_f32_16x16x32_bf16 v[60:63], a[248:251], a[56:59], v[60:63]
  ds_write_b128 v25, v[48:51] offset:12288
  s_nop 1
  ds_write_b128 v25, v[52:55] offset:13312
  s_nop 1
  ds_write_b128 v25, v[56:59] offset:14336
  s_nop 0
  ds_write_b128 v25, v[60:63] offset:15360
  s_waitcnt lgkmcnt(0)
  s_barrier
  ds_read_b128 v[108:111], v26 offset:12288
  ds_read_b128 v[112:115], v26 offset:36864
  ds_read_b128 v[116:119], v27 offset:12288
  ds_read_b128 v[120:123], v27 offset:36864
  ds_read_b64 v[102:103], v22 offset:24576
  s_add_u32 s36, s67, 49152
  s_waitcnt lgkmcnt(3)
  v_add_f32 v108, v108, v112
  v_add_f32 v109, v109, v113
  v_add_f32 v110, v110, v114
  v_add_f32 v111, v111, v115
  s_waitcnt lgkmcnt(1)
  v_add_f32 v116, v116, v120
  v_add_f32 v117, v117, v121
  v_add_f32 v118, v118, v122
  v_add_f32 v119, v119, v123
  s_waitcnt lgkmcnt(0)
  v_lshlrev_b32 v112, 16, v102
  v_and_b32 v113, s70, v102
  v_lshlrev_b32 v114, 16, v103
  v_and_b32 v115, s70, v103
  v_add_f32 v108, v108, v116
  v_add_f32 v109, v109, v117
  v_add_f32 v110, v110, v118
  v_add_f32 v111, v111, v119
  v_fmac_f32 v112, v108, v104
  v_fmac_f32 v113, v109, v105
  v_fmac_f32 v114, v110, v106
  v_fmac_f32 v115, v111, v107
  v_cvt_pk_bf16_f32 v102, v112, v113
  v_cvt_pk_bf16_f32 v103, v114, v115
  buffer_store_dwordx2 v[102:103], v19, s[52:55], s36 offen sc1
L_end:
  s_endpgm
Lchk1_retry:
  s_mov_b32 s33, 0
Lpoll2:
  buffer_load_dwordx4 v[224:227], v240, s[20:23], 0 offen offset:2048 sc1
  buffer_load_dwordx4 v[228:231], v240, s[20:23], 0 offen offset:3072 sc1
  buffer_load_dwordx4 v[232:235], v240, s[20:23], 0 offen offset:0 sc1
  buffer_load_dwordx4 v[236:239], v240, s[20:23], 0 offen offset:1024 sc1
  s_add_u32 s33, s33, 1
  s_waitcnt vmcnt(0)
  v_xor_b32 v84, s30, v225
  v_bitop3_b32 v84, v84, v227, s30 bitop3:0xf6
  v_bitop3_b32 v84, v84, v229, s30 bitop3:0xf6
  v_bitop3_b32 v84, v84, v231, s30 bitop3:0xf6
  v_bitop3_b32 v84, v84, v233, s30 bitop3:0xf6
  v_bitop3_b32 v84, v84, v235, s30 bitop3:0xf6
  v_bitop3_b32 v84, v84, v237, s30 bitop3:0xf6
  v_bitop3_b32 v84, v84, v239, s30 bitop3:0xf6
  v_cmp_ne_u32 vcc, 0, v84
  s_nop 1
  s_cmp_lt_u32 s33, 400000
  s_cselect_b64 vcc, vcc, 0
  s_cbranch_vccnz Lpoll2
  s_nop 7
  s_branch Lchk1
L_ep:
  s_mov_b32 s34, 32768
  v_mov_b32 v88, s30
  s_mov_b64 exec, 1
  buffer_store_dword v88, off, s[20:23], s34 sc1
  s_mov_b64 exec, -1
  s_nop 7
  s_branch L_noep
L_gretry:
  s_mov_b32 s33, 0
Lpoll3:
  buffer_load_dwordx4 v[64:67], v19, s[20:23], s66 offen offset:0 sc1
  buffer_load_dwordx4 v[68:71], v19, s[20:23], s66 offen offset:1024 sc1
  buffer_load_dwordx4 v[72:75], v19, s[20:23], s66 offen offset:2048 sc1
  buffer_load_dwordx4 v[76:79], v19, s[20:23], s66 offen offset:3072 sc1
  buffer_load_dwordx4 v[80:83], v19, s[20:23], s67 offen offset:0 sc1
  buffer_load_dwordx4 v[84:87], v19, s[20:23], s67 offen offset:1024 sc1
  s_add_u32 s33, s33, 1
  s_waitcnt vmcnt(0)
  v_xor_b32 v30, s30, v65
  v_bitop3_b32 v30, v30, v67, s30 bitop3:0xf6
  v_bitop3_b32 v30, v30, v69, s30 bitop3:0xf6
  v_bitop3_b32 v30, v30, v71, s30 bitop3:0xf6
  v_bitop3_b32 v30, v30, v73, s30 bitop3:0xf6
  v_bitop3_b32 v30, v30, v75, s30 bitop3:0xf6
  v_bitop3_b32 v30, v30, v77, s30 bitop3:0xf6
  v_bitop3_b32 v30, v30, v79, s30 bitop3:0xf6
  v_bitop3_b32 v30, v30, v81, s30 bitop3:0xf6
  v_bitop3_b32 v30, v30, v83, s30 bitop3:0xf6
  v_bitop3_b32 v30, v30, v85, s30 bitop3:0xf6
  v_bitop3_b32 v30, v30, v87, s30 bitop3:0xf6
  v_cmp_ne_u32 vcc, 0, v30
  s_nop 1
  s_cmp_lt_u32 s33, 400000
  s_cselect_b64 vcc, vcc, 0
  s_cbranch_vccnz Lpoll3
  s_nop 7
  s_branch L_gok
L_p0late:
  s_mov_b32 s33, 400000
Lspin4:
  s_load_dwordx8 s[4:11], s[14:15], 0 glc
  s_sub_u32 s33, s33, 1
  s_waitcnt lgkmcnt(0)
  s_xor_b64 s[4:5], s[4:5], s[16:17]
  s_xor_b64 s[6:7], s[6:7], s[16:17]
  s_xor_b64 s[8:9], s[8:9], s[16:17]
  s_xor_b64 s[10:11], s[10:11], s[16:17]
  s_or_b64 s[4:5], s[4:5], s[6:7]
  s_or_b64 s[8:9], s[8:9], s[10:11]
  s_or_b64 s[4:5], s[4:5], s[8:9]
  s_cselect_b32 s4, s33, 0
  s_cmp_lg_u32 s4, 0
  s_cbranch_scc1 Lspin4
  s_add_u32 s64, s63, 0
  buffer_load_dwordx4 v[128:131], v25, s[20:23], s64 offen sc1 nt
  s_add_u32 s64, s63, 65536
  buffer_load_dwordx4 v[132:135], v25, s[20:23], s64 offen sc1 nt
  s_add_u32 s64, s63, 131072
  buffer_load_dwordx4 v[136:139], v25, s[20:23], s64 offen sc1 nt
  s_add_u32 s64, s63, 196608
  buffer_load_dwordx4 v[140:143], v25, s[20:23], s64 offen sc1 nt
  s_add_u32 s64, s63, 262144
  buffer_load_dwordx4 v[144:147], v25, s[20:23], s64 offen sc1 nt
  s_add_u32 s64, s63, 327680
  buffer_load_dwordx4 v[148:151], v25, s[20:23], s64 offen sc1 nt
  s_add_u32 s64, s63, 393216
  buffer_load_dwordx4 v[152:155], v25, s[20:23], s64 offen sc1 nt
  s_add_u32 s64, s63, 458752
  buffer_load_dwordx4 v[156:159], v25, s[20:23], s64 offen sc1 nt
  s_nop 7
  s_branch L_p0join
L_stageX:
  s_add_u32 m0, s26, 8192
  s_add_u32 s27, s60, 458752
  buffer_load_dwordx4 v21, s[44:47], s27 offen offset:0 lds
  buffer_load_dwordx4 v22, s[44:47], s27 offen offset:1024 lds
  buffer_load_dwordx4 v23, s[44:47], s27 offen offset:2048 lds
  buffer_load_dwordx4 v24, s[44:47], s27 offen offset:3072 lds
  s_add_u32 m0, s26, 12288
  s_add_u32 s27, s60, 573440
  buffer_load_dwordx4 v21, s[44:47], s27 offen offset:0 lds
  buffer_load_dwordx4 v22, s[44:47], s27 offen offset:1024 lds
  buffer_load_dwordx4 v23, s[44:47], s27 offen offset:2048 lds
  buffer_load_dwordx4 v24, s[44:47], s27 offen offset:3072 lds
  ds_read_b64_tr_b16 a[0:1], v2 offset:0
  ds_read_b64_tr_b16 a[2:3], v2 offset:512
  ds_read_b64_tr_b16 a[8:9], v3 offset:0
  ds_read_b64_tr_b16 a[10:11], v3 offset:512
  ds_read_b64_tr_b16 a[16:17], v4 offset:0
  ds_read_b64_tr_b16 a[18:19], v4 offset:512
  ds_read_b64_tr_b16 a[24:25], v5 offset:0
  ds_read_b64_tr_b16 a[26:27], v5 offset:512
  ds_read_b64_tr_b16 a[4:5], v2 offset:4096
  ds_read_b64_tr_b16 a[6:7], v2 offset:4608
  ds_read_b64_tr_b16 a[12:13], v3 offset:4096
  ds_read_b64_tr_b16 a[14:15], v3 offset:4608
  ds_read_b64_tr_b16 a[20:21], v4 offset:4096
  ds_read_b64_tr_b16 a[22:23], v4 offset:4608
  ds_read_b64_tr_b16 a[28:29], v5 offset:4096
  ds_read_b64_tr_b16 a[30:31], v5 offset:4608
  s_waitcnt lgkmcnt(0)
  s_add_u32 m0, s26, 0
  s_add_u32 s27, s60, 688128
  buffer_load_dwordx4 v21, s[44:47], s27 offen offset:0 lds
  buffer_load_dwordx4 v22, s[44:47], s27 offen offset:1024 lds
  buffer_load_dwordx4 v23, s[44:47], s27 offen offset:2048 lds
  buffer_load_dwordx4 v24, s[44:47], s27 offen offset:3072 lds
  s_add_u32 m0, s26, 4096
  s_add_u32 s27, s60, 802816
  buffer_load_dwordx4 v21, s[44:47], s27 offen offset:0 lds
  buffer_load_dwordx4 v22, s[44:47], s27 offen offset:1024 lds
  buffer_load_dwordx4 v23, s[44:47], s27 offen offset:2048 lds
  buffer_load_dwordx4 v24, s[44:47], s27 offen offset:3072 lds
  s_waitcnt vmcnt(16)
  ds_read_b64_tr_b16 a[32:33], v2 offset:16384
  ds_read_b64_tr_b16 a[34:35], v2 offset:16896
  ds_read_b64_tr_b16 a[40:41], v3 offset:16384
  ds_read_b64_tr_b16 a[42:43], v3 offset:16896
  ds_read_b64_tr_b16 a[48:49], v4 offset:16384
  ds_read_b64_tr_b16 a[50:51], v4 offset:16896
  ds_read_b64_tr_b16 a[56:57], v5 offset:16384
  ds_read_b64_tr_b16 a[58:59], v5 offset:16896
  ds_read_b64_tr_b16 a[36:37], v2 offset:20480
  ds_read_b64_tr_b16 a[38:39], v2 offset:20992
  ds_read_b64_tr_b16 a[44:45], v3 offset:20480
  ds_read_b64_tr_b16 a[46:47], v3 offset:20992
  ds_read_b64_tr_b16 a[52:53], v4 offset:20480
  ds_read_b64_tr_b16 a[54:55], v4 offset:20992
  ds_read_b64_tr_b16 a[60:61], v5 offset:20480
  ds_read_b64_tr_b16 a[62:63], v5 offset:20992
  s_waitcnt lgkmcnt(0)
  s_add_u32 m0, s26, 16384
  s_add_u32 s27, s60, 917504
  buffer_load_dwordx4 v21, s[44:47], s27 offen offset:0 lds
  buffer_load_dwordx4 v22, s[44:47], s27 offen offset:1024 lds
  buffer_load_dwordx4 v23, s[44:47], s27 offen offset:2048 lds
  buffer_load_dwordx4 v24, s[44:47], s27 offen offset:3072 lds
  s_add_u32 m0, s26, 20480
  s_add_u32 s27, s60, 1032192
  buffer_load_dwordx4 v21, s[44:47], s27 offen offset:0 lds
  buffer_load_dwordx4 v22, s[44:47], s27 offen offset:1024 lds
  buffer_load_dwordx4 v23, s[44:47], s27 offen offset:2048 lds
  buffer_load_dwordx4 v24, s[44:47], s27 offen offset:3072 lds
  s_waitcnt vmcnt(16)
  ds_read_b64_tr_b16 a[64:65], v2 offset:8192
L_page15:
  s_cmp_eq_u32 s100, 1
  s_cbranch_scc1 L_pgretY
  ds_read_b64_tr_b16 a[66:67], v2 offset:8704
  ds_read_b64_tr_b16 a[72:73], v3 offset:8192
  ds_read_b64_tr_b16 a[74:75], v3 offset:8704
  ds_read_b64_tr_b16 a[80:81], v4 offset:8192
  ds_read_b64_tr_b16 a[82:83], v4 offset:8704
  ds_read_b64_tr_b16 a[88:89], v5 offset:8192
  ds_read_b64_tr_b16 a[90:91], v5 offset:8704
  ds_read_b64_tr_b16 a[68:69], v2 offset:12288
  ds_read_b64_tr_b16 a[70:71], v2 offset:12800
  ds_read_b64_tr_b16 a[76:77], v3 offset:12288
  ds_read_b64_tr_b16 a[78:79], v3 offset:12800
  ds_read_b64_tr_b16 a[84:85], v4 offset:12288
  ds_read_b64_tr_b16 a[86:87], v4 offset:12800
  ds_read_b64_tr_b16 a[92:93], v5 offset:12288
  ds_read_b64_tr_b16 a[94:95], v5 offset:12800
  s_waitcnt lgkmcnt(0)
  s_add_u32 m0, s26, 8192
  s_add_u32 s27, s60, 1146880
  buffer_load_dwordx4 v21, s[44:47], s27 offen offset:0 lds
  buffer_load_dwordx4 v22, s[44:47], s27 offen offset:1024 lds
  buffer_load_dwordx4 v23, s[44:47], s27 offen offset:2048 lds
  buffer_load_dwordx4 v24, s[44:47], s27 offen offset:3072 lds
  s_add_u32 m0, s26, 12288
  s_add_u32 s27, s60, 1261568
  buffer_load_dwordx4 v21, s[44:47], s27 offen offset:0 lds
  buffer_load_dwordx4 v22, s[44:47], s27 offen offset:1024 lds
  buffer_load_dwordx4 v23, s[44:47], s27 offen offset:2048 lds
  buffer_load_dwordx4 v24, s[44:47], s27 offen offset:3072 lds
  s_waitcnt vmcnt(16)
  ds_read_b64_tr_b16 a[96:97], v2 offset:0
  ds_read_b64_tr_b16 a[98:99], v2 offset:512
  ds_read_b64_tr_b16 a[104:105], v3 offset:0
  ds_read_b64_tr_b16 a[106:107], v3 offset:512
  ds_read_b64_tr_b16 a[112:113], v4 offset:0
  ds_read_b64_tr_b16 a[114:115], v4 offset:512
  ds_read_b64_tr_b16 a[120:121], v5 offset:0
  ds_read_b64_tr_b16 a[122:123], v5 offset:512
  ds_read_b64_tr_b16 a[100:101], v2 offset:4096
  ds_read_b64_tr_b16 a[102:103], v2 offset:4608
  ds_read_b64_tr_b16 a[108:109], v3 offset:4096
  ds_read_b64_tr_b16 a[110:111], v3 offset:4608
  ds_read_b64_tr_b16 a[116:117], v4 offset:4096
  ds_read_b64_tr_b16 a[118:119], v4 offset:4608
  ds_read_b64_tr_b16 a[124:125], v5 offset:4096
  ds_read_b64_tr_b16 a[126:127], v5 offset:4608
  s_waitcnt lgkmcnt(0)
  s_add_u32 m0, s26, 0
  s_add_u32 s27, s60, 1376256
  buffer_load_dwordx4 v21, s[44:47], s27 offen offset:0 lds
  buffer_load_dwordx4 v22, s[44:47], s27 offen offset:1024 lds
  buffer_load_dwordx4 v23, s[44:47], s27 offen offset:2048 lds
  buffer_load_dwordx4 v24, s[44:47], s27 offen offset:3072 lds
  s_add_u32 m0, s26, 4096
  s_add_u32 s27, s60, 1490944
  buffer_load_dwordx4 v21, s[44:47], s27 offen offset:0 lds
  buffer_load_dwordx4 v22, s[44:47], s27 offen offset:1024 lds
  buffer_load_dwordx4 v23, s[44:47], s27 offen offset:2048 lds
  buffer_load_dwordx4 v24, s[44:47], s27 offen offset:3072 lds
  s_waitcnt vmcnt(16)
  ds_read_b64_tr_b16 a[128:129], v2 offset:16384
  ds_read_b64_tr_b16 a[130:131], v2 offset:16896
  ds_read_b64_tr_b16 a[136:137], v3 offset:16384
  ds_read_b64_tr_b16 a[138:139], v3 offset:16896
  ds_read_b64_tr_b16 a[144:145], v4 offset:16384
  ds_read_b64_tr_b16 a[146:147], v4 offset:16896
  ds_read_b64_tr_b16 a[152:153], v5 offset:16384
  ds_read_b64_tr_b16 a[154:155], v5 offset:16896
  ds_read_b64_tr_b16 a[132:133], v2 offset:20480
  ds_read_b64_tr_b16 a[134:135], v2 offset:20992
  ds_read_b64_tr_b16 a[140:141], v3 offset:20480
  ds_read_b64_tr_b16 a[142:143], v3 offset:20992
  ds_read_b64_tr_b16 a[148:149], v4 offset:20480
  ds_read_b64_tr_b16 a[150:151], v4 offset:20992
  ds_read_b64_tr_b16 a[156:157], v5 offset:20480
  ds_read_b64_tr_b16 a[158:159], v5 offset:20992
  s_waitcnt lgkmcnt(0)
  s_add_u32 m0, s26, 16384
  s_add_u32 s27, s60, 1605632
  buffer_load_dwordx4 v21, s[44:47], s27 offen offset:0 lds
  buffer_load_dwordx4 v22, s[44:47], s27 offen offset:1024 lds
  buffer_load_dwordx4 v23, s[44:47], s27 offen offset:2048 lds
  buffer_load_dwordx4 v24, s[44:47], s27 offen offset:3072 lds
  s_add_u32 m0, s26, 20480
  s_add_u32 s27, s60, 1720320
  buffer_load_dwordx4 v21, s[44:47], s27 offen offset:0 lds
  buffer_load_dwordx4 v22, s[44:47], s27 offen offset:1024 lds
  buffer_load_dwordx4 v23, s[44:47], s27 offen offset:2048 lds
  buffer_load_dwordx4 v24, s[44:47], s27 offen offset:3072 lds
  s_waitcnt vmcnt(16)
  ds_read_b64_tr_b16 a[160:161], v2 offset:8192
  ds_read_b64_tr_b16 a[162:163], v2 offset:8704
  ds_read_b64_tr_b16 a[168:169], v3 offset:8192
  ds_read_b64_tr_b16 a[170:171], v3 offset:8704
  ds_read_b64_tr_b16 a[176:177], v4 offset:8192
  ds_read_b64_tr_b16 a[178:179], v4 offset:8704
  ds_read_b64_tr_b16 a[184:185], v5 offset:8192
  ds_read_b64_tr_b16 a[186:187], v5 offset:8704
  ds_read_b64_tr_b16 a[164:165], v2 offset:12288
  ds_read_b64_tr_b16 a[166:167], v2 offset:12800
  ds_read_b64_tr_b16 a[172:173], v3 offset:12288
  ds_read_b64_tr_b16 a[174:175], v3 offset:12800
  ds_read_b64_tr_b16 a[180:181], v4 offset:12288
  ds_read_b64_tr_b16 a[182:183], v4 offset:12800
  ds_read_b64_tr_b16 a[188:189], v5 offset:12288
  ds_read_b64_tr_b16 a[190:191], v5 offset:12800
  s_waitcnt lgkmcnt(0)
  s_add_u32 m0, s26, 8192
  s_add_u32 s27, s61, 0
  buffer_load_dwordx4 v10, s[48:51], s27 offen offset:0 lds
  buffer_load_dwordx4 v11, s[48:51], s27 offen offset:1024 lds
  buffer_load_dwordx4 v12, s[48:51], s27 offen offset:2048 lds
  buffer_load_dwordx4 v13, s[48:51], s27 offen offset:3072 lds
  s_add_u32 m0, s26, 12288
  s_add_u32 s27, s61, 32768
  buffer_load_dwordx4 v10, s[48:51], s27 offen offset:0 lds
  buffer_load_dwordx4 v11, s[48:51], s27 offen offset:1024 lds
  buffer_load_dwordx4 v12, s[48:51], s27 offen offset:2048 lds
  buffer_load_dwordx4 v13, s[48:51], s27 offen offset:3072 lds
  s_cmp_lt_u32 s3, 2
  s_cbranch_scc1 L_xret2
  s_nop 7
  s_branch L_xret1
Lsf5_retry:
  s_mov_b32 s33, 400000
Lspin6:
  s_load_dwordx8 s[4:11], s[14:15], 1024 glc
  s_sub_u32 s33, s33, 1
  s_waitcnt lgkmcnt(0)
  s_xor_b64 s[4:5], s[4:5], s[16:17]
  s_xor_b64 s[6:7], s[6:7], s[16:17]
  s_xor_b64 s[8:9], s[8:9], s[16:17]
  s_xor_b64 s[10:11], s[10:11], s[16:17]
  s_or_b64 s[4:5], s[4:5], s[6:7]
  s_or_b64 s[8:9], s[8:9], s[10:11]
  s_or_b64 s[4:5], s[4:5], s[8:9]
  s_cselect_b32 s4, s33, 0
  s_cmp_lg_u32 s4, 0
  s_cbranch_scc1 Lspin6
  s_nop 7
  s_branch Lsf5
L_early:
  s_branch L_stageX
L_xret2:
  s_mov_b32 s33, 400000
Lspin7:
  s_load_dwordx8 s[4:11], s[14:15], 2048 glc
  s_sub_u32 s33, s33, 1
  s_waitcnt lgkmcnt(0)
  s_xor_b64 s[4:5], s[4:5], s[16:17]
  s_xor_b64 s[6:7], s[6:7], s[16:17]
  s_xor_b64 s[8:9], s[8:9], s[16:17]
  s_xor_b64 s[10:11], s[10:11], s[16:17]
  s_or_b64 s[4:5], s[4:5], s[6:7]
  s_or_b64 s[8:9], s[8:9], s[10:11]
  s_or_b64 s[4:5], s[4:5], s[8:9]
  s_cselect_b32 s4, s33, 0
  s_cmp_lg_u32 s4, 0
  s_cbranch_scc1 Lspin7
  s_add_u32 m0, s35, 0
  s_add_u32 s36, s34, 0
  buffer_load_dwordx4 v112, s[20:23], s36 offen offset:0 sc1 lds
  buffer_load_dwordx4 v113, s[20:23], s36 offen offset:1024 sc1 lds
  buffer_load_dwordx4 v114, s[20:23], s36 offen offset:2048 sc1 lds
  buffer_load_dwordx4 v115, s[20:23], s36 offen offset:3072 sc1 lds
  s_add_u32 m0, s35, 4096
  s_add_u32 s36, s34, 4096
  buffer_load_dwordx4 v116, s[20:23], s36 offen offset:0 sc1 lds
  buffer_load_dwordx4 v117, s[20:23], s36 offen offset:1024 sc1 lds
  buffer_load_dwordx4 v118, s[20:23], s36 offen offset:2048 sc1 lds
  buffer_load_dwordx4 v119, s[20:23], s36 offen offset:3072 sc1 lds
  s_add_u32 m0, s35, 8192
  s_add_u32 s36, s34, 8192
  buffer_load_dwordx4 v120, s[20:23], s36 offen offset:0 sc1 lds
  buffer_load_dwordx4 v121, s[20:23], s36 offen offset:1024 sc1 lds
  buffer_load_dwordx4 v122, s[20:23], s36 offen offset:2048 sc1 lds
  buffer_load_dwordx4 v123, s[20:23], s36 offen offset:3072 sc1 lds
  s_add_u32 m0, s35, 12288
  s_add_u32 s36, s34, 12288
  buffer_load_dwordx4 v124, s[20:23], s36 offen offset:0 sc1 lds
  buffer_load_dwordx4 v125, s[20:23], s36 offen offset:1024 sc1 lds
  buffer_load_dwordx4 v126, s[20:23], s36 offen offset:2048 sc1 lds
  buffer_load_dwordx4 v127, s[20:23], s36 offen offset:3072 sc1 lds
  s_waitcnt vmcnt(16)
  s_nop 7
  s_branch L_both
L_nof1:
  s_atomic_swap s30, s[20:21], s65 offset:0
  s_atomic_swap s30, s[20:21], s65 offset:1024
  s_atomic_swap s30, s[20:21], s65 offset:2048
  s_atomic_swap s30, s[20:21], s65 offset:3072
  s_lshl_b32 s35, s71, 7
  s_add_u32 s35, s35, 10240
  buffer_load_dwordx4 v[104:107], v28, s[20:23], s35 offen
  v_lshrrev_b32 v14, 3, v1
  v_lshlrev_b32 v14, 10, v14
  v_and_b32 v15, 7, v1
  v_lshl_add_u32 v18, v15, 4, v14
  s_mul_i32 s34, s3, 12288
  s_add_u32 s34, s34, s67
  s_add_u32 s34, s34, 25165824
  s_add_u32 s37, s34, 7168
  s_add_u32 m0, s26, 0
  s_add_u32 s27, s61, 262144
  buffer_load_dwordx4 v10, s[48:51], s27 offen offset:0 lds
  buffer_load_dwordx4 v11, s[48:51], s27 offen offset:1024 lds
  buffer_load_dwordx4 v12, s[48:51], s27 offen offset:2048 lds
  buffer_load_dwordx4 v13, s[48:51], s27 offen offset:3072 lds
  s_add_u32 m0, s26, 4096
  s_add_u32 s27, s61, 294912
  buffer_load_dwordx4 v10, s[48:51], s27 offen offset:0 lds
  buffer_load_dwordx4 v11, s[48:51], s27 offen offset:1024 lds
  buffer_load_dwordx4 v12, s[48:51], s27 offen offset:2048 lds
  buffer_load_dwordx4 v13, s[48:51], s27 offen offset:3072 lds
  s_waitcnt lgkmcnt(0)
  s_add_u32 m0, s26, 16384
  s_add_u32 s27, s61, 524288
  buffer_load_dwordx4 v10, s[48:51], s27 offen offset:0 lds
  buffer_load_dwordx4 v11, s[48:51], s27 offen offset:1024 lds
  buffer_load_dwordx4 v12, s[48:51], s27 offen offset:2048 lds
  buffer_load_dwordx4 v13, s[48:51], s27 offen offset:3072 lds
  s_add_u32 m0, s26, 20480
  s_add_u32 s27, s61, 557056
  buffer_load_dwordx4 v10, s[48:51], s27 offen offset:0 lds
  buffer_load_dwordx4 v11, s[48:51], s27 offen offset:1024 lds
  buffer_load_dwordx4 v12, s[48:51], s27 offen offset:2048 lds
  buffer_load_dwordx4 v13, s[48:51], s27 offen offset:3072 lds
  ds_read_b64_tr_b16 v[192:193], v108 offset:8192
  ds_read_b64_tr_b16 v[194:195], v108 offset:10240
  ds_read_b64_tr_b16 v[200:201], v109 offset:8192
  ds_read_b64_tr_b16 v[202:203], v109 offset:10240
  ds_read_b64_tr_b16 v[208:209], v110 offset:8192
  ds_read_b64_tr_b16 v[210:211], v110 offset:10240
  ds_read_b64_tr_b16 v[216:217], v111 offset:8192
  ds_read_b64_tr_b16 v[218:219], v111 offset:10240
  ds_read_b64_tr_b16 v[196:197], v108 offset:12288
  ds_read_b64_tr_b16 v[198:199], v108 offset:14336
  ds_read_b64_tr_b16 v[204:205], v109 offset:12288
  ds_read_b64_tr_b16 v[206:207], v109 offset:14336
  ds_read_b64_tr_b16 v[212:213], v110 offset:12288
  ds_read_b64_tr_b16 v[214:215], v110 offset:14336
  ds_read_b64_tr_b16 v[220:221], v111 offset:12288
  ds_read_b64_tr_b16 v[222:223], v111 offset:14336
  s_waitcnt lgkmcnt(0)
  s_add_u32 m0, s26, 8192
  s_add_u32 s27, s61, 786432
  buffer_load_dwordx4 v10, s[48:51], s27 offen offset:0 lds
  buffer_load_dwordx4 v11, s[48:51], s27 offen offset:1024 lds
  buffer_load_dwordx4 v12, s[48:51], s27 offen offset:2048 lds
  buffer_load_dwordx4 v13, s[48:51], s27 offen offset:3072 lds
  s_add_u32 m0, s26, 12288
  s_add_u32 s27, s61, 819200
  buffer_load_dwordx4 v10, s[48:51], s27 offen offset:0 lds
  buffer_load_dwordx4 v11, s[48:51], s27 offen offset:1024 lds
  buffer_load_dwordx4 v12, s[48:51], s27 offen offset:2048 lds
  buffer_load_dwordx4 v13, s[48:51], s27 offen offset:3072 lds
  s_waitcnt vmcnt(16)
  ds_read_b64_tr_b16 v[224:225], v108 offset:0
  ds_read_b64_tr_b16 v[226:227], v108 offset:2048
  ds_read_b64_tr_b16 v[232:233], v109 offset:0
  ds_read_b64_tr_b16 v[234:235], v109 offset:2048
  ds_read_b64_tr_b16 v[240:241], v110 offset:0
  ds_read_b64_tr_b16 v[242:243], v110 offset:2048
  ds_read_b64_tr_b16 v[248:249], v111 offset:0
  ds_read_b64_tr_b16 v[250:251], v111 offset:2048
  ds_read_b64_tr_b16 v[228:229], v108 offset:4096
  ds_read_b64_tr_b16 v[230:231], v108 offset:6144
  ds_read_b64_tr_b16 v[236:237], v109 offset:4096
  ds_read_b64_tr_b16 v[238:239], v109 offset:6144
  ds_read_b64_tr_b16 v[244:245], v110 offset:4096
  ds_read_b64_tr_b16 v[246:247], v110 offset:6144
  ds_read_b64_tr_b16 v[252:253], v111 offset:4096
  ds_read_b64_tr_b16 v[254:255], v111 offset:6144
  s_waitcnt lgkmcnt(0)
  s_add_u32 m0, s26, 0
  s_add_u32 s27, s61, 1048576
  buffer_load_dwordx4 v10, s[48:51], s27 offen offset:0 lds
  buffer_load_dwordx4 v11, s[48:51], s27 offen offset:1024 lds
  buffer_load_dwordx4 v12, s[48:51], s27 offen offset:2048 lds
  buffer_load_dwordx4 v13, s[48:51], s27 offen offset:3072 lds
  s_add_u32 m0, s26, 4096
  s_add_u32 s27, s61, 1081344
  buffer_load_dwordx4 v10, s[48:51], s27 offen offset:0 lds
  buffer_load_dwordx4 v11, s[48:51], s27 offen offset:1024 lds
  buffer_load_dwordx4 v12, s[48:51], s27 offen offset:2048 lds
  buffer_load_dwordx4 v13, s[48:51], s27 offen offset:3072 lds
  s_waitcnt vmcnt(16)
  ds_read_b64_tr_b16 v[128:129], v108 offset:16384
  ds_read_b64_tr_b16 v[130:131], v108 offset:18432
  ds_read_b64_tr_b16 v[136:137], v109 offset:16384
  ds_read_b64_tr_b16 v[138:139], v109 offset:18432
  ds_read_b64_tr_b16 v[144:145], v110 offset:16384
  ds_read_b64_tr_b16 v[146:147], v110 offset:18432
  ds_read_b64_tr_b16 v[152:153], v111 offset:16384
  ds_read_b64_tr_b16 v[154:155], v111 offset:18432
  ds_read_b64_tr_b16 v[132:133], v108 offset:20480
  ds_read_b64_tr_b16 v[134:135], v108 offset:22528
  ds_read_b64_tr_b16 v[140:141], v109 offset:20480
  ds_read_b64_tr_b16 v[142:143], v109 offset:22528
  ds_read_b64_tr_b16 v[148:149], v110 offset:20480
  ds_read_b64_tr_b16 v[150:151], v110 offset:22528
  ds_read_b64_tr_b16 v[156:157], v111 offset:20480
  ds_read_b64_tr_b16 v[158:159], v111 offset:22528
  s_waitcnt lgkmcnt(0)
  s_add_u32 m0, s26, 16384
  s_add_u32 s27, s61, 1310720
  buffer_load_dwordx4 v10, s[48:51], s27 offen offset:0 lds
  buffer_load_dwordx4 v11, s[48:51], s27 offen offset:1024 lds
  buffer_load_dwordx4 v12, s[48:51], s27 offen offset:2048 lds
  buffer_load_dwordx4 v13, s[48:51], s27 offen offset:3072 lds
  s_add_u32 m0, s26, 20480
  s_add_u32 s27, s61, 1343488
  buffer_load_dwordx4 v10, s[48:51], s27 offen offset:0 lds
  buffer_load_dwordx4 v11, s[48:51], s27 offen offset:1024 lds
  buffer_load_dwordx4 v12, s[48:51], s27 offen offset:2048 lds
  buffer_load_dwordx4 v13, s[48:51], s27 offen offset:3072 lds
  s_mov_b32 s33, 400000
Lspin8:
  s_load_dwordx8 s[4:11], s[14:15], s12 glc
  s_sub_u32 s33, s33, 1
  s_waitcnt lgkmcnt(0)
  s_xor_b64 s[4:5], s[4:5], s[16:17]
  s_xor_b64 s[6:7], s[6:7], s[16:17]
  s_xor_b64 s[8:9], s[8:9], s[16:17]
  s_xor_b64 s[10:11], s[10:11], s[16:17]
  s_or_b64 s[4:5], s[4:5], s[6:7]
  s_or_b64 s[8:9], s[8:9], s[10:11]
  s_or_b64 s[4:5], s[4:5], s[8:9]
  s_cselect_b32 s4, s33, 0
  s_cmp_lg_u32 s4, 0
  s_cbranch_scc1 Lspin8
  s_barrier
  s_waitcnt vmcnt(16)
  ds_read_b64_tr_b16 v[160:161], v108 offset:8192
  ds_read_b64_tr_b16 v[162:163], v108 offset:10240
  ds_read_b64_tr_b16 v[168:169], v109 offset:8192
  ds_read_b64_tr_b16 v[170:171], v109 offset:10240
  ds_read_b64_tr_b16 v[176:177], v110 offset:8192
  ds_read_b64_tr_b16 v[178:179], v110 offset:10240
  ds_read_b64_tr_b16 v[184:185], v111 offset:8192
  ds_read_b64_tr_b16 v[186:187], v111 offset:10240
  ds_read_b64_tr_b16 v[164:165], v108 offset:12288
  ds_read_b64_tr_b16 v[166:167], v108 offset:14336
  ds_read_b64_tr_b16 v[172:173], v109 offset:12288
  ds_read_b64_tr_b16 v[174:175], v109 offset:14336
  ds_read_b64_tr_b16 v[180:181], v110 offset:12288
  ds_read_b64_tr_b16 v[182:183], v110 offset:14336
  ds_read_b64_tr_b16 v[188:189], v111 offset:12288
  ds_read_b64_tr_b16 v[190:191], v111 offset:14336
  s_mov_b32 s33, 400000
Lspin9:
  s_load_dwordx8 s[4:11], s[14:15], 3072 glc
  s_sub_u32 s33, s33, 1
  s_waitcnt lgkmcnt(0)
  s_xor_b64 s[4:5], s[4:5], s[16:17]
  s_xor_b64 s[6:7], s[6:7], s[16:17]
  s_xor_b64 s[8:9], s[8:9], s[16:17]
  s_xor_b64 s[10:11], s[10:11], s[16:17]
  s_or_b64 s[4:5], s[4:5], s[6:7]
  s_or_b64 s[8:9], s[8:9], s[10:11]
  s_or_b64 s[4:5], s[4:5], s[8:9]
  s_cselect_b32 s4, s33, 0
  s_cmp_lg_u32 s4, 0
  s_cbranch_scc1 Lspin9
  s_add_u32 s64, s63, 0
  buffer_load_dwordx4 a[0:3], v20, s[20:23], s64 offen sc1
  buffer_load_dwordx4 a[4:7], v20, s[20:23], s64 offen offset:1024 sc1
  s_add_u32 s64, s63, 32768
  buffer_load_dwordx4 a[8:11], v20, s[20:23], s64 offen sc1
  buffer_load_dwordx4 a[12:15], v20, s[20:23], s64 offen offset:1024 sc1
  s_add_u32 s64, s63, 65536
  buffer_load_dwordx4 a[16:19], v20, s[20:23], s64 offen sc1
  buffer_load_dwordx4 a[20:23], v20, s[20:23], s64 offen offset:1024 sc1
  s_add_u32 s64, s63, 98304
  buffer_load_dwordx4 a[24:27], v20, s[20:23], s64 offen sc1
  buffer_load_dwordx4 a[28:31], v20, s[20:23], s64 offen offset:1024 sc1
  s_add_u32 s64, s63, 131072
  buffer_load_dwordx4 a[32:35], v20, s[20:23], s64 offen sc1
  buffer_load_dwordx4 a[36:39], v20, s[20:23], s64 offen offset:1024 sc1
  s_add_u32 s64, s63, 163840
  buffer_load_dwordx4 a[40:43], v20, s[20:23], s64 offen sc1
  buffer_load_dwordx4 a[44:47], v20, s[20:23], s64 offen offset:1024 sc1
  s_waitcnt vmcnt(0) lgkmcnt(0)
  s_nop 7
  s_branch L_f1done
Lsf10_retry:
  s_mov_b32 s33, 400000
Lspin11:
  s_load_dwordx8 s[4:11], s[14:15], s12 glc
  s_sub_u32 s33, s33, 1
  s_waitcnt lgkmcnt(0)
  s_xor_b64 s[4:5], s[4:5], s[16:17]
  s_xor_b64 s[6:7], s[6:7], s[16:17]
  s_xor_b64 s[8:9], s[8:9], s[16:17]
  s_xor_b64 s[10:11], s[10:11], s[16:17]
  s_or_b64 s[4:5], s[4:5], s[6:7]
  s_or_b64 s[8:9], s[8:9], s[10:11]
  s_or_b64 s[4:5], s[4:5], s[8:9]
  s_cselect_b32 s4, s33, 0
  s_cmp_lg_u32 s4, 0
  s_cbranch_scc1 Lspin11
  s_nop 7
  s_branch Lsf10
Lsf12_retry:
  s_mov_b32 s33, 400000
Lspin13:
  s_load_dwordx8 s[4:11], s[14:15], 3072 glc
  s_sub_u32 s33, s33, 1
  s_waitcnt lgkmcnt(0)
  s_xor_b64 s[4:5], s[4:5], s[16:17]
  s_xor_b64 s[6:7], s[6:7], s[16:17]
  s_xor_b64 s[8:9], s[8:9], s[16:17]
  s_xor_b64 s[10:11], s[10:11], s[16:17]
  s_or_b64 s[4:5], s[4:5], s[6:7]
  s_or_b64 s[8:9], s[8:9], s[10:11]
  s_or_b64 s[4:5], s[4:5], s[8:9]
  s_cselect_b32 s4, s33, 0
  s_cmp_lg_u32 s4, 0
  s_cbranch_scc1 Lspin13
  s_nop 7
  s_branch Lsf12
Lchk14_retry:
  s_mov_b32 s33, 0
Lpoll15:
  buffer_load_dwordx4 v[104:107], v28, s[20:23], s35 offen sc1
  s_add_u32 s33, s33, 1
  s_waitcnt vmcnt(0)
  v_xor_b32 v124, s30, v105
  v_bitop3_b32 v124, v124, v107, s30 bitop3:0xf6
  v_cmp_ne_u32 vcc, 0, v124
  s_nop 1
  s_cmp_lt_u32 s33, 400000
  s_cselect_b64 vcc, vcc, 0
  s_cbranch_vccnz Lpoll15
  s_nop 7
  s_branch Lchk14
Lsf16_retry:
  s_mov_b32 s33, 400000
Lspin17:
  s_load_dwordx8 s[4:11], s[14:15], 4096 glc
  s_sub_u32 s33, s33, 1
  s_waitcnt lgkmcnt(0)
  s_xor_b64 s[4:5], s[4:5], s[16:17]
  s_xor_b64 s[6:7], s[6:7], s[16:17]
  s_xor_b64 s[8:9], s[8:9], s[16:17]
  s_xor_b64 s[10:11], s[10:11], s[16:17]
  s_or_b64 s[4:5], s[4:5], s[6:7]
  s_or_b64 s[8:9], s[8:9], s[10:11]
  s_or_b64 s[4:5], s[4:5], s[8:9]
  s_cselect_b32 s4, s33, 0
  s_cmp_lg_u32 s4, 0
  s_cbranch_scc1 Lspin17
  s_nop 7
  s_branch Lsf16
Lsf18_retry:
  s_mov_b32 s33, 400000
Lspin19:
  s_load_dwordx8 s[4:11], s[14:15], 5120 glc
  s_sub_u32 s33, s33, 1
  s_waitcnt lgkmcnt(0)
  s_xor_b64 s[4:5], s[4:5], s[16:17]
  s_xor_b64 s[6:7], s[6:7], s[16:17]
  s_xor_b64 s[8:9], s[8:9], s[16:17]
  s_xor_b64 s[10:11], s[10:11], s[16:17]
  s_or_b64 s[4:5], s[4:5], s[6:7]
  s_or_b64 s[8:9], s[8:9], s[10:11]
  s_or_b64 s[4:5], s[4:5], s[8:9]
  s_cselect_b32 s4, s33, 0
  s_cmp_lg_u32 s4, 0
  s_cbranch_scc1 Lspin19
  s_nop 7
  s_branch Lsf18
Lsf20_retry:
  s_mov_b32 s33, 400000
Lspin21:
  s_load_dwordx8 s[4:11], s[14:15], 6144 glc
  s_sub_u32 s33, s33, 1
  s_waitcnt lgkmcnt(0)
  s_xor_b64 s[4:5], s[4:5], s[16:17]
  s_xor_b64 s[6:7], s[6:7], s[16:17]
  s_xor_b64 s[8:9], s[8:9], s[16:17]
  s_xor_b64 s[10:11], s[10:11], s[16:17]
  s_or_b64 s[4:5], s[4:5], s[6:7]
  s_or_b64 s[8:9], s[8:9], s[10:11]
  s_or_b64 s[4:5], s[4:5], s[8:9]
  s_cselect_b32 s4, s33, 0
  s_cmp_lg_u32 s4, 0
  s_cbranch_scc1 Lspin21
  s_nop 7
  s_branch Lsf20
L_hot_end:
L_exact:
  s_waitcnt vmcnt(0) lgkmcnt(0)
  s_nop 15
  v_and_b32 v14, 15, v1
  v_lshlrev_b32 v14, 8, v14
  v_lshrrev_b32 v15, 5, v1
  v_lshl_add_u32 v14, v15, 4, v14
  v_bfe_u32 v15, v1, 4, 1
  v_lshl_add_u32 v20, v15, 5, v14
  v_lshlrev_b32 v21, 4, v1
  s_lshl_b32 s34, s3, 8
  v_lshrrev_b32 v14, 4, v1
  v_lshlrev_b32 v14, 10, v14
  v_and_b32 v16, 15, v1
  v_lshl_add_u32 v14, v16, 4, v14
  v_add_u32 v22, s34, v14
  v_lshrrev_b32 v14, 2, v1
  v_lshlrev_b32 v14, 10, v14
  v_and_b32 v16, 3, v1
  v_lshl_add_u32 v14, v16, 3, v14
  v_add_u32 v23, s34, v14
  v_mov_b32 v28, 0xff800000
  v_mov_b32 v29, 0xff800000
  v_mov_b32 v30, 0xff800000
  v_mov_b32 v31, 0xff800000
  s_add_u32 s35, s29, 393216
  s_mov_b32 s33, 16
L_ex1:
  s_add_u32 s36, s35, 4096
  buffer_load_dwordx4 a[192:195], v20, s[12:15], s35 offen offset:0
  buffer_load_dwordx4 a[196:199], v20, s[12:15], s35 offen offset:64
  buffer_load_dwordx4 a[200:203], v20, s[12:15], s35 offen offset:128
  buffer_load_dwordx4 a[204:207], v20, s[12:15], s35 offen offset:192
  buffer_load_dwordx4 a[208:211], v20, s[12:15], s36 offen offset:0
  buffer_load_dwordx4 a[212:215], v20, s[12:15], s36 offen offset:64
  buffer_load_dwordx4 a[216:219], v20, s[12:15], s36 offen offset:128
  buffer_load_dwordx4 a[220:223], v20, s[12:15], s36 offen offset:192
  s_waitcnt vmcnt(7)
  v_mfma_f32_16x16x32_bf16 v[48:51], a[192:195], a[128:131], 0
  s_waitcnt vmcnt(6)
  v_mfma_f32_16x16x32_bf16 v[48:51], a[196:199], a[132:135], v[48:51]
  s_waitcnt vmcnt(5)
  v_mfma_f32_16x16x32_bf16 v[48:51], a[200:203], a[136:139], v[48:51]
  s_waitcnt vmcnt(4)
  v_mfma_f32_16x16x32_bf16 v[48:51], a[204:207], a[140:143], v[48:51]
  s_waitcnt vmcnt(0)
  v_mfma_f32_16x16x32_bf16 v[52:55], a[220:223], a[140:143], 0
  v_mfma_f32_16x16x32_bf16 v[52:55], a[216:219], a[136:139], v[52:55]
  v_mfma_f32_16x16x32_bf16 v[52:55], a[212:215], a[132:135], v[52:55]
  v_mfma_f32_16x16x32_bf16 v[52:55], a[208:211], a[128:131], v[52:55]
  v_mfma_f32_16x16x32_bf16 v[60:63], a[208:211], a[144:147], 0
  v_mfma_f32_16x16x32_bf16 v[60:63], a[212:215], a[148:151], v[60:63]
  v_mfma_f32_16x16x32_bf16 v[60:63], a[216:219], a[152:155], v[60:63]
  v_mfma_f32_16x16x32_bf16 v[60:63], a[220:223], a[156:159], v[60:63]
  v_mfma_f32_16x16x32_bf16 v[56:59], a[204:207], a[156:159], 0
  v_mfma_f32_16x16x32_bf16 v[56:59], a[200:203], a[152:155], v[56:59]
  v_mfma_f32_16x16x32_bf16 v[56:59], a[196:199], a[148:151], v[56:59]
  v_mfma_f32_16x16x32_bf16 v[56:59], a[192:195], a[144:147], v[56:59]
  v_mfma_f32_16x16x32_bf16 v[64:67], a[192:195], a[160:163], 0
  v_mfma_f32_16x16x32_bf16 v[64:67], a[196:199], a[164:167], v[64:67]
  v_mfma_f32_16x16x32_bf16 v[64:67], a[200:203], a[168:171], v[64:67]
  v_mfma_f32_16x16x32_bf16 v[64:67], a[204:207], a[172:175], v[64:67]
  v_mfma_f32_16x16x32_bf16 v[68:71], a[220:223], a[172:175], 0
  v_mfma_f32_16x16x32_bf16 v[68:71], a[216:219], a[168:171], v[68:71]
  v_mfma_f32_16x16x32_bf16 v[68:71], a[212:215], a[164:167], v[68:71]
  v_mfma_f32_16x16x32_bf16 v[68:71], a[208:211], a[160:163], v[68:71]
  v_mfma_f32_16x16x32_bf16 v[76:79], a[208:211], a[176:179], 0
  v_mfma_f32_16x16x32_bf16 v[76:79], a[212:215], a[180:183], v[76:79]
  v_mfma_f32_16x16x32_bf16 v[76:79], a[216:219], a[184:187], v[76:79]
  v_mfma_f32_16x16x32_bf16 v[76:79], a[220:223], a[188:191], v[76:79]
  v_mfma_f32_16x16x32_bf16 v[72:75], a[204:207], a[188:191], 0
  v_mfma_f32_16x16x32_bf16 v[72:75], a[200:203], a[184:187], v[72:75]
  v_mfma_f32_16x16x32_bf16 v[72:75], a[196:199], a[180:183], v[72:75]
  v_mfma_f32_16x16x32_bf16 v[72:75], a[192:195], a[176:179], v[72:75]
  v_max3_f32 v28, v28, v48, v49
  v_max3_f32 v28, v28, v50, v51
  v_max3_f32 v28, v28, v52, v53
  v_max3_f32 v28, v28, v54, v55
  v_max3_f32 v29, v29, v56, v57
  v_max3_f32 v29, v29, v58, v59
  v_max3_f32 v29, v29, v60, v61
  v_max3_f32 v29, v29, v62, v63
  v_max3_f32 v30, v30, v64, v65
  v_max3_f32 v30, v30, v66, v67
  v_max3_f32 v30, v30, v68, v69
  v_max3_f32 v30, v30, v70, v71
  v_max3_f32 v31, v31, v72, v73
  v_max3_f32 v31, v31, v74, v75
  v_max3_f32 v31, v31, v76, v77
  v_max3_f32 v31, v31, v78, v79
  s_add_u32 s35, s35, 8192
  s_sub_u32 s33, s33, 1
  s_cmp_lg_u32 s33, 0
  s_cbranch_scc1 L_ex1
  v_mov_b32 v14, v28
  s_nop 1
  v_permlane16_swap_b32 v28, v14
  v_max_f32 v28, v28, v14
  v_mov_b32 v14, v28
  s_nop 1
  v_permlane32_swap_b32 v28, v14
  v_max_f32 v28, v28, v14
  v_sub_f32 v96, 0, v28
  v_sub_f32 v97, 0, v28
  v_sub_f32 v98, 0, v28
  v_sub_f32 v99, 0, v28
  v_mov_b32 v14, v29
  s_nop 1
  v_permlane16_swap_b32 v29, v14
  v_max_f32 v29, v29, v14
  v_mov_b32 v14, v29
  s_nop 1
  v_permlane32_swap_b32 v29, v14
  v_max_f32 v29, v29, v14
  v_sub_f32 v100, 0, v29
  v_sub_f32 v101, 0, v29
  v_sub_f32 v102, 0, v29
  v_sub_f32 v103, 0, v29
  v_mov_b32 v14, v30
  s_nop 1
  v_permlane16_swap_b32 v30, v14
  v_max_f32 v30, v30, v14
  v_mov_b32 v14, v30
  s_nop 1
  v_permlane32_swap_b32 v30, v14
  v_max_f32 v30, v30, v14
  v_sub_f32 v104, 0, v30
  v_sub_f32 v105, 0, v30
  v_sub_f32 v106, 0, v30
  v_sub_f32 v107, 0, v30
  v_mov_b32 v14, v31
  s_nop 1
  v_permlane16_swap_b32 v31, v14
  v_max_f32 v31, v31, v14
  v_mov_b32 v14, v31
  s_nop 1
  v_permlane32_swap_b32 v31, v14
  v_max_f32 v31, v31, v14
  v_sub_f32 v108, 0, v31
  v_sub_f32 v109, 0, v31
  v_sub_f32 v110, 0, v31
  v_sub_f32 v111, 0, v31
  v_mov_b32 v112, 0
  v_mov_b32 v113, 0
  v_mov_b32 v114, 0
  v_mov_b32 v115, 0
  v_mov_b32 v116, 0
  v_mov_b32 v117, 0
  v_mov_b32 v118, 0
  v_mov_b32 v119, 0
  v_mov_b32 v120, 0
  v_mov_b32 v121, 0
  v_mov_b32 v122, 0
  v_mov_b32 v123, 0
  v_mov_b32 v124, 0
  v_mov_b32 v125, 0
  v_mov_b32 v126, 0
  v_mov_b32 v127, 0
  v_mov_b32 v128, 0
  v_mov_b32 v129, 0
  v_mov_b32 v130, 0
  v_mov_b32 v131, 0
  v_mov_b32 v132, 0
  v_mov_b32 v133, 0
  v_mov_b32 v134, 0
  v_mov_b32 v135, 0
  v_mov_b32 v136, 0
  v_mov_b32 v137, 0
  v_mov_b32 v138, 0
  v_mov_b32 v139, 0
  v_mov_b32 v140, 0
  v_mov_b32 v141, 0
  v_mov_b32 v142, 0
  v_mov_b32 v143, 0
  v_mov_b32 v144, 0
  v_mov_b32 v145, 0
  v_mov_b32 v146, 0
  v_mov_b32 v147, 0
  v_mov_b32 v148, 0
  v_mov_b32 v149, 0
  v_mov_b32 v150, 0
  v_mov_b32 v151, 0
  v_mov_b32 v152, 0
  v_mov_b32 v153, 0
  v_mov_b32 v154, 0
  v_mov_b32 v155, 0
  v_mov_b32 v156, 0
  v_mov_b32 v157, 0
  v_mov_b32 v158, 0
  v_mov_b32 v159, 0
  v_mov_b32 v160, 0
  v_mov_b32 v161, 0
  v_mov_b32 v162, 0
  v_mov_b32 v163, 0
  v_mov_b32 v164, 0
  v_mov_b32 v165, 0
  v_mov_b32 v166, 0
  v_mov_b32 v167, 0
  v_mov_b32 v168, 0
  v_mov_b32 v169, 0
  v_mov_b32 v170, 0
  v_mov_b32 v171, 0
  v_mov_b32 v172, 0
  v_mov_b32 v173, 0
  v_mov_b32 v174, 0
  v_mov_b32 v175, 0
  v_mov_b32 v176, 0
  v_mov_b32 v177, 0
  v_mov_b32 v178, 0
  v_mov_b32 v179, 0
  v_mov_b32 v180, 0
  v_mov_b32 v181, 0
  v_mov_b32 v182, 0
  v_mov_b32 v183, 0
  v_mov_b32 v184, 0
  v_mov_b32 v185, 0
  v_mov_b32 v186, 0
  v_mov_b32 v187, 0
  v_mov_b32 v188, 0
  v_mov_b32 v189, 0
  v_mov_b32 v190, 0
  v_mov_b32 v191, 0
  v_mov_b32 v192, 0
  v_mov_b32 v193, 0
  v_mov_b32 v194, 0
  v_mov_b32 v195, 0
  v_mov_b32 v196, 0
  v_mov_b32 v197, 0
  v_mov_b32 v198, 0
  v_mov_b32 v199, 0
  v_mov_b32 v200, 0
  v_mov_b32 v201, 0
  v_mov_b32 v202, 0
  v_mov_b32 v203, 0
  v_mov_b32 v204, 0
  v_mov_b32 v205, 0
  v_mov_b32 v206, 0
  v_mov_b32 v207, 0
  v_mov_b32 v208, 0
  v_mov_b32 v209, 0
  v_mov_b32 v210, 0
  v_mov_b32 v211, 0
  v_mov_b32 v212, 0
  v_mov_b32 v213, 0
  v_mov_b32 v214, 0
  v_mov_b32 v215, 0
  v_mov_b32 v216, 0
  v_mov_b32 v217, 0
  v_mov_b32 v218, 0
  v_mov_b32 v219, 0
  v_mov_b32 v220, 0
  v_mov_b32 v221, 0
  v_mov_b32 v222, 0
  v_mov_b32 v223, 0
  v_mov_b32 v224, 0
  v_mov_b32 v225, 0
  v_mov_b32 v226, 0
  v_mov_b32 v227, 0
  v_mov_b32 v228, 0
  v_mov_b32 v229, 0
  v_mov_b32 v230, 0
  v_mov_b32 v231, 0
  v_mov_b32 v232, 0
  v_mov_b32 v233, 0
  v_mov_b32 v234, 0
  v_mov_b32 v235, 0
  v_mov_b32 v236, 0
  v_mov_b32 v237, 0
  v_mov_b32 v238, 0
  v_mov_b32 v239, 0
  v_mov_b32 v240, 0
  v_mov_b32 v241, 0
  v_mov_b32 v242, 0
  v_mov_b32 v243, 0
  v_mov_b32 v244, 0
  v_mov_b32 v245, 0
  v_mov_b32 v246, 0
  v_mov_b32 v247, 0
  v_mov_b32 v248, 0
  v_mov_b32 v249, 0
  v_mov_b32 v250, 0
  v_mov_b32 v251, 0
  v_mov_b32 v252, 0
  v_mov_b32 v253, 0
  v_mov_b32 v254, 0
  v_mov_b32 v255, 0
  s_add_u32 s35, s29, 393216
  s_mov_b32 s33, 16
L_ex2:
  s_add_u32 s36, s35, 4096
  buffer_load_dwordx4 a[192:195], v20, s[12:15], s35 offen offset:0
  buffer_load_dwordx4 a[196:199], v20, s[12:15], s35 offen offset:64
  buffer_load_dwordx4 a[200:203], v20, s[12:15], s35 offen offset:128
  buffer_load_dwordx4 a[204:207], v20, s[12:15], s35 offen offset:192
  buffer_load_dwordx4 a[208:211], v20, s[12:15], s36 offen offset:0
  buffer_load_dwordx4 a[212:215], v20, s[12:15], s36 offen offset:64
  buffer_load_dwordx4 a[216:219], v20, s[12:15], s36 offen offset:128
  buffer_load_dwordx4 a[220:223], v20, s[12:15], s36 offen offset:192
  buffer_load_dwordx4 v[48:51], v21, s[16:19], s35 offen offset:0
  buffer_load_dwordx4 v[52:55], v21, s[16:19], s35 offen offset:1024
  buffer_load_dwordx4 v[56:59], v21, s[16:19], s35 offen offset:2048
  buffer_load_dwordx4 v[60:63], v21, s[16:19], s35 offen offset:3072
  buffer_load_dwordx4 v[64:67], v21, s[16:19], s36 offen offset:0
  buffer_load_dwordx4 v[68:71], v21, s[16:19], s36 offen offset:1024
  buffer_load_dwordx4 v[72:75], v21, s[16:19], s36 offen offset:2048
  buffer_load_dwordx4 v[76:79], v21, s[16:19], s36 offen offset:3072
  s_waitcnt vmcnt(7)
  ds_write_b128 v22, v[48:51] offset:0
  s_waitcnt vmcnt(6)
  ds_write_b128 v22, v[52:55] offset:4096
  s_waitcnt vmcnt(5)
  ds_write_b128 v22, v[56:59] offset:8192
  s_waitcnt vmcnt(4)
  ds_write_b128 v22, v[60:63] offset:12288
  s_waitcnt lgkmcnt(0)
  ds_read_b64_tr_b16 a[224:225], v23 offset:0
  ds_read_b64_tr_b16 a[228:229], v23 offset:32
  ds_read_b64_tr_b16 a[232:233], v23 offset:64
  ds_read_b64_tr_b16 a[236:237], v23 offset:96
  ds_read_b64_tr_b16 a[240:241], v23 offset:128
  ds_read_b64_tr_b16 a[244:245], v23 offset:160
  ds_read_b64_tr_b16 a[248:249], v23 offset:192
  ds_read_b64_tr_b16 a[252:253], v23 offset:224
  s_waitcnt lgkmcnt(0)
  s_waitcnt vmcnt(3)
  ds_write_b128 v22, v[64:67] offset:0
  s_waitcnt vmcnt(2)
  ds_write_b128 v22, v[68:71] offset:4096
  s_waitcnt vmcnt(1)
  ds_write_b128 v22, v[72:75] offset:8192
  s_waitcnt vmcnt(0)
  ds_write_b128 v22, v[76:79] offset:12288
  s_waitcnt lgkmcnt(0)
  ds_read_b64_tr_b16 a[226:227], v23 offset:0
  ds_read_b64_tr_b16 a[230:231], v23 offset:32
  ds_read_b64_tr_b16 a[234:235], v23 offset:64
  ds_read_b64_tr_b16 a[238:239], v23 offset:96
  ds_read_b64_tr_b16 a[242:243], v23 offset:128
  ds_read_b64_tr_b16 a[246:247], v23 offset:160
  ds_read_b64_tr_b16 a[250:251], v23 offset:192
  ds_read_b64_tr_b16 a[254:255], v23 offset:224
  s_waitcnt lgkmcnt(0)
  v_mfma_f32_16x16x32_bf16 v[48:51], a[192:195], a[128:131], v[96:99]
  v_mfma_f32_16x16x32_bf16 v[48:51], a[196:199], a[132:135], v[48:51]
  v_mfma_f32_16x16x32_bf16 v[48:51], a[200:203], a[136:139], v[48:51]
  v_mfma_f32_16x16x32_bf16 v[48:51], a[204:207], a[140:143], v[48:51]
  v_mfma_f32_16x16x32_bf16 v[52:55], a[220:223], a[140:143], v[96:99]
  v_mfma_f32_16x16x32_bf16 v[52:55], a[216:219], a[136:139], v[52:55]
  v_mfma_f32_16x16x32_bf16 v[52:55], a[212:215], a[132:135], v[52:55]
  v_mfma_f32_16x16x32_bf16 v[52:55], a[208:211], a[128:131], v[52:55]
  v_mfma_f32_16x16x32_bf16 v[60:63], a[208:211], a[144:147], v[100:103]
  v_mfma_f32_16x16x32_bf16 v[60:63], a[212:215], a[148:151], v[60:63]
  v_mfma_f32_16x16x32_bf16 v[60:63], a[216:219], a[152:155], v[60:63]
  v_mfma_f32_16x16x32_bf16 v[60:63], a[220:223], a[156:159], v[60:63]
  v_mfma_f32_16x16x32_bf16 v[56:59], a[204:207], a[156:159], v[100:103]
  v_mfma_f32_16x16x32_bf16 v[56:59], a[200:203], a[152:155], v[56:59]
  v_mfma_f32_16x16x32_bf16 v[56:59], a[196:199], a[148:151], v[56:59]
  v_mfma_f32_16x16x32_bf16 v[56:59], a[192:195], a[144:147], v[56:59]
  v_mfma_f32_16x16x32_bf16 v[64:67], a[192:195], a[160:163], v[104:107]
  v_mfma_f32_16x16x32_bf16 v[64:67], a[196:199], a[164:167], v[64:67]
  v_mfma_f32_16x16x32_bf16 v[64:67], a[200:203], a[168:171], v[64:67]
  v_mfma_f32_16x16x32_bf16 v[64:67], a[204:207], a[172:175], v[64:67]
  v_mfma_f32_16x16x32_bf16 v[68:71], a[220:223], a[172:175], v[104:107]
  v_mfma_f32_16x16x32_bf16 v[68:71], a[216:219], a[168:171], v[68:71]
  v_mfma_f32_16x16x32_bf16 v[68:71], a[212:215], a[164:167], v[68:71]
  v_mfma_f32_16x16x32_bf16 v[68:71], a[208:211], a[160:163], v[68:71]
  v_mfma_f32_16x16x32_bf16 v[76:79], a[208:211], a[176:179], v[108:111]
  v_mfma_f32_16x16x32_bf16 v[76:79], a[212:215], a[180:183], v[76:79]
  v_mfma_f32_16x16x32_bf16 v[76:79], a[216:219], a[184:187], v[76:79]
  v_mfma_f32_16x16x32_bf16 v[76:79], a[220:223], a[188:191], v[76:79]
  v_mfma_f32_16x16x32_bf16 v[72:75], a[204:207], a[188:191], v[108:111]
  v_mfma_f32_16x16x32_bf16 v[72:75], a[200:203], a[184:187], v[72:75]
  v_mfma_f32_16x16x32_bf16 v[72:75], a[196:199], a[180:183], v[72:75]
  v_mfma_f32_16x16x32_bf16 v[72:75], a[192:195], a[176:179], v[72:75]
  v_exp_f32 v48, v48
  v_exp_f32 v49, v49
  v_exp_f32 v50, v50
  v_cvt_pk_bf16_f32 v80, v48, v49
  v_exp_f32 v51, v51
  v_exp_f32 v52, v52
  v_cvt_pk_bf16_f32 v81, v50, v51
  v_exp_f32 v53, v53
  v_exp_f32 v54, v54
  v_cvt_pk_bf16_f32 v82, v52, v53
  v_exp_f32 v55, v55
  s_nop 0
  v_cvt_pk_bf16_f32 v83, v54, v55
  v_exp_f32 v56, v56
  v_exp_f32 v57, v57
  v_exp_f32 v58, v58
  v_cvt_pk_bf16_f32 v84, v56, v57
  v_exp_f32 v59, v59
  v_exp_f32 v60, v60
  v_cvt_pk_bf16_f32 v85, v58, v59
  v_exp_f32 v61, v61
  v_exp_f32 v62, v62
  v_cvt_pk_bf16_f32 v86, v60, v61
  v_exp_f32 v63, v63
  s_nop 0
  v_cvt_pk_bf16_f32 v87, v62, v63
  v_exp_f32 v64, v64
  v_exp_f32 v65, v65
  v_exp_f32 v66, v66
  v_cvt_pk_bf16_f32 v88, v64, v65
  v_exp_f32 v67, v67
  v_exp_f32 v68, v68
  v_cvt_pk_bf16_f32 v89, v66, v67
  v_exp_f32 v69, v69
  v_exp_f32 v70, v70
  v_cvt_pk_bf16_f32 v90, v68, v69
  v_exp_f32 v71, v71
  s_nop 0
  v_cvt_pk_bf16_f32 v91, v70, v71
  v_exp_f32 v72, v72
  v_exp_f32 v73, v73
  v_exp_f32 v74, v74
  v_cvt_pk_bf16_f32 v92, v72, v73
  v_exp_f32 v75, v75
  v_exp_f32 v76, v76
  v_cvt_pk_bf16_f32 v93, v74, v75
  v_exp_f32 v77, v77
  v_exp_f32 v78, v78
  v_cvt_pk_bf16_f32 v94, v76, v77
  v_exp_f32 v79, v79
  s_nop 0
  v_cvt_pk_bf16_f32 v95, v78, v79
  v_mfma_f32_16x16x32_bf16 v[128:131], a[224:227], v[80:83], v[128:131]
  v_mfma_f32_16x16x32_bf16 v[160:163], a[224:227], v[84:87], v[160:163]
  v_mfma_f32_16x16x32_bf16 v[164:167], a[228:231], v[84:87], v[164:167]
  v_mfma_f32_16x16x32_bf16 v[132:135], a[228:231], v[80:83], v[132:135]
  v_mfma_f32_16x16x32_bf16 v[136:139], a[232:235], v[80:83], v[136:139]
  v_mfma_f32_16x16x32_bf16 v[168:171], a[232:235], v[84:87], v[168:171]
  v_mfma_f32_16x16x32_bf16 v[172:175], a[236:239], v[84:87], v[172:175]
  v_mfma_f32_16x16x32_bf16 v[140:143], a[236:239], v[80:83], v[140:143]
  v_mfma_f32_16x16x32_bf16 v[144:147], a[240:243], v[80:83], v[144:147]
  v_mfma_f32_16x16x32_bf16 v[176:179], a[240:243], v[84:87], v[176:179]
  v_mfma_f32_16x16x32_bf16 v[180:183], a[244:247], v[84:87], v[180:183]
  v_mfma_f32_16x16x32_bf16 v[148:151], a[244:247], v[80:83], v[148:151]
  v_mfma_f32_16x16x32_bf16 v[152:155], a[248:251], v[80:83], v[152:155]
  v_mfma_f32_16x16x32_bf16 v[184:187], a[248:251], v[84:87], v[184:187]
  v_mfma_f32_16x16x32_bf16 v[188:191], a[252:255], v[84:87], v[188:191]
  v_mfma_f32_16x16x32_bf16 v[156:159], a[252:255], v[80:83], v[156:159]
  v_mfma_f32_16x16x32_bf16 v[112:115], v[44:47], v[80:83], v[112:115]
  v_mfma_f32_16x16x32_bf16 v[116:119], v[44:47], v[84:87], v[116:119]
  v_mfma_f32_16x16x32_bf16 v[192:195], a[224:227], v[88:91], v[192:195]
  v_mfma_f32_16x16x32_bf16 v[224:227], a[224:227], v[92:95], v[224:227]
  v_mfma_f32_16x16x32_bf16 v[228:231], a[228:231], v[92:95], v[228:231]
  v_mfma_f32_16x16x32_bf16 v[196:199], a[228:231], v[88:91], v[196:199]
  v_mfma_f32_16x16x32_bf16 v[200:203], a[232:235], v[88:91], v[200:203]
  v_mfma_f32_16x16x32_bf16 v[232:235], a[232:235], v[92:95], v[232:235]
  v_mfma_f32_16x16x32_bf16 v[236:239], a[236:239], v[92:95], v[236:239]
  v_mfma_f32_16x16x32_bf16 v[204:207], a[236:239], v[88:91], v[204:207]
  v_mfma_f32_16x16x32_bf16 v[208:211], a[240:243], v[88:91], v[208:211]
  v_mfma_f32_16x16x32_bf16 v[240:243], a[240:243], v[92:95], v[240:243]
  v_mfma_f32_16x16x32_bf16 v[244:247], a[244:247], v[92:95], v[244:247]
  v_mfma_f32_16x16x32_bf16 v[212:215], a[244:247], v[88:91], v[212:215]
  v_mfma_f32_16x16x32_bf16 v[216:219], a[248:251], v[88:91], v[216:219]
  v_mfma_f32_16x16x32_bf16 v[248:251], a[248:251], v[92:95], v[248:251]
  v_mfma_f32_16x16x32_bf16 v[252:255], a[252:255], v[92:95], v[252:255]
  v_mfma_f32_16x16x32_bf16 v[220:223], a[252:255], v[88:91], v[220:223]
  v_mfma_f32_16x16x32_bf16 v[120:123], v[44:47], v[88:91], v[120:123]
  v_mfma_f32_16x16x32_bf16 v[124:127], v[44:47], v[92:95], v[124:127]
  s_add_u32 s35, s35, 8192
  s_sub_u32 s33, s33, 1
  s_cmp_lg_u32 s33, 0
  s_cbranch_scc1 L_ex2
  s_nop 15
  v_rcp_f32 v114, v112
  v_rcp_f32 v118, v116
  v_rcp_f32 v122, v120
  v_rcp_f32 v126, v124
  v_mul_f32 v128, v128, v114
  v_mul_f32 v129, v129, v114
  v_mul_f32 v130, v130, v114
  v_mul_f32 v131, v131, v114
  v_mul_f32 v132, v132, v114
  v_mul_f32 v133, v133, v114
  v_mul_f32 v134, v134, v114
  v_mul_f32 v135, v135, v114
  v_cvt_pk_bf16_f32 v128, v128, v129
  v_cvt_pk_bf16_f32 v129, v130, v131
  v_cvt_pk_bf16_f32 v130, v132, v133
  v_cvt_pk_bf16_f32 v131, v134, v135
  v_lshrrev_b32 v40, 4, v1
  v_and_b32 v41, 15, v1
  v_xor_b32 v40, v40, v41
  v_lshlrev_b32 v40, 4, v40
  v_lshl_add_u32 v40, v41, 10, v40
  s_lshl_b32 s34, s3, 8
  v_add_u32 v40, s34, v40
  v_xor_b32 v20, 0, v40
  v_xor_b32 v21, 64, v40
  v_xor_b32 v22, 128, v40
  v_xor_b32 v23, 192, v40
  s_sub_u32 s34, s26, s11
  v_subrev_u32 v28, s34, v2
  v_subrev_u32 v29, s34, v3
  v_subrev_u32 v30, s34, v4
  v_subrev_u32 v31, s34, v5
  v_add_u32 v27, s9, v26
  s_waitcnt vmcnt(0) lgkmcnt(0)
  s_nop 15
  s_branch L_exact_done
.section .rodata,"a"
.p2align 6
.amdhsa_kernel adaLN_cond__sliding_block_cached__dense_activation_silu__prompt_kernel
  .amdhsa_next_free_vgpr 512
  .amdhsa_next_free_sgpr 102
  .amdhsa_accum_offset 256
  .amdhsa_group_segment_fixed_size 0
  .amdhsa_kernarg_size 104
  .amdhsa_user_sgpr_count 2
  .amdhsa_user_sgpr_kernarg_segment_ptr 1
  .amdhsa_system_sgpr_workgroup_id_x 1
.end_amdhsa_kernel
```
